```python
import torch

def _softmax(x, axis=-1):
    return torch.softmax(x, dim=axis)
def _gelu(x):
    return torch.nn.functional.gelu(x, approximate="tanh")
def _silu(x):
    return torch.nn.functional.silu(x)
def _sigmoid(x):
    return torch.sigmoid(x)
def _layernorm(x, axis=-1, eps=1e-5):
    m = x.mean(dim=axis, keepdim=True)
    v = x.var(dim=axis, keepdim=True, unbiased=False)
    return (x - m) / torch.sqrt(v + eps)
def _scatter_add(tgt, idx, src, axis=0):
    return tgt.clone().index_add_(axis, idx, src)
def _segment_sum(src, seg, n):
    out = torch.zeros((n,) + src.shape[1:], dtype=src.dtype)
    return out.index_add_(0, seg, src)
def _pad(x, pw):
    flat = tuple(v for pair in reversed(pw) for v in pair)
    return torch.nn.functional.pad(x, flat)

kernel_name = 'parallel_sum__compressed_kv_cla__glu_gated_geglu__prompt'

def setup_inputs():

    _w = (lambda a: (lambda t: t.to(torch.bfloat16) if t.is_floating_point() else t)(torch.as_tensor(a)))
    def _A_setup():
        B, H, Sq, Sk, D, M = 1, 32, 2048, 2048, 128, 576
        Dc = 4 * D
        return {
            "x": _w((lambda *s: torch.randn(*s, dtype=torch.bfloat16) * 0.05)(B, Sq, M)),
            "c_kv": _w((lambda *s: torch.randn(*s, dtype=torch.bfloat16) * 0.4)(B, Sk, Dc)),
            "w_q": _w((lambda *s: torch.randn(*s, dtype=torch.bfloat16) * 3.2)(M, H, D) * (M ** -0.5)),
            "w_uk": _w((lambda *s: torch.randn(*s, dtype=torch.bfloat16) * 3.2)(Dc, H, D) * (Dc ** -0.5)),
            "w_uv": _w((lambda *s: torch.randn(*s, dtype=torch.bfloat16) * 0.4)(Dc, H, D) * (Dc ** -0.5)),
            "w_o": _w((lambda *s: torch.randn(*s, dtype=torch.bfloat16) * 0.4)(H, D, M) * ((H * D) ** -0.5)),
        }
    _A_in = _A_setup()

    def _B_setup():
        B, S, Dm, Df = 1, 2048, 576, 4608
        return {
            "x": _w((lambda *s: torch.randn(*s, dtype=torch.bfloat16) * 0.05)(B, S, Dm)),
            "w_gate": _w((lambda *s: torch.randn(*s, dtype=torch.bfloat16) * 0.4)(Dm, Df) * (Dm ** -0.5)),
            "w_up": _w((lambda *s: torch.randn(*s, dtype=torch.bfloat16) * 0.4)(Dm, Df) * (Dm ** -0.5)),
            "w_down": _w((lambda *s: torch.randn(*s, dtype=torch.bfloat16) * 0.4)(Df, Dm) * (Df ** -0.5)),
        }
    _B_in = _B_setup()

    return {
        "A_x": _A_in["x"],
        "A_c_kv": _A_in["c_kv"],
        "A_w_q": _A_in["w_q"],
        "A_w_uk": _A_in["w_uk"],
        "A_w_uv": _A_in["w_uv"],
        "A_w_o": _A_in["w_o"],
        "B_x": _B_in["x"],
        "B_w_gate": _B_in["w_gate"],
        "B_w_up": _B_in["w_up"],
        "B_w_down": _B_in["w_down"],
    }

def reference(A_x, A_c_kv, A_w_q, A_w_uk, A_w_uv, A_w_o, B_x, B_w_gate, B_w_up, B_w_down):
    def _A_ref(x, c_kv, w_q, w_uk, w_uv, w_o):
        B, Sq, M = x.shape[0], x.shape[1], x.shape[2]
        Sk = c_kv.shape[1]
        H, D = w_q.shape[1], w_q.shape[2]
        q = torch.einsum("bqm,mhd->bhqd", x, w_q)
        k = torch.einsum("bkc,chd->bhkd", c_kv, w_uk)
        v = torch.einsum("bkc,chd->bhkd", c_kv, w_uv)
        scores = torch.einsum("bhqd,bhkd->bhqk", q, k) * (D ** -0.5)
        off = Sk - Sq
        qi = torch.arange(Sq)[:, None]
        kj = torch.arange(Sk)[None, :]
        cmask = kj <= (qi + off)
        scores = torch.where(cmask[None, None], scores, -1e9)
        p = _softmax(scores, axis=-1)
        ctx = torch.einsum("bhqk,bhkd->bhqd", p, v)
        return torch.einsum("bhqd,hdm->bqm", ctx, w_o)

    def _B_ref(x, w_gate, w_up, w_down):
        g = torch.einsum("bsd,df->bsf", x, w_gate)
        u = torch.einsum("bsd,df->bsf", x, w_up)
        h = _gelu(g) * u
        return torch.einsum("bsf,fd->bsd", h, w_down)

    x = A_x
    xn = _layernorm(x, axis=-1)
    return x + _A_ref(xn, A_c_kv, A_w_q, A_w_uk, A_w_uv, A_w_o) + _B_ref(xn, B_w_gate, B_w_up, B_w_down)
```

```asm
; @launch grid=(256,1,1) block=(256,1,1) lds=163840
.amdgcn_target "amdgcn-amd-amdhsa--gfx950"
.text
.globl parallel_sum__compressed_kv_cla__glu_gated_geglu__prompt_kernel
.p2align 8
.type parallel_sum__compressed_kv_cla__glu_gated_geglu__prompt_kernel,@function
parallel_sum__compressed_kv_cla__glu_gated_geglu__prompt_kernel:
  s_cmp_ge_u32 s2, 256
  s_cbranch_scc1 L_done
  s_load_dwordx2 s[84:85], s[0:1], 96
  s_load_dwordx2 s[64:65], s[0:1], 0
  s_load_dwordx2 s[66:67], s[0:1], 8
  s_load_dwordx2 s[70:71], s[0:1], 24
  s_load_dwordx2 s[86:87], s[0:1], 32
  s_load_dwordx2 s[74:75], s[0:1], 56
  s_load_dwordx2 s[76:77], s[0:1], 64
  s_load_dwordx2 s[68:69], s[0:1], 16
  s_load_dwordx2 s[72:73], s[0:1], 40
  s_load_dwordx2 s[78:79], s[0:1], 72
  s_load_dwordx2 s[80:81], s[0:1], 80
  s_load_dwordx2 s[82:83], s[0:1], 88
  v_and_b32 v1, 63, v0
  v_lshrrev_b32 v3, 6, v0
  v_lshlrev_b32 v2, 4, v1
  s_and_b32 s89, s2, 7
  s_lshr_b32 s90, s2, 3
  v_readfirstlane_b32 s3, v3
  s_getpc_b64 s[4:5]
L_pcbase:
  s_lshl_b32 s6, s90, 2
  s_add_u32 s6, s6, s3
  s_and_b32 s6, s6, 15
  s_lshl_b32 s6, s6, 13
  v_lshlrev_b32 v23, 7, v1
  v_add_u32 v23, s6, v23
  v_cmp_gt_u32 vcc, L_codeend - L_pcbase, v23
  s_nop 0
  s_and_saveexec_b64 s[6:7], vcc
  s_cbranch_execz L_nopf
  global_load_dword v24, v23, s[4:5]
L_nopf:
  s_mov_b64 exec, -1
  s_and_b32 s4, s90, 3
  s_lshl_b32 s5, s89, 2
  s_add_u32 s34, s5, s4
  s_lshr_b32 s35, s90, 2
  v_lshrrev_b32 v20, 3, v1
  v_lshlrev_b32 v10, 10, v20
  v_lshrrev_b32 v20, 4, v1
  v_and_b32 v21, 7, v1
  v_xor_b32 v20, v20, v21
  v_lshl_add_u32 v10, v20, 4, v10
  s_lshl_b32 s4, s35, 18
  s_lshl_b32 s5, s3, 16
  s_add_u32 s4, s4, s5
  v_add_u32 v10, s4, v10
  v_xor_b32 v11, 64, v10
  s_mov_b32 s49, 7168
  s_mov_b32 s50, 14336
  s_mov_b32 s51, 21504
  s_mov_b32 s52, 32768
  s_mov_b32 s53, 39936
  s_mov_b32 s54, 47104
  s_mov_b32 s55, 54272
  s_mov_b32 s45, 31744
  s_mov_b32 s46, 63488
  s_mov_b32 s47, 95232
  s_movk_i32 s33, 8192
  v_bfe_u32 v20, v1, 3, 2
  v_mul_lo_u32 v12, v20, s33
  v_lshrrev_b32 v20, 1, v20
  v_bfe_u32 v21, v1, 2, 1
  v_xor_b32 v20, v20, v21
  v_lshl_add_u32 v12, v20, 6, v12
  v_lshrrev_b32 v20, 5, v1
  v_lshl_add_u32 v12, v20, 7, v12
  v_and_b32 v20, 3, v1
  v_lshl_add_u32 v12, v20, 4, v12
  s_and_b32 s4, s34, 15
  s_lshl_b32 s4, s4, 9
  s_and_b32 s5, s3, 1
  s_lshl_b32 s5, s5, 8
  s_add_u32 s4, s4, s5
  s_lshr_b32 s5, s3, 1
  s_lshl_b32 s5, s5, 17
  s_add_u32 s4, s4, s5
  v_add_u32 v12, s4, v12
  s_lshl_b32 s38, s3, 13
  s_and_b32 s4, s3, 1
  s_lshl_b32 s4, s4, 13
  s_lshr_b32 s5, s3, 1
  s_lshl_b32 s5, s5, 12
  s_add_u32 s39, s4, s5
  s_add_u32 s39, s39, 98304
  s_waitcnt lgkmcnt(0)
  s_mov_b32 s60, s70
  s_mov_b32 s61, s71
  s_cmp_lt_u32 s34, 16
  s_cselect_b32 s70, s70, s86
  s_cselect_b32 s71, s71, s87
  s_mov_b32 s12, s70
  s_mov_b32 s13, s71
  s_mov_b32 s14, 0x400000
  s_mov_b32 s15, 0x20000
  s_mov_b32 s16, s66
  s_mov_b32 s17, s67
  s_mov_b32 s18, 0x200000
  s_mov_b32 s19, 0x20000
  s_mov_b32 s24, s64
  s_mov_b32 s25, s65
  s_mov_b32 s26, 0x240000
  s_mov_b32 s27, 0x20000
  s_lshl_b32 s32, s2, 3
  s_lshl_b32 s33, s3, 1
  s_add_u32 s32, s32, s33
  v_lshrrev_b32 v72, 5, v1
  v_add_u32 v72, s32, v72
  v_and_b32 v73, 31, v1
  s_movk_i32 s33, 1152
  v_mul_lo_u32 v74, v72, s33
  v_lshl_add_u32 v74, v73, 4, v74
  buffer_load_dwordx4 v[32:35], v74, s[24:27], 0 offen
  buffer_load_dwordx4 v[36:39], v74, s[24:27], 0 offen offset:512
  s_mov_b32 exec_lo, 0xff
  s_mov_b32 exec_hi, 0xff
  buffer_load_dwordx4 v[40:43], v74, s[24:27], 0 offen offset:1024
  s_mov_b64 exec, -1
  s_add_u32 m0, s39, 0
  s_nop 0
  buffer_load_dwordx4 v12, s[12:15], 0 offen lds
  buffer_load_dwordx4 v12, s[12:15], s45 offen offset:1024 lds
  buffer_load_dwordx4 v12, s[12:15], s46 offen offset:2048 lds
  buffer_load_dwordx4 v12, s[12:15], s47 offen offset:3072 lds
  v_add_u32 v12, 262144, v12
  s_add_u32 m0, s38, 0
  s_nop 0
  buffer_load_dwordx4 v10, s[16:19], 0 offen lds
  buffer_load_dwordx4 v11, s[16:19], s49 offen offset:1024 lds
  buffer_load_dwordx4 v10, s[16:19], s50 offen offset:2048 lds
  buffer_load_dwordx4 v11, s[16:19], s51 offen offset:3072 lds
  s_add_u32 m0, s38, 4096
  s_nop 0
  buffer_load_dwordx4 v10, s[16:19], s52 offen lds
  buffer_load_dwordx4 v11, s[16:19], s53 offen offset:1024 lds
  buffer_load_dwordx4 v10, s[16:19], s54 offen offset:2048 lds
  buffer_load_dwordx4 v11, s[16:19], s55 offen offset:3072 lds
  v_add_u32 v10, 128, v10
  v_add_u32 v11, 128, v11
  s_add_u32 m0, s39, 16384
  s_nop 0
  buffer_load_dwordx4 v12, s[12:15], 0 offen lds
  buffer_load_dwordx4 v12, s[12:15], s45 offen offset:1024 lds
  buffer_load_dwordx4 v12, s[12:15], s46 offen offset:2048 lds
  buffer_load_dwordx4 v12, s[12:15], s47 offen offset:3072 lds
  v_add_u32 v12, 262144, v12
  s_add_u32 s4, s84, 0x9008000
  s_addc_u32 s5, s85, 0
  s_load_dword s88, s[4:5], 0
  s_add_u32 s8, s84, 0x9000000
  s_addc_u32 s9, s85, 0
  s_mov_b32 s10, 0x10000
  s_mov_b32 s11, 0x20000
  s_mov_b32 s28, s84
  s_mov_b32 s29, s85
  s_mov_b32 s30, 0x240000
  s_mov_b32 s31, 0x20000
  s_add_u32 m0, s38, 32768
  s_nop 0
  buffer_load_dwordx4 v10, s[16:19], 0 offen lds
  buffer_load_dwordx4 v11, s[16:19], s49 offen offset:1024 lds
  buffer_load_dwordx4 v10, s[16:19], s50 offen offset:2048 lds
  buffer_load_dwordx4 v11, s[16:19], s51 offen offset:3072 lds
  s_add_u32 m0, s38, 36864
  s_nop 0
  buffer_load_dwordx4 v10, s[16:19], s52 offen lds
  buffer_load_dwordx4 v11, s[16:19], s53 offen offset:1024 lds
  buffer_load_dwordx4 v10, s[16:19], s54 offen offset:2048 lds
  buffer_load_dwordx4 v11, s[16:19], s55 offen offset:3072 lds
  v_add_u32 v10, 128, v10
  v_add_u32 v11, 128, v11
  v_lshrrev_b32 v75, 5, v72
  v_mul_u32_u24 v75, 36, v75
  v_lshrrev_b32 v76, 1, v73
  v_add_u32 v75, v75, v76
  v_lshlrev_b32 v75, 10, v75
  v_and_b32 v76, 1, v73
  v_lshlrev_b32 v76, 9, v76
  v_add_u32 v75, v75, v76
  v_and_b32 v76, 31, v72
  v_lshl_add_u32 v80, v76, 4, v75
  s_mov_b32 s5, 0x2000000
  s_cmp_lt_u32 s34, 16
  s_cselect_b32 s4, 0x1000000, s5
  s_add_u32 s20, s84, s4
  s_addc_u32 s21, s85, 0
  s_mov_b32 s22, 0x1000000
  s_mov_b32 s23, 0x20000
  v_and_b32 v20, 31, v1
  v_lshlrev_b32 v3, 7, v20
  v_bfe_u32 v20, v1, 1, 3
  v_lshrrev_b32 v21, 5, v1
  v_xor_b32 v20, v20, v21
  v_lshl_add_u32 v3, v20, 4, v3
  s_and_b32 s4, s3, 1
  s_lshl_b32 s4, s4, 14
  v_add_u32 v3, s4, v3
  v_xor_b32 v4, 32, v3
  v_xor_b32 v5, 64, v3
  v_xor_b32 v6, 96, v3
  v_lshrrev_b32 v20, 5, v1
  v_mul_u32_u24 v8, 2048, v20
  v_bfe_u32 v20, v1, 2, 2
  v_lshl_add_u32 v8, v20, 7, v8
  v_bfe_u32 v21, v1, 4, 1
  v_lshl_add_u32 v8, v21, 5, v8
  v_and_b32 v21, 3, v1
  v_lshl_add_u32 v8, v21, 3, v8
  v_lshrrev_b32 v20, 1, v20
  v_lshlrev_b32 v20, 6, v20
  v_xor_b32 v21, 64, v20
  v_add_u32 v9, v8, v21
  v_add_u32 v8, v8, v20
  s_lshr_b32 s4, s3, 1
  s_lshl_b32 s4, s4, 13
  s_add_u32 s4, s4, 98304
  v_add_u32 v8, s4, v8
  v_add_u32 v9, s4, v9
  s_waitcnt vmcnt(24)
  s_mov_b32 s36, 0xffff0000
  v_lshlrev_b32 v48, 16, v32
  v_and_b32 v49, s36, v32
  v_lshlrev_b32 v50, 16, v33
  v_and_b32 v51, s36, v33
  v_lshlrev_b32 v52, 16, v34
  v_and_b32 v53, s36, v34
  v_lshlrev_b32 v54, 16, v35
  v_and_b32 v55, s36, v35
  v_lshlrev_b32 v56, 16, v36
  v_and_b32 v57, s36, v36
  v_lshlrev_b32 v58, 16, v37
  v_and_b32 v59, s36, v37
  v_lshlrev_b32 v60, 16, v38
  v_and_b32 v61, s36, v38
  v_lshlrev_b32 v62, 16, v39
  v_and_b32 v63, s36, v39
  v_mov_b32 v64, 0
  v_mov_b32 v65, 0
  v_mov_b32 v66, 0
  v_mov_b32 v67, 0
  v_mov_b32 v68, 0
  v_mov_b32 v69, 0
  v_mov_b32 v70, 0
  v_mov_b32 v71, 0
  s_mov_b32 exec_lo, 0xff
  s_mov_b32 exec_hi, 0xff
  v_lshlrev_b32 v64, 16, v40
  v_and_b32 v65, s36, v40
  v_lshlrev_b32 v66, 16, v41
  v_and_b32 v67, s36, v41
  v_lshlrev_b32 v68, 16, v42
  v_and_b32 v69, s36, v42
  v_lshlrev_b32 v70, 16, v43
  v_and_b32 v71, s36, v43
  s_mov_b64 exec, -1
  v_add_f32 v84, v48, v49
  v_add_f32 v84, v84, v50
  v_add_f32 v84, v84, v51
  v_add_f32 v84, v84, v52
  v_add_f32 v84, v84, v53
  v_add_f32 v84, v84, v54
  v_add_f32 v84, v84, v55
  v_add_f32 v84, v84, v56
  v_add_f32 v84, v84, v57
  v_add_f32 v84, v84, v58
  v_add_f32 v84, v84, v59
  v_add_f32 v84, v84, v60
  v_add_f32 v84, v84, v61
  v_add_f32 v84, v84, v62
  v_add_f32 v84, v84, v63
  v_add_f32 v84, v84, v64
  v_add_f32 v84, v84, v65
  v_add_f32 v84, v84, v66
  v_add_f32 v84, v84, v67
  v_add_f32 v84, v84, v68
  v_add_f32 v84, v84, v69
  v_add_f32 v84, v84, v70
  v_add_f32 v84, v84, v71
  s_nop 1
  v_add_f32_dpp v84, v84, v84 quad_perm:[1,0,3,2] row_mask:0xf bank_mask:0xf
  s_nop 1
  v_add_f32_dpp v84, v84, v84 quad_perm:[2,3,0,1] row_mask:0xf bank_mask:0xf
  s_nop 1
  v_add_f32_dpp v84, v84, v84 row_half_mirror row_mask:0xf bank_mask:0xf
  s_nop 1
  v_add_f32_dpp v84, v84, v84 row_mirror row_mask:0xf bank_mask:0xf
  v_mov_b32 v86, v84
  s_nop 1
  v_permlane16_swap_b32 v84, v86
  s_nop 1
  v_add_f32 v84, v84, v86
  s_mov_b32 s37, 0x3ae38e39
  v_mul_f32 v84, s37, v84
  v_mov_b32 v85, 0
  v_sub_f32 v87, v48, v84
  v_fmac_f32 v85, v87, v87
  v_sub_f32 v87, v49, v84
  v_fmac_f32 v85, v87, v87
  v_sub_f32 v87, v50, v84
  v_fmac_f32 v85, v87, v87
  v_sub_f32 v87, v51, v84
  v_fmac_f32 v85, v87, v87
  v_sub_f32 v87, v52, v84
  v_fmac_f32 v85, v87, v87
  v_sub_f32 v87, v53, v84
  v_fmac_f32 v85, v87, v87
  v_sub_f32 v87, v54, v84
  v_fmac_f32 v85, v87, v87
  v_sub_f32 v87, v55, v84
  v_fmac_f32 v85, v87, v87
  v_sub_f32 v87, v56, v84
  v_fmac_f32 v85, v87, v87
  v_sub_f32 v87, v57, v84
  v_fmac_f32 v85, v87, v87
  v_sub_f32 v87, v58, v84
  v_fmac_f32 v85, v87, v87
  v_sub_f32 v87, v59, v84
  v_fmac_f32 v85, v87, v87
  v_sub_f32 v87, v60, v84
  v_fmac_f32 v85, v87, v87
  v_sub_f32 v87, v61, v84
  v_fmac_f32 v85, v87, v87
  v_sub_f32 v87, v62, v84
  v_fmac_f32 v85, v87, v87
  v_sub_f32 v87, v63, v84
  v_fmac_f32 v85, v87, v87
  s_mov_b32 exec_lo, 0xff
  s_mov_b32 exec_hi, 0xff
  v_sub_f32 v87, v64, v84
  v_fmac_f32 v85, v87, v87
  v_sub_f32 v87, v65, v84
  v_fmac_f32 v85, v87, v87
  v_sub_f32 v87, v66, v84
  v_fmac_f32 v85, v87, v87
  v_sub_f32 v87, v67, v84
  v_fmac_f32 v85, v87, v87
  v_sub_f32 v87, v68, v84
  v_fmac_f32 v85, v87, v87
  v_sub_f32 v87, v69, v84
  v_fmac_f32 v85, v87, v87
  v_sub_f32 v87, v70, v84
  v_fmac_f32 v85, v87, v87
  v_sub_f32 v87, v71, v84
  v_fmac_f32 v85, v87, v87
  s_mov_b64 exec, -1
  s_nop 1
  v_add_f32_dpp v85, v85, v85 quad_perm:[1,0,3,2] row_mask:0xf bank_mask:0xf
  s_nop 1
  v_add_f32_dpp v85, v85, v85 quad_perm:[2,3,0,1] row_mask:0xf bank_mask:0xf
  s_nop 1
  v_add_f32_dpp v85, v85, v85 row_half_mirror row_mask:0xf bank_mask:0xf
  s_nop 1
  v_add_f32_dpp v85, v85, v85 row_mirror row_mask:0xf bank_mask:0xf
  v_mov_b32 v86, v85
  s_nop 1
  v_permlane16_swap_b32 v85, v86
  s_nop 1
  v_add_f32 v85, v85, v86
  v_mul_f32 v85, s37, v85
  v_cvt_pk_bf16_f32 v87, v84, v85
  v_lshlrev_b32 v84, 16, v87
  v_and_b32 v85, s36, v87
  v_mov_b32 v88, 0x3727c5ac
  v_add_f32 v85, v88, v85
  v_cvt_pk_bf16_f32 v87, v85, v85
  v_lshlrev_b32 v85, 16, v87
  v_sqrt_f32 v85, v85
  s_nop 0
  v_cvt_pk_bf16_f32 v87, v85, v85
  v_lshlrev_b32 v85, 16, v87
  v_rcp_f32 v88, v85
  s_nop 0
  v_sub_f32 v48, v48, v84
  v_sub_f32 v49, v49, v84
  v_cvt_pk_bf16_f32 v89, v48, v49
  v_lshlrev_b32 v48, 16, v89
  v_and_b32 v49, s36, v89
  v_mul_f32 v90, v48, v88
  v_fma_f32 v87, -v90, v85, v48
  v_fma_f32 v48, v87, v88, v90
  v_mul_f32 v90, v49, v88
  v_fma_f32 v87, -v90, v85, v49
  v_fma_f32 v49, v87, v88, v90
  v_cvt_pk_bf16_f32 v32, v48, v49
  v_sub_f32 v50, v50, v84
  v_sub_f32 v51, v51, v84
  v_cvt_pk_bf16_f32 v89, v50, v51
  v_lshlrev_b32 v50, 16, v89
  v_and_b32 v51, s36, v89
  v_mul_f32 v90, v50, v88
  v_fma_f32 v87, -v90, v85, v50
  v_fma_f32 v50, v87, v88, v90
  v_mul_f32 v90, v51, v88
  v_fma_f32 v87, -v90, v85, v51
  v_fma_f32 v51, v87, v88, v90
  v_cvt_pk_bf16_f32 v33, v50, v51
  v_sub_f32 v52, v52, v84
  v_sub_f32 v53, v53, v84
  v_cvt_pk_bf16_f32 v89, v52, v53
  v_lshlrev_b32 v52, 16, v89
  v_and_b32 v53, s36, v89
  v_mul_f32 v90, v52, v88
  v_fma_f32 v87, -v90, v85, v52
  v_fma_f32 v52, v87, v88, v90
  v_mul_f32 v90, v53, v88
  v_fma_f32 v87, -v90, v85, v53
  v_fma_f32 v53, v87, v88, v90
  v_cvt_pk_bf16_f32 v34, v52, v53
  v_sub_f32 v54, v54, v84
  v_sub_f32 v55, v55, v84
  v_cvt_pk_bf16_f32 v89, v54, v55
  v_lshlrev_b32 v54, 16, v89
  v_and_b32 v55, s36, v89
  v_mul_f32 v90, v54, v88
  v_fma_f32 v87, -v90, v85, v54
  v_fma_f32 v54, v87, v88, v90
  v_mul_f32 v90, v55, v88
  v_fma_f32 v87, -v90, v85, v55
  v_fma_f32 v55, v87, v88, v90
  v_cvt_pk_bf16_f32 v35, v54, v55
  s_mov_b32 s37, 0
  buffer_store_dwordx4 v[32:35], v80, s[28:31], s37 offen sc1
  v_sub_f32 v56, v56, v84
  v_sub_f32 v57, v57, v84
  v_cvt_pk_bf16_f32 v89, v56, v57
  v_lshlrev_b32 v56, 16, v89
  v_and_b32 v57, s36, v89
  v_mul_f32 v90, v56, v88
  v_fma_f32 v87, -v90, v85, v56
  v_fma_f32 v56, v87, v88, v90
  v_mul_f32 v90, v57, v88
  v_fma_f32 v87, -v90, v85, v57
  v_fma_f32 v57, v87, v88, v90
  v_cvt_pk_bf16_f32 v36, v56, v57
  v_sub_f32 v58, v58, v84
  v_sub_f32 v59, v59, v84
  v_cvt_pk_bf16_f32 v89, v58, v59
  v_lshlrev_b32 v58, 16, v89
  v_and_b32 v59, s36, v89
  v_mul_f32 v90, v58, v88
  v_fma_f32 v87, -v90, v85, v58
  v_fma_f32 v58, v87, v88, v90
  v_mul_f32 v90, v59, v88
  v_fma_f32 v87, -v90, v85, v59
  v_fma_f32 v59, v87, v88, v90
  v_cvt_pk_bf16_f32 v37, v58, v59
  v_sub_f32 v60, v60, v84
  v_sub_f32 v61, v61, v84
  v_cvt_pk_bf16_f32 v89, v60, v61
  v_lshlrev_b32 v60, 16, v89
  v_and_b32 v61, s36, v89
  v_mul_f32 v90, v60, v88
  v_fma_f32 v87, -v90, v85, v60
  v_fma_f32 v60, v87, v88, v90
  v_mul_f32 v90, v61, v88
  v_fma_f32 v87, -v90, v85, v61
  v_fma_f32 v61, v87, v88, v90
  v_cvt_pk_bf16_f32 v38, v60, v61
  v_sub_f32 v62, v62, v84
  v_sub_f32 v63, v63, v84
  v_cvt_pk_bf16_f32 v89, v62, v63
  v_lshlrev_b32 v62, 16, v89
  v_and_b32 v63, s36, v89
  v_mul_f32 v90, v62, v88
  v_fma_f32 v87, -v90, v85, v62
  v_fma_f32 v62, v87, v88, v90
  v_mul_f32 v90, v63, v88
  v_fma_f32 v87, -v90, v85, v63
  v_fma_f32 v63, v87, v88, v90
  v_cvt_pk_bf16_f32 v39, v62, v63
  s_mov_b32 s37, 16384
  buffer_store_dwordx4 v[36:39], v80, s[28:31], s37 offen sc1
  s_mov_b32 exec_lo, 0xff
  s_mov_b32 exec_hi, 0xff
  v_sub_f32 v64, v64, v84
  v_sub_f32 v65, v65, v84
  v_cvt_pk_bf16_f32 v89, v64, v65
  v_lshlrev_b32 v64, 16, v89
  v_and_b32 v65, s36, v89
  v_mul_f32 v90, v64, v88
  v_fma_f32 v87, -v90, v85, v64
  v_fma_f32 v64, v87, v88, v90
  v_mul_f32 v90, v65, v88
  v_fma_f32 v87, -v90, v85, v65
  v_fma_f32 v65, v87, v88, v90
  v_cvt_pk_bf16_f32 v40, v64, v65
  v_sub_f32 v66, v66, v84
  v_sub_f32 v67, v67, v84
  v_cvt_pk_bf16_f32 v89, v66, v67
  v_lshlrev_b32 v66, 16, v89
  v_and_b32 v67, s36, v89
  v_mul_f32 v90, v66, v88
  v_fma_f32 v87, -v90, v85, v66
  v_fma_f32 v66, v87, v88, v90
  v_mul_f32 v90, v67, v88
  v_fma_f32 v87, -v90, v85, v67
  v_fma_f32 v67, v87, v88, v90
  v_cvt_pk_bf16_f32 v41, v66, v67
  v_sub_f32 v68, v68, v84
  v_sub_f32 v69, v69, v84
  v_cvt_pk_bf16_f32 v89, v68, v69
  v_lshlrev_b32 v68, 16, v89
  v_and_b32 v69, s36, v89
  v_mul_f32 v90, v68, v88
  v_fma_f32 v87, -v90, v85, v68
  v_fma_f32 v68, v87, v88, v90
  v_mul_f32 v90, v69, v88
  v_fma_f32 v87, -v90, v85, v69
  v_fma_f32 v69, v87, v88, v90
  v_cvt_pk_bf16_f32 v42, v68, v69
  v_sub_f32 v70, v70, v84
  v_sub_f32 v71, v71, v84
  v_cvt_pk_bf16_f32 v89, v70, v71
  v_lshlrev_b32 v70, 16, v89
  v_and_b32 v71, s36, v89
  v_mul_f32 v90, v70, v88
  v_fma_f32 v87, -v90, v85, v70
  v_fma_f32 v70, v87, v88, v90
  v_mul_f32 v90, v71, v88
  v_fma_f32 v87, -v90, v85, v71
  v_fma_f32 v71, v87, v88, v90
  v_cvt_pk_bf16_f32 v43, v70, v71
  s_mov_b32 s37, 32768
  buffer_store_dwordx4 v[40:43], v80, s[28:31], s37 offen sc1
  s_mov_b64 exec, -1
  s_waitcnt lgkmcnt(0)
  s_mul_i32 s88, s88, 0x9E3779B1
  s_add_u32 s88, s88, 0x7F4A7C15
  s_mov_b32 s91, 0
  s_mov_b32 s24, s82
  s_mov_b32 s25, s83
  s_mov_b32 s26, 0x100
  s_mov_b32 s27, 0x20000
  s_cmp_lg_u32 s3, 0
  s_cbranch_scc1 L_noat
  v_mov_b32 v22, 1
  v_mov_b32 v20, 0
  s_mov_b64 exec, 1
  buffer_atomic_add v22, v20, s[24:27], 0 offen sc0 sc1
  s_mov_b64 exec, -1
L_noat:
  s_and_b32 s4, s90, 3
  s_lshl_b32 s5, s89, 2
  s_add_u32 s36, s5, s4
  s_mul_i32 s4, s36, 144
  s_and_b32 s5, s36, 1
  s_lshl_b32 s6, s5, 4
  s_add_u32 s37, s4, s6
  s_xor_b32 s5, s5, 1
  s_lshl_b32 s5, s5, 7
  s_add_u32 s40, s4, s5
  s_nop 4
  s_mov_b32 s24, s74
  s_mov_b32 s25, s75
  s_mov_b32 s26, 0x510000
  s_mov_b32 s27, 0x20000
  s_mov_b32 s28, s76
  s_mov_b32 s29, s77
  s_mov_b32 s30, 0x510000
  s_mov_b32 s31, 0x20000
  s_mov_b32 s56, s84
  s_mov_b32 s57, s85
  s_mov_b32 s58, 0x240000
  s_mov_b32 s59, 0x20000
  s_bitcmp1_b32 s3, 0
  s_cselect_b32 s4, s76, s74
  s_cselect_b32 s5, s77, s75
  s_mov_b32 s60, s4
  s_mov_b32 s61, s5
  s_mov_b32 s62, 0x510000
  s_mov_b32 s63, 0x20000
  s_lshl_b32 s4, s35, 3
  s_lshl_b32 s5, s3, 1
  s_add_u32 s4, s4, s5
  s_mul_i32 s4, s4, 36864
  v_add_u32 v25, s4, v2
  s_mov_b32 s41, 34816
  s_movk_i32 s6, 9216
  v_bfe_u32 v20, v1, 3, 2
  v_mul_lo_u32 v26, v20, s6
  v_lshrrev_b32 v20, 1, v20
  v_bfe_u32 v21, v1, 2, 1
  v_xor_b32 v20, v20, v21
  v_lshl_add_u32 v26, v20, 6, v26
  v_lshrrev_b32 v20, 5, v1
  v_lshl_add_u32 v26, v20, 7, v26
  v_and_b32 v20, 3, v1
  v_lshl_add_u32 v26, v20, 4, v26
  s_and_b32 s4, s3, 1
  s_lshl_b32 s4, s4, 5
  v_xor_b32 v26, s4, v26
  s_lshl_b32 s4, s37, 1
  s_mul_i32 s5, s3, 73728
  s_add_u32 s4, s4, s5
  v_add_u32 v26, s4, v26
  s_mov_b32 s42, 35840
  v_bfe_u32 v20, v1, 1, 2
  v_bfe_u32 v21, v1, 3, 1
  v_lshl_add_u32 v20, v21, 3, v20
  v_bfe_u32 v21, v1, 4, 1
  v_lshl_add_u32 v20, v21, 2, v20
  v_bfe_u32 v21, v1, 5, 1
  v_lshl_add_u32 v20, v21, 4, v20
  v_mul_lo_u32 v27, v20, s6
  v_and_b32 v20, 1, v1
  v_lshl_add_u32 v27, v20, 4, v27
  s_lshl_b32 s4, s40, 1
  v_add_u32 v27, s4, v27
  s_lshl_b32 s43, s3, 12
  s_lshl_b32 s4, s3, 11
  s_add_u32 s44, s4, 16384
  s_add_u32 s48, s4, 24576
  s_and_b32 s4, s3, 1
  s_mul_i32 s4, s4, 1152
  s_add_u32 s66, s4, 32768
  s_waitcnt vmcnt(15)
  s_barrier
  s_cmp_lt_u32 s34, 16
  s_cbranch_scc0 L_kvV
  v_add_u32 v7, 0, v3
  ds_read_b64_tr_b16 a[48:49], v8 offset:0
  ds_read_b64_tr_b16 a[50:51], v8 offset:1024
  ds_read_b128 a[32:35], v7 offset:0
  ds_read_b128 a[36:39], v7 offset:4096
  ds_read_b128 a[40:43], v7 offset:8192
  ds_read_b128 a[44:47], v7 offset:12288
  ds_read_b64_tr_b16 a[52:53], v9 offset:0
  ds_read_b64_tr_b16 a[54:55], v9 offset:1024
  ds_read_b64_tr_b16 a[56:57], v8 offset:512
  ds_read_b64_tr_b16 a[58:59], v8 offset:1536
  ds_read_b64_tr_b16 a[60:61], v9 offset:512
  ds_read_b64_tr_b16 a[62:63], v9 offset:1536
  s_waitcnt lgkmcnt(9)
  v_mfma_f32_32x32x16_bf16 v[32:47], a[48:51], a[32:35], 0
  v_add_u32 v7, 0, v4
  ds_read_b64_tr_b16 a[80:81], v8 offset:4096
  ds_read_b64_tr_b16 a[82:83], v8 offset:5120
  s_waitcnt lgkmcnt(10)
  v_mfma_f32_32x32x16_bf16 v[48:63], a[48:51], a[36:39], 0
  ds_read_b128 a[64:67], v7 offset:0
  ds_read_b128 a[68:71], v7 offset:4096
  s_add_u32 m0, s39, 32768
  s_nop 0
  buffer_load_dwordx4 v12, s[12:15], 0 offen lds
  s_waitcnt lgkmcnt(11)
  v_mfma_f32_32x32x16_bf16 v[64:79], a[48:51], a[40:43], 0
  ds_read_b128 a[72:75], v7 offset:8192
  ds_read_b128 a[76:79], v7 offset:12288
  s_waitcnt lgkmcnt(6)
  v_mfma_f32_32x32x16_bf16 v[80:95], a[48:51], a[44:47], 0
  ds_read_b64_tr_b16 a[84:85], v9 offset:4096
  ds_read_b64_tr_b16 a[86:87], v9 offset:5120
  v_mfma_f32_32x32x16_bf16 v[96:111], a[52:55], a[32:35], 0
  ds_read_b64_tr_b16 a[88:89], v8 offset:4608
  ds_read_b64_tr_b16 a[90:91], v8 offset:5632
  buffer_load_dwordx4 v12, s[12:15], s45 offen offset:1024 lds
  v_mfma_f32_32x32x16_bf16 v[112:127], a[52:55], a[36:39], 0
  ds_read_b64_tr_b16 a[92:93], v9 offset:4608
  ds_read_b64_tr_b16 a[94:95], v9 offset:5632
  v_mfma_f32_32x32x16_bf16 v[128:143], a[52:55], a[40:43], 0
  v_mfma_f32_32x32x16_bf16 v[144:159], a[52:55], a[44:47], 0
  v_mfma_f32_32x32x16_bf16 v[160:175], a[56:59], a[32:35], 0
  buffer_load_dwordx4 v12, s[12:15], s46 offen offset:2048 lds
  v_mfma_f32_32x32x16_bf16 v[176:191], a[56:59], a[36:39], 0
  v_mfma_f32_32x32x16_bf16 v[192:207], a[56:59], a[40:43], 0
  v_mfma_f32_32x32x16_bf16 v[208:223], a[56:59], a[44:47], 0
  v_mfma_f32_32x32x16_bf16 v[224:239], a[60:63], a[32:35], 0
  buffer_load_dwordx4 v12, s[12:15], s47 offen offset:3072 lds
  v_add_u32 v12, 262144, v12
  v_mfma_f32_32x32x16_bf16 v[240:255], a[60:63], a[36:39], 0
  v_mfma_f32_32x32x16_bf16 a[0:15], a[60:63], a[40:43], 0
  v_mfma_f32_32x32x16_bf16 a[16:31], a[60:63], a[44:47], 0
  s_waitcnt vmcnt(15) lgkmcnt(0)
  s_barrier
  v_mfma_f32_32x32x16_bf16 v[32:47], a[80:83], a[64:67], v[32:47]
  v_add_u32 v7, 0, v5
  ds_read_b64_tr_b16 a[48:49], v8 offset:16384
  ds_read_b64_tr_b16 a[50:51], v8 offset:17408
  v_mfma_f32_32x32x16_bf16 v[48:63], a[80:83], a[68:71], v[48:63]
  ds_read_b128 a[32:35], v7 offset:0
  ds_read_b128 a[36:39], v7 offset:4096
  s_add_u32 m0, s39, 49152
  s_nop 0
  buffer_load_dwordx4 v12, s[12:15], 0 offen lds
  buffer_load_dwordx4 v12, s[12:15], s45 offen offset:1024 lds
  v_mfma_f32_32x32x16_bf16 v[64:79], a[80:83], a[72:75], v[64:79]
  ds_read_b128 a[40:43], v7 offset:8192
  ds_read_b128 a[44:47], v7 offset:12288
  buffer_load_dwordx4 v12, s[12:15], s46 offen offset:2048 lds
  v_mfma_f32_32x32x16_bf16 v[80:95], a[80:83], a[76:79], v[80:95]
  ds_read_b64_tr_b16 a[52:53], v9 offset:16384
  ds_read_b64_tr_b16 a[54:55], v9 offset:17408
  buffer_load_dwordx4 v12, s[12:15], s47 offen offset:3072 lds
  v_add_u32 v12, 262144, v12
  v_mfma_f32_32x32x16_bf16 v[96:111], a[84:87], a[64:67], v[96:111]
  ds_read_b64_tr_b16 a[56:57], v8 offset:16896
  ds_read_b64_tr_b16 a[58:59], v8 offset:17920
  s_add_u32 m0, s38, 65536
  s_nop 0
  buffer_load_dwordx4 v10, s[16:19], 0 offen lds
  v_mfma_f32_32x32x16_bf16 v[112:127], a[84:87], a[68:71], v[112:127]
  ds_read_b64_tr_b16 a[60:61], v9 offset:16896
  ds_read_b64_tr_b16 a[62:63], v9 offset:17920
  buffer_load_dwordx4 v11, s[16:19], s49 offen offset:1024 lds
  v_mfma_f32_32x32x16_bf16 v[128:143], a[84:87], a[72:75], v[128:143]
  buffer_load_dwordx4 v10, s[16:19], s50 offen offset:2048 lds
  v_mfma_f32_32x32x16_bf16 v[144:159], a[84:87], a[76:79], v[144:159]
  buffer_load_dwordx4 v11, s[16:19], s51 offen offset:3072 lds
  v_mfma_f32_32x32x16_bf16 v[160:175], a[88:91], a[64:67], v[160:175]
  s_add_u32 m0, s38, 69632
  s_nop 0
  buffer_load_dwordx4 v10, s[16:19], s52 offen lds
  v_mfma_f32_32x32x16_bf16 v[176:191], a[88:91], a[68:71], v[176:191]
  buffer_load_dwordx4 v11, s[16:19], s53 offen offset:1024 lds
  v_mfma_f32_32x32x16_bf16 v[192:207], a[88:91], a[72:75], v[192:207]
  buffer_load_dwordx4 v10, s[16:19], s54 offen offset:2048 lds
  v_mfma_f32_32x32x16_bf16 v[208:223], a[88:91], a[76:79], v[208:223]
  buffer_load_dwordx4 v11, s[16:19], s55 offen offset:3072 lds
  v_add_u32 v10, 128, v10
  v_add_u32 v11, 128, v11
  v_mfma_f32_32x32x16_bf16 v[224:239], a[92:95], a[64:67], v[224:239]
  s_add_u32 m0, s39, 0
  s_nop 0
  buffer_load_dwordx4 v12, s[12:15], 0 offen lds
  v_mfma_f32_32x32x16_bf16 v[240:255], a[92:95], a[68:71], v[240:255]
  buffer_load_dwordx4 v12, s[12:15], s45 offen offset:1024 lds
  v_mfma_f32_32x32x16_bf16 a[0:15], a[92:95], a[72:75], a[0:15]
  buffer_load_dwordx4 v12, s[12:15], s46 offen offset:2048 lds
  v_mfma_f32_32x32x16_bf16 a[16:31], a[92:95], a[76:79], a[16:31]
  buffer_load_dwordx4 v12, s[12:15], s47 offen offset:3072 lds
  v_add_u32 v12, 262144, v12
  s_waitcnt lgkmcnt(0)
  v_mfma_f32_32x32x16_bf16 v[32:47], a[48:51], a[32:35], v[32:47]
  v_add_u32 v7, 0, v6
  ds_read_b64_tr_b16 a[80:81], v8 offset:20480
  ds_read_b64_tr_b16 a[82:83], v8 offset:21504
  v_mfma_f32_32x32x16_bf16 v[48:63], a[48:51], a[36:39], v[48:63]
  ds_read_b128 a[64:67], v7 offset:0
  ds_read_b128 a[68:71], v7 offset:4096
  v_mfma_f32_32x32x16_bf16 v[64:79], a[48:51], a[40:43], v[64:79]
  ds_read_b128 a[72:75], v7 offset:8192
  ds_read_b128 a[76:79], v7 offset:12288
  v_mfma_f32_32x32x16_bf16 v[80:95], a[48:51], a[44:47], v[80:95]
  ds_read_b64_tr_b16 a[84:85], v9 offset:20480
  ds_read_b64_tr_b16 a[86:87], v9 offset:21504
  v_mfma_f32_32x32x16_bf16 v[96:111], a[52:55], a[32:35], v[96:111]
  ds_read_b64_tr_b16 a[88:89], v8 offset:20992
  ds_read_b64_tr_b16 a[90:91], v8 offset:22016
  v_mfma_f32_32x32x16_bf16 v[112:127], a[52:55], a[36:39], v[112:127]
  ds_read_b64_tr_b16 a[92:93], v9 offset:20992
  ds_read_b64_tr_b16 a[94:95], v9 offset:22016
  v_mfma_f32_32x32x16_bf16 v[128:143], a[52:55], a[40:43], v[128:143]
  v_mfma_f32_32x32x16_bf16 v[144:159], a[52:55], a[44:47], v[144:159]
  v_mfma_f32_32x32x16_bf16 v[160:175], a[56:59], a[32:35], v[160:175]
  v_mfma_f32_32x32x16_bf16 v[176:191], a[56:59], a[36:39], v[176:191]
  v_mfma_f32_32x32x16_bf16 v[192:207], a[56:59], a[40:43], v[192:207]
  v_mfma_f32_32x32x16_bf16 v[208:223], a[56:59], a[44:47], v[208:223]
  v_mfma_f32_32x32x16_bf16 v[224:239], a[60:63], a[32:35], v[224:239]
  v_mfma_f32_32x32x16_bf16 v[240:255], a[60:63], a[36:39], v[240:255]
  v_mfma_f32_32x32x16_bf16 a[0:15], a[60:63], a[40:43], a[0:15]
  v_mfma_f32_32x32x16_bf16 a[16:31], a[60:63], a[44:47], a[16:31]
  s_waitcnt vmcnt(16) lgkmcnt(0)
  s_barrier
  v_mfma_f32_32x32x16_bf16 v[32:47], a[80:83], a[64:67], v[32:47]
  v_add_u32 v7, 32768, v3
  ds_read_b64_tr_b16 a[48:49], v8 offset:32768
  ds_read_b64_tr_b16 a[50:51], v8 offset:33792
  v_mfma_f32_32x32x16_bf16 v[48:63], a[80:83], a[68:71], v[48:63]
  ds_read_b128 a[32:35], v7 offset:0
  ds_read_b128 a[36:39], v7 offset:4096
  v_mfma_f32_32x32x16_bf16 v[64:79], a[80:83], a[72:75], v[64:79]
  ds_read_b128 a[40:43], v7 offset:8192
  ds_read_b128 a[44:47], v7 offset:12288
  v_mfma_f32_32x32x16_bf16 v[80:95], a[80:83], a[76:79], v[80:95]
  ds_read_b64_tr_b16 a[52:53], v9 offset:32768
  ds_read_b64_tr_b16 a[54:55], v9 offset:33792
  v_mfma_f32_32x32x16_bf16 v[96:111], a[84:87], a[64:67], v[96:111]
  ds_read_b64_tr_b16 a[56:57], v8 offset:33280
  ds_read_b64_tr_b16 a[58:59], v8 offset:34304
  v_mfma_f32_32x32x16_bf16 v[112:127], a[84:87], a[68:71], v[112:127]
  ds_read_b64_tr_b16 a[60:61], v9 offset:33280
  ds_read_b64_tr_b16 a[62:63], v9 offset:34304
  v_mfma_f32_32x32x16_bf16 v[128:143], a[84:87], a[72:75], v[128:143]
  s_add_u32 m0, s38, 0
  s_nop 0
  buffer_load_dwordx4 v10, s[16:19], 0 offen lds
  v_mfma_f32_32x32x16_bf16 v[144:159], a[84:87], a[76:79], v[144:159]
  buffer_load_dwordx4 v11, s[16:19], s49 offen offset:1024 lds
  v_mfma_f32_32x32x16_bf16 v[160:175], a[88:91], a[64:67], v[160:175]
  buffer_load_dwordx4 v10, s[16:19], s50 offen offset:2048 lds
  v_mfma_f32_32x32x16_bf16 v[176:191], a[88:91], a[68:71], v[176:191]
  buffer_load_dwordx4 v11, s[16:19], s51 offen offset:3072 lds
  v_mfma_f32_32x32x16_bf16 v[192:207], a[88:91], a[72:75], v[192:207]
  v_mfma_f32_32x32x16_bf16 v[208:223], a[88:91], a[76:79], v[208:223]
  s_add_u32 m0, s39, 16384
  s_nop 0
  buffer_load_dwordx4 v12, s[12:15], 0 offen lds
  v_mfma_f32_32x32x16_bf16 v[224:239], a[92:95], a[64:67], v[224:239]
  buffer_load_dwordx4 v12, s[12:15], s45 offen offset:1024 lds
  v_mfma_f32_32x32x16_bf16 v[240:255], a[92:95], a[68:71], v[240:255]
  buffer_load_dwordx4 v12, s[12:15], s46 offen offset:2048 lds
  v_mfma_f32_32x32x16_bf16 a[0:15], a[92:95], a[72:75], a[0:15]
  buffer_load_dwordx4 v12, s[12:15], s47 offen offset:3072 lds
  v_add_u32 v12, 262144, v12
  v_mfma_f32_32x32x16_bf16 a[16:31], a[92:95], a[76:79], a[16:31]
  s_waitcnt lgkmcnt(0)
  v_mfma_f32_32x32x16_bf16 v[32:47], a[48:51], a[32:35], v[32:47]
  v_add_u32 v7, 32768, v4
  ds_read_b64_tr_b16 a[80:81], v8 offset:36864
  ds_read_b64_tr_b16 a[82:83], v8 offset:37888
  v_mfma_f32_32x32x16_bf16 v[48:63], a[48:51], a[36:39], v[48:63]
  ds_read_b128 a[64:67], v7 offset:0
  ds_read_b128 a[68:71], v7 offset:4096
  v_mfma_f32_32x32x16_bf16 v[64:79], a[48:51], a[40:43], v[64:79]
  ds_read_b128 a[72:75], v7 offset:8192
  ds_read_b128 a[76:79], v7 offset:12288
  v_mfma_f32_32x32x16_bf16 v[80:95], a[48:51], a[44:47], v[80:95]
  ds_read_b64_tr_b16 a[84:85], v9 offset:36864
  ds_read_b64_tr_b16 a[86:87], v9 offset:37888
  v_mfma_f32_32x32x16_bf16 v[96:111], a[52:55], a[32:35], v[96:111]
  ds_read_b64_tr_b16 a[88:89], v8 offset:37376
  ds_read_b64_tr_b16 a[90:91], v8 offset:38400
  v_mfma_f32_32x32x16_bf16 v[112:127], a[52:55], a[36:39], v[112:127]
  ds_read_b64_tr_b16 a[92:93], v9 offset:37376
  ds_read_b64_tr_b16 a[94:95], v9 offset:38400
  v_mfma_f32_32x32x16_bf16 v[128:143], a[52:55], a[40:43], v[128:143]
  v_mfma_f32_32x32x16_bf16 v[144:159], a[52:55], a[44:47], v[144:159]
  v_mfma_f32_32x32x16_bf16 v[160:175], a[56:59], a[32:35], v[160:175]
  v_mfma_f32_32x32x16_bf16 v[176:191], a[56:59], a[36:39], v[176:191]
  v_mfma_f32_32x32x16_bf16 v[192:207], a[56:59], a[40:43], v[192:207]
  v_mfma_f32_32x32x16_bf16 v[208:223], a[56:59], a[44:47], v[208:223]
  v_mfma_f32_32x32x16_bf16 v[224:239], a[60:63], a[32:35], v[224:239]
  v_mfma_f32_32x32x16_bf16 v[240:255], a[60:63], a[36:39], v[240:255]
  v_mfma_f32_32x32x16_bf16 a[0:15], a[60:63], a[40:43], a[0:15]
  v_mfma_f32_32x32x16_bf16 a[16:31], a[60:63], a[44:47], a[16:31]
  s_waitcnt vmcnt(20) lgkmcnt(0)
  s_barrier
  v_mfma_f32_32x32x16_bf16 v[32:47], a[80:83], a[64:67], v[32:47]
  v_add_u32 v7, 32768, v5
  ds_read_b64_tr_b16 a[48:49], v8 offset:49152
  ds_read_b64_tr_b16 a[50:51], v8 offset:50176
  v_mfma_f32_32x32x16_bf16 v[48:63], a[80:83], a[68:71], v[48:63]
  ds_read_b128 a[32:35], v7 offset:0
  ds_read_b128 a[36:39], v7 offset:4096
  v_mfma_f32_32x32x16_bf16 v[64:79], a[80:83], a[72:75], v[64:79]
  ds_read_b128 a[40:43], v7 offset:8192
  ds_read_b128 a[44:47], v7 offset:12288
  v_mfma_f32_32x32x16_bf16 v[80:95], a[80:83], a[76:79], v[80:95]
  ds_read_b64_tr_b16 a[52:53], v9 offset:49152
  ds_read_b64_tr_b16 a[54:55], v9 offset:50176
  v_mfma_f32_32x32x16_bf16 v[96:111], a[84:87], a[64:67], v[96:111]
  ds_read_b64_tr_b16 a[56:57], v8 offset:49664
  ds_read_b64_tr_b16 a[58:59], v8 offset:50688
  v_mfma_f32_32x32x16_bf16 v[112:127], a[84:87], a[68:71], v[112:127]
  ds_read_b64_tr_b16 a[60:61], v9 offset:49664
  ds_read_b64_tr_b16 a[62:63], v9 offset:50688
  v_mfma_f32_32x32x16_bf16 v[128:143], a[84:87], a[72:75], v[128:143]
  s_add_u32 m0, s38, 4096
  s_nop 0
  buffer_load_dwordx4 v10, s[16:19], s52 offen lds
  v_mfma_f32_32x32x16_bf16 v[144:159], a[84:87], a[76:79], v[144:159]
  buffer_load_dwordx4 v11, s[16:19], s53 offen offset:1024 lds
  v_mfma_f32_32x32x16_bf16 v[160:175], a[88:91], a[64:67], v[160:175]
  buffer_load_dwordx4 v10, s[16:19], s54 offen offset:2048 lds
  v_mfma_f32_32x32x16_bf16 v[176:191], a[88:91], a[68:71], v[176:191]
  buffer_load_dwordx4 v11, s[16:19], s55 offen offset:3072 lds
  v_add_u32 v10, 128, v10
  v_add_u32 v11, 128, v11
  v_mfma_f32_32x32x16_bf16 v[192:207], a[88:91], a[72:75], v[192:207]
  v_mfma_f32_32x32x16_bf16 v[208:223], a[88:91], a[76:79], v[208:223]
  s_add_u32 m0, s39, 32768
  s_nop 0
  buffer_load_dwordx4 v12, s[12:15], 0 offen lds
  v_mfma_f32_32x32x16_bf16 v[224:239], a[92:95], a[64:67], v[224:239]
  buffer_load_dwordx4 v12, s[12:15], s45 offen offset:1024 lds
  v_mfma_f32_32x32x16_bf16 v[240:255], a[92:95], a[68:71], v[240:255]
  buffer_load_dwordx4 v12, s[12:15], s46 offen offset:2048 lds
  v_mfma_f32_32x32x16_bf16 a[0:15], a[92:95], a[72:75], a[0:15]
  buffer_load_dwordx4 v12, s[12:15], s47 offen offset:3072 lds
  v_add_u32 v12, 262144, v12
  v_mfma_f32_32x32x16_bf16 a[16:31], a[92:95], a[76:79], a[16:31]
  s_waitcnt lgkmcnt(0)
  v_mfma_f32_32x32x16_bf16 v[32:47], a[48:51], a[32:35], v[32:47]
  v_add_u32 v7, 32768, v6
  ds_read_b64_tr_b16 a[80:81], v8 offset:53248
  ds_read_b64_tr_b16 a[82:83], v8 offset:54272
  v_mfma_f32_32x32x16_bf16 v[48:63], a[48:51], a[36:39], v[48:63]
  ds_read_b128 a[64:67], v7 offset:0
  ds_read_b128 a[68:71], v7 offset:4096
  v_mfma_f32_32x32x16_bf16 v[64:79], a[48:51], a[40:43], v[64:79]
  ds_read_b128 a[72:75], v7 offset:8192
  ds_read_b128 a[76:79], v7 offset:12288
  v_mfma_f32_32x32x16_bf16 v[80:95], a[48:51], a[44:47], v[80:95]
  ds_read_b64_tr_b16 a[84:85], v9 offset:53248
  ds_read_b64_tr_b16 a[86:87], v9 offset:54272
  v_mfma_f32_32x32x16_bf16 v[96:111], a[52:55], a[32:35], v[96:111]
  ds_read_b64_tr_b16 a[88:89], v8 offset:53760
  ds_read_b64_tr_b16 a[90:91], v8 offset:54784
  v_mfma_f32_32x32x16_bf16 v[112:127], a[52:55], a[36:39], v[112:127]
  ds_read_b64_tr_b16 a[92:93], v9 offset:53760
  ds_read_b64_tr_b16 a[94:95], v9 offset:54784
  v_mfma_f32_32x32x16_bf16 v[128:143], a[52:55], a[40:43], v[128:143]
  v_mfma_f32_32x32x16_bf16 v[144:159], a[52:55], a[44:47], v[144:159]
  v_mfma_f32_32x32x16_bf16 v[160:175], a[56:59], a[32:35], v[160:175]
  v_mfma_f32_32x32x16_bf16 v[176:191], a[56:59], a[36:39], v[176:191]
  v_mfma_f32_32x32x16_bf16 v[192:207], a[56:59], a[40:43], v[192:207]
  v_mfma_f32_32x32x16_bf16 v[208:223], a[56:59], a[44:47], v[208:223]
  v_mfma_f32_32x32x16_bf16 v[224:239], a[60:63], a[32:35], v[224:239]
  v_mfma_f32_32x32x16_bf16 v[240:255], a[60:63], a[36:39], v[240:255]
  v_mfma_f32_32x32x16_bf16 a[0:15], a[60:63], a[40:43], a[0:15]
  v_mfma_f32_32x32x16_bf16 a[16:31], a[60:63], a[44:47], a[16:31]
  s_waitcnt vmcnt(16) lgkmcnt(0)
  s_barrier
  v_mfma_f32_32x32x16_bf16 v[32:47], a[80:83], a[64:67], v[32:47]
  v_add_u32 v7, 65536, v3
  ds_read_b64_tr_b16 a[48:49], v8 offset:0
  ds_read_b64_tr_b16 a[50:51], v8 offset:1024
  v_mfma_f32_32x32x16_bf16 v[48:63], a[80:83], a[68:71], v[48:63]
  ds_read_b128 a[32:35], v7 offset:0
  ds_read_b128 a[36:39], v7 offset:4096
  v_mfma_f32_32x32x16_bf16 v[64:79], a[80:83], a[72:75], v[64:79]
  ds_read_b128 a[40:43], v7 offset:8192
  ds_read_b128 a[44:47], v7 offset:12288
  s_cmp_lg_u32 s3, 0
  s_cbranch_scc1 L_ln1
  v_mov_b32 v14, s88
  v_mov_b32 v15, 0
  s_lshl_b32 s4, s2, 2
  v_readfirstlane_b32 s5, v22
  s_mov_b64 exec, 1
  buffer_store_dword v14, v15, s[8:11], s4 offen sc1
  s_cmp_lg_u32 s5, 255
  s_cbranch_scc1 L_ln1x
  s_mov_b32 s4, 32768
  buffer_store_dword v14, v15, s[8:11], s4 offen sc1
L_ln1x:
  s_mov_b64 exec, -1
L_ln1:
  v_mfma_f32_32x32x16_bf16 v[80:95], a[80:83], a[76:79], v[80:95]
  ds_read_b64_tr_b16 a[52:53], v9 offset:0
  ds_read_b64_tr_b16 a[54:55], v9 offset:1024
  v_mfma_f32_32x32x16_bf16 v[96:111], a[84:87], a[64:67], v[96:111]
  ds_read_b64_tr_b16 a[56:57], v8 offset:512
  ds_read_b64_tr_b16 a[58:59], v8 offset:1536
  v_mfma_f32_32x32x16_bf16 v[112:127], a[84:87], a[68:71], v[112:127]
  ds_read_b64_tr_b16 a[60:61], v9 offset:512
  ds_read_b64_tr_b16 a[62:63], v9 offset:1536
  v_mfma_f32_32x32x16_bf16 v[128:143], a[84:87], a[72:75], v[128:143]
  s_add_u32 m0, s38, 32768
  s_nop 0
  buffer_load_dwordx4 v10, s[16:19], 0 offen lds
  v_mfma_f32_32x32x16_bf16 v[144:159], a[84:87], a[76:79], v[144:159]
  buffer_load_dwordx4 v11, s[16:19], s49 offen offset:1024 lds
  v_mfma_f32_32x32x16_bf16 v[160:175], a[88:91], a[64:67], v[160:175]
  buffer_load_dwordx4 v10, s[16:19], s50 offen offset:2048 lds
  v_mfma_f32_32x32x16_bf16 v[176:191], a[88:91], a[68:71], v[176:191]
  buffer_load_dwordx4 v11, s[16:19], s51 offen offset:3072 lds
  v_mfma_f32_32x32x16_bf16 v[192:207], a[88:91], a[72:75], v[192:207]
  v_mfma_f32_32x32x16_bf16 v[208:223], a[88:91], a[76:79], v[208:223]
  s_add_u32 m0, s39, 49152
  s_nop 0
  buffer_load_dwordx4 v12, s[12:15], 0 offen lds
  v_mfma_f32_32x32x16_bf16 v[224:239], a[92:95], a[64:67], v[224:239]
  buffer_load_dwordx4 v12, s[12:15], s45 offen offset:1024 lds
  v_mfma_f32_32x32x16_bf16 v[240:255], a[92:95], a[68:71], v[240:255]
  buffer_load_dwordx4 v12, s[12:15], s46 offen offset:2048 lds
  v_mfma_f32_32x32x16_bf16 a[0:15], a[92:95], a[72:75], a[0:15]
  buffer_load_dwordx4 v12, s[12:15], s47 offen offset:3072 lds
  v_add_u32 v12, 262144, v12
  v_mfma_f32_32x32x16_bf16 a[16:31], a[92:95], a[76:79], a[16:31]
  s_waitcnt lgkmcnt(0)
  v_mfma_f32_32x32x16_bf16 v[32:47], a[48:51], a[32:35], v[32:47]
  v_add_u32 v7, 65536, v4
  ds_read_b64_tr_b16 a[80:81], v8 offset:4096
  ds_read_b64_tr_b16 a[82:83], v8 offset:5120
  v_mfma_f32_32x32x16_bf16 v[48:63], a[48:51], a[36:39], v[48:63]
  ds_read_b128 a[64:67], v7 offset:0
  ds_read_b128 a[68:71], v7 offset:4096
  v_mfma_f32_32x32x16_bf16 v[64:79], a[48:51], a[40:43], v[64:79]
  ds_read_b128 a[72:75], v7 offset:8192
  ds_read_b128 a[76:79], v7 offset:12288
  v_mfma_f32_32x32x16_bf16 v[80:95], a[48:51], a[44:47], v[80:95]
  ds_read_b64_tr_b16 a[84:85], v9 offset:4096
  ds_read_b64_tr_b16 a[86:87], v9 offset:5120
  v_mfma_f32_32x32x16_bf16 v[96:111], a[52:55], a[32:35], v[96:111]
  ds_read_b64_tr_b16 a[88:89], v8 offset:4608
  ds_read_b64_tr_b16 a[90:91], v8 offset:5632
  v_mfma_f32_32x32x16_bf16 v[112:127], a[52:55], a[36:39], v[112:127]
  ds_read_b64_tr_b16 a[92:93], v9 offset:4608
  ds_read_b64_tr_b16 a[94:95], v9 offset:5632
  v_mfma_f32_32x32x16_bf16 v[128:143], a[52:55], a[40:43], v[128:143]
  v_mfma_f32_32x32x16_bf16 v[144:159], a[52:55], a[44:47], v[144:159]
  v_mfma_f32_32x32x16_bf16 v[160:175], a[56:59], a[32:35], v[160:175]
  v_mfma_f32_32x32x16_bf16 v[176:191], a[56:59], a[36:39], v[176:191]
  v_mfma_f32_32x32x16_bf16 v[192:207], a[56:59], a[40:43], v[192:207]
  v_mfma_f32_32x32x16_bf16 v[208:223], a[56:59], a[44:47], v[208:223]
  v_mfma_f32_32x32x16_bf16 v[224:239], a[60:63], a[32:35], v[224:239]
  v_mfma_f32_32x32x16_bf16 v[240:255], a[60:63], a[36:39], v[240:255]
  v_mfma_f32_32x32x16_bf16 a[0:15], a[60:63], a[40:43], a[0:15]
  v_mfma_f32_32x32x16_bf16 a[16:31], a[60:63], a[44:47], a[16:31]
  s_waitcnt vmcnt(16) lgkmcnt(0)
  s_barrier
  v_mfma_f32_32x32x16_bf16 v[32:47], a[80:83], a[64:67], v[32:47]
  v_add_u32 v7, 65536, v5
  ds_read_b64_tr_b16 a[48:49], v8 offset:16384
  ds_read_b64_tr_b16 a[50:51], v8 offset:17408
  v_mfma_f32_32x32x16_bf16 v[48:63], a[80:83], a[68:71], v[48:63]
  ds_read_b128 a[32:35], v7 offset:0
  ds_read_b128 a[36:39], v7 offset:4096
  v_mfma_f32_32x32x16_bf16 v[64:79], a[80:83], a[72:75], v[64:79]
  ds_read_b128 a[40:43], v7 offset:8192
  ds_read_b128 a[44:47], v7 offset:12288
  v_mfma_f32_32x32x16_bf16 v[80:95], a[80:83], a[76:79], v[80:95]
  ds_read_b64_tr_b16 a[52:53], v9 offset:16384
  ds_read_b64_tr_b16 a[54:55], v9 offset:17408
  v_mfma_f32_32x32x16_bf16 v[96:111], a[84:87], a[64:67], v[96:111]
  ds_read_b64_tr_b16 a[56:57], v8 offset:16896
  ds_read_b64_tr_b16 a[58:59], v8 offset:17920
  v_mfma_f32_32x32x16_bf16 v[112:127], a[84:87], a[68:71], v[112:127]
  ds_read_b64_tr_b16 a[60:61], v9 offset:16896
  ds_read_b64_tr_b16 a[62:63], v9 offset:17920
  v_mfma_f32_32x32x16_bf16 v[128:143], a[84:87], a[72:75], v[128:143]
  s_add_u32 m0, s38, 36864
  s_nop 0
  buffer_load_dwordx4 v10, s[16:19], s52 offen lds
  v_mfma_f32_32x32x16_bf16 v[144:159], a[84:87], a[76:79], v[144:159]
  buffer_load_dwordx4 v11, s[16:19], s53 offen offset:1024 lds
  v_mfma_f32_32x32x16_bf16 v[160:175], a[88:91], a[64:67], v[160:175]
  buffer_load_dwordx4 v10, s[16:19], s54 offen offset:2048 lds
  v_mfma_f32_32x32x16_bf16 v[176:191], a[88:91], a[68:71], v[176:191]
  buffer_load_dwordx4 v11, s[16:19], s55 offen offset:3072 lds
  v_add_u32 v10, 128, v10
  v_add_u32 v11, 128, v11
  v_mfma_f32_32x32x16_bf16 v[192:207], a[88:91], a[72:75], v[192:207]
  v_mfma_f32_32x32x16_bf16 v[208:223], a[88:91], a[76:79], v[208:223]
  s_add_u32 m0, s39, 0
  s_nop 0
  buffer_load_dwordx4 v12, s[12:15], 0 offen lds
  v_mfma_f32_32x32x16_bf16 v[224:239], a[92:95], a[64:67], v[224:239]
  buffer_load_dwordx4 v12, s[12:15], s45 offen offset:1024 lds
  v_mfma_f32_32x32x16_bf16 v[240:255], a[92:95], a[68:71], v[240:255]
  buffer_load_dwordx4 v12, s[12:15], s46 offen offset:2048 lds
  v_mfma_f32_32x32x16_bf16 a[0:15], a[92:95], a[72:75], a[0:15]
  buffer_load_dwordx4 v12, s[12:15], s47 offen offset:3072 lds
  v_add_u32 v12, 262144, v12
  s_mov_b32 s4, s74
  s_mov_b32 s5, s75
  s_mov_b32 s6, 0x510000
  s_mov_b32 s7, 0x20000
  s_lshl_b32 s33, s2, 2
  s_add_u32 s33, s33, s3
  s_mul_i32 s33, s33, 5184
  s_add_u32 s33, s33, 0
  v_lshlrev_b32 v23, 7, v1
  s_mov_b32 exec_lo, 0x1ff
  s_mov_b32 exec_hi, 0x0
  buffer_load_dword v24, v23, s[4:7], s33 offen
  s_mov_b64 exec, -1
  v_mfma_f32_32x32x16_bf16 a[16:31], a[92:95], a[76:79], a[16:31]
  s_waitcnt lgkmcnt(0)
  v_mfma_f32_32x32x16_bf16 v[32:47], a[48:51], a[32:35], v[32:47]
  v_add_u32 v7, 65536, v6
  ds_read_b64_tr_b16 a[80:81], v8 offset:20480
  ds_read_b64_tr_b16 a[82:83], v8 offset:21504
  v_mfma_f32_32x32x16_bf16 v[48:63], a[48:51], a[36:39], v[48:63]
  ds_read_b128 a[64:67], v7 offset:0
  ds_read_b128 a[68:71], v7 offset:4096
  v_mfma_f32_32x32x16_bf16 v[64:79], a[48:51], a[40:43], v[64:79]
  ds_read_b128 a[72:75], v7 offset:8192
  ds_read_b128 a[76:79], v7 offset:12288
  v_mfma_f32_32x32x16_bf16 v[80:95], a[48:51], a[44:47], v[80:95]
  ds_read_b64_tr_b16 a[84:85], v9 offset:20480
  ds_read_b64_tr_b16 a[86:87], v9 offset:21504
  v_mfma_f32_32x32x16_bf16 v[96:111], a[52:55], a[32:35], v[96:111]
  ds_read_b64_tr_b16 a[88:89], v8 offset:20992
  ds_read_b64_tr_b16 a[90:91], v8 offset:22016
  v_mfma_f32_32x32x16_bf16 v[112:127], a[52:55], a[36:39], v[112:127]
  ds_read_b64_tr_b16 a[92:93], v9 offset:20992
  ds_read_b64_tr_b16 a[94:95], v9 offset:22016
  v_mfma_f32_32x32x16_bf16 v[128:143], a[52:55], a[40:43], v[128:143]
  v_mfma_f32_32x32x16_bf16 v[144:159], a[52:55], a[44:47], v[144:159]
  v_mfma_f32_32x32x16_bf16 v[160:175], a[56:59], a[32:35], v[160:175]
  v_mfma_f32_32x32x16_bf16 v[176:191], a[56:59], a[36:39], v[176:191]
  v_mfma_f32_32x32x16_bf16 v[192:207], a[56:59], a[40:43], v[192:207]
  v_mfma_f32_32x32x16_bf16 v[208:223], a[56:59], a[44:47], v[208:223]
  v_mfma_f32_32x32x16_bf16 v[224:239], a[60:63], a[32:35], v[224:239]
  v_mfma_f32_32x32x16_bf16 v[240:255], a[60:63], a[36:39], v[240:255]
  v_mfma_f32_32x32x16_bf16 a[0:15], a[60:63], a[40:43], a[0:15]
  v_mfma_f32_32x32x16_bf16 a[16:31], a[60:63], a[44:47], a[16:31]
  s_waitcnt vmcnt(17) lgkmcnt(0)
  s_barrier
  v_mfma_f32_32x32x16_bf16 v[32:47], a[80:83], a[64:67], v[32:47]
  v_add_u32 v7, 0, v3
  ds_read_b64_tr_b16 a[48:49], v8 offset:32768
  ds_read_b64_tr_b16 a[50:51], v8 offset:33792
  v_mfma_f32_32x32x16_bf16 v[48:63], a[80:83], a[68:71], v[48:63]
  ds_read_b128 a[32:35], v7 offset:0
  ds_read_b128 a[36:39], v7 offset:4096
  v_mfma_f32_32x32x16_bf16 v[64:79], a[80:83], a[72:75], v[64:79]
  ds_read_b128 a[40:43], v7 offset:8192
  ds_read_b128 a[44:47], v7 offset:12288
  v_mfma_f32_32x32x16_bf16 v[80:95], a[80:83], a[76:79], v[80:95]
  ds_read_b64_tr_b16 a[52:53], v9 offset:32768
  ds_read_b64_tr_b16 a[54:55], v9 offset:33792
  v_mfma_f32_32x32x16_bf16 v[96:111], a[84:87], a[64:67], v[96:111]
  ds_read_b64_tr_b16 a[56:57], v8 offset:33280
  ds_read_b64_tr_b16 a[58:59], v8 offset:34304
  v_mfma_f32_32x32x16_bf16 v[112:127], a[84:87], a[68:71], v[112:127]
  ds_read_b64_tr_b16 a[60:61], v9 offset:33280
  ds_read_b64_tr_b16 a[62:63], v9 offset:34304
  v_mfma_f32_32x32x16_bf16 v[128:143], a[84:87], a[72:75], v[128:143]
  s_add_u32 m0, s38, 65536
  s_nop 0
  buffer_load_dwordx4 v10, s[16:19], 0 offen lds
  v_mfma_f32_32x32x16_bf16 v[144:159], a[84:87], a[76:79], v[144:159]
  buffer_load_dwordx4 v11, s[16:19], s49 offen offset:1024 lds
  v_mfma_f32_32x32x16_bf16 v[160:175], a[88:91], a[64:67], v[160:175]
  buffer_load_dwordx4 v10, s[16:19], s50 offen offset:2048 lds
  v_mfma_f32_32x32x16_bf16 v[176:191], a[88:91], a[68:71], v[176:191]
  buffer_load_dwordx4 v11, s[16:19], s51 offen offset:3072 lds
  v_mfma_f32_32x32x16_bf16 v[192:207], a[88:91], a[72:75], v[192:207]
  v_mfma_f32_32x32x16_bf16 v[208:223], a[88:91], a[76:79], v[208:223]
  s_add_u32 m0, s39, 16384
  s_nop 0
  buffer_load_dwordx4 v12, s[12:15], 0 offen lds
  v_mfma_f32_32x32x16_bf16 v[224:239], a[92:95], a[64:67], v[224:239]
  buffer_load_dwordx4 v12, s[12:15], s45 offen offset:1024 lds
  v_mfma_f32_32x32x16_bf16 v[240:255], a[92:95], a[68:71], v[240:255]
  buffer_load_dwordx4 v12, s[12:15], s46 offen offset:2048 lds
  v_mfma_f32_32x32x16_bf16 a[0:15], a[92:95], a[72:75], a[0:15]
  buffer_load_dwordx4 v12, s[12:15], s47 offen offset:3072 lds
  v_add_u32 v12, 262144, v12
  s_mov_b32 s4, s76
  s_mov_b32 s5, s77
  s_mov_b32 s6, 0x510000
  s_mov_b32 s7, 0x20000
  s_lshl_b32 s33, s2, 2
  s_add_u32 s33, s33, s3
  s_mul_i32 s33, s33, 5184
  s_add_u32 s33, s33, 0
  v_lshlrev_b32 v23, 7, v1
  s_mov_b32 exec_lo, 0x1ff
  s_mov_b32 exec_hi, 0x0
  buffer_load_dword v24, v23, s[4:7], s33 offen
  s_mov_b64 exec, -1
  v_mfma_f32_32x32x16_bf16 a[16:31], a[92:95], a[76:79], a[16:31]
  s_waitcnt lgkmcnt(0)
  v_mfma_f32_32x32x16_bf16 v[32:47], a[48:51], a[32:35], v[32:47]
  v_add_u32 v7, 0, v4
  ds_read_b64_tr_b16 a[80:81], v8 offset:36864
  ds_read_b64_tr_b16 a[82:83], v8 offset:37888
  v_mfma_f32_32x32x16_bf16 v[48:63], a[48:51], a[36:39], v[48:63]
  ds_read_b128 a[64:67], v7 offset:0
  ds_read_b128 a[68:71], v7 offset:4096
  v_mfma_f32_32x32x16_bf16 v[64:79], a[48:51], a[40:43], v[64:79]
  ds_read_b128 a[72:75], v7 offset:8192
  ds_read_b128 a[76:79], v7 offset:12288
  v_mfma_f32_32x32x16_bf16 v[80:95], a[48:51], a[44:47], v[80:95]
  ds_read_b64_tr_b16 a[84:85], v9 offset:36864
  ds_read_b64_tr_b16 a[86:87], v9 offset:37888
  v_mfma_f32_32x32x16_bf16 v[96:111], a[52:55], a[32:35], v[96:111]
  ds_read_b64_tr_b16 a[88:89], v8 offset:37376
  ds_read_b64_tr_b16 a[90:91], v8 offset:38400
  v_mfma_f32_32x32x16_bf16 v[112:127], a[52:55], a[36:39], v[112:127]
  ds_read_b64_tr_b16 a[92:93], v9 offset:37376
  ds_read_b64_tr_b16 a[94:95], v9 offset:38400
  v_mfma_f32_32x32x16_bf16 v[128:143], a[52:55], a[40:43], v[128:143]
  v_mfma_f32_32x32x16_bf16 v[144:159], a[52:55], a[44:47], v[144:159]
  v_mfma_f32_32x32x16_bf16 v[160:175], a[56:59], a[32:35], v[160:175]
  v_mfma_f32_32x32x16_bf16 v[176:191], a[56:59], a[36:39], v[176:191]
  v_mfma_f32_32x32x16_bf16 v[192:207], a[56:59], a[40:43], v[192:207]
  v_mfma_f32_32x32x16_bf16 v[208:223], a[56:59], a[44:47], v[208:223]
  v_mfma_f32_32x32x16_bf16 v[224:239], a[60:63], a[32:35], v[224:239]
  v_mfma_f32_32x32x16_bf16 v[240:255], a[60:63], a[36:39], v[240:255]
  v_mfma_f32_32x32x16_bf16 a[0:15], a[60:63], a[40:43], a[0:15]
  v_mfma_f32_32x32x16_bf16 a[16:31], a[60:63], a[44:47], a[16:31]
  s_waitcnt vmcnt(18) lgkmcnt(0)
  s_barrier
  v_mfma_f32_32x32x16_bf16 v[32:47], a[80:83], a[64:67], v[32:47]
  v_add_u32 v7, 0, v5
  ds_read_b64_tr_b16 a[48:49], v8 offset:49152
  ds_read_b64_tr_b16 a[50:51], v8 offset:50176
  v_mfma_f32_32x32x16_bf16 v[48:63], a[80:83], a[68:71], v[48:63]
  ds_read_b128 a[32:35], v7 offset:0
  ds_read_b128 a[36:39], v7 offset:4096
  v_mfma_f32_32x32x16_bf16 v[64:79], a[80:83], a[72:75], v[64:79]
  ds_read_b128 a[40:43], v7 offset:8192
  ds_read_b128 a[44:47], v7 offset:12288
  v_mfma_f32_32x32x16_bf16 v[80:95], a[80:83], a[76:79], v[80:95]
  ds_read_b64_tr_b16 a[52:53], v9 offset:49152
  ds_read_b64_tr_b16 a[54:55], v9 offset:50176
  v_mfma_f32_32x32x16_bf16 v[96:111], a[84:87], a[64:67], v[96:111]
  ds_read_b64_tr_b16 a[56:57], v8 offset:49664
  ds_read_b64_tr_b16 a[58:59], v8 offset:50688
  v_mfma_f32_32x32x16_bf16 v[112:127], a[84:87], a[68:71], v[112:127]
  ds_read_b64_tr_b16 a[60:61], v9 offset:49664
  ds_read_b64_tr_b16 a[62:63], v9 offset:50688
  v_mfma_f32_32x32x16_bf16 v[128:143], a[84:87], a[72:75], v[128:143]
  s_add_u32 m0, s38, 69632
  s_nop 0
  buffer_load_dwordx4 v10, s[16:19], s52 offen lds
  v_mfma_f32_32x32x16_bf16 v[144:159], a[84:87], a[76:79], v[144:159]
  buffer_load_dwordx4 v11, s[16:19], s53 offen offset:1024 lds
  v_mfma_f32_32x32x16_bf16 v[160:175], a[88:91], a[64:67], v[160:175]
  buffer_load_dwordx4 v10, s[16:19], s54 offen offset:2048 lds
  v_mfma_f32_32x32x16_bf16 v[176:191], a[88:91], a[68:71], v[176:191]
  buffer_load_dwordx4 v11, s[16:19], s55 offen offset:3072 lds
  v_add_u32 v10, 128, v10
  v_add_u32 v11, 128, v11
  v_mfma_f32_32x32x16_bf16 v[192:207], a[88:91], a[72:75], v[192:207]
  v_mfma_f32_32x32x16_bf16 v[208:223], a[88:91], a[76:79], v[208:223]
  s_add_u32 m0, s39, 32768
  s_nop 0
  buffer_load_dwordx4 v12, s[12:15], 0 offen lds
  v_mfma_f32_32x32x16_bf16 v[224:239], a[92:95], a[64:67], v[224:239]
  buffer_load_dwordx4 v12, s[12:15], s45 offen offset:1024 lds
  v_mfma_f32_32x32x16_bf16 v[240:255], a[92:95], a[68:71], v[240:255]
  buffer_load_dwordx4 v12, s[12:15], s46 offen offset:2048 lds
  v_mfma_f32_32x32x16_bf16 a[0:15], a[92:95], a[72:75], a[0:15]
  buffer_load_dwordx4 v12, s[12:15], s47 offen offset:3072 lds
  v_add_u32 v12, 262144, v12
  s_mov_b32 s4, s74
  s_mov_b32 s5, s75
  s_mov_b32 s6, 0x510000
  s_mov_b32 s7, 0x20000
  s_lshl_b32 s33, s2, 2
  s_add_u32 s33, s33, s3
  s_mul_i32 s33, s33, 5184
  s_add_u32 s33, s33, 1152
  v_lshlrev_b32 v23, 7, v1
  s_mov_b32 exec_lo, 0x1ff
  s_mov_b32 exec_hi, 0x0
  buffer_load_dword v24, v23, s[4:7], s33 offen
  s_mov_b64 exec, -1
  v_mfma_f32_32x32x16_bf16 a[16:31], a[92:95], a[76:79], a[16:31]
  s_mov_b32 s4, s68
  s_mov_b32 s5, s69
  s_mov_b32 s6, 0x480000
  s_mov_b32 s7, 0x20000
  s_lshl_b32 s33, s2, 2
  s_add_u32 s33, s33, s3
  s_mul_i32 s33, s33, 4608
  s_add_u32 s33, s33, 0
  v_lshlrev_b32 v23, 7, v1
  s_mov_b32 exec_lo, 0xfff
  s_mov_b32 exec_hi, 0x0
  buffer_load_dword v24, v23, s[4:7], s33 offen
  s_mov_b64 exec, -1
  s_waitcnt lgkmcnt(0)
  v_mfma_f32_32x32x16_bf16 v[32:47], a[48:51], a[32:35], v[32:47]
  v_add_u32 v7, 0, v6
  ds_read_b64_tr_b16 a[80:81], v8 offset:53248
  ds_read_b64_tr_b16 a[82:83], v8 offset:54272
  v_mfma_f32_32x32x16_bf16 v[48:63], a[48:51], a[36:39], v[48:63]
  ds_read_b128 a[64:67], v7 offset:0
  ds_read_b128 a[68:71], v7 offset:4096
  v_mfma_f32_32x32x16_bf16 v[64:79], a[48:51], a[40:43], v[64:79]
  ds_read_b128 a[72:75], v7 offset:8192
  ds_read_b128 a[76:79], v7 offset:12288
  v_mfma_f32_32x32x16_bf16 v[80:95], a[48:51], a[44:47], v[80:95]
  ds_read_b64_tr_b16 a[84:85], v9 offset:53248
  ds_read_b64_tr_b16 a[86:87], v9 offset:54272
  v_mfma_f32_32x32x16_bf16 v[96:111], a[52:55], a[32:35], v[96:111]
  ds_read_b64_tr_b16 a[88:89], v8 offset:53760
  ds_read_b64_tr_b16 a[90:91], v8 offset:54784
  v_mfma_f32_32x32x16_bf16 v[112:127], a[52:55], a[36:39], v[112:127]
  ds_read_b64_tr_b16 a[92:93], v9 offset:53760
  ds_read_b64_tr_b16 a[94:95], v9 offset:54784
  v_mfma_f32_32x32x16_bf16 v[128:143], a[52:55], a[40:43], v[128:143]
  v_mfma_f32_32x32x16_bf16 v[144:159], a[52:55], a[44:47], v[144:159]
  v_mfma_f32_32x32x16_bf16 v[160:175], a[56:59], a[32:35], v[160:175]
  v_mfma_f32_32x32x16_bf16 v[176:191], a[56:59], a[36:39], v[176:191]
  v_mfma_f32_32x32x16_bf16 v[192:207], a[56:59], a[40:43], v[192:207]
  v_mfma_f32_32x32x16_bf16 v[208:223], a[56:59], a[44:47], v[208:223]
  v_mfma_f32_32x32x16_bf16 v[224:239], a[60:63], a[32:35], v[224:239]
  v_mfma_f32_32x32x16_bf16 v[240:255], a[60:63], a[36:39], v[240:255]
  v_mfma_f32_32x32x16_bf16 a[0:15], a[60:63], a[40:43], a[0:15]
  v_mfma_f32_32x32x16_bf16 a[16:31], a[60:63], a[44:47], a[16:31]
  s_waitcnt vmcnt(20) lgkmcnt(0)
  s_barrier
  v_mfma_f32_32x32x16_bf16 v[32:47], a[80:83], a[64:67], v[32:47]
  v_add_u32 v7, 32768, v3
  ds_read_b64_tr_b16 a[48:49], v8 offset:0
  ds_read_b64_tr_b16 a[50:51], v8 offset:1024
  v_mfma_f32_32x32x16_bf16 v[48:63], a[80:83], a[68:71], v[48:63]
  ds_read_b128 a[32:35], v7 offset:0
  ds_read_b128 a[36:39], v7 offset:4096
  v_mfma_f32_32x32x16_bf16 v[64:79], a[80:83], a[72:75], v[64:79]
  ds_read_b128 a[40:43], v7 offset:8192
  ds_read_b128 a[44:47], v7 offset:12288
  v_mfma_f32_32x32x16_bf16 v[80:95], a[80:83], a[76:79], v[80:95]
  ds_read_b64_tr_b16 a[52:53], v9 offset:0
  ds_read_b64_tr_b16 a[54:55], v9 offset:1024
  v_mfma_f32_32x32x16_bf16 v[96:111], a[84:87], a[64:67], v[96:111]
  ds_read_b64_tr_b16 a[56:57], v8 offset:512
  ds_read_b64_tr_b16 a[58:59], v8 offset:1536
  v_mfma_f32_32x32x16_bf16 v[112:127], a[84:87], a[68:71], v[112:127]
  ds_read_b64_tr_b16 a[60:61], v9 offset:512
  ds_read_b64_tr_b16 a[62:63], v9 offset:1536
  v_mfma_f32_32x32x16_bf16 v[128:143], a[84:87], a[72:75], v[128:143]
  s_add_u32 m0, s38, 0
  s_nop 0
  buffer_load_dwordx4 v10, s[16:19], 0 offen lds
  v_mfma_f32_32x32x16_bf16 v[144:159], a[84:87], a[76:79], v[144:159]
  buffer_load_dwordx4 v11, s[16:19], s49 offen offset:1024 lds
  v_mfma_f32_32x32x16_bf16 v[160:175], a[88:91], a[64:67], v[160:175]
  buffer_load_dwordx4 v10, s[16:19], s50 offen offset:2048 lds
  v_mfma_f32_32x32x16_bf16 v[176:191], a[88:91], a[68:71], v[176:191]
  buffer_load_dwordx4 v11, s[16:19], s51 offen offset:3072 lds
  v_mfma_f32_32x32x16_bf16 v[192:207], a[88:91], a[72:75], v[192:207]
  v_mfma_f32_32x32x16_bf16 v[208:223], a[88:91], a[76:79], v[208:223]
  s_add_u32 m0, s39, 49152
  s_nop 0
  buffer_load_dwordx4 v12, s[12:15], 0 offen lds
  v_mfma_f32_32x32x16_bf16 v[224:239], a[92:95], a[64:67], v[224:239]
  buffer_load_dwordx4 v12, s[12:15], s45 offen offset:1024 lds
  v_mfma_f32_32x32x16_bf16 v[240:255], a[92:95], a[68:71], v[240:255]
  buffer_load_dwordx4 v12, s[12:15], s46 offen offset:2048 lds
  v_mfma_f32_32x32x16_bf16 a[0:15], a[92:95], a[72:75], a[0:15]
  buffer_load_dwordx4 v12, s[12:15], s47 offen offset:3072 lds
  v_add_u32 v12, 262144, v12
  s_mov_b32 s4, s76
  s_mov_b32 s5, s77
  s_mov_b32 s6, 0x510000
  s_mov_b32 s7, 0x20000
  s_lshl_b32 s33, s2, 2
  s_add_u32 s33, s33, s3
  s_mul_i32 s33, s33, 5184
  s_add_u32 s33, s33, 1152
  v_lshlrev_b32 v23, 7, v1
  s_mov_b32 exec_lo, 0x1ff
  s_mov_b32 exec_hi, 0x0
  buffer_load_dword v24, v23, s[4:7], s33 offen
  s_mov_b64 exec, -1
  v_mfma_f32_32x32x16_bf16 a[16:31], a[92:95], a[76:79], a[16:31]
  s_waitcnt lgkmcnt(0)
  v_mfma_f32_32x32x16_bf16 v[32:47], a[48:51], a[32:35], v[32:47]
  v_add_u32 v7, 32768, v4
  ds_read_b64_tr_b16 a[80:81], v8 offset:4096
  ds_read_b64_tr_b16 a[82:83], v8 offset:5120
  v_mfma_f32_32x32x16_bf16 v[48:63], a[48:51], a[36:39], v[48:63]
  ds_read_b128 a[64:67], v7 offset:0
  ds_read_b128 a[68:71], v7 offset:4096
  v_mfma_f32_32x32x16_bf16 v[64:79], a[48:51], a[40:43], v[64:79]
  ds_read_b128 a[72:75], v7 offset:8192
  ds_read_b128 a[76:79], v7 offset:12288
  v_mfma_f32_32x32x16_bf16 v[80:95], a[48:51], a[44:47], v[80:95]
  ds_read_b64_tr_b16 a[84:85], v9 offset:4096
  ds_read_b64_tr_b16 a[86:87], v9 offset:5120
  v_mfma_f32_32x32x16_bf16 v[96:111], a[52:55], a[32:35], v[96:111]
  ds_read_b64_tr_b16 a[88:89], v8 offset:4608
  ds_read_b64_tr_b16 a[90:91], v8 offset:5632
  v_mfma_f32_32x32x16_bf16 v[112:127], a[52:55], a[36:39], v[112:127]
  ds_read_b64_tr_b16 a[92:93], v9 offset:4608
  ds_read_b64_tr_b16 a[94:95], v9 offset:5632
  v_mfma_f32_32x32x16_bf16 v[128:143], a[52:55], a[40:43], v[128:143]
  v_mfma_f32_32x32x16_bf16 v[144:159], a[52:55], a[44:47], v[144:159]
  v_mfma_f32_32x32x16_bf16 v[160:175], a[56:59], a[32:35], v[160:175]
  v_mfma_f32_32x32x16_bf16 v[176:191], a[56:59], a[36:39], v[176:191]
  v_mfma_f32_32x32x16_bf16 v[192:207], a[56:59], a[40:43], v[192:207]
  v_mfma_f32_32x32x16_bf16 v[208:223], a[56:59], a[44:47], v[208:223]
  v_mfma_f32_32x32x16_bf16 v[224:239], a[60:63], a[32:35], v[224:239]
  v_mfma_f32_32x32x16_bf16 v[240:255], a[60:63], a[36:39], v[240:255]
  v_mfma_f32_32x32x16_bf16 a[0:15], a[60:63], a[40:43], a[0:15]
  v_mfma_f32_32x32x16_bf16 a[16:31], a[60:63], a[44:47], a[16:31]
  s_waitcnt vmcnt(20) lgkmcnt(0)
  s_barrier
  v_mfma_f32_32x32x16_bf16 v[32:47], a[80:83], a[64:67], v[32:47]
  v_add_u32 v7, 32768, v5
  ds_read_b64_tr_b16 a[48:49], v8 offset:16384
  ds_read_b64_tr_b16 a[50:51], v8 offset:17408
  v_mfma_f32_32x32x16_bf16 v[48:63], a[80:83], a[68:71], v[48:63]
  ds_read_b128 a[32:35], v7 offset:0
  ds_read_b128 a[36:39], v7 offset:4096
  v_mfma_f32_32x32x16_bf16 v[64:79], a[80:83], a[72:75], v[64:79]
  ds_read_b128 a[40:43], v7 offset:8192
  ds_read_b128 a[44:47], v7 offset:12288
  v_mfma_f32_32x32x16_bf16 v[80:95], a[80:83], a[76:79], v[80:95]
  ds_read_b64_tr_b16 a[52:53], v9 offset:16384
  ds_read_b64_tr_b16 a[54:55], v9 offset:17408
  v_mfma_f32_32x32x16_bf16 v[96:111], a[84:87], a[64:67], v[96:111]
  ds_read_b64_tr_b16 a[56:57], v8 offset:16896
  ds_read_b64_tr_b16 a[58:59], v8 offset:17920
  v_mfma_f32_32x32x16_bf16 v[112:127], a[84:87], a[68:71], v[112:127]
  ds_read_b64_tr_b16 a[60:61], v9 offset:16896
  ds_read_b64_tr_b16 a[62:63], v9 offset:17920
  v_mfma_f32_32x32x16_bf16 v[128:143], a[84:87], a[72:75], v[128:143]
  s_add_u32 m0, s38, 4096
  s_nop 0
  buffer_load_dwordx4 v10, s[16:19], s52 offen lds
  v_mfma_f32_32x32x16_bf16 v[144:159], a[84:87], a[76:79], v[144:159]
  buffer_load_dwordx4 v11, s[16:19], s53 offen offset:1024 lds
  v_mfma_f32_32x32x16_bf16 v[160:175], a[88:91], a[64:67], v[160:175]
  buffer_load_dwordx4 v10, s[16:19], s54 offen offset:2048 lds
  v_mfma_f32_32x32x16_bf16 v[176:191], a[88:91], a[68:71], v[176:191]
  buffer_load_dwordx4 v11, s[16:19], s55 offen offset:3072 lds
  v_add_u32 v10, 128, v10
  v_add_u32 v11, 128, v11
  v_mfma_f32_32x32x16_bf16 v[192:207], a[88:91], a[72:75], v[192:207]
  v_mfma_f32_32x32x16_bf16 v[208:223], a[88:91], a[76:79], v[208:223]
  s_add_u32 m0, s39, 0
  s_nop 0
  buffer_load_dwordx4 v12, s[12:15], 0 offen lds
  v_mfma_f32_32x32x16_bf16 v[224:239], a[92:95], a[64:67], v[224:239]
  buffer_load_dwordx4 v12, s[12:15], s45 offen offset:1024 lds
  v_mfma_f32_32x32x16_bf16 v[240:255], a[92:95], a[68:71], v[240:255]
  buffer_load_dwordx4 v12, s[12:15], s46 offen offset:2048 lds
  v_mfma_f32_32x32x16_bf16 a[0:15], a[92:95], a[72:75], a[0:15]
  buffer_load_dwordx4 v12, s[12:15], s47 offen offset:3072 lds
  v_add_u32 v12, 262144, v12
  s_mov_b32 s4, s74
  s_mov_b32 s5, s75
  s_mov_b32 s6, 0x510000
  s_mov_b32 s7, 0x20000
  s_lshl_b32 s33, s2, 2
  s_add_u32 s33, s33, s3
  s_mul_i32 s33, s33, 5184
  s_add_u32 s33, s33, 2304
  v_lshlrev_b32 v23, 7, v1
  s_mov_b32 exec_lo, 0x1ff
  s_mov_b32 exec_hi, 0x0
  buffer_load_dword v24, v23, s[4:7], s33 offen
  s_mov_b64 exec, -1
  v_mfma_f32_32x32x16_bf16 a[16:31], a[92:95], a[76:79], a[16:31]
  s_waitcnt lgkmcnt(0)
  v_mfma_f32_32x32x16_bf16 v[32:47], a[48:51], a[32:35], v[32:47]
  v_add_u32 v7, 32768, v6
  ds_read_b64_tr_b16 a[80:81], v8 offset:20480
  ds_read_b64_tr_b16 a[82:83], v8 offset:21504
  v_mfma_f32_32x32x16_bf16 v[48:63], a[48:51], a[36:39], v[48:63]
  ds_read_b128 a[64:67], v7 offset:0
  ds_read_b128 a[68:71], v7 offset:4096
  v_mfma_f32_32x32x16_bf16 v[64:79], a[48:51], a[40:43], v[64:79]
  ds_read_b128 a[72:75], v7 offset:8192
  ds_read_b128 a[76:79], v7 offset:12288
  v_mfma_f32_32x32x16_bf16 v[80:95], a[48:51], a[44:47], v[80:95]
  ds_read_b64_tr_b16 a[84:85], v9 offset:20480
  ds_read_b64_tr_b16 a[86:87], v9 offset:21504
  v_mfma_f32_32x32x16_bf16 v[96:111], a[52:55], a[32:35], v[96:111]
  ds_read_b64_tr_b16 a[88:89], v8 offset:20992
  ds_read_b64_tr_b16 a[90:91], v8 offset:22016
  v_mfma_f32_32x32x16_bf16 v[112:127], a[52:55], a[36:39], v[112:127]
  ds_read_b64_tr_b16 a[92:93], v9 offset:20992
  ds_read_b64_tr_b16 a[94:95], v9 offset:22016
  v_mfma_f32_32x32x16_bf16 v[128:143], a[52:55], a[40:43], v[128:143]
  v_mfma_f32_32x32x16_bf16 v[144:159], a[52:55], a[44:47], v[144:159]
  v_mfma_f32_32x32x16_bf16 v[160:175], a[56:59], a[32:35], v[160:175]
  v_mfma_f32_32x32x16_bf16 v[176:191], a[56:59], a[36:39], v[176:191]
  v_mfma_f32_32x32x16_bf16 v[192:207], a[56:59], a[40:43], v[192:207]
  v_mfma_f32_32x32x16_bf16 v[208:223], a[56:59], a[44:47], v[208:223]
  v_mfma_f32_32x32x16_bf16 v[224:239], a[60:63], a[32:35], v[224:239]
  v_mfma_f32_32x32x16_bf16 v[240:255], a[60:63], a[36:39], v[240:255]
  v_mfma_f32_32x32x16_bf16 a[0:15], a[60:63], a[40:43], a[0:15]
  v_mfma_f32_32x32x16_bf16 a[16:31], a[60:63], a[44:47], a[16:31]
  s_waitcnt vmcnt(20) lgkmcnt(0)
  s_barrier
  v_mfma_f32_32x32x16_bf16 v[32:47], a[80:83], a[64:67], v[32:47]
  v_add_u32 v7, 65536, v3
  ds_read_b64_tr_b16 a[48:49], v8 offset:32768
  ds_read_b64_tr_b16 a[50:51], v8 offset:33792
  buffer_load_dwordx4 v[16:19], v2, s[8:11], 0 offen sc1
  v_mfma_f32_32x32x16_bf16 v[48:63], a[80:83], a[68:71], v[48:63]
  ds_read_b128 a[32:35], v7 offset:0
  ds_read_b128 a[36:39], v7 offset:4096
  v_mfma_f32_32x32x16_bf16 v[64:79], a[80:83], a[72:75], v[64:79]
  ds_read_b128 a[40:43], v7 offset:8192
  ds_read_b128 a[44:47], v7 offset:12288
  v_mfma_f32_32x32x16_bf16 v[80:95], a[80:83], a[76:79], v[80:95]
  ds_read_b64_tr_b16 a[52:53], v9 offset:32768
  ds_read_b64_tr_b16 a[54:55], v9 offset:33792
  v_mfma_f32_32x32x16_bf16 v[96:111], a[84:87], a[64:67], v[96:111]
  ds_read_b64_tr_b16 a[56:57], v8 offset:33280
  ds_read_b64_tr_b16 a[58:59], v8 offset:34304
  v_mfma_f32_32x32x16_bf16 v[112:127], a[84:87], a[68:71], v[112:127]
  ds_read_b64_tr_b16 a[60:61], v9 offset:33280
  ds_read_b64_tr_b16 a[62:63], v9 offset:34304
  v_mfma_f32_32x32x16_bf16 v[128:143], a[84:87], a[72:75], v[128:143]
  s_add_u32 m0, s38, 32768
  s_nop 0
  buffer_load_dwordx4 v10, s[16:19], 0 offen lds
  v_mfma_f32_32x32x16_bf16 v[144:159], a[84:87], a[76:79], v[144:159]
  buffer_load_dwordx4 v11, s[16:19], s49 offen offset:1024 lds
  v_mfma_f32_32x32x16_bf16 v[160:175], a[88:91], a[64:67], v[160:175]
  buffer_load_dwordx4 v10, s[16:19], s50 offen offset:2048 lds
  v_mfma_f32_32x32x16_bf16 v[176:191], a[88:91], a[68:71], v[176:191]
  buffer_load_dwordx4 v11, s[16:19], s51 offen offset:3072 lds
  v_mfma_f32_32x32x16_bf16 v[192:207], a[88:91], a[72:75], v[192:207]
  v_mfma_f32_32x32x16_bf16 v[208:223], a[88:91], a[76:79], v[208:223]
  s_add_u32 m0, s39, 16384
  s_nop 0
  buffer_load_dwordx4 v12, s[12:15], 0 offen lds
  v_mfma_f32_32x32x16_bf16 v[224:239], a[92:95], a[64:67], v[224:239]
  buffer_load_dwordx4 v12, s[12:15], s45 offen offset:1024 lds
  v_mfma_f32_32x32x16_bf16 v[240:255], a[92:95], a[68:71], v[240:255]
  buffer_load_dwordx4 v12, s[12:15], s46 offen offset:2048 lds
  v_mfma_f32_32x32x16_bf16 a[0:15], a[92:95], a[72:75], a[0:15]
  buffer_load_dwordx4 v12, s[12:15], s47 offen offset:3072 lds
  v_add_u32 v12, 262144, v12
  s_mov_b32 s4, s76
  s_mov_b32 s5, s77
  s_mov_b32 s6, 0x510000
  s_mov_b32 s7, 0x20000
  s_lshl_b32 s33, s2, 2
  s_add_u32 s33, s33, s3
  s_mul_i32 s33, s33, 5184
  s_add_u32 s33, s33, 2304
  v_lshlrev_b32 v23, 7, v1
  s_mov_b32 exec_lo, 0x1ff
  s_mov_b32 exec_hi, 0x0
  buffer_load_dword v24, v23, s[4:7], s33 offen
  s_mov_b64 exec, -1
  v_mfma_f32_32x32x16_bf16 a[16:31], a[92:95], a[76:79], a[16:31]
  s_waitcnt lgkmcnt(0)
  v_mfma_f32_32x32x16_bf16 v[32:47], a[48:51], a[32:35], v[32:47]
  v_add_u32 v7, 65536, v4
  ds_read_b64_tr_b16 a[80:81], v8 offset:36864
  ds_read_b64_tr_b16 a[82:83], v8 offset:37888
  v_mfma_f32_32x32x16_bf16 v[48:63], a[48:51], a[36:39], v[48:63]
  ds_read_b128 a[64:67], v7 offset:0
  ds_read_b128 a[68:71], v7 offset:4096
  v_mfma_f32_32x32x16_bf16 v[64:79], a[48:51], a[40:43], v[64:79]
  ds_read_b128 a[72:75], v7 offset:8192
  ds_read_b128 a[76:79], v7 offset:12288
  v_mfma_f32_32x32x16_bf16 v[80:95], a[48:51], a[44:47], v[80:95]
  ds_read_b64_tr_b16 a[84:85], v9 offset:36864
  ds_read_b64_tr_b16 a[86:87], v9 offset:37888
  v_mfma_f32_32x32x16_bf16 v[96:111], a[52:55], a[32:35], v[96:111]
  ds_read_b64_tr_b16 a[88:89], v8 offset:37376
  ds_read_b64_tr_b16 a[90:91], v8 offset:38400
  v_mfma_f32_32x32x16_bf16 v[112:127], a[52:55], a[36:39], v[112:127]
  ds_read_b64_tr_b16 a[92:93], v9 offset:37376
  ds_read_b64_tr_b16 a[94:95], v9 offset:38400
  v_mfma_f32_32x32x16_bf16 v[128:143], a[52:55], a[40:43], v[128:143]
  v_mfma_f32_32x32x16_bf16 v[144:159], a[52:55], a[44:47], v[144:159]
  v_mfma_f32_32x32x16_bf16 v[160:175], a[56:59], a[32:35], v[160:175]
  v_mfma_f32_32x32x16_bf16 v[176:191], a[56:59], a[36:39], v[176:191]
  v_mfma_f32_32x32x16_bf16 v[192:207], a[56:59], a[40:43], v[192:207]
  v_mfma_f32_32x32x16_bf16 v[208:223], a[56:59], a[44:47], v[208:223]
  v_mfma_f32_32x32x16_bf16 v[224:239], a[60:63], a[32:35], v[224:239]
  v_mfma_f32_32x32x16_bf16 v[240:255], a[60:63], a[36:39], v[240:255]
  v_mfma_f32_32x32x16_bf16 a[0:15], a[60:63], a[40:43], a[0:15]
  v_mfma_f32_32x32x16_bf16 a[16:31], a[60:63], a[44:47], a[16:31]
  s_waitcnt vmcnt(20) lgkmcnt(0)
  s_barrier
  v_mfma_f32_32x32x16_bf16 v[32:47], a[80:83], a[64:67], v[32:47]
  v_add_u32 v7, 65536, v5
  ds_read_b64_tr_b16 a[48:49], v8 offset:49152
  ds_read_b64_tr_b16 a[50:51], v8 offset:50176
  v_mfma_f32_32x32x16_bf16 v[48:63], a[80:83], a[68:71], v[48:63]
  ds_read_b128 a[32:35], v7 offset:0
  ds_read_b128 a[36:39], v7 offset:4096
  v_mfma_f32_32x32x16_bf16 v[64:79], a[80:83], a[72:75], v[64:79]
  ds_read_b128 a[40:43], v7 offset:8192
  ds_read_b128 a[44:47], v7 offset:12288
  v_mfma_f32_32x32x16_bf16 v[80:95], a[80:83], a[76:79], v[80:95]
  ds_read_b64_tr_b16 a[52:53], v9 offset:49152
  ds_read_b64_tr_b16 a[54:55], v9 offset:50176
  v_mfma_f32_32x32x16_bf16 v[96:111], a[84:87], a[64:67], v[96:111]
  ds_read_b64_tr_b16 a[56:57], v8 offset:49664
  ds_read_b64_tr_b16 a[58:59], v8 offset:50688
  v_mfma_f32_32x32x16_bf16 v[112:127], a[84:87], a[68:71], v[112:127]
  ds_read_b64_tr_b16 a[60:61], v9 offset:49664
  ds_read_b64_tr_b16 a[62:63], v9 offset:50688
  v_mfma_f32_32x32x16_bf16 v[128:143], a[84:87], a[72:75], v[128:143]
  s_add_u32 m0, s38, 36864
  s_nop 0
  buffer_load_dwordx4 v10, s[16:19], s52 offen lds
  v_mfma_f32_32x32x16_bf16 v[144:159], a[84:87], a[76:79], v[144:159]
  buffer_load_dwordx4 v11, s[16:19], s53 offen offset:1024 lds
  v_mfma_f32_32x32x16_bf16 v[160:175], a[88:91], a[64:67], v[160:175]
  buffer_load_dwordx4 v10, s[16:19], s54 offen offset:2048 lds
  v_mfma_f32_32x32x16_bf16 v[176:191], a[88:91], a[68:71], v[176:191]
  buffer_load_dwordx4 v11, s[16:19], s55 offen offset:3072 lds
  v_add_u32 v10, 128, v10
  v_add_u32 v11, 128, v11
  v_mfma_f32_32x32x16_bf16 v[192:207], a[88:91], a[72:75], v[192:207]
  v_mfma_f32_32x32x16_bf16 v[208:223], a[88:91], a[76:79], v[208:223]
  s_add_u32 m0, s39, 32768
  s_nop 0
  buffer_load_dwordx4 v12, s[12:15], 0 offen lds
  v_mfma_f32_32x32x16_bf16 v[224:239], a[92:95], a[64:67], v[224:239]
  buffer_load_dwordx4 v12, s[12:15], s45 offen offset:1024 lds
  v_mfma_f32_32x32x16_bf16 v[240:255], a[92:95], a[68:71], v[240:255]
  buffer_load_dwordx4 v12, s[12:15], s46 offen offset:2048 lds
  v_mfma_f32_32x32x16_bf16 a[0:15], a[92:95], a[72:75], a[0:15]
  buffer_load_dwordx4 v12, s[12:15], s47 offen offset:3072 lds
  v_add_u32 v12, 262144, v12
  s_mov_b32 s4, s74
  s_mov_b32 s5, s75
  s_mov_b32 s6, 0x510000
  s_mov_b32 s7, 0x20000
  s_lshl_b32 s33, s2, 2
  s_add_u32 s33, s33, s3
  s_mul_i32 s33, s33, 5184
  s_add_u32 s33, s33, 3456
  v_lshlrev_b32 v23, 7, v1
  s_mov_b32 exec_lo, 0x1ff
  s_mov_b32 exec_hi, 0x0
  buffer_load_dword v24, v23, s[4:7], s33 offen
  s_mov_b64 exec, -1
  v_mfma_f32_32x32x16_bf16 a[16:31], a[92:95], a[76:79], a[16:31]
  s_mov_b32 s4, s68
  s_mov_b32 s5, s69
  s_mov_b32 s6, 0x480000
  s_mov_b32 s7, 0x20000
  s_lshl_b32 s33, s2, 2
  s_add_u32 s33, s33, s3
  s_mul_i32 s33, s33, 4608
  s_add_u32 s33, s33, 1536
  v_lshlrev_b32 v23, 7, v1
  s_mov_b32 exec_lo, 0xfff
  s_mov_b32 exec_hi, 0x0
  buffer_load_dword v24, v23, s[4:7], s33 offen
  s_mov_b64 exec, -1
  s_waitcnt lgkmcnt(0)
  v_mfma_f32_32x32x16_bf16 v[32:47], a[48:51], a[32:35], v[32:47]
  v_add_u32 v7, 65536, v6
  ds_read_b64_tr_b16 a[80:81], v8 offset:53248
  ds_read_b64_tr_b16 a[82:83], v8 offset:54272
  v_mfma_f32_32x32x16_bf16 v[48:63], a[48:51], a[36:39], v[48:63]
  ds_read_b128 a[64:67], v7 offset:0
  ds_read_b128 a[68:71], v7 offset:4096
  v_mfma_f32_32x32x16_bf16 v[64:79], a[48:51], a[40:43], v[64:79]
  ds_read_b128 a[72:75], v7 offset:8192
  ds_read_b128 a[76:79], v7 offset:12288
  v_mfma_f32_32x32x16_bf16 v[80:95], a[48:51], a[44:47], v[80:95]
  ds_read_b64_tr_b16 a[84:85], v9 offset:53248
  ds_read_b64_tr_b16 a[86:87], v9 offset:54272
  v_mfma_f32_32x32x16_bf16 v[96:111], a[52:55], a[32:35], v[96:111]
  ds_read_b64_tr_b16 a[88:89], v8 offset:53760
  ds_read_b64_tr_b16 a[90:91], v8 offset:54784
  v_mfma_f32_32x32x16_bf16 v[112:127], a[52:55], a[36:39], v[112:127]
  ds_read_b64_tr_b16 a[92:93], v9 offset:53760
  ds_read_b64_tr_b16 a[94:95], v9 offset:54784
  v_mfma_f32_32x32x16_bf16 v[128:143], a[52:55], a[40:43], v[128:143]
  v_mfma_f32_32x32x16_bf16 v[144:159], a[52:55], a[44:47], v[144:159]
  v_mfma_f32_32x32x16_bf16 v[160:175], a[56:59], a[32:35], v[160:175]
  v_mfma_f32_32x32x16_bf16 v[176:191], a[56:59], a[36:39], v[176:191]
  v_mfma_f32_32x32x16_bf16 v[192:207], a[56:59], a[40:43], v[192:207]
  v_mfma_f32_32x32x16_bf16 v[208:223], a[56:59], a[44:47], v[208:223]
  v_mfma_f32_32x32x16_bf16 v[224:239], a[60:63], a[32:35], v[224:239]
  v_mfma_f32_32x32x16_bf16 v[240:255], a[60:63], a[36:39], v[240:255]
  v_mfma_f32_32x32x16_bf16 a[0:15], a[60:63], a[40:43], a[0:15]
  v_mfma_f32_32x32x16_bf16 a[16:31], a[60:63], a[44:47], a[16:31]
  s_waitcnt vmcnt(21) lgkmcnt(0)
  s_barrier
  v_mfma_f32_32x32x16_bf16 v[32:47], a[80:83], a[64:67], v[32:47]
  v_add_u32 v7, 0, v3
  ds_read_b64_tr_b16 a[48:49], v8 offset:0
  ds_read_b64_tr_b16 a[50:51], v8 offset:1024
  v_mfma_f32_32x32x16_bf16 v[48:63], a[80:83], a[68:71], v[48:63]
  ds_read_b128 a[32:35], v7 offset:0
  ds_read_b128 a[36:39], v7 offset:4096
  v_mfma_f32_32x32x16_bf16 v[64:79], a[80:83], a[72:75], v[64:79]
  ds_read_b128 a[40:43], v7 offset:8192
  ds_read_b128 a[44:47], v7 offset:12288
  v_mfma_f32_32x32x16_bf16 v[80:95], a[80:83], a[76:79], v[80:95]
  ds_read_b64_tr_b16 a[52:53], v9 offset:0
  ds_read_b64_tr_b16 a[54:55], v9 offset:1024
  v_mfma_f32_32x32x16_bf16 v[96:111], a[84:87], a[64:67], v[96:111]
  ds_read_b64_tr_b16 a[56:57], v8 offset:512
  ds_read_b64_tr_b16 a[58:59], v8 offset:1536
  v_mfma_f32_32x32x16_bf16 v[112:127], a[84:87], a[68:71], v[112:127]
  ds_read_b64_tr_b16 a[60:61], v9 offset:512
  ds_read_b64_tr_b16 a[62:63], v9 offset:1536
  v_mfma_f32_32x32x16_bf16 v[128:143], a[84:87], a[72:75], v[128:143]
  s_add_u32 m0, s39, 49152
  s_nop 0
  buffer_load_dwordx4 v12, s[12:15], 0 offen lds
  v_mfma_f32_32x32x16_bf16 v[144:159], a[84:87], a[76:79], v[144:159]
  v_mfma_f32_32x32x16_bf16 v[160:175], a[88:91], a[64:67], v[160:175]
  buffer_load_dwordx4 v12, s[12:15], s45 offen offset:1024 lds
  v_mfma_f32_32x32x16_bf16 v[176:191], a[88:91], a[68:71], v[176:191]
  v_mfma_f32_32x32x16_bf16 v[192:207], a[88:91], a[72:75], v[192:207]
  v_mfma_f32_32x32x16_bf16 v[208:223], a[88:91], a[76:79], v[208:223]
  buffer_load_dwordx4 v12, s[12:15], s46 offen offset:2048 lds
  v_mfma_f32_32x32x16_bf16 v[224:239], a[92:95], a[64:67], v[224:239]
  v_mfma_f32_32x32x16_bf16 v[240:255], a[92:95], a[68:71], v[240:255]
  buffer_load_dwordx4 v12, s[12:15], s47 offen offset:3072 lds
  v_add_u32 v12, 262144, v12
  v_mfma_f32_32x32x16_bf16 a[0:15], a[92:95], a[72:75], a[0:15]
  s_mov_b32 s4, s76
  s_mov_b32 s5, s77
  s_mov_b32 s6, 0x510000
  s_mov_b32 s7, 0x20000
  s_lshl_b32 s33, s2, 2
  s_add_u32 s33, s33, s3
  s_mul_i32 s33, s33, 5184
  s_add_u32 s33, s33, 3456
  v_lshlrev_b32 v23, 7, v1
  s_mov_b32 exec_lo, 0x1ff
  s_mov_b32 exec_hi, 0x0
  buffer_load_dword v24, v23, s[4:7], s33 offen
  s_mov_b64 exec, -1
  v_mfma_f32_32x32x16_bf16 a[16:31], a[92:95], a[76:79], a[16:31]
  s_waitcnt lgkmcnt(0)
  v_mfma_f32_32x32x16_bf16 v[32:47], a[48:51], a[32:35], v[32:47]
  v_add_u32 v7, 0, v4
  ds_read_b64_tr_b16 a[80:81], v8 offset:4096
  ds_read_b64_tr_b16 a[82:83], v8 offset:5120
  v_mfma_f32_32x32x16_bf16 v[48:63], a[48:51], a[36:39], v[48:63]
  ds_read_b128 a[64:67], v7 offset:0
  ds_read_b128 a[68:71], v7 offset:4096
  v_mfma_f32_32x32x16_bf16 v[64:79], a[48:51], a[40:43], v[64:79]
  ds_read_b128 a[72:75], v7 offset:8192
  ds_read_b128 a[76:79], v7 offset:12288
  v_mfma_f32_32x32x16_bf16 v[80:95], a[48:51], a[44:47], v[80:95]
  ds_read_b64_tr_b16 a[84:85], v9 offset:4096
  ds_read_b64_tr_b16 a[86:87], v9 offset:5120
  v_mfma_f32_32x32x16_bf16 v[96:111], a[52:55], a[32:35], v[96:111]
  ds_read_b64_tr_b16 a[88:89], v8 offset:4608
  ds_read_b64_tr_b16 a[90:91], v8 offset:5632
  v_mfma_f32_32x32x16_bf16 v[112:127], a[52:55], a[36:39], v[112:127]
  ds_read_b64_tr_b16 a[92:93], v9 offset:4608
  ds_read_b64_tr_b16 a[94:95], v9 offset:5632
  v_mfma_f32_32x32x16_bf16 v[128:143], a[52:55], a[40:43], v[128:143]
  v_mfma_f32_32x32x16_bf16 v[144:159], a[52:55], a[44:47], v[144:159]
  v_mfma_f32_32x32x16_bf16 v[160:175], a[56:59], a[32:35], v[160:175]
  v_mfma_f32_32x32x16_bf16 v[176:191], a[56:59], a[36:39], v[176:191]
  v_mfma_f32_32x32x16_bf16 v[192:207], a[56:59], a[40:43], v[192:207]
  v_mfma_f32_32x32x16_bf16 v[208:223], a[56:59], a[44:47], v[208:223]
  v_mfma_f32_32x32x16_bf16 v[224:239], a[60:63], a[32:35], v[224:239]
  v_mfma_f32_32x32x16_bf16 v[240:255], a[60:63], a[36:39], v[240:255]
  v_mfma_f32_32x32x16_bf16 a[0:15], a[60:63], a[40:43], a[0:15]
  v_mfma_f32_32x32x16_bf16 a[16:31], a[60:63], a[44:47], a[16:31]
  s_waitcnt vmcnt(16) lgkmcnt(0)
  s_barrier
  s_mov_b32 s6, -1
  s_mov_b32 s7, -1
  s_mov_b32 s5, 100000
LFL1:
  v_xor_b32 v16, s88, v16
  v_xor_b32 v17, s88, v17
  v_or_b32 v16, v16, v17
  v_xor_b32 v18, s88, v18
  v_or_b32 v16, v16, v18
  v_xor_b32 v19, s88, v19
  v_or_b32 v16, v16, v19
  v_cmp_ne_u32 vcc, 0, v16
  s_nop 1
  s_and_b64 vcc, vcc, s[6:7]
  s_cbranch_vccz LFL1_ok
  s_sub_u32 s5, s5, 1
  s_cmp_eq_u32 s5, 0
  s_cbranch_scc1 LFL1_ok
  s_sleep 1
  s_mov_b32 s4, 0
  buffer_load_dwordx4 v[16:19], v2, s[8:11], s4 offen sc1
  s_waitcnt vmcnt(0)
  s_branch LFL1
LFL1_ok:
  v_mfma_f32_32x32x16_bf16 v[32:47], a[80:83], a[64:67], v[32:47]
  v_add_u32 v7, 0, v5
  ds_read_b64_tr_b16 a[48:49], v8 offset:16384
  ds_read_b64_tr_b16 a[50:51], v8 offset:17408
  v_mfma_f32_32x32x16_bf16 v[48:63], a[80:83], a[68:71], v[48:63]
  ds_read_b128 a[32:35], v7 offset:0
  ds_read_b128 a[36:39], v7 offset:4096
  v_mfma_f32_32x32x16_bf16 v[64:79], a[80:83], a[72:75], v[64:79]
  ds_read_b128 a[40:43], v7 offset:8192
  ds_read_b128 a[44:47], v7 offset:12288
  v_mfma_f32_32x32x16_bf16 v[80:95], a[80:83], a[76:79], v[80:95]
  ds_read_b64_tr_b16 a[52:53], v9 offset:16384
  ds_read_b64_tr_b16 a[54:55], v9 offset:17408
  v_mfma_f32_32x32x16_bf16 v[96:111], a[84:87], a[64:67], v[96:111]
  ds_read_b64_tr_b16 a[56:57], v8 offset:16896
  ds_read_b64_tr_b16 a[58:59], v8 offset:17920
  v_mfma_f32_32x32x16_bf16 v[112:127], a[84:87], a[68:71], v[112:127]
  ds_read_b64_tr_b16 a[60:61], v9 offset:16896
  ds_read_b64_tr_b16 a[62:63], v9 offset:17920
  s_add_u32 m0, s43, 70144
  s_nop 0
  buffer_load_dwordx4 v25, s[56:59], 0 offen sc1 lds
  v_mfma_f32_32x32x16_bf16 v[128:143], a[84:87], a[72:75], v[128:143]
  v_mfma_f32_32x32x16_bf16 v[144:159], a[84:87], a[76:79], v[144:159]
  buffer_load_dwordx4 v25, s[56:59], 0 offen offset:1024 sc1 lds
  v_mfma_f32_32x32x16_bf16 v[160:175], a[88:91], a[64:67], v[160:175]
  v_mfma_f32_32x32x16_bf16 v[176:191], a[88:91], a[68:71], v[176:191]
  v_mfma_f32_32x32x16_bf16 v[192:207], a[88:91], a[72:75], v[192:207]
  buffer_load_dwordx4 v25, s[56:59], s41 offen offset:2048 sc1 lds
  v_mfma_f32_32x32x16_bf16 v[208:223], a[88:91], a[76:79], v[208:223]
  v_mfma_f32_32x32x16_bf16 v[224:239], a[92:95], a[64:67], v[224:239]
  v_mfma_f32_32x32x16_bf16 v[240:255], a[92:95], a[68:71], v[240:255]
  buffer_load_dwordx4 v25, s[56:59], s41 offen offset:3072 sc1 lds
  v_add_u32 v25, 2048, v25
  v_mfma_f32_32x32x16_bf16 a[0:15], a[92:95], a[72:75], a[0:15]
  s_mov_b32 s4, s74
  s_mov_b32 s5, s75
  s_mov_b32 s6, 0x510000
  s_mov_b32 s7, 0x20000
  s_lshl_b32 s33, s2, 2
  s_add_u32 s33, s33, s3
  s_mul_i32 s33, s33, 5184
  s_add_u32 s33, s33, 4608
  v_lshlrev_b32 v23, 7, v1
  s_mov_b32 exec_lo, 0x1f
  s_mov_b32 exec_hi, 0x0
  buffer_load_dword v24, v23, s[4:7], s33 offen
  s_mov_b64 exec, -1
  v_mfma_f32_32x32x16_bf16 a[16:31], a[92:95], a[76:79], a[16:31]
  s_waitcnt lgkmcnt(0)
  v_mfma_f32_32x32x16_bf16 v[32:47], a[48:51], a[32:35], v[32:47]
  v_add_u32 v7, 0, v6
  ds_read_b64_tr_b16 a[80:81], v8 offset:20480
  ds_read_b64_tr_b16 a[82:83], v8 offset:21504
  v_mfma_f32_32x32x16_bf16 v[48:63], a[48:51], a[36:39], v[48:63]
  ds_read_b128 a[64:67], v7 offset:0
  ds_read_b128 a[68:71], v7 offset:4096
  v_mfma_f32_32x32x16_bf16 v[64:79], a[48:51], a[40:43], v[64:79]
  ds_read_b128 a[72:75], v7 offset:8192
  ds_read_b128 a[76:79], v7 offset:12288
  v_mfma_f32_32x32x16_bf16 v[80:95], a[48:51], a[44:47], v[80:95]
  ds_read_b64_tr_b16 a[84:85], v9 offset:20480
  ds_read_b64_tr_b16 a[86:87], v9 offset:21504
  v_mfma_f32_32x32x16_bf16 v[96:111], a[52:55], a[32:35], v[96:111]
  ds_read_b64_tr_b16 a[88:89], v8 offset:20992
  ds_read_b64_tr_b16 a[90:91], v8 offset:22016
  v_mfma_f32_32x32x16_bf16 v[112:127], a[52:55], a[36:39], v[112:127]
  ds_read_b64_tr_b16 a[92:93], v9 offset:20992
  ds_read_b64_tr_b16 a[94:95], v9 offset:22016
  v_mfma_f32_32x32x16_bf16 v[128:143], a[52:55], a[40:43], v[128:143]
  v_mfma_f32_32x32x16_bf16 v[144:159], a[52:55], a[44:47], v[144:159]
  v_mfma_f32_32x32x16_bf16 v[160:175], a[56:59], a[32:35], v[160:175]
  v_mfma_f32_32x32x16_bf16 v[176:191], a[56:59], a[36:39], v[176:191]
  v_mfma_f32_32x32x16_bf16 v[192:207], a[56:59], a[40:43], v[192:207]
  v_mfma_f32_32x32x16_bf16 v[208:223], a[56:59], a[44:47], v[208:223]
  v_mfma_f32_32x32x16_bf16 v[224:239], a[60:63], a[32:35], v[224:239]
  v_mfma_f32_32x32x16_bf16 v[240:255], a[60:63], a[36:39], v[240:255]
  v_mfma_f32_32x32x16_bf16 a[0:15], a[60:63], a[40:43], a[0:15]
  v_mfma_f32_32x32x16_bf16 a[16:31], a[60:63], a[44:47], a[16:31]
  s_waitcnt vmcnt(12) lgkmcnt(0)
  s_barrier
  v_mfma_f32_32x32x16_bf16 v[32:47], a[80:83], a[64:67], v[32:47]
  v_add_u32 v7, 32768, v3
  ds_read_b64_tr_b16 a[48:49], v8 offset:32768
  ds_read_b64_tr_b16 a[50:51], v8 offset:33792
  v_mfma_f32_32x32x16_bf16 v[48:63], a[80:83], a[68:71], v[48:63]
  ds_read_b128 a[32:35], v7 offset:0
  ds_read_b128 a[36:39], v7 offset:4096
  v_mfma_f32_32x32x16_bf16 v[64:79], a[80:83], a[72:75], v[64:79]
  ds_read_b128 a[40:43], v7 offset:8192
  ds_read_b128 a[44:47], v7 offset:12288
  v_mfma_f32_32x32x16_bf16 v[80:95], a[80:83], a[76:79], v[80:95]
  ds_read_b64_tr_b16 a[52:53], v9 offset:32768
  ds_read_b64_tr_b16 a[54:55], v9 offset:33792
  v_mfma_f32_32x32x16_bf16 v[96:111], a[84:87], a[64:67], v[96:111]
  ds_read_b64_tr_b16 a[56:57], v8 offset:33280
  ds_read_b64_tr_b16 a[58:59], v8 offset:34304
  v_mfma_f32_32x32x16_bf16 v[112:127], a[84:87], a[68:71], v[112:127]
  ds_read_b64_tr_b16 a[60:61], v9 offset:33280
  ds_read_b64_tr_b16 a[62:63], v9 offset:34304
  s_add_u32 m0, s44, 70144
  s_nop 0
  buffer_load_dwordx4 v26, s[24:27], 0 offen lds
  v_mfma_f32_32x32x16_bf16 v[128:143], a[84:87], a[72:75], v[128:143]
  v_mfma_f32_32x32x16_bf16 v[144:159], a[84:87], a[76:79], v[144:159]
  buffer_load_dwordx4 v26, s[24:27], s42 offen offset:1024 lds
  v_mfma_f32_32x32x16_bf16 v[160:175], a[88:91], a[64:67], v[160:175]
  v_mfma_f32_32x32x16_bf16 v[176:191], a[88:91], a[68:71], v[176:191]
  s_add_u32 m0, s48, 70144
  s_nop 0
  buffer_load_dwordx4 v26, s[28:31], 0 offen lds
  v_mfma_f32_32x32x16_bf16 v[192:207], a[88:91], a[72:75], v[192:207]
  v_mfma_f32_32x32x16_bf16 v[208:223], a[88:91], a[76:79], v[208:223]
  buffer_load_dwordx4 v26, s[28:31], s42 offen offset:1024 lds
  v_add_u32 v26, 294912, v26
  v_mfma_f32_32x32x16_bf16 v[224:239], a[92:95], a[64:67], v[224:239]
  v_mfma_f32_32x32x16_bf16 v[240:255], a[92:95], a[68:71], v[240:255]
  s_add_u32 m0, s66, 70144
  s_nop 0
  buffer_load_dwordx4 v27, s[60:63], 0 offen lds
  v_add_u32 v27, 294912, v27
  v_mfma_f32_32x32x16_bf16 a[0:15], a[92:95], a[72:75], a[0:15]
  s_mov_b32 s4, s76
  s_mov_b32 s5, s77
  s_mov_b32 s6, 0x510000
  s_mov_b32 s7, 0x20000
  s_lshl_b32 s33, s2, 2
  s_add_u32 s33, s33, s3
  s_mul_i32 s33, s33, 5184
  s_add_u32 s33, s33, 4608
  v_lshlrev_b32 v23, 7, v1
  s_mov_b32 exec_lo, 0x1f
  s_mov_b32 exec_hi, 0x0
  buffer_load_dword v24, v23, s[4:7], s33 offen
  s_mov_b64 exec, -1
  v_mfma_f32_32x32x16_bf16 a[16:31], a[92:95], a[76:79], a[16:31]
  s_waitcnt lgkmcnt(0)
  v_mfma_f32_32x32x16_bf16 v[32:47], a[48:51], a[32:35], v[32:47]
  v_add_u32 v7, 32768, v4
  ds_read_b64_tr_b16 a[80:81], v8 offset:36864
  ds_read_b64_tr_b16 a[82:83], v8 offset:37888
  v_mfma_f32_32x32x16_bf16 v[48:63], a[48:51], a[36:39], v[48:63]
  ds_read_b128 a[64:67], v7 offset:0
  ds_read_b128 a[68:71], v7 offset:4096
  v_mfma_f32_32x32x16_bf16 v[64:79], a[48:51], a[40:43], v[64:79]
  ds_read_b128 a[72:75], v7 offset:8192
  ds_read_b128 a[76:79], v7 offset:12288
  v_mfma_f32_32x32x16_bf16 v[80:95], a[48:51], a[44:47], v[80:95]
  ds_read_b64_tr_b16 a[84:85], v9 offset:36864
  ds_read_b64_tr_b16 a[86:87], v9 offset:37888
  v_mfma_f32_32x32x16_bf16 v[96:111], a[52:55], a[32:35], v[96:111]
  ds_read_b64_tr_b16 a[88:89], v8 offset:37376
  ds_read_b64_tr_b16 a[90:91], v8 offset:38400
  v_mfma_f32_32x32x16_bf16 v[112:127], a[52:55], a[36:39], v[112:127]
  ds_read_b64_tr_b16 a[92:93], v9 offset:37376
  ds_read_b64_tr_b16 a[94:95], v9 offset:38400
  v_mfma_f32_32x32x16_bf16 v[128:143], a[52:55], a[40:43], v[128:143]
  v_mfma_f32_32x32x16_bf16 v[144:159], a[52:55], a[44:47], v[144:159]
  v_mfma_f32_32x32x16_bf16 v[160:175], a[56:59], a[32:35], v[160:175]
  v_mfma_f32_32x32x16_bf16 v[176:191], a[56:59], a[36:39], v[176:191]
  v_mfma_f32_32x32x16_bf16 v[192:207], a[56:59], a[40:43], v[192:207]
  v_mfma_f32_32x32x16_bf16 v[208:223], a[56:59], a[44:47], v[208:223]
  v_mfma_f32_32x32x16_bf16 v[224:239], a[60:63], a[32:35], v[224:239]
  v_mfma_f32_32x32x16_bf16 v[240:255], a[60:63], a[36:39], v[240:255]
  v_mfma_f32_32x32x16_bf16 a[0:15], a[60:63], a[40:43], a[0:15]
  v_mfma_f32_32x32x16_bf16 a[16:31], a[60:63], a[44:47], a[16:31]
  s_waitcnt vmcnt(12) lgkmcnt(0)
  s_barrier
  v_mfma_f32_32x32x16_bf16 v[32:47], a[80:83], a[64:67], v[32:47]
  v_add_u32 v7, 32768, v5
  ds_read_b64_tr_b16 a[48:49], v8 offset:49152
  ds_read_b64_tr_b16 a[50:51], v8 offset:50176
  v_mfma_f32_32x32x16_bf16 v[48:63], a[80:83], a[68:71], v[48:63]
  ds_read_b128 a[32:35], v7 offset:0
  ds_read_b128 a[36:39], v7 offset:4096
  v_mfma_f32_32x32x16_bf16 v[64:79], a[80:83], a[72:75], v[64:79]
  ds_read_b128 a[40:43], v7 offset:8192
  ds_read_b128 a[44:47], v7 offset:12288
  v_mfma_f32_32x32x16_bf16 v[80:95], a[80:83], a[76:79], v[80:95]
  ds_read_b64_tr_b16 a[52:53], v9 offset:49152
  ds_read_b64_tr_b16 a[54:55], v9 offset:50176
  v_mfma_f32_32x32x16_bf16 v[96:111], a[84:87], a[64:67], v[96:111]
  ds_read_b64_tr_b16 a[56:57], v8 offset:49664
  ds_read_b64_tr_b16 a[58:59], v8 offset:50688
  v_mfma_f32_32x32x16_bf16 v[112:127], a[84:87], a[68:71], v[112:127]
  ds_read_b64_tr_b16 a[60:61], v9 offset:49664
  ds_read_b64_tr_b16 a[62:63], v9 offset:50688
  s_add_u32 m0, s43, 105216
  s_nop 0
  buffer_load_dwordx4 v25, s[56:59], 0 offen sc1 lds
  v_mfma_f32_32x32x16_bf16 v[128:143], a[84:87], a[72:75], v[128:143]
  buffer_load_dwordx4 v25, s[56:59], 0 offen offset:1024 sc1 lds
  v_mfma_f32_32x32x16_bf16 v[144:159], a[84:87], a[76:79], v[144:159]
  buffer_load_dwordx4 v25, s[56:59], s41 offen offset:2048 sc1 lds
  v_mfma_f32_32x32x16_bf16 v[160:175], a[88:91], a[64:67], v[160:175]
  buffer_load_dwordx4 v25, s[56:59], s41 offen offset:3072 sc1 lds
  v_add_u32 v25, 2048, v25
  v_mfma_f32_32x32x16_bf16 v[176:191], a[88:91], a[68:71], v[176:191]
  s_add_u32 m0, s44, 105216
  s_nop 0
  buffer_load_dwordx4 v26, s[24:27], 0 offen lds
  v_mfma_f32_32x32x16_bf16 v[192:207], a[88:91], a[72:75], v[192:207]
  v_mfma_f32_32x32x16_bf16 v[208:223], a[88:91], a[76:79], v[208:223]
  buffer_load_dwordx4 v26, s[24:27], s42 offen offset:1024 lds
  v_mfma_f32_32x32x16_bf16 v[224:239], a[92:95], a[64:67], v[224:239]
  s_add_u32 m0, s48, 105216
  s_nop 0
  buffer_load_dwordx4 v26, s[28:31], 0 offen lds
  v_mfma_f32_32x32x16_bf16 v[240:255], a[92:95], a[68:71], v[240:255]
  buffer_load_dwordx4 v26, s[28:31], s42 offen offset:1024 lds
  v_add_u32 v26, 294912, v26
  v_mfma_f32_32x32x16_bf16 a[0:15], a[92:95], a[72:75], a[0:15]
  s_add_u32 m0, s66, 105216
  s_nop 0
  buffer_load_dwordx4 v27, s[60:63], 0 offen lds
  v_add_u32 v27, 294912, v27
  v_mfma_f32_32x32x16_bf16 a[16:31], a[92:95], a[76:79], a[16:31]
  s_mov_b32 s4, s68
  s_mov_b32 s5, s69
  s_mov_b32 s6, 0x480000
  s_mov_b32 s7, 0x20000
  s_lshl_b32 s33, s2, 2
  s_add_u32 s33, s33, s3
  s_mul_i32 s33, s33, 4608
  s_add_u32 s33, s33, 3072
  v_lshlrev_b32 v23, 7, v1
  s_mov_b32 exec_lo, 0xfff
  s_mov_b32 exec_hi, 0x0
  buffer_load_dword v24, v23, s[4:7], s33 offen
  s_mov_b64 exec, -1
  s_waitcnt lgkmcnt(0)
  v_mfma_f32_32x32x16_bf16 v[32:47], a[48:51], a[32:35], v[32:47]
  v_add_u32 v7, 32768, v6
  ds_read_b64_tr_b16 a[80:81], v8 offset:53248
  ds_read_b64_tr_b16 a[82:83], v8 offset:54272
  v_mfma_f32_32x32x16_bf16 v[48:63], a[48:51], a[36:39], v[48:63]
  ds_read_b128 a[64:67], v7 offset:0
  ds_read_b128 a[68:71], v7 offset:4096
  v_mfma_f32_32x32x16_bf16 v[64:79], a[48:51], a[40:43], v[64:79]
  ds_read_b128 a[72:75], v7 offset:8192
  ds_read_b128 a[76:79], v7 offset:12288
  v_mfma_f32_32x32x16_bf16 v[80:95], a[48:51], a[44:47], v[80:95]
  ds_read_b64_tr_b16 a[84:85], v9 offset:53248
  ds_read_b64_tr_b16 a[86:87], v9 offset:54272
  v_mfma_f32_32x32x16_bf16 v[96:111], a[52:55], a[32:35], v[96:111]
  ds_read_b64_tr_b16 a[88:89], v8 offset:53760
  ds_read_b64_tr_b16 a[90:91], v8 offset:54784
  v_mfma_f32_32x32x16_bf16 v[112:127], a[52:55], a[36:39], v[112:127]
  ds_read_b64_tr_b16 a[92:93], v9 offset:53760
  ds_read_b64_tr_b16 a[94:95], v9 offset:54784
  v_mfma_f32_32x32x16_bf16 v[128:143], a[52:55], a[40:43], v[128:143]
  v_mfma_f32_32x32x16_bf16 v[144:159], a[52:55], a[44:47], v[144:159]
  v_mfma_f32_32x32x16_bf16 v[160:175], a[56:59], a[32:35], v[160:175]
  v_mfma_f32_32x32x16_bf16 v[176:191], a[56:59], a[36:39], v[176:191]
  v_mfma_f32_32x32x16_bf16 v[192:207], a[56:59], a[40:43], v[192:207]
  v_mfma_f32_32x32x16_bf16 v[208:223], a[56:59], a[44:47], v[208:223]
  v_mfma_f32_32x32x16_bf16 v[224:239], a[60:63], a[32:35], v[224:239]
  v_mfma_f32_32x32x16_bf16 v[240:255], a[60:63], a[36:39], v[240:255]
  v_mfma_f32_32x32x16_bf16 a[0:15], a[60:63], a[40:43], a[0:15]
  v_mfma_f32_32x32x16_bf16 a[16:31], a[60:63], a[44:47], a[16:31]
  s_waitcnt lgkmcnt(0)
  s_barrier
  v_mfma_f32_32x32x16_bf16 v[32:47], a[80:83], a[64:67], v[32:47]
  v_mfma_f32_32x32x16_bf16 v[48:63], a[80:83], a[68:71], v[48:63]
  v_mfma_f32_32x32x16_bf16 v[64:79], a[80:83], a[72:75], v[64:79]
  v_mfma_f32_32x32x16_bf16 v[80:95], a[80:83], a[76:79], v[80:95]
  v_mfma_f32_32x32x16_bf16 v[96:111], a[84:87], a[64:67], v[96:111]
  v_mfma_f32_32x32x16_bf16 v[112:127], a[84:87], a[68:71], v[112:127]
  s_add_u32 m0, s43, 0
  s_nop 0
  buffer_load_dwordx4 v25, s[56:59], 0 offen sc1 lds
  v_mfma_f32_32x32x16_bf16 v[128:143], a[84:87], a[72:75], v[128:143]
  buffer_load_dwordx4 v25, s[56:59], 0 offen offset:1024 sc1 lds
  v_mfma_f32_32x32x16_bf16 v[144:159], a[84:87], a[76:79], v[144:159]
  buffer_load_dwordx4 v25, s[56:59], s41 offen offset:2048 sc1 lds
  v_mfma_f32_32x32x16_bf16 v[160:175], a[88:91], a[64:67], v[160:175]
  buffer_load_dwordx4 v25, s[56:59], s41 offen offset:3072 sc1 lds
  v_add_u32 v25, 2048, v25
  v_mfma_f32_32x32x16_bf16 v[176:191], a[88:91], a[68:71], v[176:191]
  s_add_u32 m0, s44, 0
  s_nop 0
  buffer_load_dwordx4 v26, s[24:27], 0 offen lds
  v_mfma_f32_32x32x16_bf16 v[192:207], a[88:91], a[72:75], v[192:207]
  v_mfma_f32_32x32x16_bf16 v[208:223], a[88:91], a[76:79], v[208:223]
  buffer_load_dwordx4 v26, s[24:27], s42 offen offset:1024 lds
  v_mfma_f32_32x32x16_bf16 v[224:239], a[92:95], a[64:67], v[224:239]
  s_add_u32 m0, s48, 0
  s_nop 0
  buffer_load_dwordx4 v26, s[28:31], 0 offen lds
  v_mfma_f32_32x32x16_bf16 v[240:255], a[92:95], a[68:71], v[240:255]
  buffer_load_dwordx4 v26, s[28:31], s42 offen offset:1024 lds
  v_add_u32 v26, 294912, v26
  v_mfma_f32_32x32x16_bf16 a[0:15], a[92:95], a[72:75], a[0:15]
  s_add_u32 m0, s66, 0
  s_nop 0
  buffer_load_dwordx4 v27, s[60:63], 0 offen lds
  v_add_u32 v27, 294912, v27
  v_mfma_f32_32x32x16_bf16 a[16:31], a[92:95], a[76:79], a[16:31]
  s_nop 7
  s_branch L_kvE
L_kvV:
  v_add_u32 v7, 0, v3
  ds_read_b64_tr_b16 a[48:49], v8 offset:0
  ds_read_b64_tr_b16 a[50:51], v8 offset:1024
  ds_read_b128 a[32:35], v7 offset:0
  ds_read_b128 a[36:39], v7 offset:4096
  ds_read_b128 a[40:43], v7 offset:8192
  ds_read_b128 a[44:47], v7 offset:12288
  ds_read_b64_tr_b16 a[52:53], v9 offset:0
  ds_read_b64_tr_b16 a[54:55], v9 offset:1024
  ds_read_b64_tr_b16 a[56:57], v8 offset:512
  ds_read_b64_tr_b16 a[58:59], v8 offset:1536
  ds_read_b64_tr_b16 a[60:61], v9 offset:512
  ds_read_b64_tr_b16 a[62:63], v9 offset:1536
  s_waitcnt lgkmcnt(9)
  v_mfma_f32_32x32x16_bf16 v[32:47], a[32:35], a[48:51], 0
  v_add_u32 v7, 0, v4
  ds_read_b64_tr_b16 a[80:81], v8 offset:4096
  ds_read_b64_tr_b16 a[82:83], v8 offset:5120
  s_waitcnt lgkmcnt(10)
  v_mfma_f32_32x32x16_bf16 v[48:63], a[36:39], a[48:51], 0
  ds_read_b128 a[64:67], v7 offset:0
  ds_read_b128 a[68:71], v7 offset:4096
  s_add_u32 m0, s39, 32768
  s_nop 0
  buffer_load_dwordx4 v12, s[12:15], 0 offen lds
  s_waitcnt lgkmcnt(11)
  v_mfma_f32_32x32x16_bf16 v[64:79], a[40:43], a[48:51], 0
  ds_read_b128 a[72:75], v7 offset:8192
  ds_read_b128 a[76:79], v7 offset:12288
  s_waitcnt lgkmcnt(6)
  v_mfma_f32_32x32x16_bf16 v[80:95], a[44:47], a[48:51], 0
  ds_read_b64_tr_b16 a[84:85], v9 offset:4096
  ds_read_b64_tr_b16 a[86:87], v9 offset:5120
  v_mfma_f32_32x32x16_bf16 v[96:111], a[32:35], a[52:55], 0
  ds_read_b64_tr_b16 a[88:89], v8 offset:4608
  ds_read_b64_tr_b16 a[90:91], v8 offset:5632
  buffer_load_dwordx4 v12, s[12:15], s45 offen offset:1024 lds
  v_mfma_f32_32x32x16_bf16 v[112:127], a[36:39], a[52:55], 0
  ds_read_b64_tr_b16 a[92:93], v9 offset:4608
  ds_read_b64_tr_b16 a[94:95], v9 offset:5632
  v_mfma_f32_32x32x16_bf16 v[128:143], a[40:43], a[52:55], 0
  v_mfma_f32_32x32x16_bf16 v[144:159], a[44:47], a[52:55], 0
  v_mfma_f32_32x32x16_bf16 v[160:175], a[32:35], a[56:59], 0
  buffer_load_dwordx4 v12, s[12:15], s46 offen offset:2048 lds
  v_mfma_f32_32x32x16_bf16 v[176:191], a[36:39], a[56:59], 0
  v_mfma_f32_32x32x16_bf16 v[192:207], a[40:43], a[56:59], 0
  v_mfma_f32_32x32x16_bf16 v[208:223], a[44:47], a[56:59], 0
  v_mfma_f32_32x32x16_bf16 v[224:239], a[32:35], a[60:63], 0
  buffer_load_dwordx4 v12, s[12:15], s47 offen offset:3072 lds
  v_add_u32 v12, 262144, v12
  v_mfma_f32_32x32x16_bf16 v[240:255], a[36:39], a[60:63], 0
  v_mfma_f32_32x32x16_bf16 a[0:15], a[40:43], a[60:63], 0
  v_mfma_f32_32x32x16_bf16 a[16:31], a[44:47], a[60:63], 0
  s_waitcnt vmcnt(15) lgkmcnt(0)
  s_barrier
  v_mfma_f32_32x32x16_bf16 v[32:47], a[64:67], a[80:83], v[32:47]
  v_add_u32 v7, 0, v5
  ds_read_b64_tr_b16 a[48:49], v8 offset:16384
  ds_read_b64_tr_b16 a[50:51], v8 offset:17408
  v_mfma_f32_32x32x16_bf16 v[48:63], a[68:71], a[80:83], v[48:63]
  ds_read_b128 a[32:35], v7 offset:0
  ds_read_b128 a[36:39], v7 offset:4096
  s_add_u32 m0, s39, 49152
  s_nop 0
  buffer_load_dwordx4 v12, s[12:15], 0 offen lds
  buffer_load_dwordx4 v12, s[12:15], s45 offen offset:1024 lds
  v_mfma_f32_32x32x16_bf16 v[64:79], a[72:75], a[80:83], v[64:79]
  ds_read_b128 a[40:43], v7 offset:8192
  ds_read_b128 a[44:47], v7 offset:12288
  buffer_load_dwordx4 v12, s[12:15], s46 offen offset:2048 lds
  v_mfma_f32_32x32x16_bf16 v[80:95], a[76:79], a[80:83], v[80:95]
  ds_read_b64_tr_b16 a[52:53], v9 offset:16384
  ds_read_b64_tr_b16 a[54:55], v9 offset:17408
  buffer_load_dwordx4 v12, s[12:15], s47 offen offset:3072 lds
  v_add_u32 v12, 262144, v12
  v_mfma_f32_32x32x16_bf16 v[96:111], a[64:67], a[84:87], v[96:111]
  ds_read_b64_tr_b16 a[56:57], v8 offset:16896
  ds_read_b64_tr_b16 a[58:59], v8 offset:17920
  s_add_u32 m0, s38, 65536
  s_nop 0
  buffer_load_dwordx4 v10, s[16:19], 0 offen lds
  v_mfma_f32_32x32x16_bf16 v[112:127], a[68:71], a[84:87], v[112:127]
  ds_read_b64_tr_b16 a[60:61], v9 offset:16896
  ds_read_b64_tr_b16 a[62:63], v9 offset:17920
  buffer_load_dwordx4 v11, s[16:19], s49 offen offset:1024 lds
  v_mfma_f32_32x32x16_bf16 v[128:143], a[72:75], a[84:87], v[128:143]
  buffer_load_dwordx4 v10, s[16:19], s50 offen offset:2048 lds
  v_mfma_f32_32x32x16_bf16 v[144:159], a[76:79], a[84:87], v[144:159]
  buffer_load_dwordx4 v11, s[16:19], s51 offen offset:3072 lds
  v_mfma_f32_32x32x16_bf16 v[160:175], a[64:67], a[88:91], v[160:175]
  s_add_u32 m0, s38, 69632
  s_nop 0
  buffer_load_dwordx4 v10, s[16:19], s52 offen lds
  v_mfma_f32_32x32x16_bf16 v[176:191], a[68:71], a[88:91], v[176:191]
  buffer_load_dwordx4 v11, s[16:19], s53 offen offset:1024 lds
  v_mfma_f32_32x32x16_bf16 v[192:207], a[72:75], a[88:91], v[192:207]
  buffer_load_dwordx4 v10, s[16:19], s54 offen offset:2048 lds
  v_mfma_f32_32x32x16_bf16 v[208:223], a[76:79], a[88:91], v[208:223]
  buffer_load_dwordx4 v11, s[16:19], s55 offen offset:3072 lds
  v_add_u32 v10, 128, v10
  v_add_u32 v11, 128, v11
  v_mfma_f32_32x32x16_bf16 v[224:239], a[64:67], a[92:95], v[224:239]
  s_add_u32 m0, s39, 0
  s_nop 0
  buffer_load_dwordx4 v12, s[12:15], 0 offen lds
  v_mfma_f32_32x32x16_bf16 v[240:255], a[68:71], a[92:95], v[240:255]
  buffer_load_dwordx4 v12, s[12:15], s45 offen offset:1024 lds
  v_mfma_f32_32x32x16_bf16 a[0:15], a[72:75], a[92:95], a[0:15]
  buffer_load_dwordx4 v12, s[12:15], s46 offen offset:2048 lds
  v_mfma_f32_32x32x16_bf16 a[16:31], a[76:79], a[92:95], a[16:31]
  buffer_load_dwordx4 v12, s[12:15], s47 offen offset:3072 lds
  v_add_u32 v12, 262144, v12
  s_waitcnt lgkmcnt(0)
  v_mfma_f32_32x32x16_bf16 v[32:47], a[32:35], a[48:51], v[32:47]
  v_add_u32 v7, 0, v6
  ds_read_b64_tr_b16 a[80:81], v8 offset:20480
  ds_read_b64_tr_b16 a[82:83], v8 offset:21504
  v_mfma_f32_32x32x16_bf16 v[48:63], a[36:39], a[48:51], v[48:63]
  ds_read_b128 a[64:67], v7 offset:0
  ds_read_b128 a[68:71], v7 offset:4096
  v_mfma_f32_32x32x16_bf16 v[64:79], a[40:43], a[48:51], v[64:79]
  ds_read_b128 a[72:75], v7 offset:8192
  ds_read_b128 a[76:79], v7 offset:12288
  v_mfma_f32_32x32x16_bf16 v[80:95], a[44:47], a[48:51], v[80:95]
  ds_read_b64_tr_b16 a[84:85], v9 offset:20480
  ds_read_b64_tr_b16 a[86:87], v9 offset:21504
  v_mfma_f32_32x32x16_bf16 v[96:111], a[32:35], a[52:55], v[96:111]
  ds_read_b64_tr_b16 a[88:89], v8 offset:20992
  ds_read_b64_tr_b16 a[90:91], v8 offset:22016
  v_mfma_f32_32x32x16_bf16 v[112:127], a[36:39], a[52:55], v[112:127]
  ds_read_b64_tr_b16 a[92:93], v9 offset:20992
  ds_read_b64_tr_b16 a[94:95], v9 offset:22016
  v_mfma_f32_32x32x16_bf16 v[128:143], a[40:43], a[52:55], v[128:143]
  v_mfma_f32_32x32x16_bf16 v[144:159], a[44:47], a[52:55], v[144:159]
  v_mfma_f32_32x32x16_bf16 v[160:175], a[32:35], a[56:59], v[160:175]
  v_mfma_f32_32x32x16_bf16 v[176:191], a[36:39], a[56:59], v[176:191]
  v_mfma_f32_32x32x16_bf16 v[192:207], a[40:43], a[56:59], v[192:207]
  v_mfma_f32_32x32x16_bf16 v[208:223], a[44:47], a[56:59], v[208:223]
  v_mfma_f32_32x32x16_bf16 v[224:239], a[32:35], a[60:63], v[224:239]
  v_mfma_f32_32x32x16_bf16 v[240:255], a[36:39], a[60:63], v[240:255]
  v_mfma_f32_32x32x16_bf16 a[0:15], a[40:43], a[60:63], a[0:15]
  v_mfma_f32_32x32x16_bf16 a[16:31], a[44:47], a[60:63], a[16:31]
  s_waitcnt vmcnt(16) lgkmcnt(0)
  s_barrier
  v_mfma_f32_32x32x16_bf16 v[32:47], a[64:67], a[80:83], v[32:47]
  v_add_u32 v7, 32768, v3
  ds_read_b64_tr_b16 a[48:49], v8 offset:32768
  ds_read_b64_tr_b16 a[50:51], v8 offset:33792
  v_mfma_f32_32x32x16_bf16 v[48:63], a[68:71], a[80:83], v[48:63]
  ds_read_b128 a[32:35], v7 offset:0
  ds_read_b128 a[36:39], v7 offset:4096
  v_mfma_f32_32x32x16_bf16 v[64:79], a[72:75], a[80:83], v[64:79]
  ds_read_b128 a[40:43], v7 offset:8192
  ds_read_b128 a[44:47], v7 offset:12288
  v_mfma_f32_32x32x16_bf16 v[80:95], a[76:79], a[80:83], v[80:95]
  ds_read_b64_tr_b16 a[52:53], v9 offset:32768
  ds_read_b64_tr_b16 a[54:55], v9 offset:33792
  v_mfma_f32_32x32x16_bf16 v[96:111], a[64:67], a[84:87], v[96:111]
  ds_read_b64_tr_b16 a[56:57], v8 offset:33280
  ds_read_b64_tr_b16 a[58:59], v8 offset:34304
  v_mfma_f32_32x32x16_bf16 v[112:127], a[68:71], a[84:87], v[112:127]
  ds_read_b64_tr_b16 a[60:61], v9 offset:33280
  ds_read_b64_tr_b16 a[62:63], v9 offset:34304
  v_mfma_f32_32x32x16_bf16 v[128:143], a[72:75], a[84:87], v[128:143]
  s_add_u32 m0, s38, 0
  s_nop 0
  buffer_load_dwordx4 v10, s[16:19], 0 offen lds
  v_mfma_f32_32x32x16_bf16 v[144:159], a[76:79], a[84:87], v[144:159]
  buffer_load_dwordx4 v11, s[16:19], s49 offen offset:1024 lds
  v_mfma_f32_32x32x16_bf16 v[160:175], a[64:67], a[88:91], v[160:175]
  buffer_load_dwordx4 v10, s[16:19], s50 offen offset:2048 lds
  v_mfma_f32_32x32x16_bf16 v[176:191], a[68:71], a[88:91], v[176:191]
  buffer_load_dwordx4 v11, s[16:19], s51 offen offset:3072 lds
  v_mfma_f32_32x32x16_bf16 v[192:207], a[72:75], a[88:91], v[192:207]
  v_mfma_f32_32x32x16_bf16 v[208:223], a[76:79], a[88:91], v[208:223]
  s_add_u32 m0, s39, 16384
  s_nop 0
  buffer_load_dwordx4 v12, s[12:15], 0 offen lds
  v_mfma_f32_32x32x16_bf16 v[224:239], a[64:67], a[92:95], v[224:239]
  buffer_load_dwordx4 v12, s[12:15], s45 offen offset:1024 lds
  v_mfma_f32_32x32x16_bf16 v[240:255], a[68:71], a[92:95], v[240:255]
  buffer_load_dwordx4 v12, s[12:15], s46 offen offset:2048 lds
  v_mfma_f32_32x32x16_bf16 a[0:15], a[72:75], a[92:95], a[0:15]
  buffer_load_dwordx4 v12, s[12:15], s47 offen offset:3072 lds
  v_add_u32 v12, 262144, v12
  v_mfma_f32_32x32x16_bf16 a[16:31], a[76:79], a[92:95], a[16:31]
  s_waitcnt lgkmcnt(0)
  v_mfma_f32_32x32x16_bf16 v[32:47], a[32:35], a[48:51], v[32:47]
  v_add_u32 v7, 32768, v4
  ds_read_b64_tr_b16 a[80:81], v8 offset:36864
  ds_read_b64_tr_b16 a[82:83], v8 offset:37888
  v_mfma_f32_32x32x16_bf16 v[48:63], a[36:39], a[48:51], v[48:63]
  ds_read_b128 a[64:67], v7 offset:0
  ds_read_b128 a[68:71], v7 offset:4096
  v_mfma_f32_32x32x16_bf16 v[64:79], a[40:43], a[48:51], v[64:79]
  ds_read_b128 a[72:75], v7 offset:8192
  ds_read_b128 a[76:79], v7 offset:12288
  v_mfma_f32_32x32x16_bf16 v[80:95], a[44:47], a[48:51], v[80:95]
  ds_read_b64_tr_b16 a[84:85], v9 offset:36864
  ds_read_b64_tr_b16 a[86:87], v9 offset:37888
  v_mfma_f32_32x32x16_bf16 v[96:111], a[32:35], a[52:55], v[96:111]
  ds_read_b64_tr_b16 a[88:89], v8 offset:37376
  ds_read_b64_tr_b16 a[90:91], v8 offset:38400
  v_mfma_f32_32x32x16_bf16 v[112:127], a[36:39], a[52:55], v[112:127]
  ds_read_b64_tr_b16 a[92:93], v9 offset:37376
  ds_read_b64_tr_b16 a[94:95], v9 offset:38400
  v_mfma_f32_32x32x16_bf16 v[128:143], a[40:43], a[52:55], v[128:143]
  v_mfma_f32_32x32x16_bf16 v[144:159], a[44:47], a[52:55], v[144:159]
  v_mfma_f32_32x32x16_bf16 v[160:175], a[32:35], a[56:59], v[160:175]
  v_mfma_f32_32x32x16_bf16 v[176:191], a[36:39], a[56:59], v[176:191]
  v_mfma_f32_32x32x16_bf16 v[192:207], a[40:43], a[56:59], v[192:207]
  v_mfma_f32_32x32x16_bf16 v[208:223], a[44:47], a[56:59], v[208:223]
  v_mfma_f32_32x32x16_bf16 v[224:239], a[32:35], a[60:63], v[224:239]
  v_mfma_f32_32x32x16_bf16 v[240:255], a[36:39], a[60:63], v[240:255]
  v_mfma_f32_32x32x16_bf16 a[0:15], a[40:43], a[60:63], a[0:15]
  v_mfma_f32_32x32x16_bf16 a[16:31], a[44:47], a[60:63], a[16:31]
  s_waitcnt vmcnt(20) lgkmcnt(0)
  s_barrier
  v_mfma_f32_32x32x16_bf16 v[32:47], a[64:67], a[80:83], v[32:47]
  v_add_u32 v7, 32768, v5
  ds_read_b64_tr_b16 a[48:49], v8 offset:49152
  ds_read_b64_tr_b16 a[50:51], v8 offset:50176
  v_mfma_f32_32x32x16_bf16 v[48:63], a[68:71], a[80:83], v[48:63]
  ds_read_b128 a[32:35], v7 offset:0
  ds_read_b128 a[36:39], v7 offset:4096
  v_mfma_f32_32x32x16_bf16 v[64:79], a[72:75], a[80:83], v[64:79]
  ds_read_b128 a[40:43], v7 offset:8192
  ds_read_b128 a[44:47], v7 offset:12288
  v_mfma_f32_32x32x16_bf16 v[80:95], a[76:79], a[80:83], v[80:95]
  ds_read_b64_tr_b16 a[52:53], v9 offset:49152
  ds_read_b64_tr_b16 a[54:55], v9 offset:50176
  v_mfma_f32_32x32x16_bf16 v[96:111], a[64:67], a[84:87], v[96:111]
  ds_read_b64_tr_b16 a[56:57], v8 offset:49664
  ds_read_b64_tr_b16 a[58:59], v8 offset:50688
  v_mfma_f32_32x32x16_bf16 v[112:127], a[68:71], a[84:87], v[112:127]
  ds_read_b64_tr_b16 a[60:61], v9 offset:49664
  ds_read_b64_tr_b16 a[62:63], v9 offset:50688
  v_mfma_f32_32x32x16_bf16 v[128:143], a[72:75], a[84:87], v[128:143]
  s_add_u32 m0, s38, 4096
  s_nop 0
  buffer_load_dwordx4 v10, s[16:19], s52 offen lds
  v_mfma_f32_32x32x16_bf16 v[144:159], a[76:79], a[84:87], v[144:159]
  buffer_load_dwordx4 v11, s[16:19], s53 offen offset:1024 lds
  v_mfma_f32_32x32x16_bf16 v[160:175], a[64:67], a[88:91], v[160:175]
  buffer_load_dwordx4 v10, s[16:19], s54 offen offset:2048 lds
  v_mfma_f32_32x32x16_bf16 v[176:191], a[68:71], a[88:91], v[176:191]
  buffer_load_dwordx4 v11, s[16:19], s55 offen offset:3072 lds
  v_add_u32 v10, 128, v10
  v_add_u32 v11, 128, v11
  v_mfma_f32_32x32x16_bf16 v[192:207], a[72:75], a[88:91], v[192:207]
  v_mfma_f32_32x32x16_bf16 v[208:223], a[76:79], a[88:91], v[208:223]
  s_add_u32 m0, s39, 32768
  s_nop 0
  buffer_load_dwordx4 v12, s[12:15], 0 offen lds
  v_mfma_f32_32x32x16_bf16 v[224:239], a[64:67], a[92:95], v[224:239]
  buffer_load_dwordx4 v12, s[12:15], s45 offen offset:1024 lds
  v_mfma_f32_32x32x16_bf16 v[240:255], a[68:71], a[92:95], v[240:255]
  buffer_load_dwordx4 v12, s[12:15], s46 offen offset:2048 lds
  v_mfma_f32_32x32x16_bf16 a[0:15], a[72:75], a[92:95], a[0:15]
  buffer_load_dwordx4 v12, s[12:15], s47 offen offset:3072 lds
  v_add_u32 v12, 262144, v12
  v_mfma_f32_32x32x16_bf16 a[16:31], a[76:79], a[92:95], a[16:31]
  s_waitcnt lgkmcnt(0)
  v_mfma_f32_32x32x16_bf16 v[32:47], a[32:35], a[48:51], v[32:47]
  v_add_u32 v7, 32768, v6
  ds_read_b64_tr_b16 a[80:81], v8 offset:53248
  ds_read_b64_tr_b16 a[82:83], v8 offset:54272
  v_mfma_f32_32x32x16_bf16 v[48:63], a[36:39], a[48:51], v[48:63]
  ds_read_b128 a[64:67], v7 offset:0
  ds_read_b128 a[68:71], v7 offset:4096
  v_mfma_f32_32x32x16_bf16 v[64:79], a[40:43], a[48:51], v[64:79]
  ds_read_b128 a[72:75], v7 offset:8192
  ds_read_b128 a[76:79], v7 offset:12288
  v_mfma_f32_32x32x16_bf16 v[80:95], a[44:47], a[48:51], v[80:95]
  ds_read_b64_tr_b16 a[84:85], v9 offset:53248
  ds_read_b64_tr_b16 a[86:87], v9 offset:54272
  v_mfma_f32_32x32x16_bf16 v[96:111], a[32:35], a[52:55], v[96:111]
  ds_read_b64_tr_b16 a[88:89], v8 offset:53760
  ds_read_b64_tr_b16 a[90:91], v8 offset:54784
  v_mfma_f32_32x32x16_bf16 v[112:127], a[36:39], a[52:55], v[112:127]
  ds_read_b64_tr_b16 a[92:93], v9 offset:53760
  ds_read_b64_tr_b16 a[94:95], v9 offset:54784
  v_mfma_f32_32x32x16_bf16 v[128:143], a[40:43], a[52:55], v[128:143]
  v_mfma_f32_32x32x16_bf16 v[144:159], a[44:47], a[52:55], v[144:159]
  v_mfma_f32_32x32x16_bf16 v[160:175], a[32:35], a[56:59], v[160:175]
  v_mfma_f32_32x32x16_bf16 v[176:191], a[36:39], a[56:59], v[176:191]
  v_mfma_f32_32x32x16_bf16 v[192:207], a[40:43], a[56:59], v[192:207]
  v_mfma_f32_32x32x16_bf16 v[208:223], a[44:47], a[56:59], v[208:223]
  v_mfma_f32_32x32x16_bf16 v[224:239], a[32:35], a[60:63], v[224:239]
  v_mfma_f32_32x32x16_bf16 v[240:255], a[36:39], a[60:63], v[240:255]
  v_mfma_f32_32x32x16_bf16 a[0:15], a[40:43], a[60:63], a[0:15]
  v_mfma_f32_32x32x16_bf16 a[16:31], a[44:47], a[60:63], a[16:31]
  s_waitcnt vmcnt(16) lgkmcnt(0)
  s_barrier
  v_mfma_f32_32x32x16_bf16 v[32:47], a[64:67], a[80:83], v[32:47]
  v_add_u32 v7, 65536, v3
  ds_read_b64_tr_b16 a[48:49], v8 offset:0
  ds_read_b64_tr_b16 a[50:51], v8 offset:1024
  v_mfma_f32_32x32x16_bf16 v[48:63], a[68:71], a[80:83], v[48:63]
  ds_read_b128 a[32:35], v7 offset:0
  ds_read_b128 a[36:39], v7 offset:4096
  v_mfma_f32_32x32x16_bf16 v[64:79], a[72:75], a[80:83], v[64:79]
  ds_read_b128 a[40:43], v7 offset:8192
  ds_read_b128 a[44:47], v7 offset:12288
  s_cmp_lg_u32 s3, 0
  s_cbranch_scc1 L_ln0
  v_mov_b32 v14, s88
  v_mov_b32 v15, 0
  s_lshl_b32 s4, s2, 2
  v_readfirstlane_b32 s5, v22
  s_mov_b64 exec, 1
  buffer_store_dword v14, v15, s[8:11], s4 offen sc1
  s_cmp_lg_u32 s5, 255
  s_cbranch_scc1 L_ln0x
  s_mov_b32 s4, 32768
  buffer_store_dword v14, v15, s[8:11], s4 offen sc1
L_ln0x:
  s_mov_b64 exec, -1
L_ln0:
  v_mfma_f32_32x32x16_bf16 v[80:95], a[76:79], a[80:83], v[80:95]
  ds_read_b64_tr_b16 a[52:53], v9 offset:0
  ds_read_b64_tr_b16 a[54:55], v9 offset:1024
  v_mfma_f32_32x32x16_bf16 v[96:111], a[64:67], a[84:87], v[96:111]
  ds_read_b64_tr_b16 a[56:57], v8 offset:512
  ds_read_b64_tr_b16 a[58:59], v8 offset:1536
  v_mfma_f32_32x32x16_bf16 v[112:127], a[68:71], a[84:87], v[112:127]
  ds_read_b64_tr_b16 a[60:61], v9 offset:512
  ds_read_b64_tr_b16 a[62:63], v9 offset:1536
  v_mfma_f32_32x32x16_bf16 v[128:143], a[72:75], a[84:87], v[128:143]
  s_add_u32 m0, s38, 32768
  s_nop 0
  buffer_load_dwordx4 v10, s[16:19], 0 offen lds
  v_mfma_f32_32x32x16_bf16 v[144:159], a[76:79], a[84:87], v[144:159]
  buffer_load_dwordx4 v11, s[16:19], s49 offen offset:1024 lds
  v_mfma_f32_32x32x16_bf16 v[160:175], a[64:67], a[88:91], v[160:175]
  buffer_load_dwordx4 v10, s[16:19], s50 offen offset:2048 lds
  v_mfma_f32_32x32x16_bf16 v[176:191], a[68:71], a[88:91], v[176:191]
  buffer_load_dwordx4 v11, s[16:19], s51 offen offset:3072 lds
  v_mfma_f32_32x32x16_bf16 v[192:207], a[72:75], a[88:91], v[192:207]
  v_mfma_f32_32x32x16_bf16 v[208:223], a[76:79], a[88:91], v[208:223]
  s_add_u32 m0, s39, 49152
  s_nop 0
  buffer_load_dwordx4 v12, s[12:15], 0 offen lds
  v_mfma_f32_32x32x16_bf16 v[224:239], a[64:67], a[92:95], v[224:239]
  buffer_load_dwordx4 v12, s[12:15], s45 offen offset:1024 lds
  v_mfma_f32_32x32x16_bf16 v[240:255], a[68:71], a[92:95], v[240:255]
  buffer_load_dwordx4 v12, s[12:15], s46 offen offset:2048 lds
  v_mfma_f32_32x32x16_bf16 a[0:15], a[72:75], a[92:95], a[0:15]
  buffer_load_dwordx4 v12, s[12:15], s47 offen offset:3072 lds
  v_add_u32 v12, 262144, v12
  v_mfma_f32_32x32x16_bf16 a[16:31], a[76:79], a[92:95], a[16:31]
  s_waitcnt lgkmcnt(0)
  v_mfma_f32_32x32x16_bf16 v[32:47], a[32:35], a[48:51], v[32:47]
  v_add_u32 v7, 65536, v4
  ds_read_b64_tr_b16 a[80:81], v8 offset:4096
  ds_read_b64_tr_b16 a[82:83], v8 offset:5120
  v_mfma_f32_32x32x16_bf16 v[48:63], a[36:39], a[48:51], v[48:63]
  ds_read_b128 a[64:67], v7 offset:0
  ds_read_b128 a[68:71], v7 offset:4096
  v_mfma_f32_32x32x16_bf16 v[64:79], a[40:43], a[48:51], v[64:79]
  ds_read_b128 a[72:75], v7 offset:8192
  ds_read_b128 a[76:79], v7 offset:12288
  v_mfma_f32_32x32x16_bf16 v[80:95], a[44:47], a[48:51], v[80:95]
  ds_read_b64_tr_b16 a[84:85], v9 offset:4096
  ds_read_b64_tr_b16 a[86:87], v9 offset:5120
  v_mfma_f32_32x32x16_bf16 v[96:111], a[32:35], a[52:55], v[96:111]
  ds_read_b64_tr_b16 a[88:89], v8 offset:4608
  ds_read_b64_tr_b16 a[90:91], v8 offset:5632
  v_mfma_f32_32x32x16_bf16 v[112:127], a[36:39], a[52:55], v[112:127]
  ds_read_b64_tr_b16 a[92:93], v9 offset:4608
  ds_read_b64_tr_b16 a[94:95], v9 offset:5632
  v_mfma_f32_32x32x16_bf16 v[128:143], a[40:43], a[52:55], v[128:143]
  v_mfma_f32_32x32x16_bf16 v[144:159], a[44:47], a[52:55], v[144:159]
  v_mfma_f32_32x32x16_bf16 v[160:175], a[32:35], a[56:59], v[160:175]
  v_mfma_f32_32x32x16_bf16 v[176:191], a[36:39], a[56:59], v[176:191]
  v_mfma_f32_32x32x16_bf16 v[192:207], a[40:43], a[56:59], v[192:207]
  v_mfma_f32_32x32x16_bf16 v[208:223], a[44:47], a[56:59], v[208:223]
  v_mfma_f32_32x32x16_bf16 v[224:239], a[32:35], a[60:63], v[224:239]
  v_mfma_f32_32x32x16_bf16 v[240:255], a[36:39], a[60:63], v[240:255]
  v_mfma_f32_32x32x16_bf16 a[0:15], a[40:43], a[60:63], a[0:15]
  v_mfma_f32_32x32x16_bf16 a[16:31], a[44:47], a[60:63], a[16:31]
  s_waitcnt vmcnt(16) lgkmcnt(0)
  s_barrier
  v_mfma_f32_32x32x16_bf16 v[32:47], a[64:67], a[80:83], v[32:47]
  v_add_u32 v7, 65536, v5
  ds_read_b64_tr_b16 a[48:49], v8 offset:16384
  ds_read_b64_tr_b16 a[50:51], v8 offset:17408
  v_mfma_f32_32x32x16_bf16 v[48:63], a[68:71], a[80:83], v[48:63]
  ds_read_b128 a[32:35], v7 offset:0
  ds_read_b128 a[36:39], v7 offset:4096
  v_mfma_f32_32x32x16_bf16 v[64:79], a[72:75], a[80:83], v[64:79]
  ds_read_b128 a[40:43], v7 offset:8192
  ds_read_b128 a[44:47], v7 offset:12288
  v_mfma_f32_32x32x16_bf16 v[80:95], a[76:79], a[80:83], v[80:95]
  ds_read_b64_tr_b16 a[52:53], v9 offset:16384
  ds_read_b64_tr_b16 a[54:55], v9 offset:17408
  v_mfma_f32_32x32x16_bf16 v[96:111], a[64:67], a[84:87], v[96:111]
  ds_read_b64_tr_b16 a[56:57], v8 offset:16896
  ds_read_b64_tr_b16 a[58:59], v8 offset:17920
  v_mfma_f32_32x32x16_bf16 v[112:127], a[68:71], a[84:87], v[112:127]
  ds_read_b64_tr_b16 a[60:61], v9 offset:16896
  ds_read_b64_tr_b16 a[62:63], v9 offset:17920
  v_mfma_f32_32x32x16_bf16 v[128:143], a[72:75], a[84:87], v[128:143]
  s_add_u32 m0, s38, 36864
  s_nop 0
  buffer_load_dwordx4 v10, s[16:19], s52 offen lds
  v_mfma_f32_32x32x16_bf16 v[144:159], a[76:79], a[84:87], v[144:159]
  buffer_load_dwordx4 v11, s[16:19], s53 offen offset:1024 lds
  v_mfma_f32_32x32x16_bf16 v[160:175], a[64:67], a[88:91], v[160:175]
  buffer_load_dwordx4 v10, s[16:19], s54 offen offset:2048 lds
  v_mfma_f32_32x32x16_bf16 v[176:191], a[68:71], a[88:91], v[176:191]
  buffer_load_dwordx4 v11, s[16:19], s55 offen offset:3072 lds
  v_add_u32 v10, 128, v10
  v_add_u32 v11, 128, v11
  v_mfma_f32_32x32x16_bf16 v[192:207], a[72:75], a[88:91], v[192:207]
  v_mfma_f32_32x32x16_bf16 v[208:223], a[76:79], a[88:91], v[208:223]
  s_add_u32 m0, s39, 0
  s_nop 0
  buffer_load_dwordx4 v12, s[12:15], 0 offen lds
  v_mfma_f32_32x32x16_bf16 v[224:239], a[64:67], a[92:95], v[224:239]
  buffer_load_dwordx4 v12, s[12:15], s45 offen offset:1024 lds
  v_mfma_f32_32x32x16_bf16 v[240:255], a[68:71], a[92:95], v[240:255]
  buffer_load_dwordx4 v12, s[12:15], s46 offen offset:2048 lds
  v_mfma_f32_32x32x16_bf16 a[0:15], a[72:75], a[92:95], a[0:15]
  buffer_load_dwordx4 v12, s[12:15], s47 offen offset:3072 lds
  v_add_u32 v12, 262144, v12
  s_mov_b32 s4, s74
  s_mov_b32 s5, s75
  s_mov_b32 s6, 0x510000
  s_mov_b32 s7, 0x20000
  s_lshl_b32 s33, s2, 2
  s_add_u32 s33, s33, s3
  s_mul_i32 s33, s33, 5184
  s_add_u32 s33, s33, 0
  v_lshlrev_b32 v23, 7, v1
  s_mov_b32 exec_lo, 0x1ff
  s_mov_b32 exec_hi, 0x0
  buffer_load_dword v24, v23, s[4:7], s33 offen
  s_mov_b64 exec, -1
  v_mfma_f32_32x32x16_bf16 a[16:31], a[76:79], a[92:95], a[16:31]
  s_waitcnt lgkmcnt(0)
  v_mfma_f32_32x32x16_bf16 v[32:47], a[32:35], a[48:51], v[32:47]
  v_add_u32 v7, 65536, v6
  ds_read_b64_tr_b16 a[80:81], v8 offset:20480
  ds_read_b64_tr_b16 a[82:83], v8 offset:21504
  v_mfma_f32_32x32x16_bf16 v[48:63], a[36:39], a[48:51], v[48:63]
  ds_read_b128 a[64:67], v7 offset:0
  ds_read_b128 a[68:71], v7 offset:4096
  v_mfma_f32_32x32x16_bf16 v[64:79], a[40:43], a[48:51], v[64:79]
  ds_read_b128 a[72:75], v7 offset:8192
  ds_read_b128 a[76:79], v7 offset:12288
  v_mfma_f32_32x32x16_bf16 v[80:95], a[44:47], a[48:51], v[80:95]
  ds_read_b64_tr_b16 a[84:85], v9 offset:20480
  ds_read_b64_tr_b16 a[86:87], v9 offset:21504
  v_mfma_f32_32x32x16_bf16 v[96:111], a[32:35], a[52:55], v[96:111]
  ds_read_b64_tr_b16 a[88:89], v8 offset:20992
  ds_read_b64_tr_b16 a[90:91], v8 offset:22016
  v_mfma_f32_32x32x16_bf16 v[112:127], a[36:39], a[52:55], v[112:127]
  ds_read_b64_tr_b16 a[92:93], v9 offset:20992
  ds_read_b64_tr_b16 a[94:95], v9 offset:22016
  v_mfma_f32_32x32x16_bf16 v[128:143], a[40:43], a[52:55], v[128:143]
  v_mfma_f32_32x32x16_bf16 v[144:159], a[44:47], a[52:55], v[144:159]
  v_mfma_f32_32x32x16_bf16 v[160:175], a[32:35], a[56:59], v[160:175]
  v_mfma_f32_32x32x16_bf16 v[176:191], a[36:39], a[56:59], v[176:191]
  v_mfma_f32_32x32x16_bf16 v[192:207], a[40:43], a[56:59], v[192:207]
  v_mfma_f32_32x32x16_bf16 v[208:223], a[44:47], a[56:59], v[208:223]
  v_mfma_f32_32x32x16_bf16 v[224:239], a[32:35], a[60:63], v[224:239]
  v_mfma_f32_32x32x16_bf16 v[240:255], a[36:39], a[60:63], v[240:255]
  v_mfma_f32_32x32x16_bf16 a[0:15], a[40:43], a[60:63], a[0:15]
  v_mfma_f32_32x32x16_bf16 a[16:31], a[44:47], a[60:63], a[16:31]
  s_waitcnt vmcnt(17) lgkmcnt(0)
  s_barrier
  v_mfma_f32_32x32x16_bf16 v[32:47], a[64:67], a[80:83], v[32:47]
  v_add_u32 v7, 0, v3
  ds_read_b64_tr_b16 a[48:49], v8 offset:32768
  ds_read_b64_tr_b16 a[50:51], v8 offset:33792
  v_mfma_f32_32x32x16_bf16 v[48:63], a[68:71], a[80:83], v[48:63]
  ds_read_b128 a[32:35], v7 offset:0
  ds_read_b128 a[36:39], v7 offset:4096
  v_mfma_f32_32x32x16_bf16 v[64:79], a[72:75], a[80:83], v[64:79]
  ds_read_b128 a[40:43], v7 offset:8192
  ds_read_b128 a[44:47], v7 offset:12288
  v_mfma_f32_32x32x16_bf16 v[80:95], a[76:79], a[80:83], v[80:95]
  ds_read_b64_tr_b16 a[52:53], v9 offset:32768
  ds_read_b64_tr_b16 a[54:55], v9 offset:33792
  v_mfma_f32_32x32x16_bf16 v[96:111], a[64:67], a[84:87], v[96:111]
  ds_read_b64_tr_b16 a[56:57], v8 offset:33280
  ds_read_b64_tr_b16 a[58:59], v8 offset:34304
  v_mfma_f32_32x32x16_bf16 v[112:127], a[68:71], a[84:87], v[112:127]
  ds_read_b64_tr_b16 a[60:61], v9 offset:33280
  ds_read_b64_tr_b16 a[62:63], v9 offset:34304
  v_mfma_f32_32x32x16_bf16 v[128:143], a[72:75], a[84:87], v[128:143]
  s_add_u32 m0, s38, 65536
  s_nop 0
  buffer_load_dwordx4 v10, s[16:19], 0 offen lds
  v_mfma_f32_32x32x16_bf16 v[144:159], a[76:79], a[84:87], v[144:159]
  buffer_load_dwordx4 v11, s[16:19], s49 offen offset:1024 lds
  v_mfma_f32_32x32x16_bf16 v[160:175], a[64:67], a[88:91], v[160:175]
  buffer_load_dwordx4 v10, s[16:19], s50 offen offset:2048 lds
  v_mfma_f32_32x32x16_bf16 v[176:191], a[68:71], a[88:91], v[176:191]
  buffer_load_dwordx4 v11, s[16:19], s51 offen offset:3072 lds
  v_mfma_f32_32x32x16_bf16 v[192:207], a[72:75], a[88:91], v[192:207]
  v_mfma_f32_32x32x16_bf16 v[208:223], a[76:79], a[88:91], v[208:223]
  s_add_u32 m0, s39, 16384
  s_nop 0
  buffer_load_dwordx4 v12, s[12:15], 0 offen lds
  v_mfma_f32_32x32x16_bf16 v[224:239], a[64:67], a[92:95], v[224:239]
  buffer_load_dwordx4 v12, s[12:15], s45 offen offset:1024 lds
  v_mfma_f32_32x32x16_bf16 v[240:255], a[68:71], a[92:95], v[240:255]
  buffer_load_dwordx4 v12, s[12:15], s46 offen offset:2048 lds
  v_mfma_f32_32x32x16_bf16 a[0:15], a[72:75], a[92:95], a[0:15]
  buffer_load_dwordx4 v12, s[12:15], s47 offen offset:3072 lds
  v_add_u32 v12, 262144, v12
  s_mov_b32 s4, s76
  s_mov_b32 s5, s77
  s_mov_b32 s6, 0x510000
  s_mov_b32 s7, 0x20000
  s_lshl_b32 s33, s2, 2
  s_add_u32 s33, s33, s3
  s_mul_i32 s33, s33, 5184
  s_add_u32 s33, s33, 0
  v_lshlrev_b32 v23, 7, v1
  s_mov_b32 exec_lo, 0x1ff
  s_mov_b32 exec_hi, 0x0
  buffer_load_dword v24, v23, s[4:7], s33 offen
  s_mov_b64 exec, -1
  v_mfma_f32_32x32x16_bf16 a[16:31], a[76:79], a[92:95], a[16:31]
  s_waitcnt lgkmcnt(0)
  v_mfma_f32_32x32x16_bf16 v[32:47], a[32:35], a[48:51], v[32:47]
  v_add_u32 v7, 0, v4
  ds_read_b64_tr_b16 a[80:81], v8 offset:36864
  ds_read_b64_tr_b16 a[82:83], v8 offset:37888
  v_mfma_f32_32x32x16_bf16 v[48:63], a[36:39], a[48:51], v[48:63]
  ds_read_b128 a[64:67], v7 offset:0
  ds_read_b128 a[68:71], v7 offset:4096
  v_mfma_f32_32x32x16_bf16 v[64:79], a[40:43], a[48:51], v[64:79]
  ds_read_b128 a[72:75], v7 offset:8192
  ds_read_b128 a[76:79], v7 offset:12288
  v_mfma_f32_32x32x16_bf16 v[80:95], a[44:47], a[48:51], v[80:95]
  ds_read_b64_tr_b16 a[84:85], v9 offset:36864
  ds_read_b64_tr_b16 a[86:87], v9 offset:37888
  v_mfma_f32_32x32x16_bf16 v[96:111], a[32:35], a[52:55], v[96:111]
  ds_read_b64_tr_b16 a[88:89], v8 offset:37376
  ds_read_b64_tr_b16 a[90:91], v8 offset:38400
  v_mfma_f32_32x32x16_bf16 v[112:127], a[36:39], a[52:55], v[112:127]
  ds_read_b64_tr_b16 a[92:93], v9 offset:37376
  ds_read_b64_tr_b16 a[94:95], v9 offset:38400
  v_mfma_f32_32x32x16_bf16 v[128:143], a[40:43], a[52:55], v[128:143]
  v_mfma_f32_32x32x16_bf16 v[144:159], a[44:47], a[52:55], v[144:159]
  v_mfma_f32_32x32x16_bf16 v[160:175], a[32:35], a[56:59], v[160:175]
  v_mfma_f32_32x32x16_bf16 v[176:191], a[36:39], a[56:59], v[176:191]
  v_mfma_f32_32x32x16_bf16 v[192:207], a[40:43], a[56:59], v[192:207]
  v_mfma_f32_32x32x16_bf16 v[208:223], a[44:47], a[56:59], v[208:223]
  v_mfma_f32_32x32x16_bf16 v[224:239], a[32:35], a[60:63], v[224:239]
  v_mfma_f32_32x32x16_bf16 v[240:255], a[36:39], a[60:63], v[240:255]
  v_mfma_f32_32x32x16_bf16 a[0:15], a[40:43], a[60:63], a[0:15]
  v_mfma_f32_32x32x16_bf16 a[16:31], a[44:47], a[60:63], a[16:31]
  s_waitcnt vmcnt(18) lgkmcnt(0)
  s_barrier
  v_mfma_f32_32x32x16_bf16 v[32:47], a[64:67], a[80:83], v[32:47]
  v_add_u32 v7, 0, v5
  ds_read_b64_tr_b16 a[48:49], v8 offset:49152
  ds_read_b64_tr_b16 a[50:51], v8 offset:50176
  v_mfma_f32_32x32x16_bf16 v[48:63], a[68:71], a[80:83], v[48:63]
  ds_read_b128 a[32:35], v7 offset:0
  ds_read_b128 a[36:39], v7 offset:4096
  v_mfma_f32_32x32x16_bf16 v[64:79], a[72:75], a[80:83], v[64:79]
  ds_read_b128 a[40:43], v7 offset:8192
  ds_read_b128 a[44:47], v7 offset:12288
  v_mfma_f32_32x32x16_bf16 v[80:95], a[76:79], a[80:83], v[80:95]
  ds_read_b64_tr_b16 a[52:53], v9 offset:49152
  ds_read_b64_tr_b16 a[54:55], v9 offset:50176
  v_mfma_f32_32x32x16_bf16 v[96:111], a[64:67], a[84:87], v[96:111]
  ds_read_b64_tr_b16 a[56:57], v8 offset:49664
  ds_read_b64_tr_b16 a[58:59], v8 offset:50688
  v_mfma_f32_32x32x16_bf16 v[112:127], a[68:71], a[84:87], v[112:127]
  ds_read_b64_tr_b16 a[60:61], v9 offset:49664
  ds_read_b64_tr_b16 a[62:63], v9 offset:50688
  v_mfma_f32_32x32x16_bf16 v[128:143], a[72:75], a[84:87], v[128:143]
  s_add_u32 m0, s38, 69632
  s_nop 0
  buffer_load_dwordx4 v10, s[16:19], s52 offen lds
  v_mfma_f32_32x32x16_bf16 v[144:159], a[76:79], a[84:87], v[144:159]
  buffer_load_dwordx4 v11, s[16:19], s53 offen offset:1024 lds
  v_mfma_f32_32x32x16_bf16 v[160:175], a[64:67], a[88:91], v[160:175]
  buffer_load_dwordx4 v10, s[16:19], s54 offen offset:2048 lds
  v_mfma_f32_32x32x16_bf16 v[176:191], a[68:71], a[88:91], v[176:191]
  buffer_load_dwordx4 v11, s[16:19], s55 offen offset:3072 lds
  v_add_u32 v10, 128, v10
  v_add_u32 v11, 128, v11
  v_mfma_f32_32x32x16_bf16 v[192:207], a[72:75], a[88:91], v[192:207]
  v_mfma_f32_32x32x16_bf16 v[208:223], a[76:79], a[88:91], v[208:223]
  s_add_u32 m0, s39, 32768
  s_nop 0
  buffer_load_dwordx4 v12, s[12:15], 0 offen lds
  v_mfma_f32_32x32x16_bf16 v[224:239], a[64:67], a[92:95], v[224:239]
  buffer_load_dwordx4 v12, s[12:15], s45 offen offset:1024 lds
  v_mfma_f32_32x32x16_bf16 v[240:255], a[68:71], a[92:95], v[240:255]
  buffer_load_dwordx4 v12, s[12:15], s46 offen offset:2048 lds
  v_mfma_f32_32x32x16_bf16 a[0:15], a[72:75], a[92:95], a[0:15]
  buffer_load_dwordx4 v12, s[12:15], s47 offen offset:3072 lds
  v_add_u32 v12, 262144, v12
  s_mov_b32 s4, s74
  s_mov_b32 s5, s75
  s_mov_b32 s6, 0x510000
  s_mov_b32 s7, 0x20000
  s_lshl_b32 s33, s2, 2
  s_add_u32 s33, s33, s3
  s_mul_i32 s33, s33, 5184
  s_add_u32 s33, s33, 1152
  v_lshlrev_b32 v23, 7, v1
  s_mov_b32 exec_lo, 0x1ff
  s_mov_b32 exec_hi, 0x0
  buffer_load_dword v24, v23, s[4:7], s33 offen
  s_mov_b64 exec, -1
  v_mfma_f32_32x32x16_bf16 a[16:31], a[76:79], a[92:95], a[16:31]
  s_mov_b32 s4, s68
  s_mov_b32 s5, s69
  s_mov_b32 s6, 0x480000
  s_mov_b32 s7, 0x20000
  s_lshl_b32 s33, s2, 2
  s_add_u32 s33, s33, s3
  s_mul_i32 s33, s33, 4608
  s_add_u32 s33, s33, 0
  v_lshlrev_b32 v23, 7, v1
  s_mov_b32 exec_lo, 0xfff
  s_mov_b32 exec_hi, 0x0
  buffer_load_dword v24, v23, s[4:7], s33 offen
  s_mov_b64 exec, -1
  s_waitcnt lgkmcnt(0)
  v_mfma_f32_32x32x16_bf16 v[32:47], a[32:35], a[48:51], v[32:47]
  v_add_u32 v7, 0, v6
  ds_read_b64_tr_b16 a[80:81], v8 offset:53248
  ds_read_b64_tr_b16 a[82:83], v8 offset:54272
  v_mfma_f32_32x32x16_bf16 v[48:63], a[36:39], a[48:51], v[48:63]
  ds_read_b128 a[64:67], v7 offset:0
  ds_read_b128 a[68:71], v7 offset:4096
  v_mfma_f32_32x32x16_bf16 v[64:79], a[40:43], a[48:51], v[64:79]
  ds_read_b128 a[72:75], v7 offset:8192
  ds_read_b128 a[76:79], v7 offset:12288
  v_mfma_f32_32x32x16_bf16 v[80:95], a[44:47], a[48:51], v[80:95]
  ds_read_b64_tr_b16 a[84:85], v9 offset:53248
  ds_read_b64_tr_b16 a[86:87], v9 offset:54272
  v_mfma_f32_32x32x16_bf16 v[96:111], a[32:35], a[52:55], v[96:111]
  ds_read_b64_tr_b16 a[88:89], v8 offset:53760
  ds_read_b64_tr_b16 a[90:91], v8 offset:54784
  v_mfma_f32_32x32x16_bf16 v[112:127], a[36:39], a[52:55], v[112:127]
  ds_read_b64_tr_b16 a[92:93], v9 offset:53760
  ds_read_b64_tr_b16 a[94:95], v9 offset:54784
  v_mfma_f32_32x32x16_bf16 v[128:143], a[40:43], a[52:55], v[128:143]
  v_mfma_f32_32x32x16_bf16 v[144:159], a[44:47], a[52:55], v[144:159]
  v_mfma_f32_32x32x16_bf16 v[160:175], a[32:35], a[56:59], v[160:175]
  v_mfma_f32_32x32x16_bf16 v[176:191], a[36:39], a[56:59], v[176:191]
  v_mfma_f32_32x32x16_bf16 v[192:207], a[40:43], a[56:59], v[192:207]
  v_mfma_f32_32x32x16_bf16 v[208:223], a[44:47], a[56:59], v[208:223]
  v_mfma_f32_32x32x16_bf16 v[224:239], a[32:35], a[60:63], v[224:239]
  v_mfma_f32_32x32x16_bf16 v[240:255], a[36:39], a[60:63], v[240:255]
  v_mfma_f32_32x32x16_bf16 a[0:15], a[40:43], a[60:63], a[0:15]
  v_mfma_f32_32x32x16_bf16 a[16:31], a[44:47], a[60:63], a[16:31]
  s_waitcnt vmcnt(20) lgkmcnt(0)
  s_barrier
  v_mfma_f32_32x32x16_bf16 v[32:47], a[64:67], a[80:83], v[32:47]
  v_add_u32 v7, 32768, v3
  ds_read_b64_tr_b16 a[48:49], v8 offset:0
  ds_read_b64_tr_b16 a[50:51], v8 offset:1024
  v_mfma_f32_32x32x16_bf16 v[48:63], a[68:71], a[80:83], v[48:63]
  ds_read_b128 a[32:35], v7 offset:0
  ds_read_b128 a[36:39], v7 offset:4096
  v_mfma_f32_32x32x16_bf16 v[64:79], a[72:75], a[80:83], v[64:79]
  ds_read_b128 a[40:43], v7 offset:8192
  ds_read_b128 a[44:47], v7 offset:12288
  v_mfma_f32_32x32x16_bf16 v[80:95], a[76:79], a[80:83], v[80:95]
  ds_read_b64_tr_b16 a[52:53], v9 offset:0
  ds_read_b64_tr_b16 a[54:55], v9 offset:1024
  v_mfma_f32_32x32x16_bf16 v[96:111], a[64:67], a[84:87], v[96:111]
  ds_read_b64_tr_b16 a[56:57], v8 offset:512
  ds_read_b64_tr_b16 a[58:59], v8 offset:1536
  v_mfma_f32_32x32x16_bf16 v[112:127], a[68:71], a[84:87], v[112:127]
  ds_read_b64_tr_b16 a[60:61], v9 offset:512
  ds_read_b64_tr_b16 a[62:63], v9 offset:1536
  v_mfma_f32_32x32x16_bf16 v[128:143], a[72:75], a[84:87], v[128:143]
  s_add_u32 m0, s38, 0
  s_nop 0
  buffer_load_dwordx4 v10, s[16:19], 0 offen lds
  v_mfma_f32_32x32x16_bf16 v[144:159], a[76:79], a[84:87], v[144:159]
  buffer_load_dwordx4 v11, s[16:19], s49 offen offset:1024 lds
  v_mfma_f32_32x32x16_bf16 v[160:175], a[64:67], a[88:91], v[160:175]
  buffer_load_dwordx4 v10, s[16:19], s50 offen offset:2048 lds
  v_mfma_f32_32x32x16_bf16 v[176:191], a[68:71], a[88:91], v[176:191]
  buffer_load_dwordx4 v11, s[16:19], s51 offen offset:3072 lds
  v_mfma_f32_32x32x16_bf16 v[192:207], a[72:75], a[88:91], v[192:207]
  v_mfma_f32_32x32x16_bf16 v[208:223], a[76:79], a[88:91], v[208:223]
  s_add_u32 m0, s39, 49152
  s_nop 0
  buffer_load_dwordx4 v12, s[12:15], 0 offen lds
  v_mfma_f32_32x32x16_bf16 v[224:239], a[64:67], a[92:95], v[224:239]
  buffer_load_dwordx4 v12, s[12:15], s45 offen offset:1024 lds
  v_mfma_f32_32x32x16_bf16 v[240:255], a[68:71], a[92:95], v[240:255]
  buffer_load_dwordx4 v12, s[12:15], s46 offen offset:2048 lds
  v_mfma_f32_32x32x16_bf16 a[0:15], a[72:75], a[92:95], a[0:15]
  buffer_load_dwordx4 v12, s[12:15], s47 offen offset:3072 lds
  v_add_u32 v12, 262144, v12
  s_mov_b32 s4, s76
  s_mov_b32 s5, s77
  s_mov_b32 s6, 0x510000
  s_mov_b32 s7, 0x20000
  s_lshl_b32 s33, s2, 2
  s_add_u32 s33, s33, s3
  s_mul_i32 s33, s33, 5184
  s_add_u32 s33, s33, 1152
  v_lshlrev_b32 v23, 7, v1
  s_mov_b32 exec_lo, 0x1ff
  s_mov_b32 exec_hi, 0x0
  buffer_load_dword v24, v23, s[4:7], s33 offen
  s_mov_b64 exec, -1
  v_mfma_f32_32x32x16_bf16 a[16:31], a[76:79], a[92:95], a[16:31]
  s_waitcnt lgkmcnt(0)
  v_mfma_f32_32x32x16_bf16 v[32:47], a[32:35], a[48:51], v[32:47]
  v_add_u32 v7, 32768, v4
  ds_read_b64_tr_b16 a[80:81], v8 offset:4096
  ds_read_b64_tr_b16 a[82:83], v8 offset:5120
  v_mfma_f32_32x32x16_bf16 v[48:63], a[36:39], a[48:51], v[48:63]
  ds_read_b128 a[64:67], v7 offset:0
  ds_read_b128 a[68:71], v7 offset:4096
  v_mfma_f32_32x32x16_bf16 v[64:79], a[40:43], a[48:51], v[64:79]
  ds_read_b128 a[72:75], v7 offset:8192
  ds_read_b128 a[76:79], v7 offset:12288
  v_mfma_f32_32x32x16_bf16 v[80:95], a[44:47], a[48:51], v[80:95]
  ds_read_b64_tr_b16 a[84:85], v9 offset:4096
  ds_read_b64_tr_b16 a[86:87], v9 offset:5120
  v_mfma_f32_32x32x16_bf16 v[96:111], a[32:35], a[52:55], v[96:111]
  ds_read_b64_tr_b16 a[88:89], v8 offset:4608
  ds_read_b64_tr_b16 a[90:91], v8 offset:5632
  v_mfma_f32_32x32x16_bf16 v[112:127], a[36:39], a[52:55], v[112:127]
  ds_read_b64_tr_b16 a[92:93], v9 offset:4608
  ds_read_b64_tr_b16 a[94:95], v9 offset:5632
  v_mfma_f32_32x32x16_bf16 v[128:143], a[40:43], a[52:55], v[128:143]
  v_mfma_f32_32x32x16_bf16 v[144:159], a[44:47], a[52:55], v[144:159]
  v_mfma_f32_32x32x16_bf16 v[160:175], a[32:35], a[56:59], v[160:175]
  v_mfma_f32_32x32x16_bf16 v[176:191], a[36:39], a[56:59], v[176:191]
  v_mfma_f32_32x32x16_bf16 v[192:207], a[40:43], a[56:59], v[192:207]
  v_mfma_f32_32x32x16_bf16 v[208:223], a[44:47], a[56:59], v[208:223]
  v_mfma_f32_32x32x16_bf16 v[224:239], a[32:35], a[60:63], v[224:239]
  v_mfma_f32_32x32x16_bf16 v[240:255], a[36:39], a[60:63], v[240:255]
  v_mfma_f32_32x32x16_bf16 a[0:15], a[40:43], a[60:63], a[0:15]
  v_mfma_f32_32x32x16_bf16 a[16:31], a[44:47], a[60:63], a[16:31]
  s_waitcnt vmcnt(20) lgkmcnt(0)
  s_barrier
  v_mfma_f32_32x32x16_bf16 v[32:47], a[64:67], a[80:83], v[32:47]
  v_add_u32 v7, 32768, v5
  ds_read_b64_tr_b16 a[48:49], v8 offset:16384
  ds_read_b64_tr_b16 a[50:51], v8 offset:17408
  v_mfma_f32_32x32x16_bf16 v[48:63], a[68:71], a[80:83], v[48:63]
  ds_read_b128 a[32:35], v7 offset:0
  ds_read_b128 a[36:39], v7 offset:4096
  v_mfma_f32_32x32x16_bf16 v[64:79], a[72:75], a[80:83], v[64:79]
  ds_read_b128 a[40:43], v7 offset:8192
  ds_read_b128 a[44:47], v7 offset:12288
  v_mfma_f32_32x32x16_bf16 v[80:95], a[76:79], a[80:83], v[80:95]
  ds_read_b64_tr_b16 a[52:53], v9 offset:16384
  ds_read_b64_tr_b16 a[54:55], v9 offset:17408
  v_mfma_f32_32x32x16_bf16 v[96:111], a[64:67], a[84:87], v[96:111]
  ds_read_b64_tr_b16 a[56:57], v8 offset:16896
  ds_read_b64_tr_b16 a[58:59], v8 offset:17920
  v_mfma_f32_32x32x16_bf16 v[112:127], a[68:71], a[84:87], v[112:127]
  ds_read_b64_tr_b16 a[60:61], v9 offset:16896
  ds_read_b64_tr_b16 a[62:63], v9 offset:17920
  v_mfma_f32_32x32x16_bf16 v[128:143], a[72:75], a[84:87], v[128:143]
  s_add_u32 m0, s38, 4096
  s_nop 0
  buffer_load_dwordx4 v10, s[16:19], s52 offen lds
  v_mfma_f32_32x32x16_bf16 v[144:159], a[76:79], a[84:87], v[144:159]
  buffer_load_dwordx4 v11, s[16:19], s53 offen offset:1024 lds
  v_mfma_f32_32x32x16_bf16 v[160:175], a[64:67], a[88:91], v[160:175]
  buffer_load_dwordx4 v10, s[16:19], s54 offen offset:2048 lds
  v_mfma_f32_32x32x16_bf16 v[176:191], a[68:71], a[88:91], v[176:191]
  buffer_load_dwordx4 v11, s[16:19], s55 offen offset:3072 lds
  v_add_u32 v10, 128, v10
  v_add_u32 v11, 128, v11
  v_mfma_f32_32x32x16_bf16 v[192:207], a[72:75], a[88:91], v[192:207]
  v_mfma_f32_32x32x16_bf16 v[208:223], a[76:79], a[88:91], v[208:223]
  s_add_u32 m0, s39, 0
  s_nop 0
  buffer_load_dwordx4 v12, s[12:15], 0 offen lds
  v_mfma_f32_32x32x16_bf16 v[224:239], a[64:67], a[92:95], v[224:239]
  buffer_load_dwordx4 v12, s[12:15], s45 offen offset:1024 lds
  v_mfma_f32_32x32x16_bf16 v[240:255], a[68:71], a[92:95], v[240:255]
  buffer_load_dwordx4 v12, s[12:15], s46 offen offset:2048 lds
  v_mfma_f32_32x32x16_bf16 a[0:15], a[72:75], a[92:95], a[0:15]
  buffer_load_dwordx4 v12, s[12:15], s47 offen offset:3072 lds
  v_add_u32 v12, 262144, v12
  s_mov_b32 s4, s74
  s_mov_b32 s5, s75
  s_mov_b32 s6, 0x510000
  s_mov_b32 s7, 0x20000
  s_lshl_b32 s33, s2, 2
  s_add_u32 s33, s33, s3
  s_mul_i32 s33, s33, 5184
  s_add_u32 s33, s33, 2304
  v_lshlrev_b32 v23, 7, v1
  s_mov_b32 exec_lo, 0x1ff
  s_mov_b32 exec_hi, 0x0
  buffer_load_dword v24, v23, s[4:7], s33 offen
  s_mov_b64 exec, -1
  v_mfma_f32_32x32x16_bf16 a[16:31], a[76:79], a[92:95], a[16:31]
  s_waitcnt lgkmcnt(0)
  v_mfma_f32_32x32x16_bf16 v[32:47], a[32:35], a[48:51], v[32:47]
  v_add_u32 v7, 32768, v6
  ds_read_b64_tr_b16 a[80:81], v8 offset:20480
  ds_read_b64_tr_b16 a[82:83], v8 offset:21504
  v_mfma_f32_32x32x16_bf16 v[48:63], a[36:39], a[48:51], v[48:63]
  ds_read_b128 a[64:67], v7 offset:0
  ds_read_b128 a[68:71], v7 offset:4096
  v_mfma_f32_32x32x16_bf16 v[64:79], a[40:43], a[48:51], v[64:79]
  ds_read_b128 a[72:75], v7 offset:8192
  ds_read_b128 a[76:79], v7 offset:12288
  v_mfma_f32_32x32x16_bf16 v[80:95], a[44:47], a[48:51], v[80:95]
  ds_read_b64_tr_b16 a[84:85], v9 offset:20480
  ds_read_b64_tr_b16 a[86:87], v9 offset:21504
  v_mfma_f32_32x32x16_bf16 v[96:111], a[32:35], a[52:55], v[96:111]
  ds_read_b64_tr_b16 a[88:89], v8 offset:20992
  ds_read_b64_tr_b16 a[90:91], v8 offset:22016
  v_mfma_f32_32x32x16_bf16 v[112:127], a[36:39], a[52:55], v[112:127]
  ds_read_b64_tr_b16 a[92:93], v9 offset:20992
  ds_read_b64_tr_b16 a[94:95], v9 offset:22016
  v_mfma_f32_32x32x16_bf16 v[128:143], a[40:43], a[52:55], v[128:143]
  v_mfma_f32_32x32x16_bf16 v[144:159], a[44:47], a[52:55], v[144:159]
  v_mfma_f32_32x32x16_bf16 v[160:175], a[32:35], a[56:59], v[160:175]
  v_mfma_f32_32x32x16_bf16 v[176:191], a[36:39], a[56:59], v[176:191]
  v_mfma_f32_32x32x16_bf16 v[192:207], a[40:43], a[56:59], v[192:207]
  v_mfma_f32_32x32x16_bf16 v[208:223], a[44:47], a[56:59], v[208:223]
  v_mfma_f32_32x32x16_bf16 v[224:239], a[32:35], a[60:63], v[224:239]
  v_mfma_f32_32x32x16_bf16 v[240:255], a[36:39], a[60:63], v[240:255]
  v_mfma_f32_32x32x16_bf16 a[0:15], a[40:43], a[60:63], a[0:15]
  v_mfma_f32_32x32x16_bf16 a[16:31], a[44:47], a[60:63], a[16:31]
  s_waitcnt vmcnt(20) lgkmcnt(0)
  s_barrier
  v_mfma_f32_32x32x16_bf16 v[32:47], a[64:67], a[80:83], v[32:47]
  v_add_u32 v7, 65536, v3
  ds_read_b64_tr_b16 a[48:49], v8 offset:32768
  ds_read_b64_tr_b16 a[50:51], v8 offset:33792
  buffer_load_dwordx4 v[16:19], v2, s[8:11], 0 offen sc1
  v_mfma_f32_32x32x16_bf16 v[48:63], a[68:71], a[80:83], v[48:63]
  ds_read_b128 a[32:35], v7 offset:0
  ds_read_b128 a[36:39], v7 offset:4096
  v_mfma_f32_32x32x16_bf16 v[64:79], a[72:75], a[80:83], v[64:79]
  ds_read_b128 a[40:43], v7 offset:8192
  ds_read_b128 a[44:47], v7 offset:12288
  v_mfma_f32_32x32x16_bf16 v[80:95], a[76:79], a[80:83], v[80:95]
  ds_read_b64_tr_b16 a[52:53], v9 offset:32768
  ds_read_b64_tr_b16 a[54:55], v9 offset:33792
  v_mfma_f32_32x32x16_bf16 v[96:111], a[64:67], a[84:87], v[96:111]
  ds_read_b64_tr_b16 a[56:57], v8 offset:33280
  ds_read_b64_tr_b16 a[58:59], v8 offset:34304
  v_mfma_f32_32x32x16_bf16 v[112:127], a[68:71], a[84:87], v[112:127]
  ds_read_b64_tr_b16 a[60:61], v9 offset:33280
  ds_read_b64_tr_b16 a[62:63], v9 offset:34304
  v_mfma_f32_32x32x16_bf16 v[128:143], a[72:75], a[84:87], v[128:143]
  s_add_u32 m0, s38, 32768
  s_nop 0
  buffer_load_dwordx4 v10, s[16:19], 0 offen lds
  v_mfma_f32_32x32x16_bf16 v[144:159], a[76:79], a[84:87], v[144:159]
  buffer_load_dwordx4 v11, s[16:19], s49 offen offset:1024 lds
  v_mfma_f32_32x32x16_bf16 v[160:175], a[64:67], a[88:91], v[160:175]
  buffer_load_dwordx4 v10, s[16:19], s50 offen offset:2048 lds
  v_mfma_f32_32x32x16_bf16 v[176:191], a[68:71], a[88:91], v[176:191]
  buffer_load_dwordx4 v11, s[16:19], s51 offen offset:3072 lds
  v_mfma_f32_32x32x16_bf16 v[192:207], a[72:75], a[88:91], v[192:207]
  v_mfma_f32_32x32x16_bf16 v[208:223], a[76:79], a[88:91], v[208:223]
  s_add_u32 m0, s39, 16384
  s_nop 0
  buffer_load_dwordx4 v12, s[12:15], 0 offen lds
  v_mfma_f32_32x32x16_bf16 v[224:239], a[64:67], a[92:95], v[224:239]
  buffer_load_dwordx4 v12, s[12:15], s45 offen offset:1024 lds
  v_mfma_f32_32x32x16_bf16 v[240:255], a[68:71], a[92:95], v[240:255]
  buffer_load_dwordx4 v12, s[12:15], s46 offen offset:2048 lds
  v_mfma_f32_32x32x16_bf16 a[0:15], a[72:75], a[92:95], a[0:15]
  buffer_load_dwordx4 v12, s[12:15], s47 offen offset:3072 lds
  v_add_u32 v12, 262144, v12
  s_mov_b32 s4, s76
  s_mov_b32 s5, s77
  s_mov_b32 s6, 0x510000
  s_mov_b32 s7, 0x20000
  s_lshl_b32 s33, s2, 2
  s_add_u32 s33, s33, s3
  s_mul_i32 s33, s33, 5184
  s_add_u32 s33, s33, 2304
  v_lshlrev_b32 v23, 7, v1
  s_mov_b32 exec_lo, 0x1ff
  s_mov_b32 exec_hi, 0x0
  buffer_load_dword v24, v23, s[4:7], s33 offen
  s_mov_b64 exec, -1
  v_mfma_f32_32x32x16_bf16 a[16:31], a[76:79], a[92:95], a[16:31]
  s_waitcnt lgkmcnt(0)
  v_mfma_f32_32x32x16_bf16 v[32:47], a[32:35], a[48:51], v[32:47]
  v_add_u32 v7, 65536, v4
  ds_read_b64_tr_b16 a[80:81], v8 offset:36864
  ds_read_b64_tr_b16 a[82:83], v8 offset:37888
  v_mfma_f32_32x32x16_bf16 v[48:63], a[36:39], a[48:51], v[48:63]
  ds_read_b128 a[64:67], v7 offset:0
  ds_read_b128 a[68:71], v7 offset:4096
  v_mfma_f32_32x32x16_bf16 v[64:79], a[40:43], a[48:51], v[64:79]
  ds_read_b128 a[72:75], v7 offset:8192
  ds_read_b128 a[76:79], v7 offset:12288
  v_mfma_f32_32x32x16_bf16 v[80:95], a[44:47], a[48:51], v[80:95]
  ds_read_b64_tr_b16 a[84:85], v9 offset:36864
  ds_read_b64_tr_b16 a[86:87], v9 offset:37888
  v_mfma_f32_32x32x16_bf16 v[96:111], a[32:35], a[52:55], v[96:111]
  ds_read_b64_tr_b16 a[88:89], v8 offset:37376
  ds_read_b64_tr_b16 a[90:91], v8 offset:38400
  v_mfma_f32_32x32x16_bf16 v[112:127], a[36:39], a[52:55], v[112:127]
  ds_read_b64_tr_b16 a[92:93], v9 offset:37376
  ds_read_b64_tr_b16 a[94:95], v9 offset:38400
  v_mfma_f32_32x32x16_bf16 v[128:143], a[40:43], a[52:55], v[128:143]
  v_mfma_f32_32x32x16_bf16 v[144:159], a[44:47], a[52:55], v[144:159]
  v_mfma_f32_32x32x16_bf16 v[160:175], a[32:35], a[56:59], v[160:175]
  v_mfma_f32_32x32x16_bf16 v[176:191], a[36:39], a[56:59], v[176:191]
  v_mfma_f32_32x32x16_bf16 v[192:207], a[40:43], a[56:59], v[192:207]
  v_mfma_f32_32x32x16_bf16 v[208:223], a[44:47], a[56:59], v[208:223]
  v_mfma_f32_32x32x16_bf16 v[224:239], a[32:35], a[60:63], v[224:239]
  v_mfma_f32_32x32x16_bf16 v[240:255], a[36:39], a[60:63], v[240:255]
  v_mfma_f32_32x32x16_bf16 a[0:15], a[40:43], a[60:63], a[0:15]
  v_mfma_f32_32x32x16_bf16 a[16:31], a[44:47], a[60:63], a[16:31]
  s_waitcnt vmcnt(20) lgkmcnt(0)
  s_barrier
  v_mfma_f32_32x32x16_bf16 v[32:47], a[64:67], a[80:83], v[32:47]
  v_add_u32 v7, 65536, v5
  ds_read_b64_tr_b16 a[48:49], v8 offset:49152
  ds_read_b64_tr_b16 a[50:51], v8 offset:50176
  v_mfma_f32_32x32x16_bf16 v[48:63], a[68:71], a[80:83], v[48:63]
  ds_read_b128 a[32:35], v7 offset:0
  ds_read_b128 a[36:39], v7 offset:4096
  v_mfma_f32_32x32x16_bf16 v[64:79], a[72:75], a[80:83], v[64:79]
  ds_read_b128 a[40:43], v7 offset:8192
  ds_read_b128 a[44:47], v7 offset:12288
  v_mfma_f32_32x32x16_bf16 v[80:95], a[76:79], a[80:83], v[80:95]
  ds_read_b64_tr_b16 a[52:53], v9 offset:49152
  ds_read_b64_tr_b16 a[54:55], v9 offset:50176
  v_mfma_f32_32x32x16_bf16 v[96:111], a[64:67], a[84:87], v[96:111]
  ds_read_b64_tr_b16 a[56:57], v8 offset:49664
  ds_read_b64_tr_b16 a[58:59], v8 offset:50688
  v_mfma_f32_32x32x16_bf16 v[112:127], a[68:71], a[84:87], v[112:127]
  ds_read_b64_tr_b16 a[60:61], v9 offset:49664
  ds_read_b64_tr_b16 a[62:63], v9 offset:50688
  v_mfma_f32_32x32x16_bf16 v[128:143], a[72:75], a[84:87], v[128:143]
  s_add_u32 m0, s38, 36864
  s_nop 0
  buffer_load_dwordx4 v10, s[16:19], s52 offen lds
  v_mfma_f32_32x32x16_bf16 v[144:159], a[76:79], a[84:87], v[144:159]
  buffer_load_dwordx4 v11, s[16:19], s53 offen offset:1024 lds
  v_mfma_f32_32x32x16_bf16 v[160:175], a[64:67], a[88:91], v[160:175]
  buffer_load_dwordx4 v10, s[16:19], s54 offen offset:2048 lds
  v_mfma_f32_32x32x16_bf16 v[176:191], a[68:71], a[88:91], v[176:191]
  buffer_load_dwordx4 v11, s[16:19], s55 offen offset:3072 lds
  v_add_u32 v10, 128, v10
  v_add_u32 v11, 128, v11
  v_mfma_f32_32x32x16_bf16 v[192:207], a[72:75], a[88:91], v[192:207]
  v_mfma_f32_32x32x16_bf16 v[208:223], a[76:79], a[88:91], v[208:223]
  s_add_u32 m0, s39, 32768
  s_nop 0
  buffer_load_dwordx4 v12, s[12:15], 0 offen lds
  v_mfma_f32_32x32x16_bf16 v[224:239], a[64:67], a[92:95], v[224:239]
  buffer_load_dwordx4 v12, s[12:15], s45 offen offset:1024 lds
  v_mfma_f32_32x32x16_bf16 v[240:255], a[68:71], a[92:95], v[240:255]
  buffer_load_dwordx4 v12, s[12:15], s46 offen offset:2048 lds
  v_mfma_f32_32x32x16_bf16 a[0:15], a[72:75], a[92:95], a[0:15]
  buffer_load_dwordx4 v12, s[12:15], s47 offen offset:3072 lds
  v_add_u32 v12, 262144, v12
  s_mov_b32 s4, s74
  s_mov_b32 s5, s75
  s_mov_b32 s6, 0x510000
  s_mov_b32 s7, 0x20000
  s_lshl_b32 s33, s2, 2
  s_add_u32 s33, s33, s3
  s_mul_i32 s33, s33, 5184
  s_add_u32 s33, s33, 3456
  v_lshlrev_b32 v23, 7, v1
  s_mov_b32 exec_lo, 0x1ff
  s_mov_b32 exec_hi, 0x0
  buffer_load_dword v24, v23, s[4:7], s33 offen
  s_mov_b64 exec, -1
  v_mfma_f32_32x32x16_bf16 a[16:31], a[76:79], a[92:95], a[16:31]
  s_mov_b32 s4, s68
  s_mov_b32 s5, s69
  s_mov_b32 s6, 0x480000
  s_mov_b32 s7, 0x20000
  s_lshl_b32 s33, s2, 2
  s_add_u32 s33, s33, s3
  s_mul_i32 s33, s33, 4608
  s_add_u32 s33, s33, 1536
  v_lshlrev_b32 v23, 7, v1
  s_mov_b32 exec_lo, 0xfff
  s_mov_b32 exec_hi, 0x0
  buffer_load_dword v24, v23, s[4:7], s33 offen
  s_mov_b64 exec, -1
  s_waitcnt lgkmcnt(0)
  v_mfma_f32_32x32x16_bf16 v[32:47], a[32:35], a[48:51], v[32:47]
  v_add_u32 v7, 65536, v6
  ds_read_b64_tr_b16 a[80:81], v8 offset:53248
  ds_read_b64_tr_b16 a[82:83], v8 offset:54272
  v_mfma_f32_32x32x16_bf16 v[48:63], a[36:39], a[48:51], v[48:63]
  ds_read_b128 a[64:67], v7 offset:0
  ds_read_b128 a[68:71], v7 offset:4096
  v_mfma_f32_32x32x16_bf16 v[64:79], a[40:43], a[48:51], v[64:79]
  ds_read_b128 a[72:75], v7 offset:8192
  ds_read_b128 a[76:79], v7 offset:12288
  v_mfma_f32_32x32x16_bf16 v[80:95], a[44:47], a[48:51], v[80:95]
  ds_read_b64_tr_b16 a[84:85], v9 offset:53248
  ds_read_b64_tr_b16 a[86:87], v9 offset:54272
  v_mfma_f32_32x32x16_bf16 v[96:111], a[32:35], a[52:55], v[96:111]
  ds_read_b64_tr_b16 a[88:89], v8 offset:53760
  ds_read_b64_tr_b16 a[90:91], v8 offset:54784
  v_mfma_f32_32x32x16_bf16 v[112:127], a[36:39], a[52:55], v[112:127]
  ds_read_b64_tr_b16 a[92:93], v9 offset:53760
  ds_read_b64_tr_b16 a[94:95], v9 offset:54784
  v_mfma_f32_32x32x16_bf16 v[128:143], a[40:43], a[52:55], v[128:143]
  v_mfma_f32_32x32x16_bf16 v[144:159], a[44:47], a[52:55], v[144:159]
  v_mfma_f32_32x32x16_bf16 v[160:175], a[32:35], a[56:59], v[160:175]
  v_mfma_f32_32x32x16_bf16 v[176:191], a[36:39], a[56:59], v[176:191]
  v_mfma_f32_32x32x16_bf16 v[192:207], a[40:43], a[56:59], v[192:207]
  v_mfma_f32_32x32x16_bf16 v[208:223], a[44:47], a[56:59], v[208:223]
  v_mfma_f32_32x32x16_bf16 v[224:239], a[32:35], a[60:63], v[224:239]
  v_mfma_f32_32x32x16_bf16 v[240:255], a[36:39], a[60:63], v[240:255]
  v_mfma_f32_32x32x16_bf16 a[0:15], a[40:43], a[60:63], a[0:15]
  v_mfma_f32_32x32x16_bf16 a[16:31], a[44:47], a[60:63], a[16:31]
  s_waitcnt vmcnt(21) lgkmcnt(0)
  s_barrier
  v_mfma_f32_32x32x16_bf16 v[32:47], a[64:67], a[80:83], v[32:47]
  v_add_u32 v7, 0, v3
  ds_read_b64_tr_b16 a[48:49], v8 offset:0
  ds_read_b64_tr_b16 a[50:51], v8 offset:1024
  v_mfma_f32_32x32x16_bf16 v[48:63], a[68:71], a[80:83], v[48:63]
  ds_read_b128 a[32:35], v7 offset:0
  ds_read_b128 a[36:39], v7 offset:4096
  v_mfma_f32_32x32x16_bf16 v[64:79], a[72:75], a[80:83], v[64:79]
  ds_read_b128 a[40:43], v7 offset:8192
  ds_read_b128 a[44:47], v7 offset:12288
  v_mfma_f32_32x32x16_bf16 v[80:95], a[76:79], a[80:83], v[80:95]
  ds_read_b64_tr_b16 a[52:53], v9 offset:0
  ds_read_b64_tr_b16 a[54:55], v9 offset:1024
  v_mfma_f32_32x32x16_bf16 v[96:111], a[64:67], a[84:87], v[96:111]
  ds_read_b64_tr_b16 a[56:57], v8 offset:512
  ds_read_b64_tr_b16 a[58:59], v8 offset:1536
  v_mfma_f32_32x32x16_bf16 v[112:127], a[68:71], a[84:87], v[112:127]
  ds_read_b64_tr_b16 a[60:61], v9 offset:512
  ds_read_b64_tr_b16 a[62:63], v9 offset:1536
  v_mfma_f32_32x32x16_bf16 v[128:143], a[72:75], a[84:87], v[128:143]
  s_add_u32 m0, s39, 49152
  s_nop 0
  buffer_load_dwordx4 v12, s[12:15], 0 offen lds
  v_mfma_f32_32x32x16_bf16 v[144:159], a[76:79], a[84:87], v[144:159]
  v_mfma_f32_32x32x16_bf16 v[160:175], a[64:67], a[88:91], v[160:175]
  buffer_load_dwordx4 v12, s[12:15], s45 offen offset:1024 lds
  v_mfma_f32_32x32x16_bf16 v[176:191], a[68:71], a[88:91], v[176:191]
  v_mfma_f32_32x32x16_bf16 v[192:207], a[72:75], a[88:91], v[192:207]
  v_mfma_f32_32x32x16_bf16 v[208:223], a[76:79], a[88:91], v[208:223]
  buffer_load_dwordx4 v12, s[12:15], s46 offen offset:2048 lds
  v_mfma_f32_32x32x16_bf16 v[224:239], a[64:67], a[92:95], v[224:239]
  v_mfma_f32_32x32x16_bf16 v[240:255], a[68:71], a[92:95], v[240:255]
  buffer_load_dwordx4 v12, s[12:15], s47 offen offset:3072 lds
  v_add_u32 v12, 262144, v12
  v_mfma_f32_32x32x16_bf16 a[0:15], a[72:75], a[92:95], a[0:15]
  s_mov_b32 s4, s76
  s_mov_b32 s5, s77
  s_mov_b32 s6, 0x510000
  s_mov_b32 s7, 0x20000
  s_lshl_b32 s33, s2, 2
  s_add_u32 s33, s33, s3
  s_mul_i32 s33, s33, 5184
  s_add_u32 s33, s33, 3456
  v_lshlrev_b32 v23, 7, v1
  s_mov_b32 exec_lo, 0x1ff
  s_mov_b32 exec_hi, 0x0
  buffer_load_dword v24, v23, s[4:7], s33 offen
  s_mov_b64 exec, -1
  v_mfma_f32_32x32x16_bf16 a[16:31], a[76:79], a[92:95], a[16:31]
  s_waitcnt lgkmcnt(0)
  v_mfma_f32_32x32x16_bf16 v[32:47], a[32:35], a[48:51], v[32:47]
  v_add_u32 v7, 0, v4
  ds_read_b64_tr_b16 a[80:81], v8 offset:4096
  ds_read_b64_tr_b16 a[82:83], v8 offset:5120
  v_mfma_f32_32x32x16_bf16 v[48:63], a[36:39], a[48:51], v[48:63]
  ds_read_b128 a[64:67], v7 offset:0
  ds_read_b128 a[68:71], v7 offset:4096
  v_mfma_f32_32x32x16_bf16 v[64:79], a[40:43], a[48:51], v[64:79]
  ds_read_b128 a[72:75], v7 offset:8192
  ds_read_b128 a[76:79], v7 offset:12288
  v_mfma_f32_32x32x16_bf16 v[80:95], a[44:47], a[48:51], v[80:95]
  ds_read_b64_tr_b16 a[84:85], v9 offset:4096
  ds_read_b64_tr_b16 a[86:87], v9 offset:5120
  v_mfma_f32_32x32x16_bf16 v[96:111], a[32:35], a[52:55], v[96:111]
  ds_read_b64_tr_b16 a[88:89], v8 offset:4608
  ds_read_b64_tr_b16 a[90:91], v8 offset:5632
  v_mfma_f32_32x32x16_bf16 v[112:127], a[36:39], a[52:55], v[112:127]
  ds_read_b64_tr_b16 a[92:93], v9 offset:4608
  ds_read_b64_tr_b16 a[94:95], v9 offset:5632
  v_mfma_f32_32x32x16_bf16 v[128:143], a[40:43], a[52:55], v[128:143]
  v_mfma_f32_32x32x16_bf16 v[144:159], a[44:47], a[52:55], v[144:159]
  v_mfma_f32_32x32x16_bf16 v[160:175], a[32:35], a[56:59], v[160:175]
  v_mfma_f32_32x32x16_bf16 v[176:191], a[36:39], a[56:59], v[176:191]
  v_mfma_f32_32x32x16_bf16 v[192:207], a[40:43], a[56:59], v[192:207]
  v_mfma_f32_32x32x16_bf16 v[208:223], a[44:47], a[56:59], v[208:223]
  v_mfma_f32_32x32x16_bf16 v[224:239], a[32:35], a[60:63], v[224:239]
  v_mfma_f32_32x32x16_bf16 v[240:255], a[36:39], a[60:63], v[240:255]
  v_mfma_f32_32x32x16_bf16 a[0:15], a[40:43], a[60:63], a[0:15]
  v_mfma_f32_32x32x16_bf16 a[16:31], a[44:47], a[60:63], a[16:31]
  s_waitcnt vmcnt(16) lgkmcnt(0)
  s_barrier
  s_mov_b32 s6, -1
  s_mov_b32 s7, -1
  s_mov_b32 s5, 100000
LFL2:
  v_xor_b32 v16, s88, v16
  v_xor_b32 v17, s88, v17
  v_or_b32 v16, v16, v17
  v_xor_b32 v18, s88, v18
  v_or_b32 v16, v16, v18
  v_xor_b32 v19, s88, v19
  v_or_b32 v16, v16, v19
  v_cmp_ne_u32 vcc, 0, v16
  s_nop 1
  s_and_b64 vcc, vcc, s[6:7]
  s_cbranch_vccz LFL2_ok
  s_sub_u32 s5, s5, 1
  s_cmp_eq_u32 s5, 0
  s_cbranch_scc1 LFL2_ok
  s_sleep 1
  s_mov_b32 s4, 0
  buffer_load_dwordx4 v[16:19], v2, s[8:11], s4 offen sc1
  s_waitcnt vmcnt(0)
  s_branch LFL2
LFL2_ok:
  v_mfma_f32_32x32x16_bf16 v[32:47], a[64:67], a[80:83], v[32:47]
  v_add_u32 v7, 0, v5
  ds_read_b64_tr_b16 a[48:49], v8 offset:16384
  ds_read_b64_tr_b16 a[50:51], v8 offset:17408
  v_mfma_f32_32x32x16_bf16 v[48:63], a[68:71], a[80:83], v[48:63]
  ds_read_b128 a[32:35], v7 offset:0
  ds_read_b128 a[36:39], v7 offset:4096
  v_mfma_f32_32x32x16_bf16 v[64:79], a[72:75], a[80:83], v[64:79]
  ds_read_b128 a[40:43], v7 offset:8192
  ds_read_b128 a[44:47], v7 offset:12288
  v_mfma_f32_32x32x16_bf16 v[80:95], a[76:79], a[80:83], v[80:95]
  ds_read_b64_tr_b16 a[52:53], v9 offset:16384
  ds_read_b64_tr_b16 a[54:55], v9 offset:17408
  v_mfma_f32_32x32x16_bf16 v[96:111], a[64:67], a[84:87], v[96:111]
  ds_read_b64_tr_b16 a[56:57], v8 offset:16896
  ds_read_b64_tr_b16 a[58:59], v8 offset:17920
  v_mfma_f32_32x32x16_bf16 v[112:127], a[68:71], a[84:87], v[112:127]
  ds_read_b64_tr_b16 a[60:61], v9 offset:16896
  ds_read_b64_tr_b16 a[62:63], v9 offset:17920
  s_add_u32 m0, s43, 70144
  s_nop 0
  buffer_load_dwordx4 v25, s[56:59], 0 offen sc1 lds
  v_mfma_f32_32x32x16_bf16 v[128:143], a[72:75], a[84:87], v[128:143]
  v_mfma_f32_32x32x16_bf16 v[144:159], a[76:79], a[84:87], v[144:159]
  buffer_load_dwordx4 v25, s[56:59], 0 offen offset:1024 sc1 lds
  v_mfma_f32_32x32x16_bf16 v[160:175], a[64:67], a[88:91], v[160:175]
  v_mfma_f32_32x32x16_bf16 v[176:191], a[68:71], a[88:91], v[176:191]
  v_mfma_f32_32x32x16_bf16 v[192:207], a[72:75], a[88:91], v[192:207]
  buffer_load_dwordx4 v25, s[56:59], s41 offen offset:2048 sc1 lds
  v_mfma_f32_32x32x16_bf16 v[208:223], a[76:79], a[88:91], v[208:223]
  v_mfma_f32_32x32x16_bf16 v[224:239], a[64:67], a[92:95], v[224:239]
  v_mfma_f32_32x32x16_bf16 v[240:255], a[68:71], a[92:95], v[240:255]
  buffer_load_dwordx4 v25, s[56:59], s41 offen offset:3072 sc1 lds
  v_add_u32 v25, 2048, v25
  v_mfma_f32_32x32x16_bf16 a[0:15], a[72:75], a[92:95], a[0:15]
  s_mov_b32 s4, s74
  s_mov_b32 s5, s75
  s_mov_b32 s6, 0x510000
  s_mov_b32 s7, 0x20000
  s_lshl_b32 s33, s2, 2
  s_add_u32 s33, s33, s3
  s_mul_i32 s33, s33, 5184
  s_add_u32 s33, s33, 4608
  v_lshlrev_b32 v23, 7, v1
  s_mov_b32 exec_lo, 0x1f
  s_mov_b32 exec_hi, 0x0
  buffer_load_dword v24, v23, s[4:7], s33 offen
  s_mov_b64 exec, -1
  v_mfma_f32_32x32x16_bf16 a[16:31], a[76:79], a[92:95], a[16:31]
  s_waitcnt lgkmcnt(0)
  v_mfma_f32_32x32x16_bf16 v[32:47], a[32:35], a[48:51], v[32:47]
  v_add_u32 v7, 0, v6
  ds_read_b64_tr_b16 a[80:81], v8 offset:20480
  ds_read_b64_tr_b16 a[82:83], v8 offset:21504
  v_mfma_f32_32x32x16_bf16 v[48:63], a[36:39], a[48:51], v[48:63]
  ds_read_b128 a[64:67], v7 offset:0
  ds_read_b128 a[68:71], v7 offset:4096
  v_mfma_f32_32x32x16_bf16 v[64:79], a[40:43], a[48:51], v[64:79]
  ds_read_b128 a[72:75], v7 offset:8192
  ds_read_b128 a[76:79], v7 offset:12288
  v_mfma_f32_32x32x16_bf16 v[80:95], a[44:47], a[48:51], v[80:95]
  ds_read_b64_tr_b16 a[84:85], v9 offset:20480
  ds_read_b64_tr_b16 a[86:87], v9 offset:21504
  v_mfma_f32_32x32x16_bf16 v[96:111], a[32:35], a[52:55], v[96:111]
  ds_read_b64_tr_b16 a[88:89], v8 offset:20992
  ds_read_b64_tr_b16 a[90:91], v8 offset:22016
  v_mfma_f32_32x32x16_bf16 v[112:127], a[36:39], a[52:55], v[112:127]
  ds_read_b64_tr_b16 a[92:93], v9 offset:20992
  ds_read_b64_tr_b16 a[94:95], v9 offset:22016
  v_mfma_f32_32x32x16_bf16 v[128:143], a[40:43], a[52:55], v[128:143]
  v_mfma_f32_32x32x16_bf16 v[144:159], a[44:47], a[52:55], v[144:159]
  v_mfma_f32_32x32x16_bf16 v[160:175], a[32:35], a[56:59], v[160:175]
  v_mfma_f32_32x32x16_bf16 v[176:191], a[36:39], a[56:59], v[176:191]
  v_mfma_f32_32x32x16_bf16 v[192:207], a[40:43], a[56:59], v[192:207]
  v_mfma_f32_32x32x16_bf16 v[208:223], a[44:47], a[56:59], v[208:223]
  v_mfma_f32_32x32x16_bf16 v[224:239], a[32:35], a[60:63], v[224:239]
  v_mfma_f32_32x32x16_bf16 v[240:255], a[36:39], a[60:63], v[240:255]
  v_mfma_f32_32x32x16_bf16 a[0:15], a[40:43], a[60:63], a[0:15]
  v_mfma_f32_32x32x16_bf16 a[16:31], a[44:47], a[60:63], a[16:31]
  s_waitcnt vmcnt(12) lgkmcnt(0)
  s_barrier
  v_mfma_f32_32x32x16_bf16 v[32:47], a[64:67], a[80:83], v[32:47]
  v_add_u32 v7, 32768, v3
  ds_read_b64_tr_b16 a[48:49], v8 offset:32768
  ds_read_b64_tr_b16 a[50:51], v8 offset:33792
  v_mfma_f32_32x32x16_bf16 v[48:63], a[68:71], a[80:83], v[48:63]
  ds_read_b128 a[32:35], v7 offset:0
  ds_read_b128 a[36:39], v7 offset:4096
  v_mfma_f32_32x32x16_bf16 v[64:79], a[72:75], a[80:83], v[64:79]
  ds_read_b128 a[40:43], v7 offset:8192
  ds_read_b128 a[44:47], v7 offset:12288
  v_mfma_f32_32x32x16_bf16 v[80:95], a[76:79], a[80:83], v[80:95]
  ds_read_b64_tr_b16 a[52:53], v9 offset:32768
  ds_read_b64_tr_b16 a[54:55], v9 offset:33792
  v_mfma_f32_32x32x16_bf16 v[96:111], a[64:67], a[84:87], v[96:111]
  ds_read_b64_tr_b16 a[56:57], v8 offset:33280
  ds_read_b64_tr_b16 a[58:59], v8 offset:34304
  v_mfma_f32_32x32x16_bf16 v[112:127], a[68:71], a[84:87], v[112:127]
  ds_read_b64_tr_b16 a[60:61], v9 offset:33280
  ds_read_b64_tr_b16 a[62:63], v9 offset:34304
  s_add_u32 m0, s44, 70144
  s_nop 0
  buffer_load_dwordx4 v26, s[24:27], 0 offen lds
  v_mfma_f32_32x32x16_bf16 v[128:143], a[72:75], a[84:87], v[128:143]
  v_mfma_f32_32x32x16_bf16 v[144:159], a[76:79], a[84:87], v[144:159]
  buffer_load_dwordx4 v26, s[24:27], s42 offen offset:1024 lds
  v_mfma_f32_32x32x16_bf16 v[160:175], a[64:67], a[88:91], v[160:175]
  v_mfma_f32_32x32x16_bf16 v[176:191], a[68:71], a[88:91], v[176:191]
  s_add_u32 m0, s48, 70144
  s_nop 0
  buffer_load_dwordx4 v26, s[28:31], 0 offen lds
  v_mfma_f32_32x32x16_bf16 v[192:207], a[72:75], a[88:91], v[192:207]
  v_mfma_f32_32x32x16_bf16 v[208:223], a[76:79], a[88:91], v[208:223]
  buffer_load_dwordx4 v26, s[28:31], s42 offen offset:1024 lds
  v_add_u32 v26, 294912, v26
  v_mfma_f32_32x32x16_bf16 v[224:239], a[64:67], a[92:95], v[224:239]
  v_mfma_f32_32x32x16_bf16 v[240:255], a[68:71], a[92:95], v[240:255]
  s_add_u32 m0, s66, 70144
  s_nop 0
  buffer_load_dwordx4 v27, s[60:63], 0 offen lds
  v_add_u32 v27, 294912, v27
  v_mfma_f32_32x32x16_bf16 a[0:15], a[72:75], a[92:95], a[0:15]
  s_mov_b32 s4, s76
  s_mov_b32 s5, s77
  s_mov_b32 s6, 0x510000
  s_mov_b32 s7, 0x20000
  s_lshl_b32 s33, s2, 2
  s_add_u32 s33, s33, s3
  s_mul_i32 s33, s33, 5184
  s_add_u32 s33, s33, 4608
  v_lshlrev_b32 v23, 7, v1
  s_mov_b32 exec_lo, 0x1f
  s_mov_b32 exec_hi, 0x0
  buffer_load_dword v24, v23, s[4:7], s33 offen
  s_mov_b64 exec, -1
  v_mfma_f32_32x32x16_bf16 a[16:31], a[76:79], a[92:95], a[16:31]
  s_waitcnt lgkmcnt(0)
  v_mfma_f32_32x32x16_bf16 v[32:47], a[32:35], a[48:51], v[32:47]
  v_add_u32 v7, 32768, v4
  ds_read_b64_tr_b16 a[80:81], v8 offset:36864
  ds_read_b64_tr_b16 a[82:83], v8 offset:37888
  v_mfma_f32_32x32x16_bf16 v[48:63], a[36:39], a[48:51], v[48:63]
  ds_read_b128 a[64:67], v7 offset:0
  ds_read_b128 a[68:71], v7 offset:4096
  v_mfma_f32_32x32x16_bf16 v[64:79], a[40:43], a[48:51], v[64:79]
  ds_read_b128 a[72:75], v7 offset:8192
  ds_read_b128 a[76:79], v7 offset:12288
  v_mfma_f32_32x32x16_bf16 v[80:95], a[44:47], a[48:51], v[80:95]
  ds_read_b64_tr_b16 a[84:85], v9 offset:36864
  ds_read_b64_tr_b16 a[86:87], v9 offset:37888
  v_mfma_f32_32x32x16_bf16 v[96:111], a[32:35], a[52:55], v[96:111]
  ds_read_b64_tr_b16 a[88:89], v8 offset:37376
  ds_read_b64_tr_b16 a[90:91], v8 offset:38400
  v_mfma_f32_32x32x16_bf16 v[112:127], a[36:39], a[52:55], v[112:127]
  ds_read_b64_tr_b16 a[92:93], v9 offset:37376
  ds_read_b64_tr_b16 a[94:95], v9 offset:38400
  v_mfma_f32_32x32x16_bf16 v[128:143], a[40:43], a[52:55], v[128:143]
  v_mfma_f32_32x32x16_bf16 v[144:159], a[44:47], a[52:55], v[144:159]
  v_mfma_f32_32x32x16_bf16 v[160:175], a[32:35], a[56:59], v[160:175]
  v_mfma_f32_32x32x16_bf16 v[176:191], a[36:39], a[56:59], v[176:191]
  v_mfma_f32_32x32x16_bf16 v[192:207], a[40:43], a[56:59], v[192:207]
  v_mfma_f32_32x32x16_bf16 v[208:223], a[44:47], a[56:59], v[208:223]
  v_mfma_f32_32x32x16_bf16 v[224:239], a[32:35], a[60:63], v[224:239]
  v_mfma_f32_32x32x16_bf16 v[240:255], a[36:39], a[60:63], v[240:255]
  v_mfma_f32_32x32x16_bf16 a[0:15], a[40:43], a[60:63], a[0:15]
  v_mfma_f32_32x32x16_bf16 a[16:31], a[44:47], a[60:63], a[16:31]
  s_waitcnt vmcnt(12) lgkmcnt(0)
  s_barrier
  v_mfma_f32_32x32x16_bf16 v[32:47], a[64:67], a[80:83], v[32:47]
  v_add_u32 v7, 32768, v5
  ds_read_b64_tr_b16 a[48:49], v8 offset:49152
  ds_read_b64_tr_b16 a[50:51], v8 offset:50176
  v_mfma_f32_32x32x16_bf16 v[48:63], a[68:71], a[80:83], v[48:63]
  ds_read_b128 a[32:35], v7 offset:0
  ds_read_b128 a[36:39], v7 offset:4096
  v_mfma_f32_32x32x16_bf16 v[64:79], a[72:75], a[80:83], v[64:79]
  ds_read_b128 a[40:43], v7 offset:8192
  ds_read_b128 a[44:47], v7 offset:12288
  v_mfma_f32_32x32x16_bf16 v[80:95], a[76:79], a[80:83], v[80:95]
  ds_read_b64_tr_b16 a[52:53], v9 offset:49152
  ds_read_b64_tr_b16 a[54:55], v9 offset:50176
  v_mfma_f32_32x32x16_bf16 v[96:111], a[64:67], a[84:87], v[96:111]
  ds_read_b64_tr_b16 a[56:57], v8 offset:49664
  ds_read_b64_tr_b16 a[58:59], v8 offset:50688
  v_mfma_f32_32x32x16_bf16 v[112:127], a[68:71], a[84:87], v[112:127]
  ds_read_b64_tr_b16 a[60:61], v9 offset:49664
  ds_read_b64_tr_b16 a[62:63], v9 offset:50688
  s_add_u32 m0, s43, 105216
  s_nop 0
  buffer_load_dwordx4 v25, s[56:59], 0 offen sc1 lds
  v_mfma_f32_32x32x16_bf16 v[128:143], a[72:75], a[84:87], v[128:143]
  buffer_load_dwordx4 v25, s[56:59], 0 offen offset:1024 sc1 lds
  v_mfma_f32_32x32x16_bf16 v[144:159], a[76:79], a[84:87], v[144:159]
  buffer_load_dwordx4 v25, s[56:59], s41 offen offset:2048 sc1 lds
  v_mfma_f32_32x32x16_bf16 v[160:175], a[64:67], a[88:91], v[160:175]
  buffer_load_dwordx4 v25, s[56:59], s41 offen offset:3072 sc1 lds
  v_add_u32 v25, 2048, v25
  v_mfma_f32_32x32x16_bf16 v[176:191], a[68:71], a[88:91], v[176:191]
  s_add_u32 m0, s44, 105216
  s_nop 0
  buffer_load_dwordx4 v26, s[24:27], 0 offen lds
  v_mfma_f32_32x32x16_bf16 v[192:207], a[72:75], a[88:91], v[192:207]
  v_mfma_f32_32x32x16_bf16 v[208:223], a[76:79], a[88:91], v[208:223]
  buffer_load_dwordx4 v26, s[24:27], s42 offen offset:1024 lds
  v_mfma_f32_32x32x16_bf16 v[224:239], a[64:67], a[92:95], v[224:239]
  s_add_u32 m0, s48, 105216
  s_nop 0
  buffer_load_dwordx4 v26, s[28:31], 0 offen lds
  v_mfma_f32_32x32x16_bf16 v[240:255], a[68:71], a[92:95], v[240:255]
  buffer_load_dwordx4 v26, s[28:31], s42 offen offset:1024 lds
  v_add_u32 v26, 294912, v26
  v_mfma_f32_32x32x16_bf16 a[0:15], a[72:75], a[92:95], a[0:15]
  s_add_u32 m0, s66, 105216
  s_nop 0
  buffer_load_dwordx4 v27, s[60:63], 0 offen lds
  v_add_u32 v27, 294912, v27
  v_mfma_f32_32x32x16_bf16 a[16:31], a[76:79], a[92:95], a[16:31]
  s_mov_b32 s4, s68
  s_mov_b32 s5, s69
  s_mov_b32 s6, 0x480000
  s_mov_b32 s7, 0x20000
  s_lshl_b32 s33, s2, 2
  s_add_u32 s33, s33, s3
  s_mul_i32 s33, s33, 4608
  s_add_u32 s33, s33, 3072
  v_lshlrev_b32 v23, 7, v1
  s_mov_b32 exec_lo, 0xfff
  s_mov_b32 exec_hi, 0x0
  buffer_load_dword v24, v23, s[4:7], s33 offen
  s_mov_b64 exec, -1
  s_waitcnt lgkmcnt(0)
  v_mfma_f32_32x32x16_bf16 v[32:47], a[32:35], a[48:51], v[32:47]
  v_add_u32 v7, 32768, v6
  ds_read_b64_tr_b16 a[80:81], v8 offset:53248
  ds_read_b64_tr_b16 a[82:83], v8 offset:54272
  v_mfma_f32_32x32x16_bf16 v[48:63], a[36:39], a[48:51], v[48:63]
  ds_read_b128 a[64:67], v7 offset:0
  ds_read_b128 a[68:71], v7 offset:4096
  v_mfma_f32_32x32x16_bf16 v[64:79], a[40:43], a[48:51], v[64:79]
  ds_read_b128 a[72:75], v7 offset:8192
  ds_read_b128 a[76:79], v7 offset:12288
  v_mfma_f32_32x32x16_bf16 v[80:95], a[44:47], a[48:51], v[80:95]
  ds_read_b64_tr_b16 a[84:85], v9 offset:53248
  ds_read_b64_tr_b16 a[86:87], v9 offset:54272
  v_mfma_f32_32x32x16_bf16 v[96:111], a[32:35], a[52:55], v[96:111]
  ds_read_b64_tr_b16 a[88:89], v8 offset:53760
  ds_read_b64_tr_b16 a[90:91], v8 offset:54784
  v_mfma_f32_32x32x16_bf16 v[112:127], a[36:39], a[52:55], v[112:127]
  ds_read_b64_tr_b16 a[92:93], v9 offset:53760
  ds_read_b64_tr_b16 a[94:95], v9 offset:54784
  v_mfma_f32_32x32x16_bf16 v[128:143], a[40:43], a[52:55], v[128:143]
  v_mfma_f32_32x32x16_bf16 v[144:159], a[44:47], a[52:55], v[144:159]
  v_mfma_f32_32x32x16_bf16 v[160:175], a[32:35], a[56:59], v[160:175]
  v_mfma_f32_32x32x16_bf16 v[176:191], a[36:39], a[56:59], v[176:191]
  v_mfma_f32_32x32x16_bf16 v[192:207], a[40:43], a[56:59], v[192:207]
  v_mfma_f32_32x32x16_bf16 v[208:223], a[44:47], a[56:59], v[208:223]
  v_mfma_f32_32x32x16_bf16 v[224:239], a[32:35], a[60:63], v[224:239]
  v_mfma_f32_32x32x16_bf16 v[240:255], a[36:39], a[60:63], v[240:255]
  v_mfma_f32_32x32x16_bf16 a[0:15], a[40:43], a[60:63], a[0:15]
  v_mfma_f32_32x32x16_bf16 a[16:31], a[44:47], a[60:63], a[16:31]
  s_waitcnt lgkmcnt(0)
  s_barrier
  v_mfma_f32_32x32x16_bf16 v[32:47], a[64:67], a[80:83], v[32:47]
  v_mfma_f32_32x32x16_bf16 v[48:63], a[68:71], a[80:83], v[48:63]
  v_mfma_f32_32x32x16_bf16 v[64:79], a[72:75], a[80:83], v[64:79]
  v_mfma_f32_32x32x16_bf16 v[80:95], a[76:79], a[80:83], v[80:95]
  v_mfma_f32_32x32x16_bf16 v[96:111], a[64:67], a[84:87], v[96:111]
  v_mfma_f32_32x32x16_bf16 v[112:127], a[68:71], a[84:87], v[112:127]
  s_add_u32 m0, s43, 0
  s_nop 0
  buffer_load_dwordx4 v25, s[56:59], 0 offen sc1 lds
  v_mfma_f32_32x32x16_bf16 v[128:143], a[72:75], a[84:87], v[128:143]
  buffer_load_dwordx4 v25, s[56:59], 0 offen offset:1024 sc1 lds
  v_mfma_f32_32x32x16_bf16 v[144:159], a[76:79], a[84:87], v[144:159]
  buffer_load_dwordx4 v25, s[56:59], s41 offen offset:2048 sc1 lds
  v_mfma_f32_32x32x16_bf16 v[160:175], a[64:67], a[88:91], v[160:175]
  buffer_load_dwordx4 v25, s[56:59], s41 offen offset:3072 sc1 lds
  v_add_u32 v25, 2048, v25
  v_mfma_f32_32x32x16_bf16 v[176:191], a[68:71], a[88:91], v[176:191]
  s_add_u32 m0, s44, 0
  s_nop 0
  buffer_load_dwordx4 v26, s[24:27], 0 offen lds
  v_mfma_f32_32x32x16_bf16 v[192:207], a[72:75], a[88:91], v[192:207]
  v_mfma_f32_32x32x16_bf16 v[208:223], a[76:79], a[88:91], v[208:223]
  buffer_load_dwordx4 v26, s[24:27], s42 offen offset:1024 lds
  v_mfma_f32_32x32x16_bf16 v[224:239], a[64:67], a[92:95], v[224:239]
  s_add_u32 m0, s48, 0
  s_nop 0
  buffer_load_dwordx4 v26, s[28:31], 0 offen lds
  v_mfma_f32_32x32x16_bf16 v[240:255], a[68:71], a[92:95], v[240:255]
  buffer_load_dwordx4 v26, s[28:31], s42 offen offset:1024 lds
  v_add_u32 v26, 294912, v26
  v_mfma_f32_32x32x16_bf16 a[0:15], a[72:75], a[92:95], a[0:15]
  s_add_u32 m0, s66, 0
  s_nop 0
  buffer_load_dwordx4 v27, s[60:63], 0 offen lds
  v_add_u32 v27, 294912, v27
  v_mfma_f32_32x32x16_bf16 a[16:31], a[76:79], a[92:95], a[16:31]
  s_nop 7
L_kvE:
  v_cvt_pk_bf16_f32 v32, v32, v33
  v_cvt_pk_bf16_f32 v33, v34, v35
  v_cvt_pk_bf16_f32 v34, v36, v37
  v_cvt_pk_bf16_f32 v35, v38, v39
  v_cvt_pk_bf16_f32 v36, v40, v41
  v_cvt_pk_bf16_f32 v37, v42, v43
  v_cvt_pk_bf16_f32 v38, v44, v45
  v_cvt_pk_bf16_f32 v39, v46, v47
  v_cvt_pk_bf16_f32 v40, v48, v49
  v_cvt_pk_bf16_f32 v41, v50, v51
  v_cvt_pk_bf16_f32 v42, v52, v53
  v_cvt_pk_bf16_f32 v43, v54, v55
  v_cvt_pk_bf16_f32 v44, v56, v57
  v_cvt_pk_bf16_f32 v45, v58, v59
  v_cvt_pk_bf16_f32 v46, v60, v61
  v_cvt_pk_bf16_f32 v47, v62, v63
  v_cvt_pk_bf16_f32 v48, v64, v65
  v_cvt_pk_bf16_f32 v49, v66, v67
  v_cvt_pk_bf16_f32 v50, v68, v69
  v_cvt_pk_bf16_f32 v51, v70, v71
  v_cvt_pk_bf16_f32 v52, v72, v73
  v_cvt_pk_bf16_f32 v53, v74, v75
  v_cvt_pk_bf16_f32 v54, v76, v77
  v_cvt_pk_bf16_f32 v55, v78, v79
  v_cvt_pk_bf16_f32 v56, v80, v81
  v_cvt_pk_bf16_f32 v57, v82, v83
  v_cvt_pk_bf16_f32 v58, v84, v85
  v_cvt_pk_bf16_f32 v59, v86, v87
  v_cvt_pk_bf16_f32 v60, v88, v89
  v_cvt_pk_bf16_f32 v61, v90, v91
  v_cvt_pk_bf16_f32 v62, v92, v93
  v_cvt_pk_bf16_f32 v63, v94, v95
  v_cvt_pk_bf16_f32 v64, v96, v97
  v_cvt_pk_bf16_f32 v65, v98, v99
  v_cvt_pk_bf16_f32 v66, v100, v101
  v_cvt_pk_bf16_f32 v67, v102, v103
  v_cvt_pk_bf16_f32 v68, v104, v105
  v_cvt_pk_bf16_f32 v69, v106, v107
  v_cvt_pk_bf16_f32 v70, v108, v109
  v_cvt_pk_bf16_f32 v71, v110, v111
  v_cvt_pk_bf16_f32 v72, v112, v113
  v_cvt_pk_bf16_f32 v73, v114, v115
  v_cvt_pk_bf16_f32 v74, v116, v117
  v_cvt_pk_bf16_f32 v75, v118, v119
  v_cvt_pk_bf16_f32 v76, v120, v121
  v_cvt_pk_bf16_f32 v77, v122, v123
  v_cvt_pk_bf16_f32 v78, v124, v125
  v_cvt_pk_bf16_f32 v79, v126, v127
  v_cvt_pk_bf16_f32 v80, v128, v129
  v_cvt_pk_bf16_f32 v81, v130, v131
  v_cvt_pk_bf16_f32 v82, v132, v133
  v_cvt_pk_bf16_f32 v83, v134, v135
  v_cvt_pk_bf16_f32 v84, v136, v137
  v_cvt_pk_bf16_f32 v85, v138, v139
  v_cvt_pk_bf16_f32 v86, v140, v141
  v_cvt_pk_bf16_f32 v87, v142, v143
  v_cvt_pk_bf16_f32 v88, v144, v145
  v_cvt_pk_bf16_f32 v89, v146, v147
  v_cvt_pk_bf16_f32 v90, v148, v149
  v_cvt_pk_bf16_f32 v91, v150, v151
  v_cvt_pk_bf16_f32 v92, v152, v153
  v_cvt_pk_bf16_f32 v93, v154, v155
  v_cvt_pk_bf16_f32 v94, v156, v157
  v_cvt_pk_bf16_f32 v95, v158, v159
  v_cvt_pk_bf16_f32 v96, v160, v161
  v_cvt_pk_bf16_f32 v97, v162, v163
  v_cvt_pk_bf16_f32 v98, v164, v165
  v_cvt_pk_bf16_f32 v99, v166, v167
  v_cvt_pk_bf16_f32 v100, v168, v169
  v_cvt_pk_bf16_f32 v101, v170, v171
  v_cvt_pk_bf16_f32 v102, v172, v173
  v_cvt_pk_bf16_f32 v103, v174, v175
  v_cvt_pk_bf16_f32 v104, v176, v177
  v_cvt_pk_bf16_f32 v105, v178, v179
  v_cvt_pk_bf16_f32 v106, v180, v181
  v_cvt_pk_bf16_f32 v107, v182, v183
  v_cvt_pk_bf16_f32 v108, v184, v185
  v_cvt_pk_bf16_f32 v109, v186, v187
  v_cvt_pk_bf16_f32 v110, v188, v189
  v_cvt_pk_bf16_f32 v111, v190, v191
  v_cvt_pk_bf16_f32 v112, v192, v193
  v_cvt_pk_bf16_f32 v113, v194, v195
  v_cvt_pk_bf16_f32 v114, v196, v197
  v_cvt_pk_bf16_f32 v115, v198, v199
  v_cvt_pk_bf16_f32 v116, v200, v201
  v_cvt_pk_bf16_f32 v117, v202, v203
  v_cvt_pk_bf16_f32 v118, v204, v205
  v_cvt_pk_bf16_f32 v119, v206, v207
  v_cvt_pk_bf16_f32 v120, v208, v209
  v_cvt_pk_bf16_f32 v121, v210, v211
  v_cvt_pk_bf16_f32 v122, v212, v213
  v_cvt_pk_bf16_f32 v123, v214, v215
  v_cvt_pk_bf16_f32 v124, v216, v217
  v_cvt_pk_bf16_f32 v125, v218, v219
  v_cvt_pk_bf16_f32 v126, v220, v221
  v_cvt_pk_bf16_f32 v127, v222, v223
  v_cvt_pk_bf16_f32 v128, v224, v225
  v_cvt_pk_bf16_f32 v129, v226, v227
  v_cvt_pk_bf16_f32 v130, v228, v229
  v_cvt_pk_bf16_f32 v131, v230, v231
  v_cvt_pk_bf16_f32 v132, v232, v233
  v_cvt_pk_bf16_f32 v133, v234, v235
  v_cvt_pk_bf16_f32 v134, v236, v237
  v_cvt_pk_bf16_f32 v135, v238, v239
  v_cvt_pk_bf16_f32 v136, v240, v241
  v_cvt_pk_bf16_f32 v137, v242, v243
  v_cvt_pk_bf16_f32 v138, v244, v245
  v_cvt_pk_bf16_f32 v139, v246, v247
  v_cvt_pk_bf16_f32 v140, v248, v249
  v_cvt_pk_bf16_f32 v141, v250, v251
  v_cvt_pk_bf16_f32 v142, v252, v253
  v_cvt_pk_bf16_f32 v143, v254, v255
  v_accvgpr_read_b32 v224, a0
  v_accvgpr_read_b32 v225, a1
  v_accvgpr_read_b32 v226, a2
  v_accvgpr_read_b32 v227, a3
  v_accvgpr_read_b32 v228, a4
  v_accvgpr_read_b32 v229, a5
  v_accvgpr_read_b32 v230, a6
  v_accvgpr_read_b32 v231, a7
  v_accvgpr_read_b32 v232, a8
  v_accvgpr_read_b32 v233, a9
  v_accvgpr_read_b32 v234, a10
  v_accvgpr_read_b32 v235, a11
  v_accvgpr_read_b32 v236, a12
  v_accvgpr_read_b32 v237, a13
  v_accvgpr_read_b32 v238, a14
  v_accvgpr_read_b32 v239, a15
  v_cvt_pk_bf16_f32 v144, v224, v225
  v_cvt_pk_bf16_f32 v145, v226, v227
  v_cvt_pk_bf16_f32 v146, v228, v229
  v_cvt_pk_bf16_f32 v147, v230, v231
  v_cvt_pk_bf16_f32 v148, v232, v233
  v_cvt_pk_bf16_f32 v149, v234, v235
  v_cvt_pk_bf16_f32 v150, v236, v237
  v_cvt_pk_bf16_f32 v151, v238, v239
  v_accvgpr_read_b32 v224, a16
  v_accvgpr_read_b32 v225, a17
  v_accvgpr_read_b32 v226, a18
  v_accvgpr_read_b32 v227, a19
  v_accvgpr_read_b32 v228, a20
  v_accvgpr_read_b32 v229, a21
  v_accvgpr_read_b32 v230, a22
  v_accvgpr_read_b32 v231, a23
  v_accvgpr_read_b32 v232, a24
  v_accvgpr_read_b32 v233, a25
  v_accvgpr_read_b32 v234, a26
  v_accvgpr_read_b32 v235, a27
  v_accvgpr_read_b32 v236, a28
  v_accvgpr_read_b32 v237, a29
  v_accvgpr_read_b32 v238, a30
  v_accvgpr_read_b32 v239, a31
  v_cvt_pk_bf16_f32 v152, v224, v225
  v_cvt_pk_bf16_f32 v153, v226, v227
  v_cvt_pk_bf16_f32 v154, v228, v229
  v_cvt_pk_bf16_f32 v155, v230, v231
  v_cvt_pk_bf16_f32 v156, v232, v233
  v_cvt_pk_bf16_f32 v157, v234, v235
  v_cvt_pk_bf16_f32 v158, v236, v237
  v_cvt_pk_bf16_f32 v159, v238, v239
  v_lshrrev_b32 v20, 5, v1
  v_lshlrev_b32 v7, 10, v20
  v_bfe_u32 v20, v1, 4, 1
  v_lshl_add_u32 v7, v20, 9, v7
  v_and_b32 v20, 15, v1
  v_lshl_add_u32 v7, v20, 4, v7
  s_lshl_b32 s4, s3, 12
  v_add_u32 v7, s4, v7
  v_lshrrev_b32 v20, 4, v1
  v_lshlrev_b32 v8, 11, v20
  v_and_b32 v20, 1, v20
  v_lshl_add_u32 v8, v20, 5, v8
  v_bfe_u32 v20, v1, 2, 2
  v_lshl_add_u32 v8, v20, 7, v8
  v_lshrrev_b32 v20, 1, v20
  v_lshl_add_u32 v8, v20, 6, v8
  v_and_b32 v20, 3, v1
  v_lshl_add_u32 v8, v20, 3, v8
  v_xor_b32 v9, 32, v8
  v_xor_b32 v10, 64, v8
  v_xor_b32 v29, 96, v8
  v_lshrrev_b32 v20, 5, v1
  v_lshlrev_b32 v13, 9, v20
  v_bfe_u32 v20, v1, 4, 1
  v_lshl_add_u32 v13, v20, 7, v13
  v_bfe_u32 v20, v1, 2, 2
  v_lshl_add_u32 v13, v20, 5, v13
  v_and_b32 v20, 3, v1
  v_lshl_add_u32 v13, v20, 3, v13
  v_add_u32 v3, 70144, v7
  v_add_u32 v16, 70144, v13
  v_add_u32 v4, 70144, v8
  v_add_u32 v5, 70144, v9
  v_add_u32 v6, 70144, v10
  v_add_u32 v30, 70144, v29
  s_waitcnt vmcnt(20)
  s_barrier
  ds_read_b64_tr_b16 v[192:193], v4 offset:16384
  ds_read_b64_tr_b16 v[194:195], v4 offset:17408
  ds_read_b128 v[224:227], v3 offset:0
  ds_read_b128 v[228:231], v3 offset:256
  ds_read_b128 v[232:235], v3 offset:2048
  ds_read_b128 v[236:239], v3 offset:2304
  ds_read_b64_tr_b16 v[196:197], v5 offset:16384
  ds_read_b64_tr_b16 v[198:199], v5 offset:17408
  ds_read_b64_tr_b16 v[200:201], v6 offset:16384
  ds_read_b64_tr_b16 v[202:203], v6 offset:17408
  ds_read_b64_tr_b16 v[204:205], v30 offset:16384
  ds_read_b64_tr_b16 v[206:207], v30 offset:17408
  ds_read_b64_tr_b16 v[208:209], v4 offset:16896
  ds_read_b64_tr_b16 v[210:211], v4 offset:17920
  ds_read_b64_tr_b16 v[212:213], v5 offset:16896
  ds_read_b64_tr_b16 v[214:215], v5 offset:17920
  s_and_b32 s4, s34, 15
  s_lshl_b32 s4, s4, 1
  s_lshr_b32 s5, s3, 1
  s_add_u32 s4, s4, s5
  s_lshl_b32 s4, s4, 6
  s_lshl_b32 s5, s35, 3
  s_and_b32 s6, s3, 1
  s_lshl_b32 s6, s6, 2
  s_add_u32 s5, s5, s6
  s_add_u32 s4, s4, s5
  s_lshl_b32 s4, s4, 13
  v_add_u32 v28, s4, v2
  s_cmp_lt_u32 s34, 16
  s_mov_b32 s4, 0
  s_cselect_b32 s67, 0, s4
  s_mov_b32 s4, 4096
  s_cselect_b32 s70, 1024, s4
  s_mov_b32 s4, 1024
  s_cselect_b32 s71, 2048, s4
  s_mov_b32 s4, 5120
  s_cselect_b32 s82, 3072, s4
  s_mov_b32 s4, 2048
  s_cselect_b32 s83, 4096, s4
  s_mov_b32 s4, 6144
  s_cselect_b32 s86, 5120, s4
  s_mov_b32 s4, 3072
  s_cselect_b32 s87, 6144, s4
  s_mov_b32 s4, 7168
  s_cselect_b32 s94, 7168, s4
  s_waitcnt lgkmcnt(13)
  v_mfma_f32_16x16x32_bf16 a[0:3], v[192:195], v[224:227], 0
  ds_read_b64_tr_b16 v[216:217], v6 offset:16896
  s_waitcnt lgkmcnt(13)
  v_mfma_f32_16x16x32_bf16 a[4:7], v[192:195], v[228:231], 0
  ds_read_b64_tr_b16 v[218:219], v6 offset:17920
  s_waitcnt lgkmcnt(13)
  v_mfma_f32_16x16x32_bf16 a[8:11], v[192:195], v[232:235], 0
  v_add_u32 v14, 105216, v7
  v_add_u32 v15, 105216, v13
  s_waitcnt lgkmcnt(12)
  v_mfma_f32_16x16x32_bf16 a[12:15], v[192:195], v[236:239], 0
  v_add_u32 v17, 105216, v8
  v_add_u32 v18, 105216, v9
  s_waitcnt lgkmcnt(10)
  v_mfma_f32_16x16x32_bf16 a[16:19], v[196:199], v[224:227], 0
  ds_read_b64_tr_b16 v[220:221], v30 offset:16896
  v_mfma_f32_16x16x32_bf16 a[20:23], v[196:199], v[228:231], 0
  ds_read_b64_tr_b16 v[222:223], v30 offset:17920
  v_mfma_f32_16x16x32_bf16 a[24:27], v[196:199], v[232:235], 0
  v_add_u32 v19, 105216, v10
  v_add_u32 v22, 105216, v29
  v_mfma_f32_16x16x32_bf16 a[28:31], v[196:199], v[236:239], 0
  s_waitcnt lgkmcnt(2)
  v_mfma_f32_16x16x32_bf16 a[32:35], v[200:203], v[224:227], 0
  ds_read_b64_tr_b16 v[192:193], v16 offset:32768
  v_mfma_f32_16x16x32_bf16 a[36:39], v[200:203], v[228:231], 0
  ds_read_b64_tr_b16 v[194:195], v16 offset:33024
  v_mfma_f32_16x16x32_bf16 a[40:43], v[200:203], v[232:235], 0
  v_mfma_f32_16x16x32_bf16 a[44:47], v[200:203], v[236:239], 0
  v_mfma_f32_16x16x32_bf16 a[48:51], v[204:207], v[224:227], 0
  ds_read_b64_tr_b16 v[196:197], v4 offset:24576
  v_mfma_f32_16x16x32_bf16 a[52:55], v[204:207], v[228:231], 0
  ds_read_b64_tr_b16 v[198:199], v4 offset:25600
  v_mfma_f32_16x16x32_bf16 a[56:59], v[204:207], v[232:235], 0
  v_mfma_f32_16x16x32_bf16 a[60:63], v[204:207], v[236:239], 0
  v_mfma_f32_16x16x32_bf16 a[64:67], v[208:211], v[224:227], 0
  ds_read_b64_tr_b16 v[200:201], v5 offset:24576
  v_mfma_f32_16x16x32_bf16 a[68:71], v[208:211], v[228:231], 0
  ds_read_b64_tr_b16 v[202:203], v5 offset:25600
  v_mfma_f32_16x16x32_bf16 a[72:75], v[208:211], v[232:235], 0
  v_mfma_f32_16x16x32_bf16 a[76:79], v[208:211], v[236:239], 0
  v_mfma_f32_16x16x32_bf16 a[80:83], v[212:215], v[224:227], 0
  ds_read_b64_tr_b16 v[204:205], v6 offset:24576
  v_mfma_f32_16x16x32_bf16 a[84:87], v[212:215], v[228:231], 0
  ds_read_b64_tr_b16 v[206:207], v6 offset:25600
  v_mfma_f32_16x16x32_bf16 a[88:91], v[212:215], v[232:235], 0
  v_mfma_f32_16x16x32_bf16 a[92:95], v[212:215], v[236:239], 0
  v_mfma_f32_16x16x32_bf16 a[96:99], v[216:219], v[224:227], 0
  ds_read_b64_tr_b16 v[208:209], v30 offset:24576
  v_mfma_f32_16x16x32_bf16 a[100:103], v[216:219], v[228:231], 0
  ds_read_b64_tr_b16 v[210:211], v30 offset:25600
  v_mfma_f32_16x16x32_bf16 a[104:107], v[216:219], v[232:235], 0
  s_add_u32 s4, s67, 0
  v_mfma_f32_16x16x32_bf16 a[108:111], v[216:219], v[236:239], 0
  buffer_store_dwordx4 v[32:35], v28, s[20:23], s4 offen sc1
  s_waitcnt lgkmcnt(2)
  v_mfma_f32_16x16x32_bf16 a[112:115], v[220:223], v[224:227], 0
  ds_read_b64_tr_b16 v[212:213], v4 offset:25088
  v_mfma_f32_16x16x32_bf16 a[116:119], v[220:223], v[228:231], 0
  ds_read_b64_tr_b16 v[214:215], v4 offset:26112
  v_mfma_f32_16x16x32_bf16 a[120:123], v[220:223], v[232:235], 0
  v_mfma_f32_16x16x32_bf16 a[124:127], v[220:223], v[236:239], 0
  v_mfma_f32_16x16x32_bf16 v[160:163], v[192:195], v[224:227], 0
  ds_read_b64_tr_b16 v[216:217], v5 offset:25088
  v_mfma_f32_16x16x32_bf16 v[164:167], v[192:195], v[228:231], 0
  ds_read_b64_tr_b16 v[218:219], v5 offset:26112
  v_mfma_f32_16x16x32_bf16 v[168:171], v[192:195], v[232:235], 0
  v_mfma_f32_16x16x32_bf16 v[172:175], v[192:195], v[236:239], 0
  v_mfma_f32_16x16x32_bf16 a[128:131], v[196:199], v[224:227], 0
  ds_read_b64_tr_b16 v[220:221], v6 offset:25088
  v_mfma_f32_16x16x32_bf16 a[132:135], v[196:199], v[228:231], 0
  ds_read_b64_tr_b16 v[222:223], v6 offset:26112
  v_mfma_f32_16x16x32_bf16 a[136:139], v[196:199], v[232:235], 0
  s_add_u32 s4, s70, 0
  v_mfma_f32_16x16x32_bf16 a[140:143], v[196:199], v[236:239], 0
  buffer_store_dwordx4 v[36:39], v28, s[20:23], s4 offen sc1
  v_mfma_f32_16x16x32_bf16 a[144:147], v[200:203], v[224:227], 0
  ds_read_b64_tr_b16 v[192:193], v30 offset:25088
  v_mfma_f32_16x16x32_bf16 a[148:151], v[200:203], v[228:231], 0
  ds_read_b64_tr_b16 v[194:195], v30 offset:26112
  v_mfma_f32_16x16x32_bf16 a[152:155], v[200:203], v[232:235], 0
  v_mfma_f32_16x16x32_bf16 a[156:159], v[200:203], v[236:239], 0
  v_mfma_f32_16x16x32_bf16 a[160:163], v[204:207], v[224:227], 0
  ds_read_b64_tr_b16 v[196:197], v16 offset:33920
  v_mfma_f32_16x16x32_bf16 a[164:167], v[204:207], v[228:231], 0
  ds_read_b64_tr_b16 v[198:199], v16 offset:34176
  v_mfma_f32_16x16x32_bf16 a[168:171], v[204:207], v[232:235], 0
  v_mfma_f32_16x16x32_bf16 a[172:175], v[204:207], v[236:239], 0
  s_waitcnt vmcnt(12)
  s_barrier
  s_add_u32 m0, s43, 35072
  s_waitcnt lgkmcnt(2)
  v_mfma_f32_16x16x32_bf16 a[176:179], v[208:211], v[224:227], 0
  ds_read_b64_tr_b16 v[200:201], v17 offset:16384
  v_mfma_f32_16x16x32_bf16 a[180:183], v[208:211], v[228:231], 0
  ds_read_b64_tr_b16 v[202:203], v17 offset:17408
  v_mfma_f32_16x16x32_bf16 a[184:187], v[208:211], v[232:235], 0
  ds_read_b128 v[240:243], v14 offset:0
  v_mfma_f32_16x16x32_bf16 a[188:191], v[208:211], v[236:239], 0
  ds_read_b128 v[244:247], v14 offset:256
  v_mfma_f32_16x16x32_bf16 a[192:195], v[212:215], v[224:227], 0
  ds_read_b64_tr_b16 v[204:205], v18 offset:16384
  v_mfma_f32_16x16x32_bf16 a[196:199], v[212:215], v[228:231], 0
  ds_read_b64_tr_b16 v[206:207], v18 offset:17408
  v_mfma_f32_16x16x32_bf16 a[200:203], v[212:215], v[232:235], 0
  ds_read_b128 v[248:251], v14 offset:2048
  v_mfma_f32_16x16x32_bf16 a[204:207], v[212:215], v[236:239], 0
  ds_read_b128 v[252:255], v14 offset:2304
  v_mfma_f32_16x16x32_bf16 a[208:211], v[216:219], v[224:227], 0
  ds_read_b64_tr_b16 v[208:209], v19 offset:16384
  v_mfma_f32_16x16x32_bf16 a[212:215], v[216:219], v[228:231], 0
  ds_read_b64_tr_b16 v[210:211], v19 offset:17408
  v_mfma_f32_16x16x32_bf16 a[216:219], v[216:219], v[232:235], 0
  buffer_load_dwordx4 v25, s[56:59], 0 offen sc1 lds
  v_mfma_f32_16x16x32_bf16 a[220:223], v[216:219], v[236:239], 0
  v_mfma_f32_16x16x32_bf16 a[224:227], v[220:223], v[224:227], 0
  ds_read_b64_tr_b16 v[212:213], v22 offset:16384
  v_mfma_f32_16x16x32_bf16 a[228:231], v[220:223], v[228:231], 0
  ds_read_b64_tr_b16 v[214:215], v22 offset:17408
  v_mfma_f32_16x16x32_bf16 a[232:235], v[220:223], v[232:235], 0
  buffer_load_dwordx4 v25, s[56:59], 0 offen offset:1024 sc1 lds
  v_mfma_f32_16x16x32_bf16 a[236:239], v[220:223], v[236:239], 0
  v_mfma_f32_16x16x32_bf16 a[240:243], v[192:195], v[224:227], 0
  ds_read_b64_tr_b16 v[216:217], v17 offset:16896
  v_mfma_f32_16x16x32_bf16 a[244:247], v[192:195], v[228:231], 0
  ds_read_b64_tr_b16 v[218:219], v17 offset:17920
  v_mfma_f32_16x16x32_bf16 a[248:251], v[192:195], v[232:235], 0
  buffer_load_dwordx4 v25, s[56:59], s41 offen offset:2048 sc1 lds
  v_mfma_f32_16x16x32_bf16 a[252:255], v[192:195], v[236:239], 0
  s_waitcnt lgkmcnt(2)
  v_mfma_f32_16x16x32_bf16 v[176:179], v[196:199], v[224:227], 0
  ds_read_b64_tr_b16 v[220:221], v18 offset:16896
  v_mfma_f32_16x16x32_bf16 v[180:183], v[196:199], v[228:231], 0
  ds_read_b64_tr_b16 v[222:223], v18 offset:17920
  v_mfma_f32_16x16x32_bf16 v[184:187], v[196:199], v[232:235], 0
  buffer_load_dwordx4 v25, s[56:59], s41 offen offset:3072 sc1 lds
  v_mfma_f32_16x16x32_bf16 v[188:191], v[196:199], v[236:239], 0
  v_add_u32 v25, 2048, v25
  s_add_u32 m0, s44, 35072
  v_mfma_f32_16x16x32_bf16 a[0:3], v[200:203], v[240:243], a[0:3]
  ds_read_b64_tr_b16 v[192:193], v19 offset:16896
  v_mfma_f32_16x16x32_bf16 a[4:7], v[200:203], v[244:247], a[4:7]
  ds_read_b64_tr_b16 v[194:195], v19 offset:17920
  v_mfma_f32_16x16x32_bf16 a[8:11], v[200:203], v[248:251], a[8:11]
  buffer_load_dwordx4 v26, s[24:27], 0 offen lds
  v_mfma_f32_16x16x32_bf16 a[12:15], v[200:203], v[252:255], a[12:15]
  v_mfma_f32_16x16x32_bf16 a[16:19], v[204:207], v[240:243], a[16:19]
  ds_read_b64_tr_b16 v[196:197], v22 offset:16896
  v_mfma_f32_16x16x32_bf16 a[20:23], v[204:207], v[244:247], a[20:23]
  ds_read_b64_tr_b16 v[198:199], v22 offset:17920
  v_mfma_f32_16x16x32_bf16 a[24:27], v[204:207], v[248:251], a[24:27]
  buffer_load_dwordx4 v26, s[24:27], s42 offen offset:1024 lds
  v_mfma_f32_16x16x32_bf16 a[28:31], v[204:207], v[252:255], a[28:31]
  s_add_u32 m0, s48, 35072
  v_mfma_f32_16x16x32_bf16 a[32:35], v[208:211], v[240:243], a[32:35]
  ds_read_b64_tr_b16 v[200:201], v15 offset:32768
  v_mfma_f32_16x16x32_bf16 a[36:39], v[208:211], v[244:247], a[36:39]
  ds_read_b64_tr_b16 v[202:203], v15 offset:33024
  v_mfma_f32_16x16x32_bf16 a[40:43], v[208:211], v[248:251], a[40:43]
  buffer_load_dwordx4 v26, s[28:31], 0 offen lds
  v_mfma_f32_16x16x32_bf16 a[44:47], v[208:211], v[252:255], a[44:47]
  v_mfma_f32_16x16x32_bf16 a[48:51], v[212:215], v[240:243], a[48:51]
  ds_read_b64_tr_b16 v[204:205], v17 offset:24576
  v_mfma_f32_16x16x32_bf16 a[52:55], v[212:215], v[244:247], a[52:55]
  ds_read_b64_tr_b16 v[206:207], v17 offset:25600
  v_mfma_f32_16x16x32_bf16 a[56:59], v[212:215], v[248:251], a[56:59]
  buffer_load_dwordx4 v26, s[28:31], s42 offen offset:1024 lds
  v_mfma_f32_16x16x32_bf16 a[60:63], v[212:215], v[252:255], a[60:63]
  v_add_u32 v26, 294912, v26
  s_add_u32 m0, s66, 35072
  s_waitcnt lgkmcnt(2)
  v_mfma_f32_16x16x32_bf16 a[64:67], v[216:219], v[240:243], a[64:67]
  ds_read_b64_tr_b16 v[208:209], v18 offset:24576
  v_mfma_f32_16x16x32_bf16 a[68:71], v[216:219], v[244:247], a[68:71]
  ds_read_b64_tr_b16 v[210:211], v18 offset:25600
  v_mfma_f32_16x16x32_bf16 a[72:75], v[216:219], v[248:251], a[72:75]
  buffer_load_dwordx4 v27, s[60:63], 0 offen lds
  v_mfma_f32_16x16x32_bf16 a[76:79], v[216:219], v[252:255], a[76:79]
  v_add_u32 v27, 294912, v27
  v_mfma_f32_16x16x32_bf16 a[80:83], v[220:223], v[240:243], a[80:83]
  ds_read_b64_tr_b16 v[212:213], v19 offset:24576
  v_mfma_f32_16x16x32_bf16 a[84:87], v[220:223], v[244:247], a[84:87]
  ds_read_b64_tr_b16 v[214:215], v19 offset:25600
  v_mfma_f32_16x16x32_bf16 a[88:91], v[220:223], v[248:251], a[88:91]
  v_add_u32 v3, 0, v7
  v_add_u32 v16, 0, v13
  v_mfma_f32_16x16x32_bf16 a[92:95], v[220:223], v[252:255], a[92:95]
  v_add_u32 v4, 0, v8
  v_add_u32 v5, 0, v9
  v_mfma_f32_16x16x32_bf16 a[96:99], v[192:195], v[240:243], a[96:99]
  ds_read_b64_tr_b16 v[216:217], v22 offset:24576
  v_mfma_f32_16x16x32_bf16 a[100:103], v[192:195], v[244:247], a[100:103]
  ds_read_b64_tr_b16 v[218:219], v22 offset:25600
  v_mfma_f32_16x16x32_bf16 a[104:107], v[192:195], v[248:251], a[104:107]
  s_add_u32 s4, s67, 8192
  v_mfma_f32_16x16x32_bf16 a[108:111], v[192:195], v[252:255], a[108:111]
  buffer_store_dwordx4 v[40:43], v28, s[20:23], s4 offen sc1
  v_mfma_f32_16x16x32_bf16 a[112:115], v[196:199], v[240:243], a[112:115]
  ds_read_b64_tr_b16 v[220:221], v17 offset:25088
  v_mfma_f32_16x16x32_bf16 a[116:119], v[196:199], v[244:247], a[116:119]
  ds_read_b64_tr_b16 v[222:223], v17 offset:26112
  v_mfma_f32_16x16x32_bf16 a[120:123], v[196:199], v[248:251], a[120:123]
  v_add_u32 v6, 0, v10
  v_add_u32 v30, 0, v29
  v_mfma_f32_16x16x32_bf16 a[124:127], v[196:199], v[252:255], a[124:127]
  v_mfma_f32_16x16x32_bf16 v[160:163], v[200:203], v[240:243], v[160:163]
  ds_read_b64_tr_b16 v[192:193], v18 offset:25088
  v_mfma_f32_16x16x32_bf16 v[164:167], v[200:203], v[244:247], v[164:167]
  ds_read_b64_tr_b16 v[194:195], v18 offset:26112
  v_mfma_f32_16x16x32_bf16 v[168:171], v[200:203], v[248:251], v[168:171]
  v_mfma_f32_16x16x32_bf16 v[172:175], v[200:203], v[252:255], v[172:175]
  s_waitcnt lgkmcnt(2)
  v_mfma_f32_16x16x32_bf16 a[128:131], v[204:207], v[240:243], a[128:131]
  ds_read_b64_tr_b16 v[196:197], v19 offset:25088
  v_mfma_f32_16x16x32_bf16 a[132:135], v[204:207], v[244:247], a[132:135]
  ds_read_b64_tr_b16 v[198:199], v19 offset:26112
  v_mfma_f32_16x16x32_bf16 a[136:139], v[204:207], v[248:251], a[136:139]
  s_add_u32 s4, s70, 8192
  v_mfma_f32_16x16x32_bf16 a[140:143], v[204:207], v[252:255], a[140:143]
  buffer_store_dwordx4 v[44:47], v28, s[20:23], s4 offen sc1
  v_mfma_f32_16x16x32_bf16 a[144:147], v[208:211], v[240:243], a[144:147]
  ds_read_b64_tr_b16 v[200:201], v22 offset:25088
  v_mfma_f32_16x16x32_bf16 a[148:151], v[208:211], v[244:247], a[148:151]
  ds_read_b64_tr_b16 v[202:203], v22 offset:26112
  v_mfma_f32_16x16x32_bf16 a[152:155], v[208:211], v[248:251], a[152:155]
  v_mfma_f32_16x16x32_bf16 a[156:159], v[208:211], v[252:255], a[156:159]
  v_mfma_f32_16x16x32_bf16 a[160:163], v[212:215], v[240:243], a[160:163]
  ds_read_b64_tr_b16 v[204:205], v15 offset:33920
  v_mfma_f32_16x16x32_bf16 a[164:167], v[212:215], v[244:247], a[164:167]
  ds_read_b64_tr_b16 v[206:207], v15 offset:34176
  v_mfma_f32_16x16x32_bf16 a[168:171], v[212:215], v[248:251], a[168:171]
  v_mfma_f32_16x16x32_bf16 a[172:175], v[212:215], v[252:255], a[172:175]
  s_waitcnt vmcnt(13)
  s_barrier
  s_add_u32 m0, s43, 70144
  v_mfma_f32_16x16x32_bf16 a[176:179], v[216:219], v[240:243], a[176:179]
  ds_read_b64_tr_b16 v[208:209], v4 offset:16384
  v_mfma_f32_16x16x32_bf16 a[180:183], v[216:219], v[244:247], a[180:183]
  ds_read_b64_tr_b16 v[210:211], v4 offset:17408
  v_mfma_f32_16x16x32_bf16 a[184:187], v[216:219], v[248:251], a[184:187]
  ds_read_b128 v[224:227], v3 offset:0
  v_mfma_f32_16x16x32_bf16 a[188:191], v[216:219], v[252:255], a[188:191]
  ds_read_b128 v[228:231], v3 offset:256
  v_mfma_f32_16x16x32_bf16 a[192:195], v[220:223], v[240:243], a[192:195]
  ds_read_b64_tr_b16 v[212:213], v5 offset:16384
  v_mfma_f32_16x16x32_bf16 a[196:199], v[220:223], v[244:247], a[196:199]
  ds_read_b64_tr_b16 v[214:215], v5 offset:17408
  v_mfma_f32_16x16x32_bf16 a[200:203], v[220:223], v[248:251], a[200:203]
  ds_read_b128 v[232:235], v3 offset:2048
  v_mfma_f32_16x16x32_bf16 a[204:207], v[220:223], v[252:255], a[204:207]
  ds_read_b128 v[236:239], v3 offset:2304
  s_waitcnt lgkmcnt(6)
  v_mfma_f32_16x16x32_bf16 a[208:211], v[192:195], v[240:243], a[208:211]
  ds_read_b64_tr_b16 v[216:217], v6 offset:16384
  v_mfma_f32_16x16x32_bf16 a[212:215], v[192:195], v[244:247], a[212:215]
  ds_read_b64_tr_b16 v[218:219], v6 offset:17408
  v_mfma_f32_16x16x32_bf16 a[216:219], v[192:195], v[248:251], a[216:219]
  buffer_load_dwordx4 v25, s[56:59], 0 offen sc1 lds
  v_mfma_f32_16x16x32_bf16 a[220:223], v[192:195], v[252:255], a[220:223]
  v_mfma_f32_16x16x32_bf16 a[224:227], v[196:199], v[240:243], a[224:227]
  ds_read_b64_tr_b16 v[220:221], v30 offset:16384
  v_mfma_f32_16x16x32_bf16 a[228:231], v[196:199], v[244:247], a[228:231]
  ds_read_b64_tr_b16 v[222:223], v30 offset:17408
  v_mfma_f32_16x16x32_bf16 a[232:235], v[196:199], v[248:251], a[232:235]
  buffer_load_dwordx4 v25, s[56:59], 0 offen offset:1024 sc1 lds
  v_mfma_f32_16x16x32_bf16 a[236:239], v[196:199], v[252:255], a[236:239]
  v_mfma_f32_16x16x32_bf16 a[240:243], v[200:203], v[240:243], a[240:243]
  ds_read_b64_tr_b16 v[192:193], v4 offset:16896
  v_mfma_f32_16x16x32_bf16 a[244:247], v[200:203], v[244:247], a[244:247]
  ds_read_b64_tr_b16 v[194:195], v4 offset:17920
  v_mfma_f32_16x16x32_bf16 a[248:251], v[200:203], v[248:251], a[248:251]
  buffer_load_dwordx4 v25, s[56:59], s41 offen offset:2048 sc1 lds
  v_mfma_f32_16x16x32_bf16 a[252:255], v[200:203], v[252:255], a[252:255]
  v_mfma_f32_16x16x32_bf16 v[176:179], v[204:207], v[240:243], v[176:179]
  ds_read_b64_tr_b16 v[196:197], v5 offset:16896
  v_mfma_f32_16x16x32_bf16 v[180:183], v[204:207], v[244:247], v[180:183]
  ds_read_b64_tr_b16 v[198:199], v5 offset:17920
  v_mfma_f32_16x16x32_bf16 v[184:187], v[204:207], v[248:251], v[184:187]
  buffer_load_dwordx4 v25, s[56:59], s41 offen offset:3072 sc1 lds
  v_mfma_f32_16x16x32_bf16 v[188:191], v[204:207], v[252:255], v[188:191]
  v_add_u32 v25, 2048, v25
  s_add_u32 m0, s44, 70144
  s_waitcnt lgkmcnt(2)
  v_mfma_f32_16x16x32_bf16 a[0:3], v[208:211], v[224:227], a[0:3]
  ds_read_b64_tr_b16 v[200:201], v6 offset:16896
  v_mfma_f32_16x16x32_bf16 a[4:7], v[208:211], v[228:231], a[4:7]
  ds_read_b64_tr_b16 v[202:203], v6 offset:17920
  v_mfma_f32_16x16x32_bf16 a[8:11], v[208:211], v[232:235], a[8:11]
  buffer_load_dwordx4 v26, s[24:27], 0 offen lds
  v_mfma_f32_16x16x32_bf16 a[12:15], v[208:211], v[236:239], a[12:15]
  v_mfma_f32_16x16x32_bf16 a[16:19], v[212:215], v[224:227], a[16:19]
  ds_read_b64_tr_b16 v[204:205], v30 offset:16896
  v_mfma_f32_16x16x32_bf16 a[20:23], v[212:215], v[228:231], a[20:23]
  ds_read_b64_tr_b16 v[206:207], v30 offset:17920
  v_mfma_f32_16x16x32_bf16 a[24:27], v[212:215], v[232:235], a[24:27]
  buffer_load_dwordx4 v26, s[24:27], s42 offen offset:1024 lds
  v_mfma_f32_16x16x32_bf16 a[28:31], v[212:215], v[236:239], a[28:31]
  s_add_u32 m0, s48, 70144
  v_mfma_f32_16x16x32_bf16 a[32:35], v[216:219], v[224:227], a[32:35]
  ds_read_b64_tr_b16 v[208:209], v16 offset:32768
  v_mfma_f32_16x16x32_bf16 a[36:39], v[216:219], v[228:231], a[36:39]
  ds_read_b64_tr_b16 v[210:211], v16 offset:33024
  v_mfma_f32_16x16x32_bf16 a[40:43], v[216:219], v[232:235], a[40:43]
  buffer_load_dwordx4 v26, s[28:31], 0 offen lds
  v_mfma_f32_16x16x32_bf16 a[44:47], v[216:219], v[236:239], a[44:47]
  v_mfma_f32_16x16x32_bf16 a[48:51], v[220:223], v[224:227], a[48:51]
  ds_read_b64_tr_b16 v[212:213], v4 offset:24576
  v_mfma_f32_16x16x32_bf16 a[52:55], v[220:223], v[228:231], a[52:55]
  ds_read_b64_tr_b16 v[214:215], v4 offset:25600
  v_mfma_f32_16x16x32_bf16 a[56:59], v[220:223], v[232:235], a[56:59]
  buffer_load_dwordx4 v26, s[28:31], s42 offen offset:1024 lds
  v_mfma_f32_16x16x32_bf16 a[60:63], v[220:223], v[236:239], a[60:63]
  v_add_u32 v26, 294912, v26
  s_add_u32 m0, s66, 70144
  v_mfma_f32_16x16x32_bf16 a[64:67], v[192:195], v[224:227], a[64:67]
  ds_read_b64_tr_b16 v[216:217], v5 offset:24576
  v_mfma_f32_16x16x32_bf16 a[68:71], v[192:195], v[228:231], a[68:71]
  ds_read_b64_tr_b16 v[218:219], v5 offset:25600
  v_mfma_f32_16x16x32_bf16 a[72:75], v[192:195], v[232:235], a[72:75]
  buffer_load_dwordx4 v27, s[60:63], 0 offen lds
  v_mfma_f32_16x16x32_bf16 a[76:79], v[192:195], v[236:239], a[76:79]
  v_add_u32 v27, 294912, v27
  s_waitcnt lgkmcnt(2)
  v_mfma_f32_16x16x32_bf16 a[80:83], v[196:199], v[224:227], a[80:83]
  ds_read_b64_tr_b16 v[220:221], v6 offset:24576
  v_mfma_f32_16x16x32_bf16 a[84:87], v[196:199], v[228:231], a[84:87]
  ds_read_b64_tr_b16 v[222:223], v6 offset:25600
  v_mfma_f32_16x16x32_bf16 a[88:91], v[196:199], v[232:235], a[88:91]
  v_add_u32 v14, 35072, v7
  v_add_u32 v15, 35072, v13
  v_mfma_f32_16x16x32_bf16 a[92:95], v[196:199], v[236:239], a[92:95]
  v_add_u32 v17, 35072, v8
  v_add_u32 v18, 35072, v9
  v_mfma_f32_16x16x32_bf16 a[96:99], v[200:203], v[224:227], a[96:99]
  ds_read_b64_tr_b16 v[192:193], v30 offset:24576
  v_mfma_f32_16x16x32_bf16 a[100:103], v[200:203], v[228:231], a[100:103]
  ds_read_b64_tr_b16 v[194:195], v30 offset:25600
  v_mfma_f32_16x16x32_bf16 a[104:107], v[200:203], v[232:235], a[104:107]
  s_add_u32 s4, s67, 16384
  v_mfma_f32_16x16x32_bf16 a[108:111], v[200:203], v[236:239], a[108:111]
  buffer_store_dwordx4 v[48:51], v28, s[20:23], s4 offen sc1
  v_mfma_f32_16x16x32_bf16 a[112:115], v[204:207], v[224:227], a[112:115]
  ds_read_b64_tr_b16 v[196:197], v4 offset:25088
  v_mfma_f32_16x16x32_bf16 a[116:119], v[204:207], v[228:231], a[116:119]
  ds_read_b64_tr_b16 v[198:199], v4 offset:26112
  v_mfma_f32_16x16x32_bf16 a[120:123], v[204:207], v[232:235], a[120:123]
  v_add_u32 v19, 35072, v10
  v_add_u32 v22, 35072, v29
  v_mfma_f32_16x16x32_bf16 a[124:127], v[204:207], v[236:239], a[124:127]
  s_and_b32 s95, s90, 3
  s_lshl_b32 s100, s89, 2
  v_mfma_f32_16x16x32_bf16 v[160:163], v[208:211], v[224:227], v[160:163]
  ds_read_b64_tr_b16 v[200:201], v5 offset:25088
  v_mfma_f32_16x16x32_bf16 v[164:167], v[208:211], v[228:231], v[164:167]
  ds_read_b64_tr_b16 v[202:203], v5 offset:26112
  v_mfma_f32_16x16x32_bf16 v[168:171], v[208:211], v[232:235], v[168:171]
  s_add_u32 s50, s100, s95
  s_lshr_b32 s51, s90, 2
  v_mfma_f32_16x16x32_bf16 v[172:175], v[208:211], v[236:239], v[172:175]
  s_lshl_b32 s52, s51, 1
  s_add_u32 s52, s52, 2
  v_mfma_f32_16x16x32_bf16 a[128:131], v[212:215], v[224:227], a[128:131]
  ds_read_b64_tr_b16 v[204:205], v6 offset:25088
  v_mfma_f32_16x16x32_bf16 a[132:135], v[212:215], v[228:231], a[132:135]
  ds_read_b64_tr_b16 v[206:207], v6 offset:26112
  v_mfma_f32_16x16x32_bf16 a[136:139], v[212:215], v[232:235], a[136:139]
  s_add_u32 s4, s70, 16384
  v_mfma_f32_16x16x32_bf16 a[140:143], v[212:215], v[236:239], a[140:143]
  buffer_store_dwordx4 v[52:55], v28, s[20:23], s4 offen sc1
  s_waitcnt lgkmcnt(2)
  v_mfma_f32_16x16x32_bf16 a[144:147], v[216:219], v[224:227], a[144:147]
  ds_read_b64_tr_b16 v[208:209], v30 offset:25088
  v_mfma_f32_16x16x32_bf16 a[148:151], v[216:219], v[228:231], a[148:151]
  ds_read_b64_tr_b16 v[210:211], v30 offset:26112
  v_mfma_f32_16x16x32_bf16 a[152:155], v[216:219], v[232:235], a[152:155]
  s_lshl_b32 s95, s51, 1
  s_sub_u32 s53, 32, s95
  v_mfma_f32_16x16x32_bf16 a[156:159], v[216:219], v[236:239], a[156:159]
  s_mov_b32 s12, s68
  s_mov_b32 s13, s69
  v_mfma_f32_16x16x32_bf16 a[160:163], v[220:223], v[224:227], a[160:163]
  ds_read_b64_tr_b16 v[212:213], v16 offset:33920
  v_mfma_f32_16x16x32_bf16 a[164:167], v[220:223], v[228:231], a[164:167]
  ds_read_b64_tr_b16 v[214:215], v16 offset:34176
  v_mfma_f32_16x16x32_bf16 a[168:171], v[220:223], v[232:235], a[168:171]
  s_mov_b32 s14, 0x480000
  s_mov_b32 s15, 0x20000
  v_mfma_f32_16x16x32_bf16 a[172:175], v[220:223], v[236:239], a[172:175]
  s_lshl_b32 s95, s51, 2
  s_add_u32 s95, s95, s3
  s_waitcnt vmcnt(13)
  s_barrier
  s_add_u32 m0, s43, 105216
  v_mfma_f32_16x16x32_bf16 a[176:179], v[192:195], v[224:227], a[176:179]
  ds_read_b64_tr_b16 v[216:217], v17 offset:16384
  v_mfma_f32_16x16x32_bf16 a[180:183], v[192:195], v[228:231], a[180:183]
  ds_read_b64_tr_b16 v[218:219], v17 offset:17408
  v_mfma_f32_16x16x32_bf16 a[184:187], v[192:195], v[232:235], a[184:187]
  ds_read_b128 v[240:243], v14 offset:0
  v_mfma_f32_16x16x32_bf16 a[188:191], v[192:195], v[236:239], a[188:191]
  ds_read_b128 v[244:247], v14 offset:256
  v_mfma_f32_16x16x32_bf16 a[192:195], v[196:199], v[224:227], a[192:195]
  ds_read_b64_tr_b16 v[220:221], v18 offset:16384
  v_mfma_f32_16x16x32_bf16 a[196:199], v[196:199], v[228:231], a[196:199]
  ds_read_b64_tr_b16 v[222:223], v18 offset:17408
  v_mfma_f32_16x16x32_bf16 a[200:203], v[196:199], v[232:235], a[200:203]
  ds_read_b128 v[248:251], v14 offset:2048
  v_mfma_f32_16x16x32_bf16 a[204:207], v[196:199], v[236:239], a[204:207]
  ds_read_b128 v[252:255], v14 offset:2304
  v_mfma_f32_16x16x32_bf16 a[208:211], v[200:203], v[224:227], a[208:211]
  ds_read_b64_tr_b16 v[192:193], v19 offset:16384
  v_mfma_f32_16x16x32_bf16 a[212:215], v[200:203], v[228:231], a[212:215]
  ds_read_b64_tr_b16 v[194:195], v19 offset:17408
  v_mfma_f32_16x16x32_bf16 a[216:219], v[200:203], v[232:235], a[216:219]
  buffer_load_dwordx4 v25, s[56:59], 0 offen sc1 lds
  v_mfma_f32_16x16x32_bf16 a[220:223], v[200:203], v[236:239], a[220:223]
  s_waitcnt lgkmcnt(4)
  v_mfma_f32_16x16x32_bf16 a[224:227], v[204:207], v[224:227], a[224:227]
  ds_read_b64_tr_b16 v[196:197], v22 offset:16384
  v_mfma_f32_16x16x32_bf16 a[228:231], v[204:207], v[228:231], a[228:231]
  ds_read_b64_tr_b16 v[198:199], v22 offset:17408
  v_mfma_f32_16x16x32_bf16 a[232:235], v[204:207], v[232:235], a[232:235]
  buffer_load_dwordx4 v25, s[56:59], 0 offen offset:1024 sc1 lds
  v_mfma_f32_16x16x32_bf16 a[236:239], v[204:207], v[236:239], a[236:239]
  v_mfma_f32_16x16x32_bf16 a[240:243], v[208:211], v[224:227], a[240:243]
  ds_read_b64_tr_b16 v[200:201], v17 offset:16896
  v_mfma_f32_16x16x32_bf16 a[244:247], v[208:211], v[228:231], a[244:247]
  ds_read_b64_tr_b16 v[202:203], v17 offset:17920
  v_mfma_f32_16x16x32_bf16 a[248:251], v[208:211], v[232:235], a[248:251]
  buffer_load_dwordx4 v25, s[56:59], s41 offen offset:2048 sc1 lds
  v_mfma_f32_16x16x32_bf16 a[252:255], v[208:211], v[236:239], a[252:255]
  v_mfma_f32_16x16x32_bf16 v[176:179], v[212:215], v[224:227], v[176:179]
  ds_read_b64_tr_b16 v[204:205], v18 offset:16896
  v_mfma_f32_16x16x32_bf16 v[180:183], v[212:215], v[228:231], v[180:183]
  ds_read_b64_tr_b16 v[206:207], v18 offset:17920
  v_mfma_f32_16x16x32_bf16 v[184:187], v[212:215], v[232:235], v[184:187]
  buffer_load_dwordx4 v25, s[56:59], s41 offen offset:3072 sc1 lds
  v_mfma_f32_16x16x32_bf16 v[188:191], v[212:215], v[236:239], v[188:191]
  v_add_u32 v25, 2048, v25
  s_add_u32 m0, s44, 105216
  v_mfma_f32_16x16x32_bf16 a[0:3], v[216:219], v[240:243], a[0:3]
  ds_read_b64_tr_b16 v[208:209], v19 offset:16896
  v_mfma_f32_16x16x32_bf16 a[4:7], v[216:219], v[244:247], a[4:7]
  ds_read_b64_tr_b16 v[210:211], v19 offset:17920
  s_waitcnt lgkmcnt(4)
  v_mfma_f32_16x16x32_bf16 a[8:11], v[216:219], v[248:251], a[8:11]
  buffer_load_dwordx4 v26, s[24:27], 0 offen lds
  v_mfma_f32_16x16x32_bf16 a[12:15], v[216:219], v[252:255], a[12:15]
  v_mfma_f32_16x16x32_bf16 a[16:19], v[220:223], v[240:243], a[16:19]
  ds_read_b64_tr_b16 v[212:213], v22 offset:16896
  v_mfma_f32_16x16x32_bf16 a[20:23], v[220:223], v[244:247], a[20:23]
  ds_read_b64_tr_b16 v[214:215], v22 offset:17920
  v_mfma_f32_16x16x32_bf16 a[24:27], v[220:223], v[248:251], a[24:27]
  buffer_load_dwordx4 v26, s[24:27], s42 offen offset:1024 lds
  v_mfma_f32_16x16x32_bf16 a[28:31], v[220:223], v[252:255], a[28:31]
  s_add_u32 m0, s48, 105216
  v_mfma_f32_16x16x32_bf16 a[32:35], v[192:195], v[240:243], a[32:35]
  ds_read_b64_tr_b16 v[216:217], v15 offset:32768
  v_mfma_f32_16x16x32_bf16 a[36:39], v[192:195], v[244:247], a[36:39]
  ds_read_b64_tr_b16 v[218:219], v15 offset:33024
  v_mfma_f32_16x16x32_bf16 a[40:43], v[192:195], v[248:251], a[40:43]
  buffer_load_dwordx4 v26, s[28:31], 0 offen lds
  v_mfma_f32_16x16x32_bf16 a[44:47], v[192:195], v[252:255], a[44:47]
  v_mfma_f32_16x16x32_bf16 a[48:51], v[196:199], v[240:243], a[48:51]
  ds_read_b64_tr_b16 v[220:221], v17 offset:24576
  v_mfma_f32_16x16x32_bf16 a[52:55], v[196:199], v[244:247], a[52:55]
  ds_read_b64_tr_b16 v[222:223], v17 offset:25600
  v_mfma_f32_16x16x32_bf16 a[56:59], v[196:199], v[248:251], a[56:59]
  buffer_load_dwordx4 v26, s[28:31], s42 offen offset:1024 lds
  v_mfma_f32_16x16x32_bf16 a[60:63], v[196:199], v[252:255], a[60:63]
  v_add_u32 v26, 294912, v26
  s_add_u32 m0, s66, 105216
  v_mfma_f32_16x16x32_bf16 a[64:67], v[200:203], v[240:243], a[64:67]
  ds_read_b64_tr_b16 v[192:193], v18 offset:24576
  v_mfma_f32_16x16x32_bf16 a[68:71], v[200:203], v[244:247], a[68:71]
  ds_read_b64_tr_b16 v[194:195], v18 offset:25600
  v_mfma_f32_16x16x32_bf16 a[72:75], v[200:203], v[248:251], a[72:75]
  buffer_load_dwordx4 v27, s[60:63], 0 offen lds
  v_mfma_f32_16x16x32_bf16 a[76:79], v[200:203], v[252:255], a[76:79]
  v_add_u32 v27, 294912, v27
  s_waitcnt lgkmcnt(2)
  v_mfma_f32_16x16x32_bf16 a[80:83], v[204:207], v[240:243], a[80:83]
  ds_read_b64_tr_b16 v[196:197], v19 offset:24576
  v_mfma_f32_16x16x32_bf16 a[84:87], v[204:207], v[244:247], a[84:87]
  ds_read_b64_tr_b16 v[198:199], v19 offset:25600
  v_mfma_f32_16x16x32_bf16 a[88:91], v[204:207], v[248:251], a[88:91]
  v_add_u32 v3, 70144, v7
  v_add_u32 v16, 70144, v13
  v_mfma_f32_16x16x32_bf16 a[92:95], v[204:207], v[252:255], a[92:95]
  v_add_u32 v4, 70144, v8
  v_add_u32 v5, 70144, v9
  v_mfma_f32_16x16x32_bf16 a[96:99], v[208:211], v[240:243], a[96:99]
  ds_read_b64_tr_b16 v[200:201], v22 offset:24576
  v_mfma_f32_16x16x32_bf16 a[100:103], v[208:211], v[244:247], a[100:103]
  ds_read_b64_tr_b16 v[202:203], v22 offset:25600
  v_mfma_f32_16x16x32_bf16 a[104:107], v[208:211], v[248:251], a[104:107]
  s_add_u32 s4, s67, 24576
  v_mfma_f32_16x16x32_bf16 a[108:111], v[208:211], v[252:255], a[108:111]
  buffer_store_dwordx4 v[56:59], v28, s[20:23], s4 offen sc1
  v_mfma_f32_16x16x32_bf16 a[112:115], v[212:215], v[240:243], a[112:115]
  ds_read_b64_tr_b16 v[204:205], v17 offset:25088
  v_mfma_f32_16x16x32_bf16 a[116:119], v[212:215], v[244:247], a[116:119]
  ds_read_b64_tr_b16 v[206:207], v17 offset:26112
  v_mfma_f32_16x16x32_bf16 a[120:123], v[212:215], v[248:251], a[120:123]
  v_add_u32 v6, 70144, v10
  v_add_u32 v30, 70144, v29
  v_mfma_f32_16x16x32_bf16 a[124:127], v[212:215], v[252:255], a[124:127]
  s_mul_i32 s95, s95, 36864
  v_add_u32 v11, s95, v2
  v_mfma_f32_16x16x32_bf16 v[160:163], v[216:219], v[240:243], v[160:163]
  ds_read_b64_tr_b16 v[208:209], v18 offset:25088
  v_mfma_f32_16x16x32_bf16 v[164:167], v[216:219], v[244:247], v[164:167]
  ds_read_b64_tr_b16 v[210:211], v18 offset:26112
  v_mfma_f32_16x16x32_bf16 v[168:171], v[216:219], v[248:251], v[168:171]
  s_lshl_b32 s95, s51, 3
  s_sub_u32 s95, 60, s95
  v_mfma_f32_16x16x32_bf16 v[172:175], v[216:219], v[252:255], v[172:175]
  s_mul_i32 s95, s95, 36864
  s_sub_u32 s45, s95, 2048
  v_mfma_f32_16x16x32_bf16 a[128:131], v[220:223], v[240:243], a[128:131]
  ds_read_b64_tr_b16 v[212:213], v19 offset:25088
  v_mfma_f32_16x16x32_bf16 a[132:135], v[220:223], v[244:247], a[132:135]
  ds_read_b64_tr_b16 v[214:215], v19 offset:26112
  v_mfma_f32_16x16x32_bf16 a[136:139], v[220:223], v[248:251], a[136:139]
  s_add_u32 s4, s70, 24576
  v_mfma_f32_16x16x32_bf16 a[140:143], v[220:223], v[252:255], a[140:143]
  buffer_store_dwordx4 v[60:63], v28, s[20:23], s4 offen sc1
  s_waitcnt lgkmcnt(2)
  v_mfma_f32_16x16x32_bf16 a[144:147], v[192:195], v[240:243], a[144:147]
  ds_read_b64_tr_b16 v[216:217], v22 offset:25088
  v_mfma_f32_16x16x32_bf16 a[148:151], v[192:195], v[244:247], a[148:151]
  ds_read_b64_tr_b16 v[218:219], v22 offset:26112
  v_mfma_f32_16x16x32_bf16 a[152:155], v[192:195], v[248:251], a[152:155]
  v_mfma_f32_16x16x32_bf16 a[156:159], v[192:195], v[252:255], a[156:159]
  v_mfma_f32_16x16x32_bf16 a[160:163], v[196:199], v[240:243], a[160:163]
  ds_read_b64_tr_b16 v[220:221], v15 offset:33920
  v_mfma_f32_16x16x32_bf16 a[164:167], v[196:199], v[244:247], a[164:167]
  ds_read_b64_tr_b16 v[222:223], v15 offset:34176
  v_mfma_f32_16x16x32_bf16 a[168:171], v[196:199], v[248:251], a[168:171]
  v_mfma_f32_16x16x32_bf16 a[172:175], v[196:199], v[252:255], a[172:175]
  s_waitcnt vmcnt(13)
  s_barrier
  s_add_u32 m0, s43, 0
  v_mfma_f32_16x16x32_bf16 a[176:179], v[200:203], v[240:243], a[176:179]
  ds_read_b64_tr_b16 v[192:193], v4 offset:16384
  v_mfma_f32_16x16x32_bf16 a[180:183], v[200:203], v[244:247], a[180:183]
  ds_read_b64_tr_b16 v[194:195], v4 offset:17408
  v_mfma_f32_16x16x32_bf16 a[184:187], v[200:203], v[248:251], a[184:187]
  ds_read_b128 v[224:227], v3 offset:0
  v_mfma_f32_16x16x32_bf16 a[188:191], v[200:203], v[252:255], a[188:191]
  ds_read_b128 v[228:231], v3 offset:256
  v_mfma_f32_16x16x32_bf16 a[192:195], v[204:207], v[240:243], a[192:195]
  ds_read_b64_tr_b16 v[196:197], v5 offset:16384
  v_mfma_f32_16x16x32_bf16 a[196:199], v[204:207], v[244:247], a[196:199]
  ds_read_b64_tr_b16 v[198:199], v5 offset:17408
  v_mfma_f32_16x16x32_bf16 a[200:203], v[204:207], v[248:251], a[200:203]
  ds_read_b128 v[232:235], v3 offset:2048
  v_mfma_f32_16x16x32_bf16 a[204:207], v[204:207], v[252:255], a[204:207]
  ds_read_b128 v[236:239], v3 offset:2304
  v_mfma_f32_16x16x32_bf16 a[208:211], v[208:211], v[240:243], a[208:211]
  ds_read_b64_tr_b16 v[200:201], v6 offset:16384
  v_mfma_f32_16x16x32_bf16 a[212:215], v[208:211], v[244:247], a[212:215]
  ds_read_b64_tr_b16 v[202:203], v6 offset:17408
  v_mfma_f32_16x16x32_bf16 a[216:219], v[208:211], v[248:251], a[216:219]
  buffer_load_dwordx4 v25, s[56:59], 0 offen sc1 lds
  v_mfma_f32_16x16x32_bf16 a[220:223], v[208:211], v[252:255], a[220:223]
  s_waitcnt lgkmcnt(4)
  v_mfma_f32_16x16x32_bf16 a[224:227], v[212:215], v[240:243], a[224:227]
  ds_read_b64_tr_b16 v[204:205], v30 offset:16384
  v_mfma_f32_16x16x32_bf16 a[228:231], v[212:215], v[244:247], a[228:231]
  ds_read_b64_tr_b16 v[206:207], v30 offset:17408
  v_mfma_f32_16x16x32_bf16 a[232:235], v[212:215], v[248:251], a[232:235]
  buffer_load_dwordx4 v25, s[56:59], 0 offen offset:1024 sc1 lds
  v_mfma_f32_16x16x32_bf16 a[236:239], v[212:215], v[252:255], a[236:239]
  v_mfma_f32_16x16x32_bf16 a[240:243], v[216:219], v[240:243], a[240:243]
  ds_read_b64_tr_b16 v[208:209], v4 offset:16896
  v_mfma_f32_16x16x32_bf16 a[244:247], v[216:219], v[244:247], a[244:247]
  ds_read_b64_tr_b16 v[210:211], v4 offset:17920
  v_mfma_f32_16x16x32_bf16 a[248:251], v[216:219], v[248:251], a[248:251]
  buffer_load_dwordx4 v25, s[56:59], s41 offen offset:2048 sc1 lds
  v_mfma_f32_16x16x32_bf16 a[252:255], v[216:219], v[252:255], a[252:255]
  v_mfma_f32_16x16x32_bf16 v[176:179], v[220:223], v[240:243], v[176:179]
  ds_read_b64_tr_b16 v[212:213], v5 offset:16896
  v_mfma_f32_16x16x32_bf16 v[180:183], v[220:223], v[244:247], v[180:183]
  ds_read_b64_tr_b16 v[214:215], v5 offset:17920
  v_mfma_f32_16x16x32_bf16 v[184:187], v[220:223], v[248:251], v[184:187]
  buffer_load_dwordx4 v25, s[56:59], s41 offen offset:3072 sc1 lds
  v_mfma_f32_16x16x32_bf16 v[188:191], v[220:223], v[252:255], v[188:191]
  v_add_u32 v25, 2048, v25
  s_add_u32 m0, s44, 0
  v_mfma_f32_16x16x32_bf16 a[0:3], v[192:195], v[224:227], a[0:3]
  ds_read_b64_tr_b16 v[216:217], v6 offset:16896
  v_mfma_f32_16x16x32_bf16 a[4:7], v[192:195], v[228:231], a[4:7]
  ds_read_b64_tr_b16 v[218:219], v6 offset:17920
  s_waitcnt lgkmcnt(4)
  v_mfma_f32_16x16x32_bf16 a[8:11], v[192:195], v[232:235], a[8:11]
  buffer_load_dwordx4 v26, s[24:27], 0 offen lds
  v_mfma_f32_16x16x32_bf16 a[12:15], v[192:195], v[236:239], a[12:15]
  v_mfma_f32_16x16x32_bf16 a[16:19], v[196:199], v[224:227], a[16:19]
  ds_read_b64_tr_b16 v[220:221], v30 offset:16896
  v_mfma_f32_16x16x32_bf16 a[20:23], v[196:199], v[228:231], a[20:23]
  ds_read_b64_tr_b16 v[222:223], v30 offset:17920
  v_mfma_f32_16x16x32_bf16 a[24:27], v[196:199], v[232:235], a[24:27]
  buffer_load_dwordx4 v26, s[24:27], s42 offen offset:1024 lds
  v_mfma_f32_16x16x32_bf16 a[28:31], v[196:199], v[236:239], a[28:31]
  s_add_u32 m0, s48, 0
  v_mfma_f32_16x16x32_bf16 a[32:35], v[200:203], v[224:227], a[32:35]
  ds_read_b64_tr_b16 v[192:193], v16 offset:32768
  v_mfma_f32_16x16x32_bf16 a[36:39], v[200:203], v[228:231], a[36:39]
  ds_read_b64_tr_b16 v[194:195], v16 offset:33024
  v_mfma_f32_16x16x32_bf16 a[40:43], v[200:203], v[232:235], a[40:43]
  buffer_load_dwordx4 v26, s[28:31], 0 offen lds
  v_mfma_f32_16x16x32_bf16 a[44:47], v[200:203], v[236:239], a[44:47]
  v_mfma_f32_16x16x32_bf16 a[48:51], v[204:207], v[224:227], a[48:51]
  ds_read_b64_tr_b16 v[196:197], v4 offset:24576
  v_mfma_f32_16x16x32_bf16 a[52:55], v[204:207], v[228:231], a[52:55]
  ds_read_b64_tr_b16 v[198:199], v4 offset:25600
  v_mfma_f32_16x16x32_bf16 a[56:59], v[204:207], v[232:235], a[56:59]
  buffer_load_dwordx4 v26, s[28:31], s42 offen offset:1024 lds
  v_mfma_f32_16x16x32_bf16 a[60:63], v[204:207], v[236:239], a[60:63]
  v_add_u32 v26, 294912, v26
  s_add_u32 m0, s66, 0
  v_mfma_f32_16x16x32_bf16 a[64:67], v[208:211], v[224:227], a[64:67]
  ds_read_b64_tr_b16 v[200:201], v5 offset:24576
  v_mfma_f32_16x16x32_bf16 a[68:71], v[208:211], v[228:231], a[68:71]
  ds_read_b64_tr_b16 v[202:203], v5 offset:25600
  v_mfma_f32_16x16x32_bf16 a[72:75], v[208:211], v[232:235], a[72:75]
  buffer_load_dwordx4 v27, s[60:63], 0 offen lds
  v_mfma_f32_16x16x32_bf16 a[76:79], v[208:211], v[236:239], a[76:79]
  v_add_u32 v27, 294912, v27
  s_waitcnt lgkmcnt(2)
  v_mfma_f32_16x16x32_bf16 a[80:83], v[212:215], v[224:227], a[80:83]
  ds_read_b64_tr_b16 v[204:205], v6 offset:24576
  v_mfma_f32_16x16x32_bf16 a[84:87], v[212:215], v[228:231], a[84:87]
  ds_read_b64_tr_b16 v[206:207], v6 offset:25600
  v_mfma_f32_16x16x32_bf16 a[88:91], v[212:215], v[232:235], a[88:91]
  v_add_u32 v14, 105216, v7
  v_add_u32 v15, 105216, v13
  v_mfma_f32_16x16x32_bf16 a[92:95], v[212:215], v[236:239], a[92:95]
  v_add_u32 v17, 105216, v8
  v_add_u32 v18, 105216, v9
  v_mfma_f32_16x16x32_bf16 a[96:99], v[216:219], v[224:227], a[96:99]
  ds_read_b64_tr_b16 v[208:209], v30 offset:24576
  v_mfma_f32_16x16x32_bf16 a[100:103], v[216:219], v[228:231], a[100:103]
  ds_read_b64_tr_b16 v[210:211], v30 offset:25600
  v_mfma_f32_16x16x32_bf16 a[104:107], v[216:219], v[232:235], a[104:107]
  s_add_u32 s4, s71, 0
  v_mfma_f32_16x16x32_bf16 a[108:111], v[216:219], v[236:239], a[108:111]
  buffer_store_dwordx4 v[64:67], v28, s[20:23], s4 offen sc1
  v_mfma_f32_16x16x32_bf16 a[112:115], v[220:223], v[224:227], a[112:115]
  ds_read_b64_tr_b16 v[212:213], v4 offset:25088
  v_mfma_f32_16x16x32_bf16 a[116:119], v[220:223], v[228:231], a[116:119]
  ds_read_b64_tr_b16 v[214:215], v4 offset:26112
  v_mfma_f32_16x16x32_bf16 a[120:123], v[220:223], v[232:235], a[120:123]
  v_add_u32 v19, 105216, v10
  v_add_u32 v22, 105216, v29
  v_mfma_f32_16x16x32_bf16 a[124:127], v[220:223], v[236:239], a[124:127]
  s_movk_i32 s101, 8192
  v_bfe_u32 v20, v1, 3, 2
  v_mfma_f32_16x16x32_bf16 v[160:163], v[192:195], v[224:227], v[160:163]
  ds_read_b64_tr_b16 v[216:217], v5 offset:25088
  v_mfma_f32_16x16x32_bf16 v[164:167], v[192:195], v[228:231], v[164:167]
  ds_read_b64_tr_b16 v[218:219], v5 offset:26112
  v_mfma_f32_16x16x32_bf16 v[168:171], v[192:195], v[232:235], v[168:171]
  v_mul_lo_u32 v12, v20, s101
  v_lshrrev_b32 v20, 1, v20
  v_mfma_f32_16x16x32_bf16 v[172:175], v[192:195], v[236:239], v[172:175]
  v_bfe_u32 v21, v1, 2, 1
  v_xor_b32 v20, v20, v21
  v_mfma_f32_16x16x32_bf16 a[128:131], v[196:199], v[224:227], a[128:131]
  ds_read_b64_tr_b16 v[220:221], v6 offset:25088
  v_mfma_f32_16x16x32_bf16 a[132:135], v[196:199], v[228:231], a[132:135]
  ds_read_b64_tr_b16 v[222:223], v6 offset:26112
  v_mfma_f32_16x16x32_bf16 a[136:139], v[196:199], v[232:235], a[136:139]
  s_add_u32 s4, s82, 0
  v_mfma_f32_16x16x32_bf16 a[140:143], v[196:199], v[236:239], a[140:143]
  buffer_store_dwordx4 v[68:71], v28, s[20:23], s4 offen sc1
  s_waitcnt lgkmcnt(2)
  v_mfma_f32_16x16x32_bf16 a[144:147], v[200:203], v[224:227], a[144:147]
  ds_read_b64_tr_b16 v[192:193], v30 offset:25088
  v_mfma_f32_16x16x32_bf16 a[148:151], v[200:203], v[228:231], a[148:151]
  ds_read_b64_tr_b16 v[194:195], v30 offset:26112
  v_mfma_f32_16x16x32_bf16 a[152:155], v[200:203], v[232:235], a[152:155]
  v_lshl_add_u32 v12, v20, 6, v12
  v_lshrrev_b32 v20, 5, v1
  v_mfma_f32_16x16x32_bf16 a[156:159], v[200:203], v[236:239], a[156:159]
  v_lshl_add_u32 v12, v20, 7, v12
  v_and_b32 v20, 3, v1
  v_mfma_f32_16x16x32_bf16 a[160:163], v[204:207], v[224:227], a[160:163]
  ds_read_b64_tr_b16 v[196:197], v16 offset:33920
  v_mfma_f32_16x16x32_bf16 a[164:167], v[204:207], v[228:231], a[164:167]
  ds_read_b64_tr_b16 v[198:199], v16 offset:34176
  v_mfma_f32_16x16x32_bf16 a[168:171], v[204:207], v[232:235], a[168:171]
  v_lshl_add_u32 v12, v20, 4, v12
  s_lshl_b32 s95, s50, 8
  v_mfma_f32_16x16x32_bf16 a[172:175], v[204:207], v[236:239], a[172:175]
  s_lshl_b32 s100, s3, 16
  s_add_u32 s95, s95, s100
  s_waitcnt vmcnt(13)
  s_barrier
  s_add_u32 m0, s43, 35072
  v_mfma_f32_16x16x32_bf16 a[176:179], v[208:211], v[224:227], a[176:179]
  ds_read_b64_tr_b16 v[200:201], v17 offset:16384
  v_mfma_f32_16x16x32_bf16 a[180:183], v[208:211], v[228:231], a[180:183]
  ds_read_b64_tr_b16 v[202:203], v17 offset:17408
  v_mfma_f32_16x16x32_bf16 a[184:187], v[208:211], v[232:235], a[184:187]
  ds_read_b128 v[240:243], v14 offset:0
  v_mfma_f32_16x16x32_bf16 a[188:191], v[208:211], v[236:239], a[188:191]
  ds_read_b128 v[244:247], v14 offset:256
  v_mfma_f32_16x16x32_bf16 a[192:195], v[212:215], v[224:227], a[192:195]
  ds_read_b64_tr_b16 v[204:205], v18 offset:16384
  v_mfma_f32_16x16x32_bf16 a[196:199], v[212:215], v[228:231], a[196:199]
  ds_read_b64_tr_b16 v[206:207], v18 offset:17408
  v_mfma_f32_16x16x32_bf16 a[200:203], v[212:215], v[232:235], a[200:203]
  ds_read_b128 v[248:251], v14 offset:2048
  v_mfma_f32_16x16x32_bf16 a[204:207], v[212:215], v[236:239], a[204:207]
  ds_read_b128 v[252:255], v14 offset:2304
  v_mfma_f32_16x16x32_bf16 a[208:211], v[216:219], v[224:227], a[208:211]
  ds_read_b64_tr_b16 v[208:209], v19 offset:16384
  v_mfma_f32_16x16x32_bf16 a[212:215], v[216:219], v[228:231], a[212:215]
  ds_read_b64_tr_b16 v[210:211], v19 offset:17408
  v_mfma_f32_16x16x32_bf16 a[216:219], v[216:219], v[232:235], a[216:219]
  buffer_load_dwordx4 v25, s[56:59], 0 offen sc1 lds
  v_mfma_f32_16x16x32_bf16 a[220:223], v[216:219], v[236:239], a[220:223]
  s_waitcnt lgkmcnt(4)
  v_mfma_f32_16x16x32_bf16 a[224:227], v[220:223], v[224:227], a[224:227]
  ds_read_b64_tr_b16 v[212:213], v22 offset:16384
  v_mfma_f32_16x16x32_bf16 a[228:231], v[220:223], v[228:231], a[228:231]
  ds_read_b64_tr_b16 v[214:215], v22 offset:17408
  v_mfma_f32_16x16x32_bf16 a[232:235], v[220:223], v[232:235], a[232:235]
  buffer_load_dwordx4 v25, s[56:59], 0 offen offset:1024 sc1 lds
  v_mfma_f32_16x16x32_bf16 a[236:239], v[220:223], v[236:239], a[236:239]
  v_mfma_f32_16x16x32_bf16 a[240:243], v[192:195], v[224:227], a[240:243]
  ds_read_b64_tr_b16 v[216:217], v17 offset:16896
  v_mfma_f32_16x16x32_bf16 a[244:247], v[192:195], v[228:231], a[244:247]
  ds_read_b64_tr_b16 v[218:219], v17 offset:17920
  v_mfma_f32_16x16x32_bf16 a[248:251], v[192:195], v[232:235], a[248:251]
  buffer_load_dwordx4 v25, s[56:59], s41 offen offset:2048 sc1 lds
  v_mfma_f32_16x16x32_bf16 a[252:255], v[192:195], v[236:239], a[252:255]
  v_mfma_f32_16x16x32_bf16 v[176:179], v[196:199], v[224:227], v[176:179]
  ds_read_b64_tr_b16 v[220:221], v18 offset:16896
  v_mfma_f32_16x16x32_bf16 v[180:183], v[196:199], v[228:231], v[180:183]
  ds_read_b64_tr_b16 v[222:223], v18 offset:17920
  v_mfma_f32_16x16x32_bf16 v[184:187], v[196:199], v[232:235], v[184:187]
  buffer_load_dwordx4 v25, s[56:59], s41 offen offset:3072 sc1 lds
  v_mfma_f32_16x16x32_bf16 v[188:191], v[196:199], v[236:239], v[188:191]
  v_add_u32 v25, 2048, v25
  s_add_u32 m0, s44, 35072
  v_mfma_f32_16x16x32_bf16 a[0:3], v[200:203], v[240:243], a[0:3]
  ds_read_b64_tr_b16 v[192:193], v19 offset:16896
  v_mfma_f32_16x16x32_bf16 a[4:7], v[200:203], v[244:247], a[4:7]
  ds_read_b64_tr_b16 v[194:195], v19 offset:17920
  s_waitcnt lgkmcnt(4)
  v_mfma_f32_16x16x32_bf16 a[8:11], v[200:203], v[248:251], a[8:11]
  buffer_load_dwordx4 v26, s[24:27], 0 offen lds
  v_mfma_f32_16x16x32_bf16 a[12:15], v[200:203], v[252:255], a[12:15]
  v_mfma_f32_16x16x32_bf16 a[16:19], v[204:207], v[240:243], a[16:19]
  ds_read_b64_tr_b16 v[196:197], v22 offset:16896
  v_mfma_f32_16x16x32_bf16 a[20:23], v[204:207], v[244:247], a[20:23]
  ds_read_b64_tr_b16 v[198:199], v22 offset:17920
  v_mfma_f32_16x16x32_bf16 a[24:27], v[204:207], v[248:251], a[24:27]
  buffer_load_dwordx4 v26, s[24:27], s42 offen offset:1024 lds
  v_mfma_f32_16x16x32_bf16 a[28:31], v[204:207], v[252:255], a[28:31]
  s_add_u32 m0, s48, 35072
  v_mfma_f32_16x16x32_bf16 a[32:35], v[208:211], v[240:243], a[32:35]
  ds_read_b64_tr_b16 v[200:201], v15 offset:32768
  v_mfma_f32_16x16x32_bf16 a[36:39], v[208:211], v[244:247], a[36:39]
  ds_read_b64_tr_b16 v[202:203], v15 offset:33024
  v_mfma_f32_16x16x32_bf16 a[40:43], v[208:211], v[248:251], a[40:43]
  buffer_load_dwordx4 v26, s[28:31], 0 offen lds
  v_mfma_f32_16x16x32_bf16 a[44:47], v[208:211], v[252:255], a[44:47]
  v_mfma_f32_16x16x32_bf16 a[48:51], v[212:215], v[240:243], a[48:51]
  ds_read_b64_tr_b16 v[204:205], v17 offset:24576
  v_mfma_f32_16x16x32_bf16 a[52:55], v[212:215], v[244:247], a[52:55]
  ds_read_b64_tr_b16 v[206:207], v17 offset:25600
  v_mfma_f32_16x16x32_bf16 a[56:59], v[212:215], v[248:251], a[56:59]
  buffer_load_dwordx4 v26, s[28:31], s42 offen offset:1024 lds
  v_mfma_f32_16x16x32_bf16 a[60:63], v[212:215], v[252:255], a[60:63]
  v_add_u32 v26, 294912, v26
  s_add_u32 m0, s66, 35072
  v_mfma_f32_16x16x32_bf16 a[64:67], v[216:219], v[240:243], a[64:67]
  ds_read_b64_tr_b16 v[208:209], v18 offset:24576
  v_mfma_f32_16x16x32_bf16 a[68:71], v[216:219], v[244:247], a[68:71]
  ds_read_b64_tr_b16 v[210:211], v18 offset:25600
  v_mfma_f32_16x16x32_bf16 a[72:75], v[216:219], v[248:251], a[72:75]
  buffer_load_dwordx4 v27, s[60:63], 0 offen lds
  v_mfma_f32_16x16x32_bf16 a[76:79], v[216:219], v[252:255], a[76:79]
  v_add_u32 v27, 294912, v27
  s_waitcnt lgkmcnt(2)
  v_mfma_f32_16x16x32_bf16 a[80:83], v[220:223], v[240:243], a[80:83]
  ds_read_b64_tr_b16 v[212:213], v19 offset:24576
  v_mfma_f32_16x16x32_bf16 a[84:87], v[220:223], v[244:247], a[84:87]
  ds_read_b64_tr_b16 v[214:215], v19 offset:25600
  v_mfma_f32_16x16x32_bf16 a[88:91], v[220:223], v[248:251], a[88:91]
  v_add_u32 v3, 0, v7
  v_add_u32 v16, 0, v13
  v_mfma_f32_16x16x32_bf16 a[92:95], v[220:223], v[252:255], a[92:95]
  v_add_u32 v4, 0, v8
  v_add_u32 v5, 0, v9
  v_mfma_f32_16x16x32_bf16 a[96:99], v[192:195], v[240:243], a[96:99]
  ds_read_b64_tr_b16 v[216:217], v22 offset:24576
  v_mfma_f32_16x16x32_bf16 a[100:103], v[192:195], v[244:247], a[100:103]
  ds_read_b64_tr_b16 v[218:219], v22 offset:25600
  v_mfma_f32_16x16x32_bf16 a[104:107], v[192:195], v[248:251], a[104:107]
  s_add_u32 s4, s71, 8192
  v_mfma_f32_16x16x32_bf16 a[108:111], v[192:195], v[252:255], a[108:111]
  buffer_store_dwordx4 v[72:75], v28, s[20:23], s4 offen sc1
  v_mfma_f32_16x16x32_bf16 a[112:115], v[196:199], v[240:243], a[112:115]
  ds_read_b64_tr_b16 v[220:221], v17 offset:25088
  v_mfma_f32_16x16x32_bf16 a[116:119], v[196:199], v[244:247], a[116:119]
  ds_read_b64_tr_b16 v[222:223], v17 offset:26112
  v_mfma_f32_16x16x32_bf16 a[120:123], v[196:199], v[248:251], a[120:123]
  v_add_u32 v6, 0, v10
  v_add_u32 v30, 0, v29
  v_mfma_f32_16x16x32_bf16 a[124:127], v[196:199], v[252:255], a[124:127]
  v_add_u32 v12, s95, v12
  s_mov_b32 s46, 31744
  v_mfma_f32_16x16x32_bf16 v[160:163], v[200:203], v[240:243], v[160:163]
  ds_read_b64_tr_b16 v[192:193], v18 offset:25088
  v_mfma_f32_16x16x32_bf16 v[164:167], v[200:203], v[244:247], v[164:167]
  ds_read_b64_tr_b16 v[194:195], v18 offset:26112
  v_mfma_f32_16x16x32_bf16 v[168:171], v[200:203], v[248:251], v[168:171]
  s_lshl_b32 s47, s3, 12
  s_lshl_b32 s95, s3, 11
  v_mfma_f32_16x16x32_bf16 v[172:175], v[200:203], v[252:255], v[172:175]
  s_add_u32 s49, s95, 16384
  v_mfma_f32_16x16x32_bf16 a[128:131], v[204:207], v[240:243], a[128:131]
  ds_read_b64_tr_b16 v[196:197], v19 offset:25088
  v_mfma_f32_16x16x32_bf16 a[132:135], v[204:207], v[244:247], a[132:135]
  ds_read_b64_tr_b16 v[198:199], v19 offset:26112
  v_mfma_f32_16x16x32_bf16 a[136:139], v[204:207], v[248:251], a[136:139]
  s_add_u32 s4, s82, 8192
  v_mfma_f32_16x16x32_bf16 a[140:143], v[204:207], v[252:255], a[140:143]
  buffer_store_dwordx4 v[76:79], v28, s[20:23], s4 offen sc1
  s_waitcnt lgkmcnt(2)
  v_mfma_f32_16x16x32_bf16 a[144:147], v[208:211], v[240:243], a[144:147]
  ds_read_b64_tr_b16 v[200:201], v22 offset:25088
  v_mfma_f32_16x16x32_bf16 a[148:151], v[208:211], v[244:247], a[148:151]
  ds_read_b64_tr_b16 v[202:203], v22 offset:26112
  v_mfma_f32_16x16x32_bf16 a[152:155], v[208:211], v[248:251], a[152:155]
  v_mfma_f32_16x16x32_bf16 a[156:159], v[208:211], v[252:255], a[156:159]
  v_mfma_f32_16x16x32_bf16 a[160:163], v[212:215], v[240:243], a[160:163]
  ds_read_b64_tr_b16 v[204:205], v15 offset:33920
  v_mfma_f32_16x16x32_bf16 a[164:167], v[212:215], v[244:247], a[164:167]
  ds_read_b64_tr_b16 v[206:207], v15 offset:34176
  v_mfma_f32_16x16x32_bf16 a[168:171], v[212:215], v[248:251], a[168:171]
  v_mfma_f32_16x16x32_bf16 a[172:175], v[212:215], v[252:255], a[172:175]
  s_waitcnt vmcnt(13)
  s_barrier
  s_add_u32 m0, s43, 70144
  v_mfma_f32_16x16x32_bf16 a[176:179], v[216:219], v[240:243], a[176:179]
  ds_read_b64_tr_b16 v[208:209], v4 offset:16384
  v_mfma_f32_16x16x32_bf16 a[180:183], v[216:219], v[244:247], a[180:183]
  ds_read_b64_tr_b16 v[210:211], v4 offset:17408
  v_mfma_f32_16x16x32_bf16 a[184:187], v[216:219], v[248:251], a[184:187]
  ds_read_b128 v[224:227], v3 offset:0
  v_mfma_f32_16x16x32_bf16 a[188:191], v[216:219], v[252:255], a[188:191]
  ds_read_b128 v[228:231], v3 offset:256
  v_mfma_f32_16x16x32_bf16 a[192:195], v[220:223], v[240:243], a[192:195]
  ds_read_b64_tr_b16 v[212:213], v5 offset:16384
  v_mfma_f32_16x16x32_bf16 a[196:199], v[220:223], v[244:247], a[196:199]
  ds_read_b64_tr_b16 v[214:215], v5 offset:17408
  v_mfma_f32_16x16x32_bf16 a[200:203], v[220:223], v[248:251], a[200:203]
  ds_read_b128 v[232:235], v3 offset:2048
  v_mfma_f32_16x16x32_bf16 a[204:207], v[220:223], v[252:255], a[204:207]
  ds_read_b128 v[236:239], v3 offset:2304
  v_mfma_f32_16x16x32_bf16 a[208:211], v[192:195], v[240:243], a[208:211]
  ds_read_b64_tr_b16 v[216:217], v6 offset:16384
  v_mfma_f32_16x16x32_bf16 a[212:215], v[192:195], v[244:247], a[212:215]
  ds_read_b64_tr_b16 v[218:219], v6 offset:17408
  v_mfma_f32_16x16x32_bf16 a[216:219], v[192:195], v[248:251], a[216:219]
  buffer_load_dwordx4 v25, s[56:59], 0 offen sc1 lds
  v_mfma_f32_16x16x32_bf16 a[220:223], v[192:195], v[252:255], a[220:223]
  s_waitcnt lgkmcnt(4)
  v_mfma_f32_16x16x32_bf16 a[224:227], v[196:199], v[240:243], a[224:227]
  ds_read_b64_tr_b16 v[220:221], v30 offset:16384
  v_mfma_f32_16x16x32_bf16 a[228:231], v[196:199], v[244:247], a[228:231]
  ds_read_b64_tr_b16 v[222:223], v30 offset:17408
  v_mfma_f32_16x16x32_bf16 a[232:235], v[196:199], v[248:251], a[232:235]
  buffer_load_dwordx4 v25, s[56:59], 0 offen offset:1024 sc1 lds
  v_mfma_f32_16x16x32_bf16 a[236:239], v[196:199], v[252:255], a[236:239]
  v_mfma_f32_16x16x32_bf16 a[240:243], v[200:203], v[240:243], a[240:243]
  ds_read_b64_tr_b16 v[192:193], v4 offset:16896
  v_mfma_f32_16x16x32_bf16 a[244:247], v[200:203], v[244:247], a[244:247]
  ds_read_b64_tr_b16 v[194:195], v4 offset:17920
  v_mfma_f32_16x16x32_bf16 a[248:251], v[200:203], v[248:251], a[248:251]
  buffer_load_dwordx4 v25, s[56:59], s41 offen offset:2048 sc1 lds
  v_mfma_f32_16x16x32_bf16 a[252:255], v[200:203], v[252:255], a[252:255]
  v_mfma_f32_16x16x32_bf16 v[176:179], v[204:207], v[240:243], v[176:179]
  ds_read_b64_tr_b16 v[196:197], v5 offset:16896
  v_mfma_f32_16x16x32_bf16 v[180:183], v[204:207], v[244:247], v[180:183]
  ds_read_b64_tr_b16 v[198:199], v5 offset:17920
  v_mfma_f32_16x16x32_bf16 v[184:187], v[204:207], v[248:251], v[184:187]
  buffer_load_dwordx4 v25, s[56:59], s41 offen offset:3072 sc1 lds
  v_mfma_f32_16x16x32_bf16 v[188:191], v[204:207], v[252:255], v[188:191]
  v_add_u32 v25, 2048, v25
  s_add_u32 m0, s44, 70144
  v_mfma_f32_16x16x32_bf16 a[0:3], v[208:211], v[224:227], a[0:3]
  ds_read_b64_tr_b16 v[200:201], v6 offset:16896
  v_mfma_f32_16x16x32_bf16 a[4:7], v[208:211], v[228:231], a[4:7]
  ds_read_b64_tr_b16 v[202:203], v6 offset:17920
  s_waitcnt lgkmcnt(4)
  v_mfma_f32_16x16x32_bf16 a[8:11], v[208:211], v[232:235], a[8:11]
  buffer_load_dwordx4 v26, s[24:27], 0 offen lds
  v_mfma_f32_16x16x32_bf16 a[12:15], v[208:211], v[236:239], a[12:15]
  v_mfma_f32_16x16x32_bf16 a[16:19], v[212:215], v[224:227], a[16:19]
  ds_read_b64_tr_b16 v[204:205], v30 offset:16896
  v_mfma_f32_16x16x32_bf16 a[20:23], v[212:215], v[228:231], a[20:23]
  ds_read_b64_tr_b16 v[206:207], v30 offset:17920
  v_mfma_f32_16x16x32_bf16 a[24:27], v[212:215], v[232:235], a[24:27]
  buffer_load_dwordx4 v26, s[24:27], s42 offen offset:1024 lds
  v_mfma_f32_16x16x32_bf16 a[28:31], v[212:215], v[236:239], a[28:31]
  s_add_u32 m0, s48, 70144
  v_mfma_f32_16x16x32_bf16 a[32:35], v[216:219], v[224:227], a[32:35]
  ds_read_b64_tr_b16 v[208:209], v16 offset:32768
  v_mfma_f32_16x16x32_bf16 a[36:39], v[216:219], v[228:231], a[36:39]
  ds_read_b64_tr_b16 v[210:211], v16 offset:33024
  v_mfma_f32_16x16x32_bf16 a[40:43], v[216:219], v[232:235], a[40:43]
  buffer_load_dwordx4 v26, s[28:31], 0 offen lds
  v_mfma_f32_16x16x32_bf16 a[44:47], v[216:219], v[236:239], a[44:47]
  v_mfma_f32_16x16x32_bf16 a[48:51], v[220:223], v[224:227], a[48:51]
  ds_read_b64_tr_b16 v[212:213], v4 offset:24576
  v_mfma_f32_16x16x32_bf16 a[52:55], v[220:223], v[228:231], a[52:55]
  ds_read_b64_tr_b16 v[214:215], v4 offset:25600
  v_mfma_f32_16x16x32_bf16 a[56:59], v[220:223], v[232:235], a[56:59]
  buffer_load_dwordx4 v26, s[28:31], s42 offen offset:1024 lds
  v_mfma_f32_16x16x32_bf16 a[60:63], v[220:223], v[236:239], a[60:63]
  v_add_u32 v26, 294912, v26
  s_add_u32 m0, s66, 70144
  v_mfma_f32_16x16x32_bf16 a[64:67], v[192:195], v[224:227], a[64:67]
  ds_read_b64_tr_b16 v[216:217], v5 offset:24576
  v_mfma_f32_16x16x32_bf16 a[68:71], v[192:195], v[228:231], a[68:71]
  ds_read_b64_tr_b16 v[218:219], v5 offset:25600
  v_mfma_f32_16x16x32_bf16 a[72:75], v[192:195], v[232:235], a[72:75]
  buffer_load_dwordx4 v27, s[60:63], 0 offen lds
  v_mfma_f32_16x16x32_bf16 a[76:79], v[192:195], v[236:239], a[76:79]
  v_add_u32 v27, 294912, v27
  s_waitcnt lgkmcnt(2)
  v_mfma_f32_16x16x32_bf16 a[80:83], v[196:199], v[224:227], a[80:83]
  ds_read_b64_tr_b16 v[220:221], v6 offset:24576
  v_mfma_f32_16x16x32_bf16 a[84:87], v[196:199], v[228:231], a[84:87]
  ds_read_b64_tr_b16 v[222:223], v6 offset:25600
  v_mfma_f32_16x16x32_bf16 a[88:91], v[196:199], v[232:235], a[88:91]
  v_add_u32 v14, 35072, v7
  v_add_u32 v15, 35072, v13
  v_mfma_f32_16x16x32_bf16 a[92:95], v[196:199], v[236:239], a[92:95]
  v_add_u32 v17, 35072, v8
  v_add_u32 v18, 35072, v9
  v_mfma_f32_16x16x32_bf16 a[96:99], v[200:203], v[224:227], a[96:99]
  ds_read_b64_tr_b16 v[192:193], v30 offset:24576
  v_mfma_f32_16x16x32_bf16 a[100:103], v[200:203], v[228:231], a[100:103]
  ds_read_b64_tr_b16 v[194:195], v30 offset:25600
  v_mfma_f32_16x16x32_bf16 a[104:107], v[200:203], v[232:235], a[104:107]
  s_add_u32 s4, s71, 16384
  v_mfma_f32_16x16x32_bf16 a[108:111], v[200:203], v[236:239], a[108:111]
  buffer_store_dwordx4 v[80:83], v28, s[20:23], s4 offen sc1
  v_mfma_f32_16x16x32_bf16 a[112:115], v[204:207], v[224:227], a[112:115]
  ds_read_b64_tr_b16 v[196:197], v4 offset:25088
  v_mfma_f32_16x16x32_bf16 a[116:119], v[204:207], v[228:231], a[116:119]
  ds_read_b64_tr_b16 v[198:199], v4 offset:26112
  v_mfma_f32_16x16x32_bf16 a[120:123], v[204:207], v[232:235], a[120:123]
  v_add_u32 v19, 35072, v10
  v_add_u32 v22, 35072, v29
  v_mfma_f32_16x16x32_bf16 a[124:127], v[204:207], v[236:239], a[124:127]
  v_mfma_f32_16x16x32_bf16 v[160:163], v[208:211], v[224:227], v[160:163]
  ds_read_b64_tr_b16 v[200:201], v5 offset:25088
  v_mfma_f32_16x16x32_bf16 v[164:167], v[208:211], v[228:231], v[164:167]
  ds_read_b64_tr_b16 v[202:203], v5 offset:26112
  v_mfma_f32_16x16x32_bf16 v[168:171], v[208:211], v[232:235], v[168:171]
  v_mfma_f32_16x16x32_bf16 v[172:175], v[208:211], v[236:239], v[172:175]
  v_mfma_f32_16x16x32_bf16 a[128:131], v[212:215], v[224:227], a[128:131]
  ds_read_b64_tr_b16 v[204:205], v6 offset:25088
  v_mfma_f32_16x16x32_bf16 a[132:135], v[212:215], v[228:231], a[132:135]
  ds_read_b64_tr_b16 v[206:207], v6 offset:26112
  v_mfma_f32_16x16x32_bf16 a[136:139], v[212:215], v[232:235], a[136:139]
  s_add_u32 s4, s82, 16384
  v_mfma_f32_16x16x32_bf16 a[140:143], v[212:215], v[236:239], a[140:143]
  buffer_store_dwordx4 v[84:87], v28, s[20:23], s4 offen sc1
  s_waitcnt lgkmcnt(2)
  v_mfma_f32_16x16x32_bf16 a[144:147], v[216:219], v[224:227], a[144:147]
  ds_read_b64_tr_b16 v[208:209], v30 offset:25088
  v_mfma_f32_16x16x32_bf16 a[148:151], v[216:219], v[228:231], a[148:151]
  ds_read_b64_tr_b16 v[210:211], v30 offset:26112
  v_mfma_f32_16x16x32_bf16 a[152:155], v[216:219], v[232:235], a[152:155]
  v_mfma_f32_16x16x32_bf16 a[156:159], v[216:219], v[236:239], a[156:159]
  v_mfma_f32_16x16x32_bf16 a[160:163], v[220:223], v[224:227], a[160:163]
  ds_read_b64_tr_b16 v[212:213], v16 offset:33920
  v_mfma_f32_16x16x32_bf16 a[164:167], v[220:223], v[228:231], a[164:167]
  ds_read_b64_tr_b16 v[214:215], v16 offset:34176
  v_mfma_f32_16x16x32_bf16 a[168:171], v[220:223], v[232:235], a[168:171]
  v_mfma_f32_16x16x32_bf16 a[172:175], v[220:223], v[236:239], a[172:175]
  s_waitcnt vmcnt(13)
  s_barrier
  s_add_u32 m0, s43, 105216
  v_mfma_f32_16x16x32_bf16 a[176:179], v[192:195], v[224:227], a[176:179]
  ds_read_b64_tr_b16 v[216:217], v17 offset:16384
  v_mfma_f32_16x16x32_bf16 a[180:183], v[192:195], v[228:231], a[180:183]
  ds_read_b64_tr_b16 v[218:219], v17 offset:17408
  v_mfma_f32_16x16x32_bf16 a[184:187], v[192:195], v[232:235], a[184:187]
  ds_read_b128 v[240:243], v14 offset:0
  v_mfma_f32_16x16x32_bf16 a[188:191], v[192:195], v[236:239], a[188:191]
  ds_read_b128 v[244:247], v14 offset:256
  v_mfma_f32_16x16x32_bf16 a[192:195], v[196:199], v[224:227], a[192:195]
  ds_read_b64_tr_b16 v[220:221], v18 offset:16384
  v_mfma_f32_16x16x32_bf16 a[196:199], v[196:199], v[228:231], a[196:199]
  ds_read_b64_tr_b16 v[222:223], v18 offset:17408
  v_mfma_f32_16x16x32_bf16 a[200:203], v[196:199], v[232:235], a[200:203]
  ds_read_b128 v[248:251], v14 offset:2048
  v_mfma_f32_16x16x32_bf16 a[204:207], v[196:199], v[236:239], a[204:207]
  ds_read_b128 v[252:255], v14 offset:2304
  v_mfma_f32_16x16x32_bf16 a[208:211], v[200:203], v[224:227], a[208:211]
  ds_read_b64_tr_b16 v[192:193], v19 offset:16384
  v_mfma_f32_16x16x32_bf16 a[212:215], v[200:203], v[228:231], a[212:215]
  ds_read_b64_tr_b16 v[194:195], v19 offset:17408
  v_mfma_f32_16x16x32_bf16 a[216:219], v[200:203], v[232:235], a[216:219]
  buffer_load_dwordx4 v25, s[56:59], 0 offen sc1 lds
  v_mfma_f32_16x16x32_bf16 a[220:223], v[200:203], v[236:239], a[220:223]
  s_waitcnt lgkmcnt(4)
  v_mfma_f32_16x16x32_bf16 a[224:227], v[204:207], v[224:227], a[224:227]
  ds_read_b64_tr_b16 v[196:197], v22 offset:16384
  v_mfma_f32_16x16x32_bf16 a[228:231], v[204:207], v[228:231], a[228:231]
  ds_read_b64_tr_b16 v[198:199], v22 offset:17408
  v_mfma_f32_16x16x32_bf16 a[232:235], v[204:207], v[232:235], a[232:235]
  buffer_load_dwordx4 v25, s[56:59], 0 offen offset:1024 sc1 lds
  v_mfma_f32_16x16x32_bf16 a[236:239], v[204:207], v[236:239], a[236:239]
  v_mfma_f32_16x16x32_bf16 a[240:243], v[208:211], v[224:227], a[240:243]
  ds_read_b64_tr_b16 v[200:201], v17 offset:16896
  v_mfma_f32_16x16x32_bf16 a[244:247], v[208:211], v[228:231], a[244:247]
  ds_read_b64_tr_b16 v[202:203], v17 offset:17920
  v_mfma_f32_16x16x32_bf16 a[248:251], v[208:211], v[232:235], a[248:251]
  buffer_load_dwordx4 v25, s[56:59], s41 offen offset:2048 sc1 lds
  v_mfma_f32_16x16x32_bf16 a[252:255], v[208:211], v[236:239], a[252:255]
  v_mfma_f32_16x16x32_bf16 v[176:179], v[212:215], v[224:227], v[176:179]
  ds_read_b64_tr_b16 v[204:205], v18 offset:16896
  v_mfma_f32_16x16x32_bf16 v[180:183], v[212:215], v[228:231], v[180:183]
  ds_read_b64_tr_b16 v[206:207], v18 offset:17920
  v_mfma_f32_16x16x32_bf16 v[184:187], v[212:215], v[232:235], v[184:187]
  buffer_load_dwordx4 v25, s[56:59], s41 offen offset:3072 sc1 lds
  v_mfma_f32_16x16x32_bf16 v[188:191], v[212:215], v[236:239], v[188:191]
  v_add_u32 v25, 2048, v25
  s_add_u32 m0, s44, 105216
  v_mfma_f32_16x16x32_bf16 a[0:3], v[216:219], v[240:243], a[0:3]
  ds_read_b64_tr_b16 v[208:209], v19 offset:16896
  v_mfma_f32_16x16x32_bf16 a[4:7], v[216:219], v[244:247], a[4:7]
  ds_read_b64_tr_b16 v[210:211], v19 offset:17920
  s_waitcnt lgkmcnt(4)
  v_mfma_f32_16x16x32_bf16 a[8:11], v[216:219], v[248:251], a[8:11]
  buffer_load_dwordx4 v26, s[24:27], 0 offen lds
  v_mfma_f32_16x16x32_bf16 a[12:15], v[216:219], v[252:255], a[12:15]
  v_mfma_f32_16x16x32_bf16 a[16:19], v[220:223], v[240:243], a[16:19]
  ds_read_b64_tr_b16 v[212:213], v22 offset:16896
  v_mfma_f32_16x16x32_bf16 a[20:23], v[220:223], v[244:247], a[20:23]
  ds_read_b64_tr_b16 v[214:215], v22 offset:17920
  v_mfma_f32_16x16x32_bf16 a[24:27], v[220:223], v[248:251], a[24:27]
  buffer_load_dwordx4 v26, s[24:27], s42 offen offset:1024 lds
  v_mfma_f32_16x16x32_bf16 a[28:31], v[220:223], v[252:255], a[28:31]
  s_add_u32 m0, s48, 105216
  v_mfma_f32_16x16x32_bf16 a[32:35], v[192:195], v[240:243], a[32:35]
  ds_read_b64_tr_b16 v[216:217], v15 offset:32768
  v_mfma_f32_16x16x32_bf16 a[36:39], v[192:195], v[244:247], a[36:39]
  ds_read_b64_tr_b16 v[218:219], v15 offset:33024
  v_mfma_f32_16x16x32_bf16 a[40:43], v[192:195], v[248:251], a[40:43]
  buffer_load_dwordx4 v26, s[28:31], 0 offen lds
  v_mfma_f32_16x16x32_bf16 a[44:47], v[192:195], v[252:255], a[44:47]
  v_mfma_f32_16x16x32_bf16 a[48:51], v[196:199], v[240:243], a[48:51]
  ds_read_b64_tr_b16 v[220:221], v17 offset:24576
  v_mfma_f32_16x16x32_bf16 a[52:55], v[196:199], v[244:247], a[52:55]
  ds_read_b64_tr_b16 v[222:223], v17 offset:25600
  v_mfma_f32_16x16x32_bf16 a[56:59], v[196:199], v[248:251], a[56:59]
  buffer_load_dwordx4 v26, s[28:31], s42 offen offset:1024 lds
  v_mfma_f32_16x16x32_bf16 a[60:63], v[196:199], v[252:255], a[60:63]
  v_add_u32 v26, 294912, v26
  s_add_u32 m0, s66, 105216
  v_mfma_f32_16x16x32_bf16 a[64:67], v[200:203], v[240:243], a[64:67]
  ds_read_b64_tr_b16 v[192:193], v18 offset:24576
  v_mfma_f32_16x16x32_bf16 a[68:71], v[200:203], v[244:247], a[68:71]
  ds_read_b64_tr_b16 v[194:195], v18 offset:25600
  v_mfma_f32_16x16x32_bf16 a[72:75], v[200:203], v[248:251], a[72:75]
  buffer_load_dwordx4 v27, s[60:63], 0 offen lds
  v_mfma_f32_16x16x32_bf16 a[76:79], v[200:203], v[252:255], a[76:79]
  v_add_u32 v27, 294912, v27
  s_waitcnt lgkmcnt(2)
  v_mfma_f32_16x16x32_bf16 a[80:83], v[204:207], v[240:243], a[80:83]
  ds_read_b64_tr_b16 v[196:197], v19 offset:24576
  v_mfma_f32_16x16x32_bf16 a[84:87], v[204:207], v[244:247], a[84:87]
  ds_read_b64_tr_b16 v[198:199], v19 offset:25600
  v_mfma_f32_16x16x32_bf16 a[88:91], v[204:207], v[248:251], a[88:91]
  v_add_u32 v3, 70144, v7
  v_add_u32 v16, 70144, v13
  v_mfma_f32_16x16x32_bf16 a[92:95], v[204:207], v[252:255], a[92:95]
  v_add_u32 v4, 70144, v8
  v_add_u32 v5, 70144, v9
  v_mfma_f32_16x16x32_bf16 a[96:99], v[208:211], v[240:243], a[96:99]
  ds_read_b64_tr_b16 v[200:201], v22 offset:24576
  v_mfma_f32_16x16x32_bf16 a[100:103], v[208:211], v[244:247], a[100:103]
  ds_read_b64_tr_b16 v[202:203], v22 offset:25600
  v_mfma_f32_16x16x32_bf16 a[104:107], v[208:211], v[248:251], a[104:107]
  s_add_u32 s4, s71, 24576
  v_mfma_f32_16x16x32_bf16 a[108:111], v[208:211], v[252:255], a[108:111]
  buffer_store_dwordx4 v[88:91], v28, s[20:23], s4 offen sc1
  v_mfma_f32_16x16x32_bf16 a[112:115], v[212:215], v[240:243], a[112:115]
  ds_read_b64_tr_b16 v[204:205], v17 offset:25088
  v_mfma_f32_16x16x32_bf16 a[116:119], v[212:215], v[244:247], a[116:119]
  ds_read_b64_tr_b16 v[206:207], v17 offset:26112
  v_mfma_f32_16x16x32_bf16 a[120:123], v[212:215], v[248:251], a[120:123]
  v_add_u32 v6, 70144, v10
  v_add_u32 v30, 70144, v29
  v_mfma_f32_16x16x32_bf16 a[124:127], v[212:215], v[252:255], a[124:127]
  v_mfma_f32_16x16x32_bf16 v[160:163], v[216:219], v[240:243], v[160:163]
  ds_read_b64_tr_b16 v[208:209], v18 offset:25088
  v_mfma_f32_16x16x32_bf16 v[164:167], v[216:219], v[244:247], v[164:167]
  ds_read_b64_tr_b16 v[210:211], v18 offset:26112
  v_mfma_f32_16x16x32_bf16 v[168:171], v[216:219], v[248:251], v[168:171]
  v_mfma_f32_16x16x32_bf16 v[172:175], v[216:219], v[252:255], v[172:175]
  v_mfma_f32_16x16x32_bf16 a[128:131], v[220:223], v[240:243], a[128:131]
  ds_read_b64_tr_b16 v[212:213], v19 offset:25088
  v_mfma_f32_16x16x32_bf16 a[132:135], v[220:223], v[244:247], a[132:135]
  ds_read_b64_tr_b16 v[214:215], v19 offset:26112
  v_mfma_f32_16x16x32_bf16 a[136:139], v[220:223], v[248:251], a[136:139]
  s_add_u32 s4, s82, 24576
  v_mfma_f32_16x16x32_bf16 a[140:143], v[220:223], v[252:255], a[140:143]
  buffer_store_dwordx4 v[92:95], v28, s[20:23], s4 offen sc1
  s_waitcnt lgkmcnt(2)
  v_mfma_f32_16x16x32_bf16 a[144:147], v[192:195], v[240:243], a[144:147]
  ds_read_b64_tr_b16 v[216:217], v22 offset:25088
  v_mfma_f32_16x16x32_bf16 a[148:151], v[192:195], v[244:247], a[148:151]
  ds_read_b64_tr_b16 v[218:219], v22 offset:26112
  v_mfma_f32_16x16x32_bf16 a[152:155], v[192:195], v[248:251], a[152:155]
  v_mfma_f32_16x16x32_bf16 a[156:159], v[192:195], v[252:255], a[156:159]
  v_mfma_f32_16x16x32_bf16 a[160:163], v[196:199], v[240:243], a[160:163]
  ds_read_b64_tr_b16 v[220:221], v15 offset:33920
  v_mfma_f32_16x16x32_bf16 a[164:167], v[196:199], v[244:247], a[164:167]
  ds_read_b64_tr_b16 v[222:223], v15 offset:34176
  v_mfma_f32_16x16x32_bf16 a[168:171], v[196:199], v[248:251], a[168:171]
  v_mfma_f32_16x16x32_bf16 a[172:175], v[196:199], v[252:255], a[172:175]
  s_waitcnt vmcnt(13)
  s_barrier
  s_add_u32 m0, s43, 0
  v_mfma_f32_16x16x32_bf16 a[176:179], v[200:203], v[240:243], a[176:179]
  ds_read_b64_tr_b16 v[192:193], v4 offset:16384
  v_mfma_f32_16x16x32_bf16 a[180:183], v[200:203], v[244:247], a[180:183]
  ds_read_b64_tr_b16 v[194:195], v4 offset:17408
  v_mfma_f32_16x16x32_bf16 a[184:187], v[200:203], v[248:251], a[184:187]
  ds_read_b128 v[224:227], v3 offset:0
  v_mfma_f32_16x16x32_bf16 a[188:191], v[200:203], v[252:255], a[188:191]
  ds_read_b128 v[228:231], v3 offset:256
  v_mfma_f32_16x16x32_bf16 a[192:195], v[204:207], v[240:243], a[192:195]
  ds_read_b64_tr_b16 v[196:197], v5 offset:16384
  v_mfma_f32_16x16x32_bf16 a[196:199], v[204:207], v[244:247], a[196:199]
  ds_read_b64_tr_b16 v[198:199], v5 offset:17408
  v_mfma_f32_16x16x32_bf16 a[200:203], v[204:207], v[248:251], a[200:203]
  ds_read_b128 v[232:235], v3 offset:2048
  v_mfma_f32_16x16x32_bf16 a[204:207], v[204:207], v[252:255], a[204:207]
  ds_read_b128 v[236:239], v3 offset:2304
  v_mfma_f32_16x16x32_bf16 a[208:211], v[208:211], v[240:243], a[208:211]
  ds_read_b64_tr_b16 v[200:201], v6 offset:16384
  v_mfma_f32_16x16x32_bf16 a[212:215], v[208:211], v[244:247], a[212:215]
  ds_read_b64_tr_b16 v[202:203], v6 offset:17408
  v_mfma_f32_16x16x32_bf16 a[216:219], v[208:211], v[248:251], a[216:219]
  buffer_load_dwordx4 v25, s[56:59], 0 offen sc1 lds
  v_mfma_f32_16x16x32_bf16 a[220:223], v[208:211], v[252:255], a[220:223]
  s_waitcnt lgkmcnt(4)
  v_mfma_f32_16x16x32_bf16 a[224:227], v[212:215], v[240:243], a[224:227]
  ds_read_b64_tr_b16 v[204:205], v30 offset:16384
  v_mfma_f32_16x16x32_bf16 a[228:231], v[212:215], v[244:247], a[228:231]
  ds_read_b64_tr_b16 v[206:207], v30 offset:17408
  v_mfma_f32_16x16x32_bf16 a[232:235], v[212:215], v[248:251], a[232:235]
  buffer_load_dwordx4 v25, s[56:59], 0 offen offset:1024 sc1 lds
  v_mfma_f32_16x16x32_bf16 a[236:239], v[212:215], v[252:255], a[236:239]
  v_mfma_f32_16x16x32_bf16 a[240:243], v[216:219], v[240:243], a[240:243]
  ds_read_b64_tr_b16 v[208:209], v4 offset:16896
  v_mfma_f32_16x16x32_bf16 a[244:247], v[216:219], v[244:247], a[244:247]
  ds_read_b64_tr_b16 v[210:211], v4 offset:17920
  v_mfma_f32_16x16x32_bf16 a[248:251], v[216:219], v[248:251], a[248:251]
  buffer_load_dwordx4 v25, s[56:59], s41 offen offset:2048 sc1 lds
  v_mfma_f32_16x16x32_bf16 a[252:255], v[216:219], v[252:255], a[252:255]
  v_mfma_f32_16x16x32_bf16 v[176:179], v[220:223], v[240:243], v[176:179]
  ds_read_b64_tr_b16 v[212:213], v5 offset:16896
  v_mfma_f32_16x16x32_bf16 v[180:183], v[220:223], v[244:247], v[180:183]
  ds_read_b64_tr_b16 v[214:215], v5 offset:17920
  v_mfma_f32_16x16x32_bf16 v[184:187], v[220:223], v[248:251], v[184:187]
  buffer_load_dwordx4 v25, s[56:59], s41 offen offset:3072 sc1 lds
  v_mfma_f32_16x16x32_bf16 v[188:191], v[220:223], v[252:255], v[188:191]
  v_add_u32 v25, 2048, v25
  s_add_u32 m0, s44, 0
  v_mfma_f32_16x16x32_bf16 a[0:3], v[192:195], v[224:227], a[0:3]
  ds_read_b64_tr_b16 v[216:217], v6 offset:16896
  v_mfma_f32_16x16x32_bf16 a[4:7], v[192:195], v[228:231], a[4:7]
  ds_read_b64_tr_b16 v[218:219], v6 offset:17920
  s_waitcnt lgkmcnt(4)
  v_mfma_f32_16x16x32_bf16 a[8:11], v[192:195], v[232:235], a[8:11]
  buffer_load_dwordx4 v26, s[24:27], 0 offen lds
  v_mfma_f32_16x16x32_bf16 a[12:15], v[192:195], v[236:239], a[12:15]
  v_mfma_f32_16x16x32_bf16 a[16:19], v[196:199], v[224:227], a[16:19]
  ds_read_b64_tr_b16 v[220:221], v30 offset:16896
  v_mfma_f32_16x16x32_bf16 a[20:23], v[196:199], v[228:231], a[20:23]
  ds_read_b64_tr_b16 v[222:223], v30 offset:17920
  v_mfma_f32_16x16x32_bf16 a[24:27], v[196:199], v[232:235], a[24:27]
  buffer_load_dwordx4 v26, s[24:27], s42 offen offset:1024 lds
  v_mfma_f32_16x16x32_bf16 a[28:31], v[196:199], v[236:239], a[28:31]
  s_add_u32 m0, s48, 0
  v_mfma_f32_16x16x32_bf16 a[32:35], v[200:203], v[224:227], a[32:35]
  ds_read_b64_tr_b16 v[192:193], v16 offset:32768
  v_mfma_f32_16x16x32_bf16 a[36:39], v[200:203], v[228:231], a[36:39]
  ds_read_b64_tr_b16 v[194:195], v16 offset:33024
  v_mfma_f32_16x16x32_bf16 a[40:43], v[200:203], v[232:235], a[40:43]
  buffer_load_dwordx4 v26, s[28:31], 0 offen lds
  v_mfma_f32_16x16x32_bf16 a[44:47], v[200:203], v[236:239], a[44:47]
  v_mfma_f32_16x16x32_bf16 a[48:51], v[204:207], v[224:227], a[48:51]
  ds_read_b64_tr_b16 v[196:197], v4 offset:24576
  v_mfma_f32_16x16x32_bf16 a[52:55], v[204:207], v[228:231], a[52:55]
  ds_read_b64_tr_b16 v[198:199], v4 offset:25600
  v_mfma_f32_16x16x32_bf16 a[56:59], v[204:207], v[232:235], a[56:59]
  buffer_load_dwordx4 v26, s[28:31], s42 offen offset:1024 lds
  v_mfma_f32_16x16x32_bf16 a[60:63], v[204:207], v[236:239], a[60:63]
  v_add_u32 v26, 294912, v26
  s_add_u32 m0, s66, 0
  v_mfma_f32_16x16x32_bf16 a[64:67], v[208:211], v[224:227], a[64:67]
  ds_read_b64_tr_b16 v[200:201], v5 offset:24576
  v_mfma_f32_16x16x32_bf16 a[68:71], v[208:211], v[228:231], a[68:71]
  ds_read_b64_tr_b16 v[202:203], v5 offset:25600
  v_mfma_f32_16x16x32_bf16 a[72:75], v[208:211], v[232:235], a[72:75]
  buffer_load_dwordx4 v27, s[60:63], 0 offen lds
  v_mfma_f32_16x16x32_bf16 a[76:79], v[208:211], v[236:239], a[76:79]
  v_add_u32 v27, 294912, v27
  s_waitcnt lgkmcnt(2)
  v_mfma_f32_16x16x32_bf16 a[80:83], v[212:215], v[224:227], a[80:83]
  ds_read_b64_tr_b16 v[204:205], v6 offset:24576
  v_mfma_f32_16x16x32_bf16 a[84:87], v[212:215], v[228:231], a[84:87]
  ds_read_b64_tr_b16 v[206:207], v6 offset:25600
  v_mfma_f32_16x16x32_bf16 a[88:91], v[212:215], v[232:235], a[88:91]
  v_add_u32 v14, 105216, v7
  v_add_u32 v15, 105216, v13
  v_mfma_f32_16x16x32_bf16 a[92:95], v[212:215], v[236:239], a[92:95]
  v_add_u32 v17, 105216, v8
  v_add_u32 v18, 105216, v9
  v_mfma_f32_16x16x32_bf16 a[96:99], v[216:219], v[224:227], a[96:99]
  ds_read_b64_tr_b16 v[208:209], v30 offset:24576
  v_mfma_f32_16x16x32_bf16 a[100:103], v[216:219], v[228:231], a[100:103]
  ds_read_b64_tr_b16 v[210:211], v30 offset:25600
  v_mfma_f32_16x16x32_bf16 a[104:107], v[216:219], v[232:235], a[104:107]
  s_add_u32 s4, s83, 0
  v_mfma_f32_16x16x32_bf16 a[108:111], v[216:219], v[236:239], a[108:111]
  buffer_store_dwordx4 v[96:99], v28, s[20:23], s4 offen sc1
  v_mfma_f32_16x16x32_bf16 a[112:115], v[220:223], v[224:227], a[112:115]
  ds_read_b64_tr_b16 v[212:213], v4 offset:25088
  v_mfma_f32_16x16x32_bf16 a[116:119], v[220:223], v[228:231], a[116:119]
  ds_read_b64_tr_b16 v[214:215], v4 offset:26112
  v_mfma_f32_16x16x32_bf16 a[120:123], v[220:223], v[232:235], a[120:123]
  v_add_u32 v19, 105216, v10
  v_add_u32 v22, 105216, v29
  v_mfma_f32_16x16x32_bf16 a[124:127], v[220:223], v[236:239], a[124:127]
  v_mfma_f32_16x16x32_bf16 v[160:163], v[192:195], v[224:227], v[160:163]
  ds_read_b64_tr_b16 v[216:217], v5 offset:25088
  v_mfma_f32_16x16x32_bf16 v[164:167], v[192:195], v[228:231], v[164:167]
  ds_read_b64_tr_b16 v[218:219], v5 offset:26112
  v_mfma_f32_16x16x32_bf16 v[168:171], v[192:195], v[232:235], v[168:171]
  v_mfma_f32_16x16x32_bf16 v[172:175], v[192:195], v[236:239], v[172:175]
  v_mfma_f32_16x16x32_bf16 a[128:131], v[196:199], v[224:227], a[128:131]
  ds_read_b64_tr_b16 v[220:221], v6 offset:25088
  v_mfma_f32_16x16x32_bf16 a[132:135], v[196:199], v[228:231], a[132:135]
  ds_read_b64_tr_b16 v[222:223], v6 offset:26112
  v_mfma_f32_16x16x32_bf16 a[136:139], v[196:199], v[232:235], a[136:139]
  s_add_u32 s4, s86, 0
  v_mfma_f32_16x16x32_bf16 a[140:143], v[196:199], v[236:239], a[140:143]
  buffer_store_dwordx4 v[100:103], v28, s[20:23], s4 offen sc1
  s_waitcnt lgkmcnt(2)
  v_mfma_f32_16x16x32_bf16 a[144:147], v[200:203], v[224:227], a[144:147]
  ds_read_b64_tr_b16 v[192:193], v30 offset:25088
  v_mfma_f32_16x16x32_bf16 a[148:151], v[200:203], v[228:231], a[148:151]
  ds_read_b64_tr_b16 v[194:195], v30 offset:26112
  v_mfma_f32_16x16x32_bf16 a[152:155], v[200:203], v[232:235], a[152:155]
  v_mfma_f32_16x16x32_bf16 a[156:159], v[200:203], v[236:239], a[156:159]
  v_mfma_f32_16x16x32_bf16 a[160:163], v[204:207], v[224:227], a[160:163]
  ds_read_b64_tr_b16 v[196:197], v16 offset:33920
  v_mfma_f32_16x16x32_bf16 a[164:167], v[204:207], v[228:231], a[164:167]
  ds_read_b64_tr_b16 v[198:199], v16 offset:34176
  v_mfma_f32_16x16x32_bf16 a[168:171], v[204:207], v[232:235], a[168:171]
  v_mfma_f32_16x16x32_bf16 a[172:175], v[204:207], v[236:239], a[172:175]
  s_waitcnt vmcnt(13)
  s_barrier
  s_add_u32 m0, s43, 35072
  v_mfma_f32_16x16x32_bf16 a[176:179], v[208:211], v[224:227], a[176:179]
  ds_read_b64_tr_b16 v[200:201], v17 offset:16384
  v_mfma_f32_16x16x32_bf16 a[180:183], v[208:211], v[228:231], a[180:183]
  ds_read_b64_tr_b16 v[202:203], v17 offset:17408
  v_mfma_f32_16x16x32_bf16 a[184:187], v[208:211], v[232:235], a[184:187]
  ds_read_b128 v[240:243], v14 offset:0
  v_mfma_f32_16x16x32_bf16 a[188:191], v[208:211], v[236:239], a[188:191]
  ds_read_b128 v[244:247], v14 offset:256
  v_mfma_f32_16x16x32_bf16 a[192:195], v[212:215], v[224:227], a[192:195]
  ds_read_b64_tr_b16 v[204:205], v18 offset:16384
  v_mfma_f32_16x16x32_bf16 a[196:199], v[212:215], v[228:231], a[196:199]
  ds_read_b64_tr_b16 v[206:207], v18 offset:17408
  v_mfma_f32_16x16x32_bf16 a[200:203], v[212:215], v[232:235], a[200:203]
  ds_read_b128 v[248:251], v14 offset:2048
  v_mfma_f32_16x16x32_bf16 a[204:207], v[212:215], v[236:239], a[204:207]
  ds_read_b128 v[252:255], v14 offset:2304
  v_mfma_f32_16x16x32_bf16 a[208:211], v[216:219], v[224:227], a[208:211]
  ds_read_b64_tr_b16 v[208:209], v19 offset:16384
  v_mfma_f32_16x16x32_bf16 a[212:215], v[216:219], v[228:231], a[212:215]
  ds_read_b64_tr_b16 v[210:211], v19 offset:17408
  v_mfma_f32_16x16x32_bf16 a[216:219], v[216:219], v[232:235], a[216:219]
  buffer_load_dwordx4 v25, s[56:59], 0 offen sc1 lds
  v_mfma_f32_16x16x32_bf16 a[220:223], v[216:219], v[236:239], a[220:223]
  s_waitcnt lgkmcnt(4)
  v_mfma_f32_16x16x32_bf16 a[224:227], v[220:223], v[224:227], a[224:227]
  ds_read_b64_tr_b16 v[212:213], v22 offset:16384
  v_mfma_f32_16x16x32_bf16 a[228:231], v[220:223], v[228:231], a[228:231]
  ds_read_b64_tr_b16 v[214:215], v22 offset:17408
  v_mfma_f32_16x16x32_bf16 a[232:235], v[220:223], v[232:235], a[232:235]
  buffer_load_dwordx4 v25, s[56:59], 0 offen offset:1024 sc1 lds
  v_mfma_f32_16x16x32_bf16 a[236:239], v[220:223], v[236:239], a[236:239]
  v_mfma_f32_16x16x32_bf16 a[240:243], v[192:195], v[224:227], a[240:243]
  ds_read_b64_tr_b16 v[216:217], v17 offset:16896
  v_mfma_f32_16x16x32_bf16 a[244:247], v[192:195], v[228:231], a[244:247]
  ds_read_b64_tr_b16 v[218:219], v17 offset:17920
  v_mfma_f32_16x16x32_bf16 a[248:251], v[192:195], v[232:235], a[248:251]
  buffer_load_dwordx4 v25, s[56:59], s41 offen offset:2048 sc1 lds
  v_mfma_f32_16x16x32_bf16 a[252:255], v[192:195], v[236:239], a[252:255]
  v_mfma_f32_16x16x32_bf16 v[176:179], v[196:199], v[224:227], v[176:179]
  ds_read_b64_tr_b16 v[220:221], v18 offset:16896
  v_mfma_f32_16x16x32_bf16 v[180:183], v[196:199], v[228:231], v[180:183]
  ds_read_b64_tr_b16 v[222:223], v18 offset:17920
  v_mfma_f32_16x16x32_bf16 v[184:187], v[196:199], v[232:235], v[184:187]
  buffer_load_dwordx4 v25, s[56:59], s41 offen offset:3072 sc1 lds
  v_mfma_f32_16x16x32_bf16 v[188:191], v[196:199], v[236:239], v[188:191]
  v_add_u32 v25, 2048, v25
  s_add_u32 m0, s44, 35072
  v_mfma_f32_16x16x32_bf16 a[0:3], v[200:203], v[240:243], a[0:3]
  ds_read_b64_tr_b16 v[192:193], v19 offset:16896
  v_mfma_f32_16x16x32_bf16 a[4:7], v[200:203], v[244:247], a[4:7]
  ds_read_b64_tr_b16 v[194:195], v19 offset:17920
  s_waitcnt lgkmcnt(4)
  v_mfma_f32_16x16x32_bf16 a[8:11], v[200:203], v[248:251], a[8:11]
  buffer_load_dwordx4 v26, s[24:27], 0 offen lds
  v_mfma_f32_16x16x32_bf16 a[12:15], v[200:203], v[252:255], a[12:15]
  v_mfma_f32_16x16x32_bf16 a[16:19], v[204:207], v[240:243], a[16:19]
  ds_read_b64_tr_b16 v[196:197], v22 offset:16896
  v_mfma_f32_16x16x32_bf16 a[20:23], v[204:207], v[244:247], a[20:23]
  ds_read_b64_tr_b16 v[198:199], v22 offset:17920
  v_mfma_f32_16x16x32_bf16 a[24:27], v[204:207], v[248:251], a[24:27]
  buffer_load_dwordx4 v26, s[24:27], s42 offen offset:1024 lds
  v_mfma_f32_16x16x32_bf16 a[28:31], v[204:207], v[252:255], a[28:31]
  s_add_u32 m0, s48, 35072
  v_mfma_f32_16x16x32_bf16 a[32:35], v[208:211], v[240:243], a[32:35]
  ds_read_b64_tr_b16 v[200:201], v15 offset:32768
  v_mfma_f32_16x16x32_bf16 a[36:39], v[208:211], v[244:247], a[36:39]
  ds_read_b64_tr_b16 v[202:203], v15 offset:33024
  v_mfma_f32_16x16x32_bf16 a[40:43], v[208:211], v[248:251], a[40:43]
  buffer_load_dwordx4 v26, s[28:31], 0 offen lds
  v_mfma_f32_16x16x32_bf16 a[44:47], v[208:211], v[252:255], a[44:47]
  v_mfma_f32_16x16x32_bf16 a[48:51], v[212:215], v[240:243], a[48:51]
  ds_read_b64_tr_b16 v[204:205], v17 offset:24576
  v_mfma_f32_16x16x32_bf16 a[52:55], v[212:215], v[244:247], a[52:55]
  ds_read_b64_tr_b16 v[206:207], v17 offset:25600
  v_mfma_f32_16x16x32_bf16 a[56:59], v[212:215], v[248:251], a[56:59]
  buffer_load_dwordx4 v26, s[28:31], s42 offen offset:1024 lds
  v_mfma_f32_16x16x32_bf16 a[60:63], v[212:215], v[252:255], a[60:63]
  v_add_u32 v26, 294912, v26
  s_add_u32 m0, s66, 35072
  v_mfma_f32_16x16x32_bf16 a[64:67], v[216:219], v[240:243], a[64:67]
  ds_read_b64_tr_b16 v[208:209], v18 offset:24576
  v_mfma_f32_16x16x32_bf16 a[68:71], v[216:219], v[244:247], a[68:71]
  ds_read_b64_tr_b16 v[210:211], v18 offset:25600
  v_mfma_f32_16x16x32_bf16 a[72:75], v[216:219], v[248:251], a[72:75]
  buffer_load_dwordx4 v27, s[60:63], 0 offen lds
  v_mfma_f32_16x16x32_bf16 a[76:79], v[216:219], v[252:255], a[76:79]
  v_add_u32 v27, 294912, v27
  s_waitcnt lgkmcnt(2)
  v_mfma_f32_16x16x32_bf16 a[80:83], v[220:223], v[240:243], a[80:83]
  ds_read_b64_tr_b16 v[212:213], v19 offset:24576
  v_mfma_f32_16x16x32_bf16 a[84:87], v[220:223], v[244:247], a[84:87]
  ds_read_b64_tr_b16 v[214:215], v19 offset:25600
  v_mfma_f32_16x16x32_bf16 a[88:91], v[220:223], v[248:251], a[88:91]
  v_add_u32 v3, 0, v7
  v_add_u32 v16, 0, v13
  v_mfma_f32_16x16x32_bf16 a[92:95], v[220:223], v[252:255], a[92:95]
  v_add_u32 v4, 0, v8
  v_add_u32 v5, 0, v9
  v_mfma_f32_16x16x32_bf16 a[96:99], v[192:195], v[240:243], a[96:99]
  ds_read_b64_tr_b16 v[216:217], v22 offset:24576
  v_mfma_f32_16x16x32_bf16 a[100:103], v[192:195], v[244:247], a[100:103]
  ds_read_b64_tr_b16 v[218:219], v22 offset:25600
  v_mfma_f32_16x16x32_bf16 a[104:107], v[192:195], v[248:251], a[104:107]
  s_add_u32 s4, s83, 8192
  v_mfma_f32_16x16x32_bf16 a[108:111], v[192:195], v[252:255], a[108:111]
  buffer_store_dwordx4 v[104:107], v28, s[20:23], s4 offen sc1
  v_mfma_f32_16x16x32_bf16 a[112:115], v[196:199], v[240:243], a[112:115]
  ds_read_b64_tr_b16 v[220:221], v17 offset:25088
  v_mfma_f32_16x16x32_bf16 a[116:119], v[196:199], v[244:247], a[116:119]
  ds_read_b64_tr_b16 v[222:223], v17 offset:26112
  v_mfma_f32_16x16x32_bf16 a[120:123], v[196:199], v[248:251], a[120:123]
  v_add_u32 v6, 0, v10
  v_add_u32 v30, 0, v29
  v_mfma_f32_16x16x32_bf16 a[124:127], v[196:199], v[252:255], a[124:127]
  v_mfma_f32_16x16x32_bf16 v[160:163], v[200:203], v[240:243], v[160:163]
  ds_read_b64_tr_b16 v[192:193], v18 offset:25088
  v_mfma_f32_16x16x32_bf16 v[164:167], v[200:203], v[244:247], v[164:167]
  ds_read_b64_tr_b16 v[194:195], v18 offset:26112
  v_mfma_f32_16x16x32_bf16 v[168:171], v[200:203], v[248:251], v[168:171]
  v_mfma_f32_16x16x32_bf16 v[172:175], v[200:203], v[252:255], v[172:175]
  v_mfma_f32_16x16x32_bf16 a[128:131], v[204:207], v[240:243], a[128:131]
  ds_read_b64_tr_b16 v[196:197], v19 offset:25088
  v_mfma_f32_16x16x32_bf16 a[132:135], v[204:207], v[244:247], a[132:135]
  ds_read_b64_tr_b16 v[198:199], v19 offset:26112
  v_mfma_f32_16x16x32_bf16 a[136:139], v[204:207], v[248:251], a[136:139]
  s_add_u32 s4, s86, 8192
  v_mfma_f32_16x16x32_bf16 a[140:143], v[204:207], v[252:255], a[140:143]
  buffer_store_dwordx4 v[108:111], v28, s[20:23], s4 offen sc1
  s_waitcnt lgkmcnt(2)
  v_mfma_f32_16x16x32_bf16 a[144:147], v[208:211], v[240:243], a[144:147]
  ds_read_b64_tr_b16 v[200:201], v22 offset:25088
  v_mfma_f32_16x16x32_bf16 a[148:151], v[208:211], v[244:247], a[148:151]
  ds_read_b64_tr_b16 v[202:203], v22 offset:26112
  v_mfma_f32_16x16x32_bf16 a[152:155], v[208:211], v[248:251], a[152:155]
  v_mfma_f32_16x16x32_bf16 a[156:159], v[208:211], v[252:255], a[156:159]
  v_mfma_f32_16x16x32_bf16 a[160:163], v[212:215], v[240:243], a[160:163]
  ds_read_b64_tr_b16 v[204:205], v15 offset:33920
  v_mfma_f32_16x16x32_bf16 a[164:167], v[212:215], v[244:247], a[164:167]
  ds_read_b64_tr_b16 v[206:207], v15 offset:34176
  v_mfma_f32_16x16x32_bf16 a[168:171], v[212:215], v[248:251], a[168:171]
  v_mfma_f32_16x16x32_bf16 a[172:175], v[212:215], v[252:255], a[172:175]
  s_waitcnt vmcnt(13)
  s_barrier
  s_add_u32 m0, s43, 70144
  v_mfma_f32_16x16x32_bf16 a[176:179], v[216:219], v[240:243], a[176:179]
  ds_read_b64_tr_b16 v[208:209], v4 offset:16384
  v_mfma_f32_16x16x32_bf16 a[180:183], v[216:219], v[244:247], a[180:183]
  ds_read_b64_tr_b16 v[210:211], v4 offset:17408
  v_mfma_f32_16x16x32_bf16 a[184:187], v[216:219], v[248:251], a[184:187]
  ds_read_b128 v[224:227], v3 offset:0
  v_mfma_f32_16x16x32_bf16 a[188:191], v[216:219], v[252:255], a[188:191]
  ds_read_b128 v[228:231], v3 offset:256
  v_mfma_f32_16x16x32_bf16 a[192:195], v[220:223], v[240:243], a[192:195]
  ds_read_b64_tr_b16 v[212:213], v5 offset:16384
  v_mfma_f32_16x16x32_bf16 a[196:199], v[220:223], v[244:247], a[196:199]
  ds_read_b64_tr_b16 v[214:215], v5 offset:17408
  v_mfma_f32_16x16x32_bf16 a[200:203], v[220:223], v[248:251], a[200:203]
  ds_read_b128 v[232:235], v3 offset:2048
  v_mfma_f32_16x16x32_bf16 a[204:207], v[220:223], v[252:255], a[204:207]
  ds_read_b128 v[236:239], v3 offset:2304
  v_mfma_f32_16x16x32_bf16 a[208:211], v[192:195], v[240:243], a[208:211]
  ds_read_b64_tr_b16 v[216:217], v6 offset:16384
  v_mfma_f32_16x16x32_bf16 a[212:215], v[192:195], v[244:247], a[212:215]
  ds_read_b64_tr_b16 v[218:219], v6 offset:17408
  v_mfma_f32_16x16x32_bf16 a[216:219], v[192:195], v[248:251], a[216:219]
  buffer_load_dwordx4 v25, s[56:59], 0 offen sc1 lds
  v_mfma_f32_16x16x32_bf16 a[220:223], v[192:195], v[252:255], a[220:223]
  s_waitcnt lgkmcnt(4)
  v_mfma_f32_16x16x32_bf16 a[224:227], v[196:199], v[240:243], a[224:227]
  ds_read_b64_tr_b16 v[220:221], v30 offset:16384
  v_mfma_f32_16x16x32_bf16 a[228:231], v[196:199], v[244:247], a[228:231]
  ds_read_b64_tr_b16 v[222:223], v30 offset:17408
  v_mfma_f32_16x16x32_bf16 a[232:235], v[196:199], v[248:251], a[232:235]
  buffer_load_dwordx4 v25, s[56:59], 0 offen offset:1024 sc1 lds
  v_mfma_f32_16x16x32_bf16 a[236:239], v[196:199], v[252:255], a[236:239]
  v_mfma_f32_16x16x32_bf16 a[240:243], v[200:203], v[240:243], a[240:243]
  ds_read_b64_tr_b16 v[192:193], v4 offset:16896
  v_mfma_f32_16x16x32_bf16 a[244:247], v[200:203], v[244:247], a[244:247]
  ds_read_b64_tr_b16 v[194:195], v4 offset:17920
  v_mfma_f32_16x16x32_bf16 a[248:251], v[200:203], v[248:251], a[248:251]
  buffer_load_dwordx4 v25, s[56:59], s41 offen offset:2048 sc1 lds
  v_mfma_f32_16x16x32_bf16 a[252:255], v[200:203], v[252:255], a[252:255]
  v_mfma_f32_16x16x32_bf16 v[176:179], v[204:207], v[240:243], v[176:179]
  ds_read_b64_tr_b16 v[196:197], v5 offset:16896
  v_mfma_f32_16x16x32_bf16 v[180:183], v[204:207], v[244:247], v[180:183]
  ds_read_b64_tr_b16 v[198:199], v5 offset:17920
  v_mfma_f32_16x16x32_bf16 v[184:187], v[204:207], v[248:251], v[184:187]
  buffer_load_dwordx4 v25, s[56:59], s41 offen offset:3072 sc1 lds
  v_mfma_f32_16x16x32_bf16 v[188:191], v[204:207], v[252:255], v[188:191]
  v_add_u32 v25, 2048, v25
  s_add_u32 m0, s44, 70144
  v_mfma_f32_16x16x32_bf16 a[0:3], v[208:211], v[224:227], a[0:3]
  ds_read_b64_tr_b16 v[200:201], v6 offset:16896
  v_mfma_f32_16x16x32_bf16 a[4:7], v[208:211], v[228:231], a[4:7]
  ds_read_b64_tr_b16 v[202:203], v6 offset:17920
  s_waitcnt lgkmcnt(4)
  v_mfma_f32_16x16x32_bf16 a[8:11], v[208:211], v[232:235], a[8:11]
  buffer_load_dwordx4 v26, s[24:27], 0 offen lds
  v_mfma_f32_16x16x32_bf16 a[12:15], v[208:211], v[236:239], a[12:15]
  v_mfma_f32_16x16x32_bf16 a[16:19], v[212:215], v[224:227], a[16:19]
  ds_read_b64_tr_b16 v[204:205], v30 offset:16896
  v_mfma_f32_16x16x32_bf16 a[20:23], v[212:215], v[228:231], a[20:23]
  ds_read_b64_tr_b16 v[206:207], v30 offset:17920
  v_mfma_f32_16x16x32_bf16 a[24:27], v[212:215], v[232:235], a[24:27]
  buffer_load_dwordx4 v26, s[24:27], s42 offen offset:1024 lds
  v_mfma_f32_16x16x32_bf16 a[28:31], v[212:215], v[236:239], a[28:31]
  s_add_u32 m0, s48, 70144
  v_mfma_f32_16x16x32_bf16 a[32:35], v[216:219], v[224:227], a[32:35]
  ds_read_b64_tr_b16 v[208:209], v16 offset:32768
  v_mfma_f32_16x16x32_bf16 a[36:39], v[216:219], v[228:231], a[36:39]
  ds_read_b64_tr_b16 v[210:211], v16 offset:33024
  v_mfma_f32_16x16x32_bf16 a[40:43], v[216:219], v[232:235], a[40:43]
  buffer_load_dwordx4 v26, s[28:31], 0 offen lds
  v_mfma_f32_16x16x32_bf16 a[44:47], v[216:219], v[236:239], a[44:47]
  v_mfma_f32_16x16x32_bf16 a[48:51], v[220:223], v[224:227], a[48:51]
  ds_read_b64_tr_b16 v[212:213], v4 offset:24576
  v_mfma_f32_16x16x32_bf16 a[52:55], v[220:223], v[228:231], a[52:55]
  ds_read_b64_tr_b16 v[214:215], v4 offset:25600
  v_mfma_f32_16x16x32_bf16 a[56:59], v[220:223], v[232:235], a[56:59]
  buffer_load_dwordx4 v26, s[28:31], s42 offen offset:1024 lds
  v_mfma_f32_16x16x32_bf16 a[60:63], v[220:223], v[236:239], a[60:63]
  v_add_u32 v26, 294912, v26
  s_add_u32 m0, s66, 70144
  v_mfma_f32_16x16x32_bf16 a[64:67], v[192:195], v[224:227], a[64:67]
  ds_read_b64_tr_b16 v[216:217], v5 offset:24576
  v_mfma_f32_16x16x32_bf16 a[68:71], v[192:195], v[228:231], a[68:71]
  ds_read_b64_tr_b16 v[218:219], v5 offset:25600
  v_mfma_f32_16x16x32_bf16 a[72:75], v[192:195], v[232:235], a[72:75]
  buffer_load_dwordx4 v27, s[60:63], 0 offen lds
  v_mfma_f32_16x16x32_bf16 a[76:79], v[192:195], v[236:239], a[76:79]
  v_add_u32 v27, 294912, v27
  s_waitcnt lgkmcnt(2)
  v_mfma_f32_16x16x32_bf16 a[80:83], v[196:199], v[224:227], a[80:83]
  ds_read_b64_tr_b16 v[220:221], v6 offset:24576
  v_mfma_f32_16x16x32_bf16 a[84:87], v[196:199], v[228:231], a[84:87]
  ds_read_b64_tr_b16 v[222:223], v6 offset:25600
  v_mfma_f32_16x16x32_bf16 a[88:91], v[196:199], v[232:235], a[88:91]
  v_add_u32 v14, 35072, v7
  v_add_u32 v15, 35072, v13
  v_mfma_f32_16x16x32_bf16 a[92:95], v[196:199], v[236:239], a[92:95]
  v_add_u32 v17, 35072, v8
  v_add_u32 v18, 35072, v9
  v_mfma_f32_16x16x32_bf16 a[96:99], v[200:203], v[224:227], a[96:99]
  ds_read_b64_tr_b16 v[192:193], v30 offset:24576
  v_mfma_f32_16x16x32_bf16 a[100:103], v[200:203], v[228:231], a[100:103]
  ds_read_b64_tr_b16 v[194:195], v30 offset:25600
  v_mfma_f32_16x16x32_bf16 a[104:107], v[200:203], v[232:235], a[104:107]
  s_add_u32 s4, s83, 16384
  v_mfma_f32_16x16x32_bf16 a[108:111], v[200:203], v[236:239], a[108:111]
  buffer_store_dwordx4 v[112:115], v28, s[20:23], s4 offen sc1
  v_mfma_f32_16x16x32_bf16 a[112:115], v[204:207], v[224:227], a[112:115]
  ds_read_b64_tr_b16 v[196:197], v4 offset:25088
  v_mfma_f32_16x16x32_bf16 a[116:119], v[204:207], v[228:231], a[116:119]
  ds_read_b64_tr_b16 v[198:199], v4 offset:26112
  v_mfma_f32_16x16x32_bf16 a[120:123], v[204:207], v[232:235], a[120:123]
  v_add_u32 v19, 35072, v10
  v_add_u32 v22, 35072, v29
  v_mfma_f32_16x16x32_bf16 a[124:127], v[204:207], v[236:239], a[124:127]
  v_mfma_f32_16x16x32_bf16 v[160:163], v[208:211], v[224:227], v[160:163]
  ds_read_b64_tr_b16 v[200:201], v5 offset:25088
  v_mfma_f32_16x16x32_bf16 v[164:167], v[208:211], v[228:231], v[164:167]
  ds_read_b64_tr_b16 v[202:203], v5 offset:26112
  v_mfma_f32_16x16x32_bf16 v[168:171], v[208:211], v[232:235], v[168:171]
  v_mfma_f32_16x16x32_bf16 v[172:175], v[208:211], v[236:239], v[172:175]
  v_mfma_f32_16x16x32_bf16 a[128:131], v[212:215], v[224:227], a[128:131]
  ds_read_b64_tr_b16 v[204:205], v6 offset:25088
  v_mfma_f32_16x16x32_bf16 a[132:135], v[212:215], v[228:231], a[132:135]
  ds_read_b64_tr_b16 v[206:207], v6 offset:26112
  v_mfma_f32_16x16x32_bf16 a[136:139], v[212:215], v[232:235], a[136:139]
  s_add_u32 s4, s86, 16384
  v_mfma_f32_16x16x32_bf16 a[140:143], v[212:215], v[236:239], a[140:143]
  buffer_store_dwordx4 v[116:119], v28, s[20:23], s4 offen sc1
  s_waitcnt lgkmcnt(2)
  v_mfma_f32_16x16x32_bf16 a[144:147], v[216:219], v[224:227], a[144:147]
  ds_read_b64_tr_b16 v[208:209], v30 offset:25088
  v_mfma_f32_16x16x32_bf16 a[148:151], v[216:219], v[228:231], a[148:151]
  ds_read_b64_tr_b16 v[210:211], v30 offset:26112
  v_mfma_f32_16x16x32_bf16 a[152:155], v[216:219], v[232:235], a[152:155]
  v_mfma_f32_16x16x32_bf16 a[156:159], v[216:219], v[236:239], a[156:159]
  v_mfma_f32_16x16x32_bf16 a[160:163], v[220:223], v[224:227], a[160:163]
  ds_read_b64_tr_b16 v[212:213], v16 offset:33920
  v_mfma_f32_16x16x32_bf16 a[164:167], v[220:223], v[228:231], a[164:167]
  ds_read_b64_tr_b16 v[214:215], v16 offset:34176
  v_mfma_f32_16x16x32_bf16 a[168:171], v[220:223], v[232:235], a[168:171]
  v_mfma_f32_16x16x32_bf16 a[172:175], v[220:223], v[236:239], a[172:175]
  s_waitcnt vmcnt(13)
  s_barrier
  s_add_u32 m0, s43, 105216
  v_mfma_f32_16x16x32_bf16 a[176:179], v[192:195], v[224:227], a[176:179]
  ds_read_b64_tr_b16 v[216:217], v17 offset:16384
  v_mfma_f32_16x16x32_bf16 a[180:183], v[192:195], v[228:231], a[180:183]
  ds_read_b64_tr_b16 v[218:219], v17 offset:17408
  v_mfma_f32_16x16x32_bf16 a[184:187], v[192:195], v[232:235], a[184:187]
  ds_read_b128 v[240:243], v14 offset:0
  v_mfma_f32_16x16x32_bf16 a[188:191], v[192:195], v[236:239], a[188:191]
  ds_read_b128 v[244:247], v14 offset:256
  v_mfma_f32_16x16x32_bf16 a[192:195], v[196:199], v[224:227], a[192:195]
  ds_read_b64_tr_b16 v[220:221], v18 offset:16384
  v_mfma_f32_16x16x32_bf16 a[196:199], v[196:199], v[228:231], a[196:199]
  ds_read_b64_tr_b16 v[222:223], v18 offset:17408
  v_mfma_f32_16x16x32_bf16 a[200:203], v[196:199], v[232:235], a[200:203]
  ds_read_b128 v[248:251], v14 offset:2048
  v_mfma_f32_16x16x32_bf16 a[204:207], v[196:199], v[236:239], a[204:207]
  ds_read_b128 v[252:255], v14 offset:2304
  v_mfma_f32_16x16x32_bf16 a[208:211], v[200:203], v[224:227], a[208:211]
  ds_read_b64_tr_b16 v[192:193], v19 offset:16384
  v_mfma_f32_16x16x32_bf16 a[212:215], v[200:203], v[228:231], a[212:215]
  ds_read_b64_tr_b16 v[194:195], v19 offset:17408
  v_mfma_f32_16x16x32_bf16 a[216:219], v[200:203], v[232:235], a[216:219]
  buffer_load_dwordx4 v25, s[56:59], 0 offen sc1 lds
  v_mfma_f32_16x16x32_bf16 a[220:223], v[200:203], v[236:239], a[220:223]
  s_waitcnt lgkmcnt(4)
  v_mfma_f32_16x16x32_bf16 a[224:227], v[204:207], v[224:227], a[224:227]
  ds_read_b64_tr_b16 v[196:197], v22 offset:16384
  v_mfma_f32_16x16x32_bf16 a[228:231], v[204:207], v[228:231], a[228:231]
  ds_read_b64_tr_b16 v[198:199], v22 offset:17408
  v_mfma_f32_16x16x32_bf16 a[232:235], v[204:207], v[232:235], a[232:235]
  buffer_load_dwordx4 v25, s[56:59], 0 offen offset:1024 sc1 lds
  v_mfma_f32_16x16x32_bf16 a[236:239], v[204:207], v[236:239], a[236:239]
  v_mfma_f32_16x16x32_bf16 a[240:243], v[208:211], v[224:227], a[240:243]
  ds_read_b64_tr_b16 v[200:201], v17 offset:16896
  v_mfma_f32_16x16x32_bf16 a[244:247], v[208:211], v[228:231], a[244:247]
  ds_read_b64_tr_b16 v[202:203], v17 offset:17920
  v_mfma_f32_16x16x32_bf16 a[248:251], v[208:211], v[232:235], a[248:251]
  buffer_load_dwordx4 v25, s[56:59], s41 offen offset:2048 sc1 lds
  v_mfma_f32_16x16x32_bf16 a[252:255], v[208:211], v[236:239], a[252:255]
  v_mfma_f32_16x16x32_bf16 v[176:179], v[212:215], v[224:227], v[176:179]
  ds_read_b64_tr_b16 v[204:205], v18 offset:16896
  v_mfma_f32_16x16x32_bf16 v[180:183], v[212:215], v[228:231], v[180:183]
  ds_read_b64_tr_b16 v[206:207], v18 offset:17920
  v_mfma_f32_16x16x32_bf16 v[184:187], v[212:215], v[232:235], v[184:187]
  buffer_load_dwordx4 v25, s[56:59], s41 offen offset:3072 sc1 lds
  v_mfma_f32_16x16x32_bf16 v[188:191], v[212:215], v[236:239], v[188:191]
  v_add_u32 v25, 2048, v25
  s_add_u32 m0, s44, 105216
  v_mfma_f32_16x16x32_bf16 a[0:3], v[216:219], v[240:243], a[0:3]
  ds_read_b64_tr_b16 v[208:209], v19 offset:16896
  v_mfma_f32_16x16x32_bf16 a[4:7], v[216:219], v[244:247], a[4:7]
  ds_read_b64_tr_b16 v[210:211], v19 offset:17920
  s_waitcnt lgkmcnt(4)
  v_mfma_f32_16x16x32_bf16 a[8:11], v[216:219], v[248:251], a[8:11]
  buffer_load_dwordx4 v26, s[24:27], 0 offen lds
  v_mfma_f32_16x16x32_bf16 a[12:15], v[216:219], v[252:255], a[12:15]
  v_mfma_f32_16x16x32_bf16 a[16:19], v[220:223], v[240:243], a[16:19]
  ds_read_b64_tr_b16 v[212:213], v22 offset:16896
  v_mfma_f32_16x16x32_bf16 a[20:23], v[220:223], v[244:247], a[20:23]
  ds_read_b64_tr_b16 v[214:215], v22 offset:17920
  v_mfma_f32_16x16x32_bf16 a[24:27], v[220:223], v[248:251], a[24:27]
  buffer_load_dwordx4 v26, s[24:27], s42 offen offset:1024 lds
  v_mfma_f32_16x16x32_bf16 a[28:31], v[220:223], v[252:255], a[28:31]
  s_add_u32 m0, s48, 105216
  v_mfma_f32_16x16x32_bf16 a[32:35], v[192:195], v[240:243], a[32:35]
  ds_read_b64_tr_b16 v[216:217], v15 offset:32768
  v_mfma_f32_16x16x32_bf16 a[36:39], v[192:195], v[244:247], a[36:39]
  ds_read_b64_tr_b16 v[218:219], v15 offset:33024
  v_mfma_f32_16x16x32_bf16 a[40:43], v[192:195], v[248:251], a[40:43]
  buffer_load_dwordx4 v26, s[28:31], 0 offen lds
  v_mfma_f32_16x16x32_bf16 a[44:47], v[192:195], v[252:255], a[44:47]
  v_mfma_f32_16x16x32_bf16 a[48:51], v[196:199], v[240:243], a[48:51]
  ds_read_b64_tr_b16 v[220:221], v17 offset:24576
  v_mfma_f32_16x16x32_bf16 a[52:55], v[196:199], v[244:247], a[52:55]
  ds_read_b64_tr_b16 v[222:223], v17 offset:25600
  v_mfma_f32_16x16x32_bf16 a[56:59], v[196:199], v[248:251], a[56:59]
  buffer_load_dwordx4 v26, s[28:31], s42 offen offset:1024 lds
  v_mfma_f32_16x16x32_bf16 a[60:63], v[196:199], v[252:255], a[60:63]
  v_add_u32 v26, 294912, v26
  s_add_u32 m0, s66, 105216
  v_mfma_f32_16x16x32_bf16 a[64:67], v[200:203], v[240:243], a[64:67]
  ds_read_b64_tr_b16 v[192:193], v18 offset:24576
  v_mfma_f32_16x16x32_bf16 a[68:71], v[200:203], v[244:247], a[68:71]
  ds_read_b64_tr_b16 v[194:195], v18 offset:25600
  v_mfma_f32_16x16x32_bf16 a[72:75], v[200:203], v[248:251], a[72:75]
  buffer_load_dwordx4 v27, s[60:63], 0 offen lds
  v_mfma_f32_16x16x32_bf16 a[76:79], v[200:203], v[252:255], a[76:79]
  v_add_u32 v27, 294912, v27
  s_waitcnt lgkmcnt(2)
  v_mfma_f32_16x16x32_bf16 a[80:83], v[204:207], v[240:243], a[80:83]
  ds_read_b64_tr_b16 v[196:197], v19 offset:24576
  v_mfma_f32_16x16x32_bf16 a[84:87], v[204:207], v[244:247], a[84:87]
  ds_read_b64_tr_b16 v[198:199], v19 offset:25600
  v_mfma_f32_16x16x32_bf16 a[88:91], v[204:207], v[248:251], a[88:91]
  v_add_u32 v3, 70144, v7
  v_add_u32 v16, 70144, v13
  v_mfma_f32_16x16x32_bf16 a[92:95], v[204:207], v[252:255], a[92:95]
  v_add_u32 v4, 70144, v8
  v_add_u32 v5, 70144, v9
  v_mfma_f32_16x16x32_bf16 a[96:99], v[208:211], v[240:243], a[96:99]
  ds_read_b64_tr_b16 v[200:201], v22 offset:24576
  v_mfma_f32_16x16x32_bf16 a[100:103], v[208:211], v[244:247], a[100:103]
  ds_read_b64_tr_b16 v[202:203], v22 offset:25600
  v_mfma_f32_16x16x32_bf16 a[104:107], v[208:211], v[248:251], a[104:107]
  s_add_u32 s4, s83, 24576
  v_mfma_f32_16x16x32_bf16 a[108:111], v[208:211], v[252:255], a[108:111]
  buffer_store_dwordx4 v[120:123], v28, s[20:23], s4 offen sc1
  v_mfma_f32_16x16x32_bf16 a[112:115], v[212:215], v[240:243], a[112:115]
  ds_read_b64_tr_b16 v[204:205], v17 offset:25088
  v_mfma_f32_16x16x32_bf16 a[116:119], v[212:215], v[244:247], a[116:119]
  ds_read_b64_tr_b16 v[206:207], v17 offset:26112
  v_mfma_f32_16x16x32_bf16 a[120:123], v[212:215], v[248:251], a[120:123]
  v_add_u32 v6, 70144, v10
  v_add_u32 v30, 70144, v29
  v_mfma_f32_16x16x32_bf16 a[124:127], v[212:215], v[252:255], a[124:127]
  v_mfma_f32_16x16x32_bf16 v[160:163], v[216:219], v[240:243], v[160:163]
  ds_read_b64_tr_b16 v[208:209], v18 offset:25088
  v_mfma_f32_16x16x32_bf16 v[164:167], v[216:219], v[244:247], v[164:167]
  ds_read_b64_tr_b16 v[210:211], v18 offset:26112
  v_mfma_f32_16x16x32_bf16 v[168:171], v[216:219], v[248:251], v[168:171]
  v_mfma_f32_16x16x32_bf16 v[172:175], v[216:219], v[252:255], v[172:175]
  v_mfma_f32_16x16x32_bf16 a[128:131], v[220:223], v[240:243], a[128:131]
  ds_read_b64_tr_b16 v[212:213], v19 offset:25088
  v_mfma_f32_16x16x32_bf16 a[132:135], v[220:223], v[244:247], a[132:135]
  ds_read_b64_tr_b16 v[214:215], v19 offset:26112
  v_mfma_f32_16x16x32_bf16 a[136:139], v[220:223], v[248:251], a[136:139]
  s_add_u32 s4, s86, 24576
  v_mfma_f32_16x16x32_bf16 a[140:143], v[220:223], v[252:255], a[140:143]
  buffer_store_dwordx4 v[124:127], v28, s[20:23], s4 offen sc1
  s_waitcnt lgkmcnt(2)
  v_mfma_f32_16x16x32_bf16 a[144:147], v[192:195], v[240:243], a[144:147]
  ds_read_b64_tr_b16 v[216:217], v22 offset:25088
  v_mfma_f32_16x16x32_bf16 a[148:151], v[192:195], v[244:247], a[148:151]
  ds_read_b64_tr_b16 v[218:219], v22 offset:26112
  v_mfma_f32_16x16x32_bf16 a[152:155], v[192:195], v[248:251], a[152:155]
  v_mfma_f32_16x16x32_bf16 a[156:159], v[192:195], v[252:255], a[156:159]
  v_mfma_f32_16x16x32_bf16 a[160:163], v[196:199], v[240:243], a[160:163]
  ds_read_b64_tr_b16 v[220:221], v15 offset:33920
  v_mfma_f32_16x16x32_bf16 a[164:167], v[196:199], v[244:247], a[164:167]
  ds_read_b64_tr_b16 v[222:223], v15 offset:34176
  v_mfma_f32_16x16x32_bf16 a[168:171], v[196:199], v[248:251], a[168:171]
  v_mfma_f32_16x16x32_bf16 a[172:175], v[196:199], v[252:255], a[172:175]
  s_waitcnt vmcnt(13)
  s_barrier
  s_add_u32 m0, s43, 0
  v_mfma_f32_16x16x32_bf16 a[176:179], v[200:203], v[240:243], a[176:179]
  ds_read_b64_tr_b16 v[192:193], v4 offset:16384
  v_mfma_f32_16x16x32_bf16 a[180:183], v[200:203], v[244:247], a[180:183]
  ds_read_b64_tr_b16 v[194:195], v4 offset:17408
  v_mfma_f32_16x16x32_bf16 a[184:187], v[200:203], v[248:251], a[184:187]
  ds_read_b128 v[224:227], v3 offset:0
  v_mfma_f32_16x16x32_bf16 a[188:191], v[200:203], v[252:255], a[188:191]
  ds_read_b128 v[228:231], v3 offset:256
  v_mfma_f32_16x16x32_bf16 a[192:195], v[204:207], v[240:243], a[192:195]
  ds_read_b64_tr_b16 v[196:197], v5 offset:16384
  v_mfma_f32_16x16x32_bf16 a[196:199], v[204:207], v[244:247], a[196:199]
  ds_read_b64_tr_b16 v[198:199], v5 offset:17408
  v_mfma_f32_16x16x32_bf16 a[200:203], v[204:207], v[248:251], a[200:203]
  ds_read_b128 v[232:235], v3 offset:2048
  v_mfma_f32_16x16x32_bf16 a[204:207], v[204:207], v[252:255], a[204:207]
  ds_read_b128 v[236:239], v3 offset:2304
  v_mfma_f32_16x16x32_bf16 a[208:211], v[208:211], v[240:243], a[208:211]
  ds_read_b64_tr_b16 v[200:201], v6 offset:16384
  v_mfma_f32_16x16x32_bf16 a[212:215], v[208:211], v[244:247], a[212:215]
  ds_read_b64_tr_b16 v[202:203], v6 offset:17408
  v_mfma_f32_16x16x32_bf16 a[216:219], v[208:211], v[248:251], a[216:219]
  buffer_load_dwordx4 v25, s[56:59], 0 offen sc1 lds
  v_mfma_f32_16x16x32_bf16 a[220:223], v[208:211], v[252:255], a[220:223]
  s_waitcnt lgkmcnt(4)
  v_mfma_f32_16x16x32_bf16 a[224:227], v[212:215], v[240:243], a[224:227]
  ds_read_b64_tr_b16 v[204:205], v30 offset:16384
  v_mfma_f32_16x16x32_bf16 a[228:231], v[212:215], v[244:247], a[228:231]
  ds_read_b64_tr_b16 v[206:207], v30 offset:17408
  v_mfma_f32_16x16x32_bf16 a[232:235], v[212:215], v[248:251], a[232:235]
  buffer_load_dwordx4 v25, s[56:59], 0 offen offset:1024 sc1 lds
  v_mfma_f32_16x16x32_bf16 a[236:239], v[212:215], v[252:255], a[236:239]
  v_mfma_f32_16x16x32_bf16 a[240:243], v[216:219], v[240:243], a[240:243]
  ds_read_b64_tr_b16 v[208:209], v4 offset:16896
  v_mfma_f32_16x16x32_bf16 a[244:247], v[216:219], v[244:247], a[244:247]
  ds_read_b64_tr_b16 v[210:211], v4 offset:17920
  v_mfma_f32_16x16x32_bf16 a[248:251], v[216:219], v[248:251], a[248:251]
  buffer_load_dwordx4 v25, s[56:59], s41 offen offset:2048 sc1 lds
  v_mfma_f32_16x16x32_bf16 a[252:255], v[216:219], v[252:255], a[252:255]
  v_mfma_f32_16x16x32_bf16 v[176:179], v[220:223], v[240:243], v[176:179]
  ds_read_b64_tr_b16 v[212:213], v5 offset:16896
  v_mfma_f32_16x16x32_bf16 v[180:183], v[220:223], v[244:247], v[180:183]
  ds_read_b64_tr_b16 v[214:215], v5 offset:17920
  v_mfma_f32_16x16x32_bf16 v[184:187], v[220:223], v[248:251], v[184:187]
  buffer_load_dwordx4 v25, s[56:59], s41 offen offset:3072 sc1 lds
  v_mfma_f32_16x16x32_bf16 v[188:191], v[220:223], v[252:255], v[188:191]
  v_add_u32 v25, 2048, v25
  s_add_u32 m0, s44, 0
  v_mfma_f32_16x16x32_bf16 a[0:3], v[192:195], v[224:227], a[0:3]
  ds_read_b64_tr_b16 v[216:217], v6 offset:16896
  v_mfma_f32_16x16x32_bf16 a[4:7], v[192:195], v[228:231], a[4:7]
  ds_read_b64_tr_b16 v[218:219], v6 offset:17920
  s_waitcnt lgkmcnt(4)
  v_mfma_f32_16x16x32_bf16 a[8:11], v[192:195], v[232:235], a[8:11]
  buffer_load_dwordx4 v26, s[24:27], 0 offen lds
  v_mfma_f32_16x16x32_bf16 a[12:15], v[192:195], v[236:239], a[12:15]
  v_mfma_f32_16x16x32_bf16 a[16:19], v[196:199], v[224:227], a[16:19]
  ds_read_b64_tr_b16 v[220:221], v30 offset:16896
  v_mfma_f32_16x16x32_bf16 a[20:23], v[196:199], v[228:231], a[20:23]
  ds_read_b64_tr_b16 v[222:223], v30 offset:17920
  v_mfma_f32_16x16x32_bf16 a[24:27], v[196:199], v[232:235], a[24:27]
  buffer_load_dwordx4 v26, s[24:27], s42 offen offset:1024 lds
  v_mfma_f32_16x16x32_bf16 a[28:31], v[196:199], v[236:239], a[28:31]
  s_add_u32 m0, s48, 0
  v_mfma_f32_16x16x32_bf16 a[32:35], v[200:203], v[224:227], a[32:35]
  ds_read_b64_tr_b16 v[192:193], v16 offset:32768
  v_mfma_f32_16x16x32_bf16 a[36:39], v[200:203], v[228:231], a[36:39]
  ds_read_b64_tr_b16 v[194:195], v16 offset:33024
  v_mfma_f32_16x16x32_bf16 a[40:43], v[200:203], v[232:235], a[40:43]
  buffer_load_dwordx4 v26, s[28:31], 0 offen lds
  v_mfma_f32_16x16x32_bf16 a[44:47], v[200:203], v[236:239], a[44:47]
  v_mfma_f32_16x16x32_bf16 a[48:51], v[204:207], v[224:227], a[48:51]
  ds_read_b64_tr_b16 v[196:197], v4 offset:24576
  v_mfma_f32_16x16x32_bf16 a[52:55], v[204:207], v[228:231], a[52:55]
  ds_read_b64_tr_b16 v[198:199], v4 offset:25600
  v_mfma_f32_16x16x32_bf16 a[56:59], v[204:207], v[232:235], a[56:59]
  buffer_load_dwordx4 v26, s[28:31], s42 offen offset:1024 lds
  v_mfma_f32_16x16x32_bf16 a[60:63], v[204:207], v[236:239], a[60:63]
  v_add_u32 v26, 294912, v26
  s_add_u32 m0, s66, 0
  v_mfma_f32_16x16x32_bf16 a[64:67], v[208:211], v[224:227], a[64:67]
  ds_read_b64_tr_b16 v[200:201], v5 offset:24576
  v_mfma_f32_16x16x32_bf16 a[68:71], v[208:211], v[228:231], a[68:71]
  ds_read_b64_tr_b16 v[202:203], v5 offset:25600
  v_mfma_f32_16x16x32_bf16 a[72:75], v[208:211], v[232:235], a[72:75]
  buffer_load_dwordx4 v27, s[60:63], 0 offen lds
  v_mfma_f32_16x16x32_bf16 a[76:79], v[208:211], v[236:239], a[76:79]
  v_add_u32 v27, 294912, v27
  s_waitcnt lgkmcnt(2)
  v_mfma_f32_16x16x32_bf16 a[80:83], v[212:215], v[224:227], a[80:83]
  ds_read_b64_tr_b16 v[204:205], v6 offset:24576
  v_mfma_f32_16x16x32_bf16 a[84:87], v[212:215], v[228:231], a[84:87]
  ds_read_b64_tr_b16 v[206:207], v6 offset:25600
  v_mfma_f32_16x16x32_bf16 a[88:91], v[212:215], v[232:235], a[88:91]
  v_add_u32 v14, 105216, v7
  v_add_u32 v15, 105216, v13
  v_mfma_f32_16x16x32_bf16 a[92:95], v[212:215], v[236:239], a[92:95]
  v_add_u32 v17, 105216, v8
  v_add_u32 v18, 105216, v9
  v_mfma_f32_16x16x32_bf16 a[96:99], v[216:219], v[224:227], a[96:99]
  ds_read_b64_tr_b16 v[208:209], v30 offset:24576
  v_mfma_f32_16x16x32_bf16 a[100:103], v[216:219], v[228:231], a[100:103]
  ds_read_b64_tr_b16 v[210:211], v30 offset:25600
  v_mfma_f32_16x16x32_bf16 a[104:107], v[216:219], v[232:235], a[104:107]
  s_add_u32 s4, s87, 0
  v_mfma_f32_16x16x32_bf16 a[108:111], v[216:219], v[236:239], a[108:111]
  buffer_store_dwordx4 v[128:131], v28, s[20:23], s4 offen sc1
  v_mfma_f32_16x16x32_bf16 a[112:115], v[220:223], v[224:227], a[112:115]
  ds_read_b64_tr_b16 v[212:213], v4 offset:25088
  v_mfma_f32_16x16x32_bf16 a[116:119], v[220:223], v[228:231], a[116:119]
  ds_read_b64_tr_b16 v[214:215], v4 offset:26112
  v_mfma_f32_16x16x32_bf16 a[120:123], v[220:223], v[232:235], a[120:123]
  v_add_u32 v19, 105216, v10
  v_add_u32 v22, 105216, v29
  v_mfma_f32_16x16x32_bf16 a[124:127], v[220:223], v[236:239], a[124:127]
  v_mfma_f32_16x16x32_bf16 v[160:163], v[192:195], v[224:227], v[160:163]
  ds_read_b64_tr_b16 v[216:217], v5 offset:25088
  v_mfma_f32_16x16x32_bf16 v[164:167], v[192:195], v[228:231], v[164:167]
  ds_read_b64_tr_b16 v[218:219], v5 offset:26112
  v_mfma_f32_16x16x32_bf16 v[168:171], v[192:195], v[232:235], v[168:171]
  v_mfma_f32_16x16x32_bf16 v[172:175], v[192:195], v[236:239], v[172:175]
  v_mfma_f32_16x16x32_bf16 a[128:131], v[196:199], v[224:227], a[128:131]
  ds_read_b64_tr_b16 v[220:221], v6 offset:25088
  v_mfma_f32_16x16x32_bf16 a[132:135], v[196:199], v[228:231], a[132:135]
  ds_read_b64_tr_b16 v[222:223], v6 offset:26112
  v_mfma_f32_16x16x32_bf16 a[136:139], v[196:199], v[232:235], a[136:139]
  s_add_u32 s4, s94, 0
  v_mfma_f32_16x16x32_bf16 a[140:143], v[196:199], v[236:239], a[140:143]
  buffer_store_dwordx4 v[132:135], v28, s[20:23], s4 offen sc1
  s_waitcnt lgkmcnt(2)
  v_mfma_f32_16x16x32_bf16 a[144:147], v[200:203], v[224:227], a[144:147]
  ds_read_b64_tr_b16 v[192:193], v30 offset:25088
  v_mfma_f32_16x16x32_bf16 a[148:151], v[200:203], v[228:231], a[148:151]
  ds_read_b64_tr_b16 v[194:195], v30 offset:26112
  v_mfma_f32_16x16x32_bf16 a[152:155], v[200:203], v[232:235], a[152:155]
  v_mfma_f32_16x16x32_bf16 a[156:159], v[200:203], v[236:239], a[156:159]
  v_mfma_f32_16x16x32_bf16 a[160:163], v[204:207], v[224:227], a[160:163]
  ds_read_b64_tr_b16 v[196:197], v16 offset:33920
  v_mfma_f32_16x16x32_bf16 a[164:167], v[204:207], v[228:231], a[164:167]
  ds_read_b64_tr_b16 v[198:199], v16 offset:34176
  v_mfma_f32_16x16x32_bf16 a[168:171], v[204:207], v[232:235], a[168:171]
  v_mfma_f32_16x16x32_bf16 a[172:175], v[204:207], v[236:239], a[172:175]
  s_waitcnt vmcnt(13)
  s_barrier
  s_add_u32 m0, s43, 35072
  v_mfma_f32_16x16x32_bf16 a[176:179], v[208:211], v[224:227], a[176:179]
  ds_read_b64_tr_b16 v[200:201], v17 offset:16384
  v_mfma_f32_16x16x32_bf16 a[180:183], v[208:211], v[228:231], a[180:183]
  ds_read_b64_tr_b16 v[202:203], v17 offset:17408
  v_mfma_f32_16x16x32_bf16 a[184:187], v[208:211], v[232:235], a[184:187]
  ds_read_b128 v[240:243], v14 offset:0
  v_mfma_f32_16x16x32_bf16 a[188:191], v[208:211], v[236:239], a[188:191]
  ds_read_b128 v[244:247], v14 offset:256
  v_mfma_f32_16x16x32_bf16 a[192:195], v[212:215], v[224:227], a[192:195]
  ds_read_b64_tr_b16 v[204:205], v18 offset:16384
  v_mfma_f32_16x16x32_bf16 a[196:199], v[212:215], v[228:231], a[196:199]
  ds_read_b64_tr_b16 v[206:207], v18 offset:17408
  v_mfma_f32_16x16x32_bf16 a[200:203], v[212:215], v[232:235], a[200:203]
  ds_read_b128 v[248:251], v14 offset:2048
  v_mfma_f32_16x16x32_bf16 a[204:207], v[212:215], v[236:239], a[204:207]
  ds_read_b128 v[252:255], v14 offset:2304
  v_mfma_f32_16x16x32_bf16 a[208:211], v[216:219], v[224:227], a[208:211]
  ds_read_b64_tr_b16 v[208:209], v19 offset:16384
  v_mfma_f32_16x16x32_bf16 a[212:215], v[216:219], v[228:231], a[212:215]
  ds_read_b64_tr_b16 v[210:211], v19 offset:17408
  v_mfma_f32_16x16x32_bf16 a[216:219], v[216:219], v[232:235], a[216:219]
  buffer_load_dwordx4 v25, s[56:59], 0 offen sc1 lds
  v_mfma_f32_16x16x32_bf16 a[220:223], v[216:219], v[236:239], a[220:223]
  s_waitcnt lgkmcnt(4)
  v_mfma_f32_16x16x32_bf16 a[224:227], v[220:223], v[224:227], a[224:227]
  ds_read_b64_tr_b16 v[212:213], v22 offset:16384
  v_mfma_f32_16x16x32_bf16 a[228:231], v[220:223], v[228:231], a[228:231]
  ds_read_b64_tr_b16 v[214:215], v22 offset:17408
  v_mfma_f32_16x16x32_bf16 a[232:235], v[220:223], v[232:235], a[232:235]
  buffer_load_dwordx4 v25, s[56:59], 0 offen offset:1024 sc1 lds
  v_mfma_f32_16x16x32_bf16 a[236:239], v[220:223], v[236:239], a[236:239]
  v_mfma_f32_16x16x32_bf16 a[240:243], v[192:195], v[224:227], a[240:243]
  ds_read_b64_tr_b16 v[216:217], v17 offset:16896
  v_mfma_f32_16x16x32_bf16 a[244:247], v[192:195], v[228:231], a[244:247]
  ds_read_b64_tr_b16 v[218:219], v17 offset:17920
  v_mfma_f32_16x16x32_bf16 a[248:251], v[192:195], v[232:235], a[248:251]
  buffer_load_dwordx4 v25, s[56:59], s41 offen offset:2048 sc1 lds
  v_mfma_f32_16x16x32_bf16 a[252:255], v[192:195], v[236:239], a[252:255]
  v_mfma_f32_16x16x32_bf16 v[176:179], v[196:199], v[224:227], v[176:179]
  ds_read_b64_tr_b16 v[220:221], v18 offset:16896
  v_mfma_f32_16x16x32_bf16 v[180:183], v[196:199], v[228:231], v[180:183]
  ds_read_b64_tr_b16 v[222:223], v18 offset:17920
  v_mfma_f32_16x16x32_bf16 v[184:187], v[196:199], v[232:235], v[184:187]
  buffer_load_dwordx4 v25, s[56:59], s41 offen offset:3072 sc1 lds
  v_mfma_f32_16x16x32_bf16 v[188:191], v[196:199], v[236:239], v[188:191]
  v_add_u32 v25, 2048, v25
  s_add_u32 m0, s44, 35072
  v_mfma_f32_16x16x32_bf16 a[0:3], v[200:203], v[240:243], a[0:3]
  ds_read_b64_tr_b16 v[192:193], v19 offset:16896
  v_mfma_f32_16x16x32_bf16 a[4:7], v[200:203], v[244:247], a[4:7]
  ds_read_b64_tr_b16 v[194:195], v19 offset:17920
  s_waitcnt lgkmcnt(4)
  v_mfma_f32_16x16x32_bf16 a[8:11], v[200:203], v[248:251], a[8:11]
  buffer_load_dwordx4 v26, s[24:27], 0 offen lds
  v_mfma_f32_16x16x32_bf16 a[12:15], v[200:203], v[252:255], a[12:15]
  v_mfma_f32_16x16x32_bf16 a[16:19], v[204:207], v[240:243], a[16:19]
  ds_read_b64_tr_b16 v[196:197], v22 offset:16896
  v_mfma_f32_16x16x32_bf16 a[20:23], v[204:207], v[244:247], a[20:23]
  ds_read_b64_tr_b16 v[198:199], v22 offset:17920
  v_mfma_f32_16x16x32_bf16 a[24:27], v[204:207], v[248:251], a[24:27]
  buffer_load_dwordx4 v26, s[24:27], s42 offen offset:1024 lds
  v_mfma_f32_16x16x32_bf16 a[28:31], v[204:207], v[252:255], a[28:31]
  s_add_u32 m0, s48, 35072
  v_mfma_f32_16x16x32_bf16 a[32:35], v[208:211], v[240:243], a[32:35]
  ds_read_b64_tr_b16 v[200:201], v15 offset:32768
  v_mfma_f32_16x16x32_bf16 a[36:39], v[208:211], v[244:247], a[36:39]
  ds_read_b64_tr_b16 v[202:203], v15 offset:33024
  v_mfma_f32_16x16x32_bf16 a[40:43], v[208:211], v[248:251], a[40:43]
  buffer_load_dwordx4 v26, s[28:31], 0 offen lds
  v_mfma_f32_16x16x32_bf16 a[44:47], v[208:211], v[252:255], a[44:47]
  v_mfma_f32_16x16x32_bf16 a[48:51], v[212:215], v[240:243], a[48:51]
  ds_read_b64_tr_b16 v[204:205], v17 offset:24576
  v_mfma_f32_16x16x32_bf16 a[52:55], v[212:215], v[244:247], a[52:55]
  ds_read_b64_tr_b16 v[206:207], v17 offset:25600
  v_mfma_f32_16x16x32_bf16 a[56:59], v[212:215], v[248:251], a[56:59]
  buffer_load_dwordx4 v26, s[28:31], s42 offen offset:1024 lds
  v_mfma_f32_16x16x32_bf16 a[60:63], v[212:215], v[252:255], a[60:63]
  v_add_u32 v26, 294912, v26
  s_add_u32 m0, s66, 35072
  v_mfma_f32_16x16x32_bf16 a[64:67], v[216:219], v[240:243], a[64:67]
  ds_read_b64_tr_b16 v[208:209], v18 offset:24576
  v_mfma_f32_16x16x32_bf16 a[68:71], v[216:219], v[244:247], a[68:71]
  ds_read_b64_tr_b16 v[210:211], v18 offset:25600
  v_mfma_f32_16x16x32_bf16 a[72:75], v[216:219], v[248:251], a[72:75]
  buffer_load_dwordx4 v27, s[60:63], 0 offen lds
  v_mfma_f32_16x16x32_bf16 a[76:79], v[216:219], v[252:255], a[76:79]
  v_add_u32 v27, 294912, v27
  s_waitcnt lgkmcnt(2)
  v_mfma_f32_16x16x32_bf16 a[80:83], v[220:223], v[240:243], a[80:83]
  ds_read_b64_tr_b16 v[212:213], v19 offset:24576
  v_mfma_f32_16x16x32_bf16 a[84:87], v[220:223], v[244:247], a[84:87]
  ds_read_b64_tr_b16 v[214:215], v19 offset:25600
  v_mfma_f32_16x16x32_bf16 a[88:91], v[220:223], v[248:251], a[88:91]
  v_add_u32 v3, 0, v7
  v_add_u32 v16, 0, v13
  v_mfma_f32_16x16x32_bf16 a[92:95], v[220:223], v[252:255], a[92:95]
  v_add_u32 v4, 0, v8
  v_add_u32 v5, 0, v9
  v_mfma_f32_16x16x32_bf16 a[96:99], v[192:195], v[240:243], a[96:99]
  ds_read_b64_tr_b16 v[216:217], v22 offset:24576
  v_mfma_f32_16x16x32_bf16 a[100:103], v[192:195], v[244:247], a[100:103]
  ds_read_b64_tr_b16 v[218:219], v22 offset:25600
  v_mfma_f32_16x16x32_bf16 a[104:107], v[192:195], v[248:251], a[104:107]
  s_add_u32 s4, s87, 8192
  v_mfma_f32_16x16x32_bf16 a[108:111], v[192:195], v[252:255], a[108:111]
  buffer_store_dwordx4 v[136:139], v28, s[20:23], s4 offen sc1
  v_mfma_f32_16x16x32_bf16 a[112:115], v[196:199], v[240:243], a[112:115]
  ds_read_b64_tr_b16 v[220:221], v17 offset:25088
  v_mfma_f32_16x16x32_bf16 a[116:119], v[196:199], v[244:247], a[116:119]
  ds_read_b64_tr_b16 v[222:223], v17 offset:26112
  v_mfma_f32_16x16x32_bf16 a[120:123], v[196:199], v[248:251], a[120:123]
  v_add_u32 v6, 0, v10
  v_add_u32 v30, 0, v29
  v_mfma_f32_16x16x32_bf16 a[124:127], v[196:199], v[252:255], a[124:127]
  v_mfma_f32_16x16x32_bf16 v[160:163], v[200:203], v[240:243], v[160:163]
  ds_read_b64_tr_b16 v[192:193], v18 offset:25088
  v_mfma_f32_16x16x32_bf16 v[164:167], v[200:203], v[244:247], v[164:167]
  ds_read_b64_tr_b16 v[194:195], v18 offset:26112
  v_mfma_f32_16x16x32_bf16 v[168:171], v[200:203], v[248:251], v[168:171]
  v_mfma_f32_16x16x32_bf16 v[172:175], v[200:203], v[252:255], v[172:175]
  v_mfma_f32_16x16x32_bf16 a[128:131], v[204:207], v[240:243], a[128:131]
  ds_read_b64_tr_b16 v[196:197], v19 offset:25088
  v_mfma_f32_16x16x32_bf16 a[132:135], v[204:207], v[244:247], a[132:135]
  ds_read_b64_tr_b16 v[198:199], v19 offset:26112
  v_mfma_f32_16x16x32_bf16 a[136:139], v[204:207], v[248:251], a[136:139]
  s_add_u32 s4, s94, 8192
  v_mfma_f32_16x16x32_bf16 a[140:143], v[204:207], v[252:255], a[140:143]
  buffer_store_dwordx4 v[140:143], v28, s[20:23], s4 offen sc1
  s_waitcnt lgkmcnt(2)
  v_mfma_f32_16x16x32_bf16 a[144:147], v[208:211], v[240:243], a[144:147]
  ds_read_b64_tr_b16 v[200:201], v22 offset:25088
  v_mfma_f32_16x16x32_bf16 a[148:151], v[208:211], v[244:247], a[148:151]
  ds_read_b64_tr_b16 v[202:203], v22 offset:26112
  v_mfma_f32_16x16x32_bf16 a[152:155], v[208:211], v[248:251], a[152:155]
  v_mfma_f32_16x16x32_bf16 a[156:159], v[208:211], v[252:255], a[156:159]
  v_mfma_f32_16x16x32_bf16 a[160:163], v[212:215], v[240:243], a[160:163]
  ds_read_b64_tr_b16 v[204:205], v15 offset:33920
  v_mfma_f32_16x16x32_bf16 a[164:167], v[212:215], v[244:247], a[164:167]
  ds_read_b64_tr_b16 v[206:207], v15 offset:34176
  v_mfma_f32_16x16x32_bf16 a[168:171], v[212:215], v[248:251], a[168:171]
  v_mfma_f32_16x16x32_bf16 a[172:175], v[212:215], v[252:255], a[172:175]
  s_waitcnt vmcnt(13)
  s_barrier
  s_add_u32 m0, s43, 70144
  v_mfma_f32_16x16x32_bf16 a[176:179], v[216:219], v[240:243], a[176:179]
  ds_read_b64_tr_b16 v[208:209], v4 offset:16384
  v_mfma_f32_16x16x32_bf16 a[180:183], v[216:219], v[244:247], a[180:183]
  ds_read_b64_tr_b16 v[210:211], v4 offset:17408
  v_mfma_f32_16x16x32_bf16 a[184:187], v[216:219], v[248:251], a[184:187]
  ds_read_b128 v[224:227], v3 offset:0
  v_mfma_f32_16x16x32_bf16 a[188:191], v[216:219], v[252:255], a[188:191]
  ds_read_b128 v[228:231], v3 offset:256
  v_mfma_f32_16x16x32_bf16 a[192:195], v[220:223], v[240:243], a[192:195]
  ds_read_b64_tr_b16 v[212:213], v5 offset:16384
  v_mfma_f32_16x16x32_bf16 a[196:199], v[220:223], v[244:247], a[196:199]
  ds_read_b64_tr_b16 v[214:215], v5 offset:17408
  v_mfma_f32_16x16x32_bf16 a[200:203], v[220:223], v[248:251], a[200:203]
  ds_read_b128 v[232:235], v3 offset:2048
  v_mfma_f32_16x16x32_bf16 a[204:207], v[220:223], v[252:255], a[204:207]
  ds_read_b128 v[236:239], v3 offset:2304
  v_mfma_f32_16x16x32_bf16 a[208:211], v[192:195], v[240:243], a[208:211]
  ds_read_b64_tr_b16 v[216:217], v6 offset:16384
  v_mfma_f32_16x16x32_bf16 a[212:215], v[192:195], v[244:247], a[212:215]
  ds_read_b64_tr_b16 v[218:219], v6 offset:17408
  v_mfma_f32_16x16x32_bf16 a[216:219], v[192:195], v[248:251], a[216:219]
  buffer_load_dwordx4 v25, s[56:59], 0 offen sc1 lds
  v_mfma_f32_16x16x32_bf16 a[220:223], v[192:195], v[252:255], a[220:223]
  s_waitcnt lgkmcnt(4)
  v_mfma_f32_16x16x32_bf16 a[224:227], v[196:199], v[240:243], a[224:227]
  ds_read_b64_tr_b16 v[220:221], v30 offset:16384
  v_mfma_f32_16x16x32_bf16 a[228:231], v[196:199], v[244:247], a[228:231]
  ds_read_b64_tr_b16 v[222:223], v30 offset:17408
  v_mfma_f32_16x16x32_bf16 a[232:235], v[196:199], v[248:251], a[232:235]
  buffer_load_dwordx4 v25, s[56:59], 0 offen offset:1024 sc1 lds
  v_mfma_f32_16x16x32_bf16 a[236:239], v[196:199], v[252:255], a[236:239]
  v_mfma_f32_16x16x32_bf16 a[240:243], v[200:203], v[240:243], a[240:243]
  ds_read_b64_tr_b16 v[192:193], v4 offset:16896
  v_mfma_f32_16x16x32_bf16 a[244:247], v[200:203], v[244:247], a[244:247]
  ds_read_b64_tr_b16 v[194:195], v4 offset:17920
  v_mfma_f32_16x16x32_bf16 a[248:251], v[200:203], v[248:251], a[248:251]
  buffer_load_dwordx4 v25, s[56:59], s41 offen offset:2048 sc1 lds
  v_mfma_f32_16x16x32_bf16 a[252:255], v[200:203], v[252:255], a[252:255]
  v_mfma_f32_16x16x32_bf16 v[176:179], v[204:207], v[240:243], v[176:179]
  ds_read_b64_tr_b16 v[196:197], v5 offset:16896
  v_mfma_f32_16x16x32_bf16 v[180:183], v[204:207], v[244:247], v[180:183]
  ds_read_b64_tr_b16 v[198:199], v5 offset:17920
  v_mfma_f32_16x16x32_bf16 v[184:187], v[204:207], v[248:251], v[184:187]
  buffer_load_dwordx4 v25, s[56:59], s41 offen offset:3072 sc1 lds
  v_mfma_f32_16x16x32_bf16 v[188:191], v[204:207], v[252:255], v[188:191]
  v_add_u32 v25, 2048, v25
  s_add_u32 m0, s44, 70144
  v_mfma_f32_16x16x32_bf16 a[0:3], v[208:211], v[224:227], a[0:3]
  ds_read_b64_tr_b16 v[200:201], v6 offset:16896
  v_mfma_f32_16x16x32_bf16 a[4:7], v[208:211], v[228:231], a[4:7]
  ds_read_b64_tr_b16 v[202:203], v6 offset:17920
  s_waitcnt lgkmcnt(4)
  v_mfma_f32_16x16x32_bf16 a[8:11], v[208:211], v[232:235], a[8:11]
  buffer_load_dwordx4 v26, s[24:27], 0 offen lds
  v_mfma_f32_16x16x32_bf16 a[12:15], v[208:211], v[236:239], a[12:15]
  v_mfma_f32_16x16x32_bf16 a[16:19], v[212:215], v[224:227], a[16:19]
  ds_read_b64_tr_b16 v[204:205], v30 offset:16896
  v_mfma_f32_16x16x32_bf16 a[20:23], v[212:215], v[228:231], a[20:23]
  ds_read_b64_tr_b16 v[206:207], v30 offset:17920
  v_mfma_f32_16x16x32_bf16 a[24:27], v[212:215], v[232:235], a[24:27]
  buffer_load_dwordx4 v26, s[24:27], s42 offen offset:1024 lds
  v_mfma_f32_16x16x32_bf16 a[28:31], v[212:215], v[236:239], a[28:31]
  s_add_u32 m0, s48, 70144
  v_mfma_f32_16x16x32_bf16 a[32:35], v[216:219], v[224:227], a[32:35]
  ds_read_b64_tr_b16 v[208:209], v16 offset:32768
  v_mfma_f32_16x16x32_bf16 a[36:39], v[216:219], v[228:231], a[36:39]
  ds_read_b64_tr_b16 v[210:211], v16 offset:33024
  v_mfma_f32_16x16x32_bf16 a[40:43], v[216:219], v[232:235], a[40:43]
  buffer_load_dwordx4 v26, s[28:31], 0 offen lds
  v_mfma_f32_16x16x32_bf16 a[44:47], v[216:219], v[236:239], a[44:47]
  v_mfma_f32_16x16x32_bf16 a[48:51], v[220:223], v[224:227], a[48:51]
  ds_read_b64_tr_b16 v[212:213], v4 offset:24576
  v_mfma_f32_16x16x32_bf16 a[52:55], v[220:223], v[228:231], a[52:55]
  ds_read_b64_tr_b16 v[214:215], v4 offset:25600
  v_mfma_f32_16x16x32_bf16 a[56:59], v[220:223], v[232:235], a[56:59]
  buffer_load_dwordx4 v26, s[28:31], s42 offen offset:1024 lds
  v_mfma_f32_16x16x32_bf16 a[60:63], v[220:223], v[236:239], a[60:63]
  v_add_u32 v26, 294912, v26
  s_add_u32 m0, s66, 70144
  v_mfma_f32_16x16x32_bf16 a[64:67], v[192:195], v[224:227], a[64:67]
  ds_read_b64_tr_b16 v[216:217], v5 offset:24576
  v_mfma_f32_16x16x32_bf16 a[68:71], v[192:195], v[228:231], a[68:71]
  ds_read_b64_tr_b16 v[218:219], v5 offset:25600
  v_mfma_f32_16x16x32_bf16 a[72:75], v[192:195], v[232:235], a[72:75]
  buffer_load_dwordx4 v27, s[60:63], 0 offen lds
  v_mfma_f32_16x16x32_bf16 a[76:79], v[192:195], v[236:239], a[76:79]
  v_add_u32 v27, 294912, v27
  s_waitcnt lgkmcnt(2)
  v_mfma_f32_16x16x32_bf16 a[80:83], v[196:199], v[224:227], a[80:83]
  ds_read_b64_tr_b16 v[220:221], v6 offset:24576
  v_mfma_f32_16x16x32_bf16 a[84:87], v[196:199], v[228:231], a[84:87]
  ds_read_b64_tr_b16 v[222:223], v6 offset:25600
  v_mfma_f32_16x16x32_bf16 a[88:91], v[196:199], v[232:235], a[88:91]
  v_add_u32 v14, 35072, v7
  v_add_u32 v15, 35072, v13
  v_mfma_f32_16x16x32_bf16 a[92:95], v[196:199], v[236:239], a[92:95]
  v_add_u32 v17, 35072, v8
  v_add_u32 v18, 35072, v9
  v_mfma_f32_16x16x32_bf16 a[96:99], v[200:203], v[224:227], a[96:99]
  ds_read_b64_tr_b16 v[192:193], v30 offset:24576
  v_mfma_f32_16x16x32_bf16 a[100:103], v[200:203], v[228:231], a[100:103]
  ds_read_b64_tr_b16 v[194:195], v30 offset:25600
  v_mfma_f32_16x16x32_bf16 a[104:107], v[200:203], v[232:235], a[104:107]
  s_add_u32 s4, s87, 16384
  v_mfma_f32_16x16x32_bf16 a[108:111], v[200:203], v[236:239], a[108:111]
  buffer_store_dwordx4 v[144:147], v28, s[20:23], s4 offen sc1
  v_mfma_f32_16x16x32_bf16 a[112:115], v[204:207], v[224:227], a[112:115]
  ds_read_b64_tr_b16 v[196:197], v4 offset:25088
  v_mfma_f32_16x16x32_bf16 a[116:119], v[204:207], v[228:231], a[116:119]
  ds_read_b64_tr_b16 v[198:199], v4 offset:26112
  v_mfma_f32_16x16x32_bf16 a[120:123], v[204:207], v[232:235], a[120:123]
  v_add_u32 v19, 35072, v10
  v_add_u32 v22, 35072, v29
  v_mfma_f32_16x16x32_bf16 a[124:127], v[204:207], v[236:239], a[124:127]
  v_mfma_f32_16x16x32_bf16 v[160:163], v[208:211], v[224:227], v[160:163]
  ds_read_b64_tr_b16 v[200:201], v5 offset:25088
  v_mfma_f32_16x16x32_bf16 v[164:167], v[208:211], v[228:231], v[164:167]
  ds_read_b64_tr_b16 v[202:203], v5 offset:26112
  v_mfma_f32_16x16x32_bf16 v[168:171], v[208:211], v[232:235], v[168:171]
  v_mfma_f32_16x16x32_bf16 v[172:175], v[208:211], v[236:239], v[172:175]
  v_mfma_f32_16x16x32_bf16 a[128:131], v[212:215], v[224:227], a[128:131]
  ds_read_b64_tr_b16 v[204:205], v6 offset:25088
  v_mfma_f32_16x16x32_bf16 a[132:135], v[212:215], v[228:231], a[132:135]
  ds_read_b64_tr_b16 v[206:207], v6 offset:26112
  v_mfma_f32_16x16x32_bf16 a[136:139], v[212:215], v[232:235], a[136:139]
  s_add_u32 s4, s94, 16384
  v_mfma_f32_16x16x32_bf16 a[140:143], v[212:215], v[236:239], a[140:143]
  buffer_store_dwordx4 v[148:151], v28, s[20:23], s4 offen sc1
  s_waitcnt lgkmcnt(2)
  v_mfma_f32_16x16x32_bf16 a[144:147], v[216:219], v[224:227], a[144:147]
  ds_read_b64_tr_b16 v[208:209], v30 offset:25088
  v_mfma_f32_16x16x32_bf16 a[148:151], v[216:219], v[228:231], a[148:151]
  ds_read_b64_tr_b16 v[210:211], v30 offset:26112
  v_mfma_f32_16x16x32_bf16 a[152:155], v[216:219], v[232:235], a[152:155]
  v_mfma_f32_16x16x32_bf16 a[156:159], v[216:219], v[236:239], a[156:159]
  v_mfma_f32_16x16x32_bf16 a[160:163], v[220:223], v[224:227], a[160:163]
  ds_read_b64_tr_b16 v[212:213], v16 offset:33920
  v_mfma_f32_16x16x32_bf16 a[164:167], v[220:223], v[228:231], a[164:167]
  ds_read_b64_tr_b16 v[214:215], v16 offset:34176
  v_mfma_f32_16x16x32_bf16 a[168:171], v[220:223], v[232:235], a[168:171]
  v_mfma_f32_16x16x32_bf16 a[172:175], v[220:223], v[236:239], a[172:175]
  s_waitcnt vmcnt(13)
  s_barrier
  s_add_u32 m0, s43, 105216
  v_mfma_f32_16x16x32_bf16 a[176:179], v[192:195], v[224:227], a[176:179]
  ds_read_b64_tr_b16 v[216:217], v17 offset:16384
  v_mfma_f32_16x16x32_bf16 a[180:183], v[192:195], v[228:231], a[180:183]
  ds_read_b64_tr_b16 v[218:219], v17 offset:17408
  v_mfma_f32_16x16x32_bf16 a[184:187], v[192:195], v[232:235], a[184:187]
  ds_read_b128 v[240:243], v14 offset:0
  v_mfma_f32_16x16x32_bf16 a[188:191], v[192:195], v[236:239], a[188:191]
  ds_read_b128 v[244:247], v14 offset:256
  v_mfma_f32_16x16x32_bf16 a[192:195], v[196:199], v[224:227], a[192:195]
  ds_read_b64_tr_b16 v[220:221], v18 offset:16384
  v_mfma_f32_16x16x32_bf16 a[196:199], v[196:199], v[228:231], a[196:199]
  ds_read_b64_tr_b16 v[222:223], v18 offset:17408
  v_mfma_f32_16x16x32_bf16 a[200:203], v[196:199], v[232:235], a[200:203]
  ds_read_b128 v[248:251], v14 offset:2048
  v_mfma_f32_16x16x32_bf16 a[204:207], v[196:199], v[236:239], a[204:207]
  ds_read_b128 v[252:255], v14 offset:2304
  v_mfma_f32_16x16x32_bf16 a[208:211], v[200:203], v[224:227], a[208:211]
  ds_read_b64_tr_b16 v[192:193], v19 offset:16384
  v_mfma_f32_16x16x32_bf16 a[212:215], v[200:203], v[228:231], a[212:215]
  ds_read_b64_tr_b16 v[194:195], v19 offset:17408
  v_mfma_f32_16x16x32_bf16 a[216:219], v[200:203], v[232:235], a[216:219]
  buffer_load_dwordx4 v25, s[56:59], 0 offen sc1 lds
  v_mfma_f32_16x16x32_bf16 a[220:223], v[200:203], v[236:239], a[220:223]
  s_waitcnt lgkmcnt(4)
  v_mfma_f32_16x16x32_bf16 a[224:227], v[204:207], v[224:227], a[224:227]
  ds_read_b64_tr_b16 v[196:197], v22 offset:16384
  v_mfma_f32_16x16x32_bf16 a[228:231], v[204:207], v[228:231], a[228:231]
  ds_read_b64_tr_b16 v[198:199], v22 offset:17408
  v_mfma_f32_16x16x32_bf16 a[232:235], v[204:207], v[232:235], a[232:235]
  buffer_load_dwordx4 v25, s[56:59], 0 offen offset:1024 sc1 lds
  v_mfma_f32_16x16x32_bf16 a[236:239], v[204:207], v[236:239], a[236:239]
  v_mfma_f32_16x16x32_bf16 a[240:243], v[208:211], v[224:227], a[240:243]
  ds_read_b64_tr_b16 v[200:201], v17 offset:16896
  v_mfma_f32_16x16x32_bf16 a[244:247], v[208:211], v[228:231], a[244:247]
  ds_read_b64_tr_b16 v[202:203], v17 offset:17920
  v_mfma_f32_16x16x32_bf16 a[248:251], v[208:211], v[232:235], a[248:251]
  buffer_load_dwordx4 v25, s[56:59], s41 offen offset:2048 sc1 lds
  v_mfma_f32_16x16x32_bf16 a[252:255], v[208:211], v[236:239], a[252:255]
  v_mfma_f32_16x16x32_bf16 v[176:179], v[212:215], v[224:227], v[176:179]
  ds_read_b64_tr_b16 v[204:205], v18 offset:16896
  v_mfma_f32_16x16x32_bf16 v[180:183], v[212:215], v[228:231], v[180:183]
  ds_read_b64_tr_b16 v[206:207], v18 offset:17920
  v_mfma_f32_16x16x32_bf16 v[184:187], v[212:215], v[232:235], v[184:187]
  buffer_load_dwordx4 v25, s[56:59], s41 offen offset:3072 sc1 lds
  v_mfma_f32_16x16x32_bf16 v[188:191], v[212:215], v[236:239], v[188:191]
  v_add_u32 v25, 2048, v25
  s_add_u32 m0, s44, 105216
  v_mfma_f32_16x16x32_bf16 a[0:3], v[216:219], v[240:243], a[0:3]
  ds_read_b64_tr_b16 v[208:209], v19 offset:16896
  v_mfma_f32_16x16x32_bf16 a[4:7], v[216:219], v[244:247], a[4:7]
  ds_read_b64_tr_b16 v[210:211], v19 offset:17920
  s_waitcnt lgkmcnt(4)
  v_mfma_f32_16x16x32_bf16 a[8:11], v[216:219], v[248:251], a[8:11]
  buffer_load_dwordx4 v26, s[24:27], 0 offen lds
  v_mfma_f32_16x16x32_bf16 a[12:15], v[216:219], v[252:255], a[12:15]
  v_mfma_f32_16x16x32_bf16 a[16:19], v[220:223], v[240:243], a[16:19]
  ds_read_b64_tr_b16 v[212:213], v22 offset:16896
  v_mfma_f32_16x16x32_bf16 a[20:23], v[220:223], v[244:247], a[20:23]
  ds_read_b64_tr_b16 v[214:215], v22 offset:17920
  v_mfma_f32_16x16x32_bf16 a[24:27], v[220:223], v[248:251], a[24:27]
  buffer_load_dwordx4 v26, s[24:27], s42 offen offset:1024 lds
  v_mfma_f32_16x16x32_bf16 a[28:31], v[220:223], v[252:255], a[28:31]
  s_add_u32 m0, s48, 105216
  v_mfma_f32_16x16x32_bf16 a[32:35], v[192:195], v[240:243], a[32:35]
  ds_read_b64_tr_b16 v[216:217], v15 offset:32768
  v_mfma_f32_16x16x32_bf16 a[36:39], v[192:195], v[244:247], a[36:39]
  ds_read_b64_tr_b16 v[218:219], v15 offset:33024
  v_mfma_f32_16x16x32_bf16 a[40:43], v[192:195], v[248:251], a[40:43]
  buffer_load_dwordx4 v26, s[28:31], 0 offen lds
  v_mfma_f32_16x16x32_bf16 a[44:47], v[192:195], v[252:255], a[44:47]
  v_mfma_f32_16x16x32_bf16 a[48:51], v[196:199], v[240:243], a[48:51]
  ds_read_b64_tr_b16 v[220:221], v17 offset:24576
  v_mfma_f32_16x16x32_bf16 a[52:55], v[196:199], v[244:247], a[52:55]
  ds_read_b64_tr_b16 v[222:223], v17 offset:25600
  v_mfma_f32_16x16x32_bf16 a[56:59], v[196:199], v[248:251], a[56:59]
  buffer_load_dwordx4 v26, s[28:31], s42 offen offset:1024 lds
  v_mfma_f32_16x16x32_bf16 a[60:63], v[196:199], v[252:255], a[60:63]
  v_add_u32 v26, 294912, v26
  s_add_u32 m0, s66, 105216
  v_mfma_f32_16x16x32_bf16 a[64:67], v[200:203], v[240:243], a[64:67]
  ds_read_b64_tr_b16 v[192:193], v18 offset:24576
  v_mfma_f32_16x16x32_bf16 a[68:71], v[200:203], v[244:247], a[68:71]
  ds_read_b64_tr_b16 v[194:195], v18 offset:25600
  v_mfma_f32_16x16x32_bf16 a[72:75], v[200:203], v[248:251], a[72:75]
  buffer_load_dwordx4 v27, s[60:63], 0 offen lds
  v_mfma_f32_16x16x32_bf16 a[76:79], v[200:203], v[252:255], a[76:79]
  v_add_u32 v27, 294912, v27
  s_waitcnt lgkmcnt(2)
  v_mfma_f32_16x16x32_bf16 a[80:83], v[204:207], v[240:243], a[80:83]
  ds_read_b64_tr_b16 v[196:197], v19 offset:24576
  v_mfma_f32_16x16x32_bf16 a[84:87], v[204:207], v[244:247], a[84:87]
  ds_read_b64_tr_b16 v[198:199], v19 offset:25600
  v_mfma_f32_16x16x32_bf16 a[88:91], v[204:207], v[248:251], a[88:91]
  v_add_u32 v3, 70144, v7
  v_add_u32 v16, 70144, v13
  v_mfma_f32_16x16x32_bf16 a[92:95], v[204:207], v[252:255], a[92:95]
  v_add_u32 v4, 70144, v8
  v_add_u32 v5, 70144, v9
  v_mfma_f32_16x16x32_bf16 a[96:99], v[208:211], v[240:243], a[96:99]
  ds_read_b64_tr_b16 v[200:201], v22 offset:24576
  v_mfma_f32_16x16x32_bf16 a[100:103], v[208:211], v[244:247], a[100:103]
  ds_read_b64_tr_b16 v[202:203], v22 offset:25600
  v_mfma_f32_16x16x32_bf16 a[104:107], v[208:211], v[248:251], a[104:107]
  s_add_u32 s4, s87, 24576
  v_mfma_f32_16x16x32_bf16 a[108:111], v[208:211], v[252:255], a[108:111]
  buffer_store_dwordx4 v[152:155], v28, s[20:23], s4 offen sc1
  v_mfma_f32_16x16x32_bf16 a[112:115], v[212:215], v[240:243], a[112:115]
  ds_read_b64_tr_b16 v[204:205], v17 offset:25088
  v_mfma_f32_16x16x32_bf16 a[116:119], v[212:215], v[244:247], a[116:119]
  ds_read_b64_tr_b16 v[206:207], v17 offset:26112
  v_mfma_f32_16x16x32_bf16 a[120:123], v[212:215], v[248:251], a[120:123]
  v_add_u32 v6, 70144, v10
  v_add_u32 v30, 70144, v29
  v_mfma_f32_16x16x32_bf16 a[124:127], v[212:215], v[252:255], a[124:127]
  v_mfma_f32_16x16x32_bf16 v[160:163], v[216:219], v[240:243], v[160:163]
  ds_read_b64_tr_b16 v[208:209], v18 offset:25088
  v_mfma_f32_16x16x32_bf16 v[164:167], v[216:219], v[244:247], v[164:167]
  ds_read_b64_tr_b16 v[210:211], v18 offset:26112
  v_mfma_f32_16x16x32_bf16 v[168:171], v[216:219], v[248:251], v[168:171]
  v_mfma_f32_16x16x32_bf16 v[172:175], v[216:219], v[252:255], v[172:175]
  v_mfma_f32_16x16x32_bf16 a[128:131], v[220:223], v[240:243], a[128:131]
  ds_read_b64_tr_b16 v[212:213], v19 offset:25088
  v_mfma_f32_16x16x32_bf16 a[132:135], v[220:223], v[244:247], a[132:135]
  ds_read_b64_tr_b16 v[214:215], v19 offset:26112
  v_mfma_f32_16x16x32_bf16 a[136:139], v[220:223], v[248:251], a[136:139]
  s_add_u32 s4, s94, 24576
  v_mfma_f32_16x16x32_bf16 a[140:143], v[220:223], v[252:255], a[140:143]
  buffer_store_dwordx4 v[156:159], v28, s[20:23], s4 offen sc1
  s_waitcnt lgkmcnt(2)
  v_mfma_f32_16x16x32_bf16 a[144:147], v[192:195], v[240:243], a[144:147]
  ds_read_b64_tr_b16 v[216:217], v22 offset:25088
  v_mfma_f32_16x16x32_bf16 a[148:151], v[192:195], v[244:247], a[148:151]
  ds_read_b64_tr_b16 v[218:219], v22 offset:26112
  v_mfma_f32_16x16x32_bf16 a[152:155], v[192:195], v[248:251], a[152:155]
  v_mfma_f32_16x16x32_bf16 a[156:159], v[192:195], v[252:255], a[156:159]
  v_mfma_f32_16x16x32_bf16 a[160:163], v[196:199], v[240:243], a[160:163]
  ds_read_b64_tr_b16 v[220:221], v15 offset:33920
  v_mfma_f32_16x16x32_bf16 a[164:167], v[196:199], v[244:247], a[164:167]
  ds_read_b64_tr_b16 v[222:223], v15 offset:34176
  v_mfma_f32_16x16x32_bf16 a[168:171], v[196:199], v[248:251], a[168:171]
  v_mfma_f32_16x16x32_bf16 a[172:175], v[196:199], v[252:255], a[172:175]
  s_waitcnt vmcnt(13)
  s_barrier
  s_add_u32 m0, s47, 0
  v_mfma_f32_16x16x32_bf16 a[176:179], v[200:203], v[240:243], a[176:179]
  ds_read_b64_tr_b16 v[192:193], v4 offset:16384
  v_mfma_f32_16x16x32_bf16 a[180:183], v[200:203], v[244:247], a[180:183]
  ds_read_b64_tr_b16 v[194:195], v4 offset:17408
  v_mfma_f32_16x16x32_bf16 a[184:187], v[200:203], v[248:251], a[184:187]
  ds_read_b128 v[224:227], v3 offset:0
  v_mfma_f32_16x16x32_bf16 a[188:191], v[200:203], v[252:255], a[188:191]
  ds_read_b128 v[228:231], v3 offset:256
  v_mfma_f32_16x16x32_bf16 a[192:195], v[204:207], v[240:243], a[192:195]
  ds_read_b64_tr_b16 v[196:197], v5 offset:16384
  v_mfma_f32_16x16x32_bf16 a[196:199], v[204:207], v[244:247], a[196:199]
  ds_read_b64_tr_b16 v[198:199], v5 offset:17408
  v_mfma_f32_16x16x32_bf16 a[200:203], v[204:207], v[248:251], a[200:203]
  ds_read_b128 v[232:235], v3 offset:2048
  v_mfma_f32_16x16x32_bf16 a[204:207], v[204:207], v[252:255], a[204:207]
  ds_read_b128 v[236:239], v3 offset:2304
  v_mfma_f32_16x16x32_bf16 a[208:211], v[208:211], v[240:243], a[208:211]
  ds_read_b64_tr_b16 v[200:201], v6 offset:16384
  v_mfma_f32_16x16x32_bf16 a[212:215], v[208:211], v[244:247], a[212:215]
  ds_read_b64_tr_b16 v[202:203], v6 offset:17408
  v_mfma_f32_16x16x32_bf16 a[216:219], v[208:211], v[248:251], a[216:219]
  buffer_load_dwordx4 v11, s[56:59], 0 offen sc1 lds
  v_mfma_f32_16x16x32_bf16 a[220:223], v[208:211], v[252:255], a[220:223]
  s_waitcnt lgkmcnt(4)
  v_mfma_f32_16x16x32_bf16 a[224:227], v[212:215], v[240:243], a[224:227]
  ds_read_b64_tr_b16 v[204:205], v30 offset:16384
  v_mfma_f32_16x16x32_bf16 a[228:231], v[212:215], v[244:247], a[228:231]
  ds_read_b64_tr_b16 v[206:207], v30 offset:17408
  v_mfma_f32_16x16x32_bf16 a[232:235], v[212:215], v[248:251], a[232:235]
  buffer_load_dwordx4 v11, s[56:59], 0 offen offset:1024 sc1 lds
  v_mfma_f32_16x16x32_bf16 a[236:239], v[212:215], v[252:255], a[236:239]
  v_mfma_f32_16x16x32_bf16 a[240:243], v[216:219], v[240:243], a[240:243]
  ds_read_b64_tr_b16 v[208:209], v4 offset:16896
  v_mfma_f32_16x16x32_bf16 a[244:247], v[216:219], v[244:247], a[244:247]
  ds_read_b64_tr_b16 v[210:211], v4 offset:17920
  v_mfma_f32_16x16x32_bf16 a[248:251], v[216:219], v[248:251], a[248:251]
  buffer_load_dwordx4 v11, s[56:59], s45 offen offset:2048 sc1 lds
  v_mfma_f32_16x16x32_bf16 a[252:255], v[216:219], v[252:255], a[252:255]
  v_mfma_f32_16x16x32_bf16 v[176:179], v[220:223], v[240:243], v[176:179]
  ds_read_b64_tr_b16 v[212:213], v5 offset:16896
  v_mfma_f32_16x16x32_bf16 v[180:183], v[220:223], v[244:247], v[180:183]
  ds_read_b64_tr_b16 v[214:215], v5 offset:17920
  v_mfma_f32_16x16x32_bf16 v[184:187], v[220:223], v[248:251], v[184:187]
  buffer_load_dwordx4 v11, s[56:59], s45 offen offset:3072 sc1 lds
  v_mfma_f32_16x16x32_bf16 v[188:191], v[220:223], v[252:255], v[188:191]
  v_add_u32 v11, 2048, v11
  s_add_u32 m0, s49, 0
  v_mfma_f32_16x16x32_bf16 a[0:3], v[192:195], v[224:227], a[0:3]
  ds_read_b64_tr_b16 v[216:217], v6 offset:16896
  v_mfma_f32_16x16x32_bf16 a[4:7], v[192:195], v[228:231], a[4:7]
  ds_read_b64_tr_b16 v[218:219], v6 offset:17920
  s_waitcnt lgkmcnt(4)
  v_mfma_f32_16x16x32_bf16 a[8:11], v[192:195], v[232:235], a[8:11]
  buffer_load_dwordx4 v12, s[12:15], 0 offen lds
  v_mfma_f32_16x16x32_bf16 a[12:15], v[192:195], v[236:239], a[12:15]
  v_mfma_f32_16x16x32_bf16 a[16:19], v[196:199], v[224:227], a[16:19]
  ds_read_b64_tr_b16 v[220:221], v30 offset:16896
  v_mfma_f32_16x16x32_bf16 a[20:23], v[196:199], v[228:231], a[20:23]
  ds_read_b64_tr_b16 v[222:223], v30 offset:17920
  v_mfma_f32_16x16x32_bf16 a[24:27], v[196:199], v[232:235], a[24:27]
  buffer_load_dwordx4 v12, s[12:15], s46 offen offset:1024 lds
  v_mfma_f32_16x16x32_bf16 a[28:31], v[196:199], v[236:239], a[28:31]
  v_add_u32 v12, 262144, v12
  v_mfma_f32_16x16x32_bf16 a[32:35], v[200:203], v[224:227], a[32:35]
  ds_read_b64_tr_b16 v[192:193], v16 offset:32768
  v_mfma_f32_16x16x32_bf16 a[36:39], v[200:203], v[228:231], a[36:39]
  ds_read_b64_tr_b16 v[194:195], v16 offset:33024
  v_mfma_f32_16x16x32_bf16 a[40:43], v[200:203], v[232:235], a[40:43]
  v_add_u32 v14, 105216, v7
  v_add_u32 v15, 105216, v13
  v_mfma_f32_16x16x32_bf16 a[44:47], v[200:203], v[236:239], a[44:47]
  v_add_u32 v17, 105216, v8
  v_add_u32 v18, 105216, v9
  v_mfma_f32_16x16x32_bf16 a[48:51], v[204:207], v[224:227], a[48:51]
  ds_read_b64_tr_b16 v[196:197], v4 offset:24576
  v_mfma_f32_16x16x32_bf16 a[52:55], v[204:207], v[228:231], a[52:55]
  ds_read_b64_tr_b16 v[198:199], v4 offset:25600
  v_mfma_f32_16x16x32_bf16 a[56:59], v[204:207], v[232:235], a[56:59]
  v_add_u32 v19, 105216, v10
  v_add_u32 v22, 105216, v29
  v_mfma_f32_16x16x32_bf16 a[60:63], v[204:207], v[236:239], a[60:63]
  v_mfma_f32_16x16x32_bf16 a[64:67], v[208:211], v[224:227], a[64:67]
  ds_read_b64_tr_b16 v[200:201], v5 offset:24576
  v_mfma_f32_16x16x32_bf16 a[68:71], v[208:211], v[228:231], a[68:71]
  ds_read_b64_tr_b16 v[202:203], v5 offset:25600
  v_mfma_f32_16x16x32_bf16 a[72:75], v[208:211], v[232:235], a[72:75]
  v_mfma_f32_16x16x32_bf16 a[76:79], v[208:211], v[236:239], a[76:79]
  s_waitcnt lgkmcnt(2)
  v_mfma_f32_16x16x32_bf16 a[80:83], v[212:215], v[224:227], a[80:83]
  ds_read_b64_tr_b16 v[204:205], v6 offset:24576
  v_mfma_f32_16x16x32_bf16 a[84:87], v[212:215], v[228:231], a[84:87]
  ds_read_b64_tr_b16 v[206:207], v6 offset:25600
  v_mfma_f32_16x16x32_bf16 a[88:91], v[212:215], v[232:235], a[88:91]
  v_mfma_f32_16x16x32_bf16 a[92:95], v[212:215], v[236:239], a[92:95]
  v_mfma_f32_16x16x32_bf16 a[96:99], v[216:219], v[224:227], a[96:99]
  ds_read_b64_tr_b16 v[208:209], v30 offset:24576
  v_mfma_f32_16x16x32_bf16 a[100:103], v[216:219], v[228:231], a[100:103]
  ds_read_b64_tr_b16 v[210:211], v30 offset:25600
  v_mfma_f32_16x16x32_bf16 a[104:107], v[216:219], v[232:235], a[104:107]
  v_mfma_f32_16x16x32_bf16 a[108:111], v[216:219], v[236:239], a[108:111]
  v_mfma_f32_16x16x32_bf16 a[112:115], v[220:223], v[224:227], a[112:115]
  ds_read_b64_tr_b16 v[212:213], v4 offset:25088
  v_mfma_f32_16x16x32_bf16 a[116:119], v[220:223], v[228:231], a[116:119]
  ds_read_b64_tr_b16 v[214:215], v4 offset:26112
  v_mfma_f32_16x16x32_bf16 a[120:123], v[220:223], v[232:235], a[120:123]
  v_mfma_f32_16x16x32_bf16 a[124:127], v[220:223], v[236:239], a[124:127]
  v_mfma_f32_16x16x32_bf16 v[160:163], v[192:195], v[224:227], v[160:163]
  ds_read_b64_tr_b16 v[216:217], v5 offset:25088
  v_mfma_f32_16x16x32_bf16 v[164:167], v[192:195], v[228:231], v[164:167]
  ds_read_b64_tr_b16 v[218:219], v5 offset:26112
  v_mfma_f32_16x16x32_bf16 v[168:171], v[192:195], v[232:235], v[168:171]
  v_mfma_f32_16x16x32_bf16 v[172:175], v[192:195], v[236:239], v[172:175]
  v_mfma_f32_16x16x32_bf16 a[128:131], v[196:199], v[224:227], a[128:131]
  ds_read_b64_tr_b16 v[220:221], v6 offset:25088
  v_mfma_f32_16x16x32_bf16 a[132:135], v[196:199], v[228:231], a[132:135]
  ds_read_b64_tr_b16 v[222:223], v6 offset:26112
  v_mfma_f32_16x16x32_bf16 a[136:139], v[196:199], v[232:235], a[136:139]
  v_mfma_f32_16x16x32_bf16 a[140:143], v[196:199], v[236:239], a[140:143]
  s_waitcnt lgkmcnt(2)
  v_mfma_f32_16x16x32_bf16 a[144:147], v[200:203], v[224:227], a[144:147]
  ds_read_b64_tr_b16 v[192:193], v30 offset:25088
  v_mfma_f32_16x16x32_bf16 a[148:151], v[200:203], v[228:231], a[148:151]
  ds_read_b64_tr_b16 v[194:195], v30 offset:26112
  v_mfma_f32_16x16x32_bf16 a[152:155], v[200:203], v[232:235], a[152:155]
  v_mfma_f32_16x16x32_bf16 a[156:159], v[200:203], v[236:239], a[156:159]
  v_mfma_f32_16x16x32_bf16 a[160:163], v[204:207], v[224:227], a[160:163]
  ds_read_b64_tr_b16 v[196:197], v16 offset:33920
  v_mfma_f32_16x16x32_bf16 a[164:167], v[204:207], v[228:231], a[164:167]
  ds_read_b64_tr_b16 v[198:199], v16 offset:34176
  v_mfma_f32_16x16x32_bf16 a[168:171], v[204:207], v[232:235], a[168:171]
  v_mfma_f32_16x16x32_bf16 a[172:175], v[204:207], v[236:239], a[172:175]
  s_waitcnt vmcnt(8)
  s_barrier
  s_add_u32 m0, s47, 24576
  v_mfma_f32_16x16x32_bf16 a[176:179], v[208:211], v[224:227], a[176:179]
  ds_read_b64_tr_b16 v[200:201], v17 offset:16384
  v_mfma_f32_16x16x32_bf16 a[180:183], v[208:211], v[228:231], a[180:183]
  ds_read_b64_tr_b16 v[202:203], v17 offset:17408
  v_mfma_f32_16x16x32_bf16 a[184:187], v[208:211], v[232:235], a[184:187]
  ds_read_b128 v[240:243], v14 offset:0
  v_mfma_f32_16x16x32_bf16 a[188:191], v[208:211], v[236:239], a[188:191]
  ds_read_b128 v[244:247], v14 offset:256
  v_mfma_f32_16x16x32_bf16 a[192:195], v[212:215], v[224:227], a[192:195]
  ds_read_b64_tr_b16 v[204:205], v18 offset:16384
  v_mfma_f32_16x16x32_bf16 a[196:199], v[212:215], v[228:231], a[196:199]
  ds_read_b64_tr_b16 v[206:207], v18 offset:17408
  v_mfma_f32_16x16x32_bf16 a[200:203], v[212:215], v[232:235], a[200:203]
  ds_read_b128 v[248:251], v14 offset:2048
  v_mfma_f32_16x16x32_bf16 a[204:207], v[212:215], v[236:239], a[204:207]
  ds_read_b128 v[252:255], v14 offset:2304
  v_mfma_f32_16x16x32_bf16 a[208:211], v[216:219], v[224:227], a[208:211]
  ds_read_b64_tr_b16 v[208:209], v19 offset:16384
  v_mfma_f32_16x16x32_bf16 a[212:215], v[216:219], v[228:231], a[212:215]
  ds_read_b64_tr_b16 v[210:211], v19 offset:17408
  v_mfma_f32_16x16x32_bf16 a[216:219], v[216:219], v[232:235], a[216:219]
  buffer_load_dwordx4 v11, s[56:59], 0 offen sc1 lds
  v_mfma_f32_16x16x32_bf16 a[220:223], v[216:219], v[236:239], a[220:223]
  s_waitcnt lgkmcnt(4)
  v_mfma_f32_16x16x32_bf16 a[224:227], v[220:223], v[224:227], a[224:227]
  ds_read_b64_tr_b16 v[212:213], v22 offset:16384
  v_mfma_f32_16x16x32_bf16 a[228:231], v[220:223], v[228:231], a[228:231]
  ds_read_b64_tr_b16 v[214:215], v22 offset:17408
  v_mfma_f32_16x16x32_bf16 a[232:235], v[220:223], v[232:235], a[232:235]
  buffer_load_dwordx4 v11, s[56:59], 0 offen offset:1024 sc1 lds
  v_mfma_f32_16x16x32_bf16 a[236:239], v[220:223], v[236:239], a[236:239]
  v_mfma_f32_16x16x32_bf16 a[240:243], v[192:195], v[224:227], a[240:243]
  ds_read_b64_tr_b16 v[216:217], v17 offset:16896
  v_mfma_f32_16x16x32_bf16 a[244:247], v[192:195], v[228:231], a[244:247]
  ds_read_b64_tr_b16 v[218:219], v17 offset:17920
  v_mfma_f32_16x16x32_bf16 a[248:251], v[192:195], v[232:235], a[248:251]
  buffer_load_dwordx4 v11, s[56:59], s45 offen offset:2048 sc1 lds
  v_mfma_f32_16x16x32_bf16 a[252:255], v[192:195], v[236:239], a[252:255]
  v_mfma_f32_16x16x32_bf16 v[176:179], v[196:199], v[224:227], v[176:179]
  ds_read_b64_tr_b16 v[220:221], v18 offset:16896
  v_mfma_f32_16x16x32_bf16 v[180:183], v[196:199], v[228:231], v[180:183]
  ds_read_b64_tr_b16 v[222:223], v18 offset:17920
  v_mfma_f32_16x16x32_bf16 v[184:187], v[196:199], v[232:235], v[184:187]
  buffer_load_dwordx4 v11, s[56:59], s45 offen offset:3072 sc1 lds
  v_mfma_f32_16x16x32_bf16 v[188:191], v[196:199], v[236:239], v[188:191]
  v_add_u32 v11, 2048, v11
  s_add_u32 m0, s49, 24576
  v_mfma_f32_16x16x32_bf16 a[0:3], v[200:203], v[240:243], a[0:3]
  ds_read_b64_tr_b16 v[192:193], v19 offset:16896
  v_mfma_f32_16x16x32_bf16 a[4:7], v[200:203], v[244:247], a[4:7]
  ds_read_b64_tr_b16 v[194:195], v19 offset:17920
  s_waitcnt lgkmcnt(4)
  v_mfma_f32_16x16x32_bf16 a[8:11], v[200:203], v[248:251], a[8:11]
  buffer_load_dwordx4 v12, s[12:15], 0 offen lds
  v_mfma_f32_16x16x32_bf16 a[12:15], v[200:203], v[252:255], a[12:15]
  v_mfma_f32_16x16x32_bf16 a[16:19], v[204:207], v[240:243], a[16:19]
  ds_read_b64_tr_b16 v[196:197], v22 offset:16896
  v_mfma_f32_16x16x32_bf16 a[20:23], v[204:207], v[244:247], a[20:23]
  ds_read_b64_tr_b16 v[198:199], v22 offset:17920
  v_mfma_f32_16x16x32_bf16 a[24:27], v[204:207], v[248:251], a[24:27]
  buffer_load_dwordx4 v12, s[12:15], s46 offen offset:1024 lds
  v_mfma_f32_16x16x32_bf16 a[28:31], v[204:207], v[252:255], a[28:31]
  v_add_u32 v12, 262144, v12
  v_mfma_f32_16x16x32_bf16 a[32:35], v[208:211], v[240:243], a[32:35]
  ds_read_b64_tr_b16 v[200:201], v15 offset:32768
  v_mfma_f32_16x16x32_bf16 a[36:39], v[208:211], v[244:247], a[36:39]
  ds_read_b64_tr_b16 v[202:203], v15 offset:33024
  v_mfma_f32_16x16x32_bf16 a[40:43], v[208:211], v[248:251], a[40:43]
  v_mfma_f32_16x16x32_bf16 a[44:47], v[208:211], v[252:255], a[44:47]
  v_mfma_f32_16x16x32_bf16 a[48:51], v[212:215], v[240:243], a[48:51]
  ds_read_b64_tr_b16 v[204:205], v17 offset:24576
  v_mfma_f32_16x16x32_bf16 a[52:55], v[212:215], v[244:247], a[52:55]
  ds_read_b64_tr_b16 v[206:207], v17 offset:25600
  v_mfma_f32_16x16x32_bf16 a[56:59], v[212:215], v[248:251], a[56:59]
  v_mfma_f32_16x16x32_bf16 a[60:63], v[212:215], v[252:255], a[60:63]
  v_mfma_f32_16x16x32_bf16 a[64:67], v[216:219], v[240:243], a[64:67]
  ds_read_b64_tr_b16 v[208:209], v18 offset:24576
  v_mfma_f32_16x16x32_bf16 a[68:71], v[216:219], v[244:247], a[68:71]
  ds_read_b64_tr_b16 v[210:211], v18 offset:25600
  v_mfma_f32_16x16x32_bf16 a[72:75], v[216:219], v[248:251], a[72:75]
  v_mfma_f32_16x16x32_bf16 a[76:79], v[216:219], v[252:255], a[76:79]
  s_waitcnt lgkmcnt(2)
  v_mfma_f32_16x16x32_bf16 a[80:83], v[220:223], v[240:243], a[80:83]
  ds_read_b64_tr_b16 v[212:213], v19 offset:24576
  v_mfma_f32_16x16x32_bf16 a[84:87], v[220:223], v[244:247], a[84:87]
  ds_read_b64_tr_b16 v[214:215], v19 offset:25600
  v_mfma_f32_16x16x32_bf16 a[88:91], v[220:223], v[248:251], a[88:91]
  v_mfma_f32_16x16x32_bf16 a[92:95], v[220:223], v[252:255], a[92:95]
  v_mfma_f32_16x16x32_bf16 a[96:99], v[192:195], v[240:243], a[96:99]
  ds_read_b64_tr_b16 v[216:217], v22 offset:24576
  v_mfma_f32_16x16x32_bf16 a[100:103], v[192:195], v[244:247], a[100:103]
  ds_read_b64_tr_b16 v[218:219], v22 offset:25600
  v_mfma_f32_16x16x32_bf16 a[104:107], v[192:195], v[248:251], a[104:107]
  v_mfma_f32_16x16x32_bf16 a[108:111], v[192:195], v[252:255], a[108:111]
  v_mfma_f32_16x16x32_bf16 a[112:115], v[196:199], v[240:243], a[112:115]
  ds_read_b64_tr_b16 v[220:221], v17 offset:25088
  v_mfma_f32_16x16x32_bf16 a[116:119], v[196:199], v[244:247], a[116:119]
  ds_read_b64_tr_b16 v[222:223], v17 offset:26112
  v_mfma_f32_16x16x32_bf16 a[120:123], v[196:199], v[248:251], a[120:123]
  v_mfma_f32_16x16x32_bf16 a[124:127], v[196:199], v[252:255], a[124:127]
  v_mfma_f32_16x16x32_bf16 v[160:163], v[200:203], v[240:243], v[160:163]
  ds_read_b64_tr_b16 v[192:193], v18 offset:25088
  v_mfma_f32_16x16x32_bf16 v[164:167], v[200:203], v[244:247], v[164:167]
  ds_read_b64_tr_b16 v[194:195], v18 offset:26112
  v_mfma_f32_16x16x32_bf16 v[168:171], v[200:203], v[248:251], v[168:171]
  v_mfma_f32_16x16x32_bf16 v[172:175], v[200:203], v[252:255], v[172:175]
  v_mfma_f32_16x16x32_bf16 a[128:131], v[204:207], v[240:243], a[128:131]
  ds_read_b64_tr_b16 v[196:197], v19 offset:25088
  v_mfma_f32_16x16x32_bf16 a[132:135], v[204:207], v[244:247], a[132:135]
  ds_read_b64_tr_b16 v[198:199], v19 offset:26112
  v_mfma_f32_16x16x32_bf16 a[136:139], v[204:207], v[248:251], a[136:139]
  v_mfma_f32_16x16x32_bf16 a[140:143], v[204:207], v[252:255], a[140:143]
  s_waitcnt lgkmcnt(2)
  v_mfma_f32_16x16x32_bf16 a[144:147], v[208:211], v[240:243], a[144:147]
  ds_read_b64_tr_b16 v[200:201], v22 offset:25088
  v_mfma_f32_16x16x32_bf16 a[148:151], v[208:211], v[244:247], a[148:151]
  ds_read_b64_tr_b16 v[202:203], v22 offset:26112
  v_mfma_f32_16x16x32_bf16 a[152:155], v[208:211], v[248:251], a[152:155]
  v_mfma_f32_16x16x32_bf16 a[156:159], v[208:211], v[252:255], a[156:159]
  v_mfma_f32_16x16x32_bf16 a[160:163], v[212:215], v[240:243], a[160:163]
  ds_read_b64_tr_b16 v[204:205], v15 offset:33920
  v_mfma_f32_16x16x32_bf16 a[164:167], v[212:215], v[244:247], a[164:167]
  ds_read_b64_tr_b16 v[206:207], v15 offset:34176
  v_mfma_f32_16x16x32_bf16 a[168:171], v[212:215], v[248:251], a[168:171]
  v_mfma_f32_16x16x32_bf16 a[172:175], v[212:215], v[252:255], a[172:175]
  s_barrier
  s_add_u32 m0, s47, 49152
  v_mfma_f32_16x16x32_bf16 a[176:179], v[216:219], v[240:243], a[176:179]
  v_mfma_f32_16x16x32_bf16 a[180:183], v[216:219], v[244:247], a[180:183]
  v_mfma_f32_16x16x32_bf16 a[184:187], v[216:219], v[248:251], a[184:187]
  buffer_load_dwordx4 v11, s[56:59], 0 offen sc1 lds
  v_mfma_f32_16x16x32_bf16 a[188:191], v[216:219], v[252:255], a[188:191]
  v_mfma_f32_16x16x32_bf16 a[192:195], v[220:223], v[240:243], a[192:195]
  v_mfma_f32_16x16x32_bf16 a[196:199], v[220:223], v[244:247], a[196:199]
  v_mfma_f32_16x16x32_bf16 a[200:203], v[220:223], v[248:251], a[200:203]
  buffer_load_dwordx4 v11, s[56:59], 0 offen offset:1024 sc1 lds
  v_mfma_f32_16x16x32_bf16 a[204:207], v[220:223], v[252:255], a[204:207]
  v_mfma_f32_16x16x32_bf16 a[208:211], v[192:195], v[240:243], a[208:211]
  v_mfma_f32_16x16x32_bf16 a[212:215], v[192:195], v[244:247], a[212:215]
  v_mfma_f32_16x16x32_bf16 a[216:219], v[192:195], v[248:251], a[216:219]
  buffer_load_dwordx4 v11, s[56:59], s45 offen offset:2048 sc1 lds
  v_mfma_f32_16x16x32_bf16 a[220:223], v[192:195], v[252:255], a[220:223]
  s_waitcnt lgkmcnt(0)
  v_mfma_f32_16x16x32_bf16 a[224:227], v[196:199], v[240:243], a[224:227]
  v_mfma_f32_16x16x32_bf16 a[228:231], v[196:199], v[244:247], a[228:231]
  v_mfma_f32_16x16x32_bf16 a[232:235], v[196:199], v[248:251], a[232:235]
  buffer_load_dwordx4 v11, s[56:59], s45 offen offset:3072 sc1 lds
  v_mfma_f32_16x16x32_bf16 a[236:239], v[196:199], v[252:255], a[236:239]
  v_add_u32 v11, 2048, v11
  s_add_u32 m0, s49, 49152
  v_mfma_f32_16x16x32_bf16 a[240:243], v[200:203], v[240:243], a[240:243]
  v_mfma_f32_16x16x32_bf16 a[244:247], v[200:203], v[244:247], a[244:247]
  v_mfma_f32_16x16x32_bf16 a[248:251], v[200:203], v[248:251], a[248:251]
  buffer_load_dwordx4 v12, s[12:15], 0 offen lds
  v_mfma_f32_16x16x32_bf16 a[252:255], v[200:203], v[252:255], a[252:255]
  v_mfma_f32_16x16x32_bf16 v[176:179], v[204:207], v[240:243], v[176:179]
  v_mfma_f32_16x16x32_bf16 v[180:183], v[204:207], v[244:247], v[180:183]
  v_mfma_f32_16x16x32_bf16 v[184:187], v[204:207], v[248:251], v[184:187]
  buffer_load_dwordx4 v12, s[12:15], s46 offen offset:1024 lds
  v_mfma_f32_16x16x32_bf16 v[188:191], v[204:207], v[252:255], v[188:191]
  v_add_u32 v12, 262144, v12
  s_lshl_b32 s43, s3, 12
  v_add_u32 v7, s43, v2
  v_lshrrev_b32 v20, 5, v1
  v_mul_u32_u24 v8, 2048, v20
  v_bfe_u32 v20, v1, 2, 2
  v_lshl_add_u32 v8, v20, 7, v8
  v_bfe_u32 v21, v1, 4, 1
  v_lshl_add_u32 v8, v21, 5, v8
  v_and_b32 v21, 3, v1
  v_lshl_add_u32 v8, v21, 3, v8
  v_lshrrev_b32 v20, 1, v20
  v_lshlrev_b32 v20, 6, v20
  v_xor_b32 v21, 64, v20
  v_add_u32 v9, v8, v21
  v_add_u32 v8, v8, v20
  v_add_u32 v8, 16384, v8
  v_add_u32 v9, 16384, v9
  v_bfe_u32 v20, v1, 4, 1
  v_lshlrev_b32 v10, 9, v20
  v_and_b32 v20, 15, v1
  v_lshl_add_u32 v10, v20, 4, v10
  v_lshrrev_b32 v20, 5, v1
  v_lshl_add_u32 v10, v20, 8, v10
  v_add_u32 v3, 0, v7
  v_add_u32 v4, 0, v8
  v_add_u32 v5, 0, v9
  s_waitcnt vmcnt(12) lgkmcnt(0)
  s_barrier
  ds_read_b64_tr_b16 v[200:201], v4 offset:0
  ds_read_b64_tr_b16 v[202:203], v4 offset:1024
  ds_read_b128 v[192:195], v3 offset:0
  ds_read_b128 v[196:199], v3 offset:2048
  ds_read_b64_tr_b16 v[204:205], v5 offset:0
  ds_read_b64_tr_b16 v[206:207], v5 offset:1024
  ds_read_b64_tr_b16 v[208:209], v4 offset:512
  ds_read_b64_tr_b16 v[210:211], v4 offset:1536
  ds_read_b64_tr_b16 v[212:213], v5 offset:512
  ds_read_b64_tr_b16 v[214:215], v5 offset:1536
  s_add_u32 s96, s84, 0x3000000
  s_addc_u32 s97, s85, 0
  s_mov_b32 s98, 0x2200000
  s_mov_b32 s99, 0x20000
  s_lshl_b32 s4, s50, 19
  s_lshl_b32 s5, s53, 14
  s_add_u32 s16, s84, 0x1000000
  s_addc_u32 s17, s85, 0
  s_add_u32 s16, s16, s4
  s_addc_u32 s17, s17, 0
  s_mov_b32 s18, s5
  s_mov_b32 s19, 0x20000
  s_add_u32 s20, s84, 0x2000000
  s_addc_u32 s21, s85, 0
  s_add_u32 s20, s20, s4
  s_addc_u32 s21, s21, 0
  s_mov_b32 s22, s5
  s_mov_b32 s23, 0x20000
  s_mov_b32 s101, 0xbdd2d3e8
  v_mov_b32 v29, 0xc0135761
  s_lshl_b32 s4, s35, 3
  s_lshl_b32 s5, s3, 1
  s_add_u32 s4, s4, s5
  s_mul_i32 s4, s4, 557056
  s_add_u32 s4, s4, 262144
  s_lshl_b32 s37, s37, 6
  s_add_u32 s37, s37, s4
  s_lshl_b32 s40, s40, 6
  s_add_u32 s40, s40, s4
  v_add_u32 v13, s43, v2
  s_mov_b32 s39, 0
  s_mov_b32 s41, 0
  s_waitcnt lgkmcnt(6)
  v_mfma_f32_32x32x16_bf16 v[32:47], v[200:203], v[196:199], 0
  ds_read_b64_tr_b16 v[224:225], v4 offset:4096
  ds_read_b64_tr_b16 v[226:227], v4 offset:5120
  s_nop 7
  v_mul_f32 v240, v160, v160
  v_mul_f32 v241, v161, v161
  v_mul_f32 v242, v162, v162
  v_mfma_f32_32x32x16_bf16 v[96:111], v[200:203], v[192:195], 0
  ds_read_b128 v[216:219], v3 offset:1024
  ds_read_b128 v[220:223], v3 offset:3072
  v_mul_f32 v243, v163, v163
  v_mul_f32 v244, v164, v164
  v_mul_f32 v245, v165, v165
  v_mul_f32 v246, v166, v166
  v_mul_f32 v247, v167, v167
  s_waitcnt lgkmcnt(8)
  v_mfma_f32_32x32x16_bf16 v[48:63], v[204:207], v[196:199], 0
  ds_read_b64_tr_b16 v[228:229], v5 offset:4096
  ds_read_b64_tr_b16 v[230:231], v5 offset:5120
  v_fma_f32 v240, v240, s101, v29
  v_fma_f32 v241, v241, s101, v29
  v_fma_f32 v242, v242, s101, v29
  v_fma_f32 v243, v243, s101, v29
  v_mfma_f32_32x32x16_bf16 v[112:127], v[204:207], v[192:195], 0
  ds_read_b64_tr_b16 v[232:233], v4 offset:4608
  ds_read_b64_tr_b16 v[234:235], v4 offset:5632
  v_fma_f32 v244, v244, s101, v29
  v_fma_f32 v245, v245, s101, v29
  v_fma_f32 v246, v246, s101, v29
  v_fma_f32 v247, v247, s101, v29
  v_mul_f32 v240, v160, v240
  s_waitcnt lgkmcnt(6)
  v_mfma_f32_32x32x16_bf16 v[64:79], v[208:211], v[196:199], 0
  ds_read_b64_tr_b16 v[236:237], v5 offset:4608
  ds_read_b64_tr_b16 v[238:239], v5 offset:5632
  v_mul_f32 v241, v161, v241
  v_mul_f32 v242, v162, v242
  v_mul_f32 v243, v163, v243
  v_mul_f32 v244, v164, v244
  v_mul_f32 v245, v165, v245
  v_mfma_f32_32x32x16_bf16 v[128:143], v[208:211], v[192:195], 0
  v_mul_f32 v246, v166, v246
  v_mul_f32 v247, v167, v247
  v_exp_f32 v240, v240
  v_mul_f32 v160, v160, v176
  v_mfma_f32_32x32x16_bf16 v[80:95], v[212:215], v[196:199], 0
  v_exp_f32 v241, v241
  v_mul_f32 v161, v161, v177
  v_exp_f32 v242, v242
  v_mul_f32 v162, v162, v178
  v_exp_f32 v243, v243
  v_mfma_f32_32x32x16_bf16 v[144:159], v[212:215], v[192:195], 0
  v_mul_f32 v163, v163, v179
  v_exp_f32 v244, v244
  v_mul_f32 v164, v164, v180
  v_exp_f32 v245, v245
  v_mul_f32 v165, v165, v181
  v_add_u32 v3, 24576, v7
  v_add_u32 v4, 24576, v8
  v_add_u32 v5, 24576, v9
  s_waitcnt vmcnt(6) lgkmcnt(0)
  s_barrier
  v_mfma_f32_32x32x16_bf16 v[32:47], v[224:227], v[220:223], v[32:47]
  ds_read_b64_tr_b16 v[200:201], v4 offset:0
  ds_read_b64_tr_b16 v[202:203], v4 offset:1024
  v_exp_f32 v246, v246
  v_mul_f32 v166, v166, v182
  v_exp_f32 v247, v247
  v_mul_f32 v167, v167, v183
  v_mfma_f32_32x32x16_bf16 v[96:111], v[224:227], v[216:219], v[96:111]
  ds_read_b128 v[192:195], v3 offset:0
  ds_read_b128 v[196:199], v3 offset:2048
  s_add_u32 m0, s47, 73728
  s_nop 0
  buffer_load_dwordx4 v11, s[56:59], 0 offen sc1 lds
  v_add_f32 v240, 1.0, v240
  v_add_f32 v241, 1.0, v241
  v_add_f32 v242, 1.0, v242
  v_add_f32 v243, 1.0, v243
  v_add_f32 v244, 1.0, v244
  v_mfma_f32_32x32x16_bf16 v[48:63], v[228:231], v[220:223], v[48:63]
  ds_read_b64_tr_b16 v[204:205], v5 offset:0
  ds_read_b64_tr_b16 v[206:207], v5 offset:1024
  buffer_load_dwordx4 v11, s[56:59], 0 offen offset:1024 sc1 lds
  v_add_f32 v245, 1.0, v245
  v_add_f32 v246, 1.0, v246
  v_add_f32 v247, 1.0, v247
  v_rcp_f32 v240, v240
  v_mfma_f32_32x32x16_bf16 v[112:127], v[228:231], v[216:219], v[112:127]
  ds_read_b64_tr_b16 v[208:209], v4 offset:512
  ds_read_b64_tr_b16 v[210:211], v4 offset:1536
  buffer_load_dwordx4 v11, s[56:59], s45 offen offset:2048 sc1 lds
  v_rcp_f32 v241, v241
  v_rcp_f32 v242, v242
  v_rcp_f32 v243, v243
  v_rcp_f32 v244, v244
  v_rcp_f32 v245, v245
  v_mfma_f32_32x32x16_bf16 v[64:79], v[232:235], v[220:223], v[64:79]
  ds_read_b64_tr_b16 v[212:213], v5 offset:512
  ds_read_b64_tr_b16 v[214:215], v5 offset:1536
  buffer_load_dwordx4 v11, s[56:59], s45 offen offset:3072 sc1 lds
  v_add_u32 v11, 2048, v11
  v_rcp_f32 v246, v246
  v_rcp_f32 v247, v247
  v_mul_f32 v160, v160, v240
  v_mul_f32 v161, v161, v241
  v_mul_f32 v162, v162, v242
  v_mfma_f32_32x32x16_bf16 v[128:143], v[232:235], v[216:219], v[128:143]
  s_add_u32 m0, s49, 73728
  s_nop 0
  buffer_load_dwordx4 v12, s[12:15], 0 offen lds
  v_mul_f32 v163, v163, v243
  v_mul_f32 v164, v164, v244
  v_mul_f32 v165, v165, v245
  v_mul_f32 v166, v166, v246
  v_mfma_f32_32x32x16_bf16 v[80:95], v[236:239], v[220:223], v[80:95]
  buffer_load_dwordx4 v12, s[12:15], s46 offen offset:1024 lds
  v_add_u32 v12, 262144, v12
  v_mul_f32 v167, v167, v247
  v_mfma_f32_32x32x16_bf16 v[144:159], v[236:239], v[216:219], v[144:159]
  v_cvt_pk_bf16_f32 v248, v160, v161
  v_cvt_pk_bf16_f32 v249, v162, v163
  v_cvt_pk_bf16_f32 v250, v164, v165
  v_cvt_pk_bf16_f32 v251, v166, v167
  s_nop 1
  v_permlane32_swap_b32 v248, v250
  v_permlane32_swap_b32 v249, v251
  s_add_u32 s4, s40, 0
  buffer_store_dwordx4 v[248:251], v10, s[96:99], s4 offen sc1
  s_waitcnt lgkmcnt(0)
  v_mfma_f32_32x32x16_bf16 v[32:47], v[200:203], v[196:199], v[32:47]
  ds_read_b64_tr_b16 v[224:225], v4 offset:4096
  ds_read_b64_tr_b16 v[226:227], v4 offset:5120
  v_mul_f32 v240, v168, v168
  v_mul_f32 v241, v169, v169
  v_mul_f32 v242, v170, v170
  v_mul_f32 v243, v171, v171
  v_mfma_f32_32x32x16_bf16 v[96:111], v[200:203], v[192:195], v[96:111]
  ds_read_b128 v[216:219], v3 offset:1024
  ds_read_b128 v[220:223], v3 offset:3072
  v_mul_f32 v244, v172, v172
  v_mul_f32 v245, v173, v173
  v_mul_f32 v246, v174, v174
  v_mul_f32 v247, v175, v175
  v_fma_f32 v240, v240, s101, v29
  v_mfma_f32_32x32x16_bf16 v[48:63], v[204:207], v[196:199], v[48:63]
  ds_read_b64_tr_b16 v[228:229], v5 offset:4096
  ds_read_b64_tr_b16 v[230:231], v5 offset:5120
  v_fma_f32 v241, v241, s101, v29
  v_fma_f32 v242, v242, s101, v29
  v_fma_f32 v243, v243, s101, v29
  v_fma_f32 v244, v244, s101, v29
  v_mfma_f32_32x32x16_bf16 v[112:127], v[204:207], v[192:195], v[112:127]
  ds_read_b64_tr_b16 v[232:233], v4 offset:4608
  ds_read_b64_tr_b16 v[234:235], v4 offset:5632
  v_fma_f32 v245, v245, s101, v29
  v_fma_f32 v246, v246, s101, v29
  v_fma_f32 v247, v247, s101, v29
  v_mul_f32 v240, v168, v240
  v_mul_f32 v241, v169, v241
  v_mfma_f32_32x32x16_bf16 v[64:79], v[208:211], v[196:199], v[64:79]
  ds_read_b64_tr_b16 v[236:237], v5 offset:4608
  ds_read_b64_tr_b16 v[238:239], v5 offset:5632
  v_mul_f32 v242, v170, v242
  v_mul_f32 v243, v171, v243
  v_mul_f32 v244, v172, v244
  v_mul_f32 v245, v173, v245
  v_mfma_f32_32x32x16_bf16 v[128:143], v[208:211], v[192:195], v[128:143]
  v_mul_f32 v246, v174, v246
  v_mul_f32 v247, v175, v247
  v_exp_f32 v240, v240
  v_mul_f32 v168, v168, v184
  v_exp_f32 v241, v241
  v_mfma_f32_32x32x16_bf16 v[80:95], v[212:215], v[196:199], v[80:95]
  v_mul_f32 v169, v169, v185
  v_exp_f32 v242, v242
  v_mul_f32 v170, v170, v186
  v_exp_f32 v243, v243
  v_mfma_f32_32x32x16_bf16 v[144:159], v[212:215], v[192:195], v[144:159]
  v_mul_f32 v171, v171, v187
  v_exp_f32 v244, v244
  v_mul_f32 v172, v172, v188
  v_exp_f32 v245, v245
  v_mul_f32 v173, v173, v189
  v_add_u32 v3, 49152, v7
  v_add_u32 v4, 49152, v8
  v_add_u32 v5, 49152, v9
  s_waitcnt vmcnt(7) lgkmcnt(0)
  s_barrier
  v_mfma_f32_32x32x16_bf16 v[32:47], v[224:227], v[220:223], v[32:47]
  ds_read_b64_tr_b16 v[200:201], v4 offset:0
  ds_read_b64_tr_b16 v[202:203], v4 offset:1024
  v_exp_f32 v246, v246
  v_mul_f32 v174, v174, v190
  v_exp_f32 v247, v247
  v_mul_f32 v175, v175, v191
  v_add_f32 v240, 1.0, v240
  v_mfma_f32_32x32x16_bf16 v[96:111], v[224:227], v[216:219], v[96:111]
  ds_read_b128 v[192:195], v3 offset:0
  ds_read_b128 v[196:199], v3 offset:2048
  s_add_u32 m0, s47, 0
  s_nop 0
  buffer_load_dwordx4 v11, s[56:59], 0 offen sc1 lds
  v_add_f32 v241, 1.0, v241
  v_add_f32 v242, 1.0, v242
  v_add_f32 v243, 1.0, v243
  v_add_f32 v244, 1.0, v244
  v_mfma_f32_32x32x16_bf16 v[48:63], v[228:231], v[220:223], v[48:63]
  ds_read_b64_tr_b16 v[204:205], v5 offset:0
  ds_read_b64_tr_b16 v[206:207], v5 offset:1024
  buffer_load_dwordx4 v11, s[56:59], 0 offen offset:1024 sc1 lds
  v_add_f32 v245, 1.0, v245
  v_add_f32 v246, 1.0, v246
  v_add_f32 v247, 1.0, v247
  v_rcp_f32 v240, v240
  v_rcp_f32 v241, v241
  v_mfma_f32_32x32x16_bf16 v[112:127], v[228:231], v[216:219], v[112:127]
  ds_read_b64_tr_b16 v[208:209], v4 offset:512
  ds_read_b64_tr_b16 v[210:211], v4 offset:1536
  buffer_load_dwordx4 v11, s[56:59], s45 offen offset:2048 sc1 lds
  v_rcp_f32 v242, v242
  v_rcp_f32 v243, v243
  v_rcp_f32 v244, v244
  v_rcp_f32 v245, v245
  v_mfma_f32_32x32x16_bf16 v[64:79], v[232:235], v[220:223], v[64:79]
  ds_read_b64_tr_b16 v[212:213], v5 offset:512
  ds_read_b64_tr_b16 v[214:215], v5 offset:1536
  buffer_load_dwordx4 v11, s[56:59], s45 offen offset:3072 sc1 lds
  v_add_u32 v11, 2048, v11
  v_rcp_f32 v246, v246
  v_rcp_f32 v247, v247
  v_mul_f32 v168, v168, v240
  v_mul_f32 v169, v169, v241
  v_mul_f32 v170, v170, v242
  v_mfma_f32_32x32x16_bf16 v[128:143], v[232:235], v[216:219], v[128:143]
  s_add_u32 m0, s49, 0
  s_nop 0
  buffer_load_dwordx4 v12, s[12:15], 0 offen lds
  v_mul_f32 v171, v171, v243
  v_mul_f32 v172, v172, v244
  v_mul_f32 v173, v173, v245
  v_mul_f32 v174, v174, v246
  v_mfma_f32_32x32x16_bf16 v[80:95], v[236:239], v[220:223], v[80:95]
  buffer_load_dwordx4 v12, s[12:15], s46 offen offset:1024 lds
  v_add_u32 v12, 262144, v12
  v_mul_f32 v175, v175, v247
  v_mfma_f32_32x32x16_bf16 v[144:159], v[236:239], v[216:219], v[144:159]
  v_cvt_pk_bf16_f32 v248, v168, v169
  v_cvt_pk_bf16_f32 v249, v170, v171
  v_cvt_pk_bf16_f32 v250, v172, v173
  v_cvt_pk_bf16_f32 v251, v174, v175
  s_nop 1
  v_permlane32_swap_b32 v248, v250
  v_permlane32_swap_b32 v249, v251
  s_add_u32 s4, s40, 557056
  buffer_store_dwordx4 v[248:251], v10, s[96:99], s4 offen sc1
  s_waitcnt lgkmcnt(0)
  v_mfma_f32_32x32x16_bf16 v[32:47], v[200:203], v[196:199], v[32:47]
  ds_read_b64_tr_b16 v[224:225], v4 offset:4096
  ds_read_b64_tr_b16 v[226:227], v4 offset:5120
  v_accvgpr_read_b32 v160, a0
  v_accvgpr_read_b32 v161, a1
  v_accvgpr_read_b32 v162, a2
  v_accvgpr_read_b32 v163, a3
  v_accvgpr_read_b32 v164, a4
  v_mfma_f32_32x32x16_bf16 v[96:111], v[200:203], v[192:195], v[96:111]
  ds_read_b128 v[216:219], v3 offset:1024
  ds_read_b128 v[220:223], v3 offset:3072
  v_accvgpr_read_b32 v165, a5
  v_accvgpr_read_b32 v166, a6
  v_accvgpr_read_b32 v167, a7
  v_mul_f32 v176, v160, v160
  v_mul_f32 v177, v161, v161
  v_mul_f32 v178, v162, v162
  v_mfma_f32_32x32x16_bf16 v[48:63], v[204:207], v[196:199], v[48:63]
  ds_read_b64_tr_b16 v[228:229], v5 offset:4096
  ds_read_b64_tr_b16 v[230:231], v5 offset:5120
  v_mul_f32 v179, v163, v163
  v_mul_f32 v180, v164, v164
  v_mul_f32 v181, v165, v165
  v_mul_f32 v182, v166, v166
  v_mul_f32 v183, v167, v167
  v_mfma_f32_32x32x16_bf16 v[112:127], v[204:207], v[192:195], v[112:127]
  ds_read_b64_tr_b16 v[232:233], v4 offset:4608
  ds_read_b64_tr_b16 v[234:235], v4 offset:5632
  v_accvgpr_read_b32 v168, a128
  v_accvgpr_read_b32 v169, a129
  v_accvgpr_read_b32 v170, a130
  v_accvgpr_read_b32 v171, a131
  v_accvgpr_read_b32 v172, a132
  v_accvgpr_read_b32 v173, a133
  v_mfma_f32_32x32x16_bf16 v[64:79], v[208:211], v[196:199], v[64:79]
  ds_read_b64_tr_b16 v[236:237], v5 offset:4608
  ds_read_b64_tr_b16 v[238:239], v5 offset:5632
  v_accvgpr_read_b32 v174, a134
  v_accvgpr_read_b32 v175, a135
  v_fma_f32 v176, v176, s101, v29
  v_fma_f32 v177, v177, s101, v29
  v_fma_f32 v178, v178, s101, v29
  v_mfma_f32_32x32x16_bf16 v[128:143], v[208:211], v[192:195], v[128:143]
  v_fma_f32 v179, v179, s101, v29
  v_fma_f32 v180, v180, s101, v29
  v_fma_f32 v181, v181, s101, v29
  v_fma_f32 v182, v182, s101, v29
  v_fma_f32 v183, v183, s101, v29
  v_mul_f32 v176, v160, v176
  v_mfma_f32_32x32x16_bf16 v[80:95], v[212:215], v[196:199], v[80:95]
  v_mul_f32 v177, v161, v177
  v_mul_f32 v178, v162, v178
  v_mul_f32 v179, v163, v179
  v_mul_f32 v180, v164, v180
  v_mul_f32 v181, v165, v181
  v_mfma_f32_32x32x16_bf16 v[144:159], v[212:215], v[192:195], v[144:159]
  v_mul_f32 v182, v166, v182
  v_mul_f32 v183, v167, v183
  v_exp_f32 v176, v176
  v_mul_f32 v160, v160, v168
  v_exp_f32 v177, v177
  v_mul_f32 v161, v161, v169
  v_add_u32 v3, 73728, v7
  v_add_u32 v4, 73728, v8
  v_add_u32 v5, 73728, v9
  s_waitcnt vmcnt(8) lgkmcnt(0)
  s_barrier
  v_mfma_f32_32x32x16_bf16 v[32:47], v[224:227], v[220:223], v[32:47]
  ds_read_b64_tr_b16 v[200:201], v4 offset:0
  ds_read_b64_tr_b16 v[202:203], v4 offset:1024
  v_exp_f32 v178, v178
  v_mul_f32 v162, v162, v170
  v_exp_f32 v179, v179
  v_mul_f32 v163, v163, v171
  v_exp_f32 v180, v180
  v_mul_f32 v164, v164, v172
  v_mfma_f32_32x32x16_bf16 v[96:111], v[224:227], v[216:219], v[96:111]
  ds_read_b128 v[192:195], v3 offset:0
  ds_read_b128 v[196:199], v3 offset:2048
  s_add_u32 m0, s47, 24576
  s_nop 0
  buffer_load_dwordx4 v11, s[56:59], 0 offen sc1 lds
  v_exp_f32 v181, v181
  v_mul_f32 v165, v165, v173
  v_exp_f32 v182, v182
  v_mul_f32 v166, v166, v174
  v_exp_f32 v183, v183
  v_mfma_f32_32x32x16_bf16 v[48:63], v[228:231], v[220:223], v[48:63]
  ds_read_b64_tr_b16 v[204:205], v5 offset:0
  ds_read_b64_tr_b16 v[206:207], v5 offset:1024
  buffer_load_dwordx4 v11, s[56:59], 0 offen offset:1024 sc1 lds
  v_mul_f32 v167, v167, v175
  v_add_f32 v176, 1.0, v176
  v_add_f32 v177, 1.0, v177
  v_add_f32 v178, 1.0, v178
  v_add_f32 v179, 1.0, v179
  v_add_f32 v180, 1.0, v180
  v_mfma_f32_32x32x16_bf16 v[112:127], v[228:231], v[216:219], v[112:127]
  ds_read_b64_tr_b16 v[208:209], v4 offset:512
  ds_read_b64_tr_b16 v[210:211], v4 offset:1536
  buffer_load_dwordx4 v11, s[56:59], s45 offen offset:2048 sc1 lds
  v_add_f32 v181, 1.0, v181
  v_add_f32 v182, 1.0, v182
  v_add_f32 v183, 1.0, v183
  v_rcp_f32 v176, v176
  v_rcp_f32 v177, v177
  v_mfma_f32_32x32x16_bf16 v[64:79], v[232:235], v[220:223], v[64:79]
  ds_read_b64_tr_b16 v[212:213], v5 offset:512
  ds_read_b64_tr_b16 v[214:215], v5 offset:1536
  buffer_load_dwordx4 v11, s[56:59], s45 offen offset:3072 sc1 lds
  v_add_u32 v11, 2048, v11
  v_rcp_f32 v178, v178
  v_rcp_f32 v179, v179
  v_rcp_f32 v180, v180
  v_rcp_f32 v181, v181
  v_rcp_f32 v182, v182
  v_rcp_f32 v183, v183
  v_mfma_f32_32x32x16_bf16 v[128:143], v[232:235], v[216:219], v[128:143]
  s_add_u32 m0, s49, 24576
  s_nop 0
  buffer_load_dwordx4 v12, s[12:15], 0 offen lds
  v_mul_f32 v160, v160, v176
  v_mul_f32 v161, v161, v177
  v_mul_f32 v162, v162, v178
  v_mul_f32 v163, v163, v179
  v_mul_f32 v164, v164, v180
  v_mfma_f32_32x32x16_bf16 v[80:95], v[236:239], v[220:223], v[80:95]
  buffer_load_dwordx4 v12, s[12:15], s46 offen offset:1024 lds
  v_add_u32 v12, 262144, v12
  v_mul_f32 v165, v165, v181
  v_mul_f32 v166, v166, v182
  v_mul_f32 v167, v167, v183
  v_mfma_f32_32x32x16_bf16 v[144:159], v[236:239], v[216:219], v[144:159]
  v_cvt_pk_bf16_f32 v184, v160, v161
  v_cvt_pk_bf16_f32 v185, v162, v163
  v_cvt_pk_bf16_f32 v186, v164, v165
  v_cvt_pk_bf16_f32 v187, v166, v167
  s_nop 1
  v_permlane32_swap_b32 v184, v186
  v_permlane32_swap_b32 v185, v187
  s_add_u32 s4, s37, 0
  buffer_store_dwordx4 v[184:187], v10, s[96:99], s4 offen sc1
  s_waitcnt lgkmcnt(0)
  v_mfma_f32_32x32x16_bf16 v[32:47], v[200:203], v[196:199], v[32:47]
  ds_read_b64_tr_b16 v[224:225], v4 offset:4096
  ds_read_b64_tr_b16 v[226:227], v4 offset:5120
  v_accvgpr_read_b32 v160, a16
  v_accvgpr_read_b32 v161, a17
  v_accvgpr_read_b32 v162, a18
  v_accvgpr_read_b32 v163, a19
  v_accvgpr_read_b32 v164, a20
  v_mfma_f32_32x32x16_bf16 v[96:111], v[200:203], v[192:195], v[96:111]
  ds_read_b128 v[216:219], v3 offset:1024
  ds_read_b128 v[220:223], v3 offset:3072
  v_accvgpr_read_b32 v165, a21
  v_accvgpr_read_b32 v166, a22
  v_accvgpr_read_b32 v167, a23
  v_mul_f32 v176, v160, v160
  v_mul_f32 v177, v161, v161
  v_mul_f32 v178, v162, v162
  v_mfma_f32_32x32x16_bf16 v[48:63], v[204:207], v[196:199], v[48:63]
  ds_read_b64_tr_b16 v[228:229], v5 offset:4096
  ds_read_b64_tr_b16 v[230:231], v5 offset:5120
  v_mul_f32 v179, v163, v163
  v_mul_f32 v180, v164, v164
  v_mul_f32 v181, v165, v165
  v_mul_f32 v182, v166, v166
  v_mul_f32 v183, v167, v167
  v_mfma_f32_32x32x16_bf16 v[112:127], v[204:207], v[192:195], v[112:127]
  ds_read_b64_tr_b16 v[232:233], v4 offset:4608
  ds_read_b64_tr_b16 v[234:235], v4 offset:5632
  v_accvgpr_read_b32 v168, a144
  v_accvgpr_read_b32 v169, a145
  v_accvgpr_read_b32 v170, a146
  v_accvgpr_read_b32 v171, a147
  v_accvgpr_read_b32 v172, a148
  v_accvgpr_read_b32 v173, a149
  v_mfma_f32_32x32x16_bf16 v[64:79], v[208:211], v[196:199], v[64:79]
  ds_read_b64_tr_b16 v[236:237], v5 offset:4608
  ds_read_b64_tr_b16 v[238:239], v5 offset:5632
  v_accvgpr_read_b32 v174, a150
  v_accvgpr_read_b32 v175, a151
  v_fma_f32 v176, v176, s101, v29
  v_fma_f32 v177, v177, s101, v29
  v_fma_f32 v178, v178, s101, v29
  v_mfma_f32_32x32x16_bf16 v[128:143], v[208:211], v[192:195], v[128:143]
  v_fma_f32 v179, v179, s101, v29
  v_fma_f32 v180, v180, s101, v29
  v_fma_f32 v181, v181, s101, v29
  v_fma_f32 v182, v182, s101, v29
  v_fma_f32 v183, v183, s101, v29
  v_mul_f32 v176, v160, v176
  v_mfma_f32_32x32x16_bf16 v[80:95], v[212:215], v[196:199], v[80:95]
  v_mul_f32 v177, v161, v177
  v_mul_f32 v178, v162, v178
  v_mul_f32 v179, v163, v179
  v_mul_f32 v180, v164, v180
  v_mul_f32 v181, v165, v181
  v_mfma_f32_32x32x16_bf16 v[144:159], v[212:215], v[192:195], v[144:159]
  v_mul_f32 v182, v166, v182
  v_mul_f32 v183, v167, v183
  v_exp_f32 v176, v176
  v_mul_f32 v160, v160, v168
  v_exp_f32 v177, v177
  v_mul_f32 v161, v161, v169
  v_add_u32 v3, 0, v7
  v_add_u32 v4, 0, v8
  v_add_u32 v5, 0, v9
  s_waitcnt vmcnt(8) lgkmcnt(0)
  s_barrier
  v_mfma_f32_32x32x16_bf16 v[32:47], v[224:227], v[220:223], v[32:47]
  ds_read_b64_tr_b16 v[200:201], v4 offset:0
  ds_read_b64_tr_b16 v[202:203], v4 offset:1024
  v_exp_f32 v178, v178
  v_mul_f32 v162, v162, v170
  v_exp_f32 v179, v179
  v_mul_f32 v163, v163, v171
  v_exp_f32 v180, v180
  v_mul_f32 v164, v164, v172
  v_mfma_f32_32x32x16_bf16 v[96:111], v[224:227], v[216:219], v[96:111]
  ds_read_b128 v[192:195], v3 offset:0
  ds_read_b128 v[196:199], v3 offset:2048
  s_add_u32 m0, s47, 49152
  s_nop 0
  buffer_load_dwordx4 v11, s[56:59], 0 offen sc1 lds
  v_exp_f32 v181, v181
  v_mul_f32 v165, v165, v173
  v_exp_f32 v182, v182
  v_mul_f32 v166, v166, v174
  v_exp_f32 v183, v183
  v_mfma_f32_32x32x16_bf16 v[48:63], v[228:231], v[220:223], v[48:63]
  ds_read_b64_tr_b16 v[204:205], v5 offset:0
  ds_read_b64_tr_b16 v[206:207], v5 offset:1024
  buffer_load_dwordx4 v11, s[56:59], 0 offen offset:1024 sc1 lds
  v_mul_f32 v167, v167, v175
  v_add_f32 v176, 1.0, v176
  v_add_f32 v177, 1.0, v177
  v_add_f32 v178, 1.0, v178
  v_add_f32 v179, 1.0, v179
  v_add_f32 v180, 1.0, v180
  v_mfma_f32_32x32x16_bf16 v[112:127], v[228:231], v[216:219], v[112:127]
  ds_read_b64_tr_b16 v[208:209], v4 offset:512
  ds_read_b64_tr_b16 v[210:211], v4 offset:1536
  buffer_load_dwordx4 v11, s[56:59], s45 offen offset:2048 sc1 lds
  v_add_f32 v181, 1.0, v181
  v_add_f32 v182, 1.0, v182
  v_add_f32 v183, 1.0, v183
  v_rcp_f32 v176, v176
  v_rcp_f32 v177, v177
  v_mfma_f32_32x32x16_bf16 v[64:79], v[232:235], v[220:223], v[64:79]
  ds_read_b64_tr_b16 v[212:213], v5 offset:512
  ds_read_b64_tr_b16 v[214:215], v5 offset:1536
  buffer_load_dwordx4 v11, s[56:59], s45 offen offset:3072 sc1 lds
  v_add_u32 v11, 2048, v11
  v_rcp_f32 v178, v178
  v_rcp_f32 v179, v179
  v_rcp_f32 v180, v180
  v_rcp_f32 v181, v181
  v_rcp_f32 v182, v182
  v_rcp_f32 v183, v183
  v_mfma_f32_32x32x16_bf16 v[128:143], v[232:235], v[216:219], v[128:143]
  s_add_u32 m0, s49, 49152
  s_nop 0
  buffer_load_dwordx4 v12, s[12:15], 0 offen lds
  v_mul_f32 v160, v160, v176
  v_mul_f32 v161, v161, v177
  v_mul_f32 v162, v162, v178
  v_mul_f32 v163, v163, v179
  v_mul_f32 v164, v164, v180
  v_mfma_f32_32x32x16_bf16 v[80:95], v[236:239], v[220:223], v[80:95]
  buffer_load_dwordx4 v12, s[12:15], s46 offen offset:1024 lds
  v_add_u32 v12, 262144, v12
  v_mul_f32 v165, v165, v181
  v_mul_f32 v166, v166, v182
  v_mul_f32 v167, v167, v183
  v_mfma_f32_32x32x16_bf16 v[144:159], v[236:239], v[216:219], v[144:159]
  v_cvt_pk_bf16_f32 v188, v160, v161
  v_cvt_pk_bf16_f32 v189, v162, v163
  v_cvt_pk_bf16_f32 v190, v164, v165
  v_cvt_pk_bf16_f32 v191, v166, v167
  s_nop 1
  v_permlane32_swap_b32 v188, v190
  v_permlane32_swap_b32 v189, v191
  s_add_u32 s4, s37, 1024
  buffer_store_dwordx4 v[188:191], v10, s[96:99], s4 offen sc1
  s_waitcnt lgkmcnt(0)
  v_mfma_f32_32x32x16_bf16 v[32:47], v[200:203], v[196:199], v[32:47]
  ds_read_b64_tr_b16 v[224:225], v4 offset:4096
  ds_read_b64_tr_b16 v[226:227], v4 offset:5120
  v_accvgpr_read_b32 v160, a32
  v_accvgpr_read_b32 v161, a33
  v_accvgpr_read_b32 v162, a34
  v_accvgpr_read_b32 v163, a35
  v_accvgpr_read_b32 v164, a36
  v_mfma_f32_32x32x16_bf16 v[96:111], v[200:203], v[192:195], v[96:111]
  ds_read_b128 v[216:219], v3 offset:1024
  ds_read_b128 v[220:223], v3 offset:3072
  v_accvgpr_read_b32 v165, a37
  v_accvgpr_read_b32 v166, a38
  v_accvgpr_read_b32 v167, a39
  v_mul_f32 v176, v160, v160
  v_mul_f32 v177, v161, v161
  v_mul_f32 v178, v162, v162
  v_mfma_f32_32x32x16_bf16 v[48:63], v[204:207], v[196:199], v[48:63]
  ds_read_b64_tr_b16 v[228:229], v5 offset:4096
  ds_read_b64_tr_b16 v[230:231], v5 offset:5120
  v_mul_f32 v179, v163, v163
  v_mul_f32 v180, v164, v164
  v_mul_f32 v181, v165, v165
  v_mul_f32 v182, v166, v166
  v_mul_f32 v183, v167, v167
  v_mfma_f32_32x32x16_bf16 v[112:127], v[204:207], v[192:195], v[112:127]
  ds_read_b64_tr_b16 v[232:233], v4 offset:4608
  ds_read_b64_tr_b16 v[234:235], v4 offset:5632
  v_accvgpr_read_b32 v168, a160
  v_accvgpr_read_b32 v169, a161
  v_accvgpr_read_b32 v170, a162
  v_accvgpr_read_b32 v171, a163
  v_accvgpr_read_b32 v172, a164
  v_accvgpr_read_b32 v173, a165
  v_mfma_f32_32x32x16_bf16 v[64:79], v[208:211], v[196:199], v[64:79]
  ds_read_b64_tr_b16 v[236:237], v5 offset:4608
  ds_read_b64_tr_b16 v[238:239], v5 offset:5632
  v_accvgpr_read_b32 v174, a166
  v_accvgpr_read_b32 v175, a167
  v_fma_f32 v176, v176, s101, v29
  v_fma_f32 v177, v177, s101, v29
  v_fma_f32 v178, v178, s101, v29
  v_mfma_f32_32x32x16_bf16 v[128:143], v[208:211], v[192:195], v[128:143]
  v_fma_f32 v179, v179, s101, v29
  v_fma_f32 v180, v180, s101, v29
  v_fma_f32 v181, v181, s101, v29
  v_fma_f32 v182, v182, s101, v29
  v_fma_f32 v183, v183, s101, v29
  v_mul_f32 v176, v160, v176
  v_mfma_f32_32x32x16_bf16 v[80:95], v[212:215], v[196:199], v[80:95]
  v_mul_f32 v177, v161, v177
  v_mul_f32 v178, v162, v178
  v_mul_f32 v179, v163, v179
  v_mul_f32 v180, v164, v180
  v_mul_f32 v181, v165, v181
  v_mfma_f32_32x32x16_bf16 v[144:159], v[212:215], v[192:195], v[144:159]
  v_mul_f32 v182, v166, v182
  v_mul_f32 v183, v167, v183
  v_exp_f32 v176, v176
  v_mul_f32 v160, v160, v168
  v_exp_f32 v177, v177
  v_mul_f32 v161, v161, v169
  v_add_u32 v3, 24576, v7
  v_add_u32 v4, 24576, v8
  v_add_u32 v5, 24576, v9
  s_waitcnt vmcnt(8) lgkmcnt(0)
  s_barrier
  v_mfma_f32_32x32x16_bf16 v[32:47], v[224:227], v[220:223], v[32:47]
  ds_read_b64_tr_b16 v[200:201], v4 offset:0
  ds_read_b64_tr_b16 v[202:203], v4 offset:1024
  s_cmp_lg_u32 s3, 0
  s_cbranch_scc1 L_pubkv
  v_mov_b32 v14, s88
  v_mov_b32 v15, 0
  s_lshl_b32 s4, s34, 3
  s_add_u32 s4, s4, s35
  s_lshl_b32 s4, s4, 2
  s_add_u32 s4, s4, 1024
  s_mov_b64 exec, 1
  buffer_store_dword v14, v15, s[8:11], s4 offen sc1
  s_mov_b64 exec, -1
L_pubkv:
  v_exp_f32 v178, v178
  v_mul_f32 v162, v162, v170
  v_exp_f32 v179, v179
  v_mul_f32 v163, v163, v171
  v_exp_f32 v180, v180
  v_mul_f32 v164, v164, v172
  v_mfma_f32_32x32x16_bf16 v[96:111], v[224:227], v[216:219], v[96:111]
  ds_read_b128 v[192:195], v3 offset:0
  ds_read_b128 v[196:199], v3 offset:2048
  s_add_u32 m0, s47, 73728
  s_nop 0
  buffer_load_dwordx4 v11, s[56:59], 0 offen sc1 lds
  v_exp_f32 v181, v181
  v_mul_f32 v165, v165, v173
  v_exp_f32 v182, v182
  v_mul_f32 v166, v166, v174
  v_exp_f32 v183, v183
  v_mfma_f32_32x32x16_bf16 v[48:63], v[228:231], v[220:223], v[48:63]
  ds_read_b64_tr_b16 v[204:205], v5 offset:0
  ds_read_b64_tr_b16 v[206:207], v5 offset:1024
  buffer_load_dwordx4 v11, s[56:59], 0 offen offset:1024 sc1 lds
  v_mul_f32 v167, v167, v175
  v_add_f32 v176, 1.0, v176
  v_add_f32 v177, 1.0, v177
  v_add_f32 v178, 1.0, v178
  v_add_f32 v179, 1.0, v179
  v_add_f32 v180, 1.0, v180
  v_mfma_f32_32x32x16_bf16 v[112:127], v[228:231], v[216:219], v[112:127]
  ds_read_b64_tr_b16 v[208:209], v4 offset:512
  ds_read_b64_tr_b16 v[210:211], v4 offset:1536
  buffer_load_dwordx4 v11, s[56:59], s45 offen offset:2048 sc1 lds
  v_add_f32 v181, 1.0, v181
  v_add_f32 v182, 1.0, v182
  v_add_f32 v183, 1.0, v183
  v_rcp_f32 v176, v176
  v_rcp_f32 v177, v177
  v_mfma_f32_32x32x16_bf16 v[64:79], v[232:235], v[220:223], v[64:79]
  ds_read_b64_tr_b16 v[212:213], v5 offset:512
  ds_read_b64_tr_b16 v[214:215], v5 offset:1536
  buffer_load_dwordx4 v11, s[56:59], s45 offen offset:3072 sc1 lds
  v_add_u32 v11, 2048, v11
  v_rcp_f32 v178, v178
  v_rcp_f32 v179, v179
  v_rcp_f32 v180, v180
  v_rcp_f32 v181, v181
  v_rcp_f32 v182, v182
  v_rcp_f32 v183, v183
  v_mfma_f32_32x32x16_bf16 v[128:143], v[232:235], v[216:219], v[128:143]
  s_add_u32 m0, s49, 73728
  s_nop 0
  buffer_load_dwordx4 v12, s[12:15], 0 offen lds
  v_mul_f32 v160, v160, v176
  v_mul_f32 v161, v161, v177
  v_mul_f32 v162, v162, v178
  v_mul_f32 v163, v163, v179
  v_mul_f32 v164, v164, v180
  v_mfma_f32_32x32x16_bf16 v[80:95], v[236:239], v[220:223], v[80:95]
  buffer_load_dwordx4 v12, s[12:15], s46 offen offset:1024 lds
  v_add_u32 v12, 262144, v12
  v_mul_f32 v165, v165, v181
  v_mul_f32 v166, v166, v182
  v_mul_f32 v167, v167, v183
  v_mfma_f32_32x32x16_bf16 v[144:159], v[236:239], v[216:219], v[144:159]
  v_cvt_pk_bf16_f32 v184, v160, v161
  v_cvt_pk_bf16_f32 v185, v162, v163
  v_cvt_pk_bf16_f32 v186, v164, v165
  v_cvt_pk_bf16_f32 v187, v166, v167
  s_nop 1
  v_permlane32_swap_b32 v184, v186
  v_permlane32_swap_b32 v185, v187
  s_add_u32 s4, s37, 2048
  buffer_store_dwordx4 v[184:187], v10, s[96:99], s4 offen sc1
  s_waitcnt lgkmcnt(0)
  v_mfma_f32_32x32x16_bf16 v[32:47], v[200:203], v[196:199], v[32:47]
  ds_read_b64_tr_b16 v[224:225], v4 offset:4096
  ds_read_b64_tr_b16 v[226:227], v4 offset:5120
  v_accvgpr_read_b32 v160, a48
  v_accvgpr_read_b32 v161, a49
  v_accvgpr_read_b32 v162, a50
  v_accvgpr_read_b32 v163, a51
  v_accvgpr_read_b32 v164, a52
  v_mfma_f32_32x32x16_bf16 v[96:111], v[200:203], v[192:195], v[96:111]
  ds_read_b128 v[216:219], v3 offset:1024
  ds_read_b128 v[220:223], v3 offset:3072
  v_accvgpr_read_b32 v165, a53
  v_accvgpr_read_b32 v166, a54
  v_accvgpr_read_b32 v167, a55
  v_mul_f32 v176, v160, v160
  v_mul_f32 v177, v161, v161
  v_mul_f32 v178, v162, v162
  v_mfma_f32_32x32x16_bf16 v[48:63], v[204:207], v[196:199], v[48:63]
  ds_read_b64_tr_b16 v[228:229], v5 offset:4096
  ds_read_b64_tr_b16 v[230:231], v5 offset:5120
  v_mul_f32 v179, v163, v163
  v_mul_f32 v180, v164, v164
  v_mul_f32 v181, v165, v165
  v_mul_f32 v182, v166, v166
  v_mul_f32 v183, v167, v167
  v_mfma_f32_32x32x16_bf16 v[112:127], v[204:207], v[192:195], v[112:127]
  ds_read_b64_tr_b16 v[232:233], v4 offset:4608
  ds_read_b64_tr_b16 v[234:235], v4 offset:5632
  v_accvgpr_read_b32 v168, a176
  v_accvgpr_read_b32 v169, a177
  v_accvgpr_read_b32 v170, a178
  v_accvgpr_read_b32 v171, a179
  v_accvgpr_read_b32 v172, a180
  v_accvgpr_read_b32 v173, a181
  v_mfma_f32_32x32x16_bf16 v[64:79], v[208:211], v[196:199], v[64:79]
  ds_read_b64_tr_b16 v[236:237], v5 offset:4608
  ds_read_b64_tr_b16 v[238:239], v5 offset:5632
  v_accvgpr_read_b32 v174, a182
  v_accvgpr_read_b32 v175, a183
  v_fma_f32 v176, v176, s101, v29
  v_fma_f32 v177, v177, s101, v29
  v_fma_f32 v178, v178, s101, v29
  v_mfma_f32_32x32x16_bf16 v[128:143], v[208:211], v[192:195], v[128:143]
  v_fma_f32 v179, v179, s101, v29
  v_fma_f32 v180, v180, s101, v29
  v_fma_f32 v181, v181, s101, v29
  v_fma_f32 v182, v182, s101, v29
  v_fma_f32 v183, v183, s101, v29
  v_mul_f32 v176, v160, v176
  v_mfma_f32_32x32x16_bf16 v[80:95], v[212:215], v[196:199], v[80:95]
  v_mul_f32 v177, v161, v177
  v_mul_f32 v178, v162, v178
  v_mul_f32 v179, v163, v179
  v_mul_f32 v180, v164, v180
  v_mul_f32 v181, v165, v181
  v_mfma_f32_32x32x16_bf16 v[144:159], v[212:215], v[192:195], v[144:159]
  v_mul_f32 v182, v166, v182
  v_mul_f32 v183, v167, v183
  v_exp_f32 v176, v176
  v_mul_f32 v160, v160, v168
  v_exp_f32 v177, v177
  v_mul_f32 v161, v161, v169
  v_add_u32 v3, 49152, v7
  v_add_u32 v4, 49152, v8
  v_add_u32 v5, 49152, v9
  s_waitcnt vmcnt(8) lgkmcnt(0)
  s_barrier
  v_mfma_f32_32x32x16_bf16 v[32:47], v[224:227], v[220:223], v[32:47]
  ds_read_b64_tr_b16 v[200:201], v4 offset:0
  ds_read_b64_tr_b16 v[202:203], v4 offset:1024
  v_exp_f32 v178, v178
  v_mul_f32 v162, v162, v170
  v_exp_f32 v179, v179
  v_mul_f32 v163, v163, v171
  v_exp_f32 v180, v180
  v_mul_f32 v164, v164, v172
  v_mfma_f32_32x32x16_bf16 v[96:111], v[224:227], v[216:219], v[96:111]
  ds_read_b128 v[192:195], v3 offset:0
  ds_read_b128 v[196:199], v3 offset:2048
  s_add_u32 m0, s47, 0
  s_nop 0
  buffer_load_dwordx4 v11, s[56:59], 0 offen sc1 lds
  v_exp_f32 v181, v181
  v_mul_f32 v165, v165, v173
  v_exp_f32 v182, v182
  v_mul_f32 v166, v166, v174
  v_exp_f32 v183, v183
  v_mfma_f32_32x32x16_bf16 v[48:63], v[228:231], v[220:223], v[48:63]
  ds_read_b64_tr_b16 v[204:205], v5 offset:0
  ds_read_b64_tr_b16 v[206:207], v5 offset:1024
  buffer_load_dwordx4 v11, s[56:59], 0 offen offset:1024 sc1 lds
  v_mul_f32 v167, v167, v175
  v_add_f32 v176, 1.0, v176
  v_add_f32 v177, 1.0, v177
  v_add_f32 v178, 1.0, v178
  v_add_f32 v179, 1.0, v179
  v_add_f32 v180, 1.0, v180
  v_mfma_f32_32x32x16_bf16 v[112:127], v[228:231], v[216:219], v[112:127]
  ds_read_b64_tr_b16 v[208:209], v4 offset:512
  ds_read_b64_tr_b16 v[210:211], v4 offset:1536
  buffer_load_dwordx4 v11, s[56:59], s45 offen offset:2048 sc1 lds
  v_add_f32 v181, 1.0, v181
  v_add_f32 v182, 1.0, v182
  v_add_f32 v183, 1.0, v183
  v_rcp_f32 v176, v176
  v_rcp_f32 v177, v177
  v_mfma_f32_32x32x16_bf16 v[64:79], v[232:235], v[220:223], v[64:79]
  ds_read_b64_tr_b16 v[212:213], v5 offset:512
  ds_read_b64_tr_b16 v[214:215], v5 offset:1536
  buffer_load_dwordx4 v11, s[56:59], s45 offen offset:3072 sc1 lds
  v_add_u32 v11, 2048, v11
  v_rcp_f32 v178, v178
  v_rcp_f32 v179, v179
  v_rcp_f32 v180, v180
  v_rcp_f32 v181, v181
  v_rcp_f32 v182, v182
  v_rcp_f32 v183, v183
  v_mfma_f32_32x32x16_bf16 v[128:143], v[232:235], v[216:219], v[128:143]
  s_add_u32 m0, s49, 0
  s_nop 0
  buffer_load_dwordx4 v12, s[12:15], 0 offen lds
  v_mul_f32 v160, v160, v176
  v_mul_f32 v161, v161, v177
  v_mul_f32 v162, v162, v178
  v_mul_f32 v163, v163, v179
  v_mul_f32 v164, v164, v180
  v_mfma_f32_32x32x16_bf16 v[80:95], v[236:239], v[220:223], v[80:95]
  buffer_load_dwordx4 v12, s[12:15], s46 offen offset:1024 lds
  v_add_u32 v12, 262144, v12
  v_mul_f32 v165, v165, v181
  v_mul_f32 v166, v166, v182
  v_mul_f32 v167, v167, v183
  v_mfma_f32_32x32x16_bf16 v[144:159], v[236:239], v[216:219], v[144:159]
  v_cvt_pk_bf16_f32 v188, v160, v161
  v_cvt_pk_bf16_f32 v189, v162, v163
  v_cvt_pk_bf16_f32 v190, v164, v165
  v_cvt_pk_bf16_f32 v191, v166, v167
  s_nop 1
  v_permlane32_swap_b32 v188, v190
  v_permlane32_swap_b32 v189, v191
  s_add_u32 s4, s37, 3072
  buffer_store_dwordx4 v[188:191], v10, s[96:99], s4 offen sc1
  s_waitcnt lgkmcnt(0)
  v_mfma_f32_32x32x16_bf16 v[32:47], v[200:203], v[196:199], v[32:47]
  ds_read_b64_tr_b16 v[224:225], v4 offset:4096
  ds_read_b64_tr_b16 v[226:227], v4 offset:5120
  v_accvgpr_read_b32 v160, a64
  v_accvgpr_read_b32 v161, a65
  v_accvgpr_read_b32 v162, a66
  v_accvgpr_read_b32 v163, a67
  v_accvgpr_read_b32 v164, a68
  v_mfma_f32_32x32x16_bf16 v[96:111], v[200:203], v[192:195], v[96:111]
  ds_read_b128 v[216:219], v3 offset:1024
  ds_read_b128 v[220:223], v3 offset:3072
  v_accvgpr_read_b32 v165, a69
  v_accvgpr_read_b32 v166, a70
  v_accvgpr_read_b32 v167, a71
  v_mul_f32 v176, v160, v160
  v_mul_f32 v177, v161, v161
  v_mul_f32 v178, v162, v162
  v_mfma_f32_32x32x16_bf16 v[48:63], v[204:207], v[196:199], v[48:63]
  ds_read_b64_tr_b16 v[228:229], v5 offset:4096
  ds_read_b64_tr_b16 v[230:231], v5 offset:5120
  v_mul_f32 v179, v163, v163
  v_mul_f32 v180, v164, v164
  v_mul_f32 v181, v165, v165
  v_mul_f32 v182, v166, v166
  v_mul_f32 v183, v167, v167
  v_mfma_f32_32x32x16_bf16 v[112:127], v[204:207], v[192:195], v[112:127]
  ds_read_b64_tr_b16 v[232:233], v4 offset:4608
  ds_read_b64_tr_b16 v[234:235], v4 offset:5632
  v_accvgpr_read_b32 v168, a192
  v_accvgpr_read_b32 v169, a193
  v_accvgpr_read_b32 v170, a194
  v_accvgpr_read_b32 v171, a195
  v_accvgpr_read_b32 v172, a196
  v_accvgpr_read_b32 v173, a197
  v_mfma_f32_32x32x16_bf16 v[64:79], v[208:211], v[196:199], v[64:79]
  ds_read_b64_tr_b16 v[236:237], v5 offset:4608
  ds_read_b64_tr_b16 v[238:239], v5 offset:5632
  v_accvgpr_read_b32 v174, a198
  v_accvgpr_read_b32 v175, a199
  v_fma_f32 v176, v176, s101, v29
  v_fma_f32 v177, v177, s101, v29
  v_fma_f32 v178, v178, s101, v29
  v_mfma_f32_32x32x16_bf16 v[128:143], v[208:211], v[192:195], v[128:143]
  v_fma_f32 v179, v179, s101, v29
  v_fma_f32 v180, v180, s101, v29
  v_fma_f32 v181, v181, s101, v29
  v_fma_f32 v182, v182, s101, v29
  v_fma_f32 v183, v183, s101, v29
  v_mul_f32 v176, v160, v176
  v_mfma_f32_32x32x16_bf16 v[80:95], v[212:215], v[196:199], v[80:95]
  v_mul_f32 v177, v161, v177
  v_mul_f32 v178, v162, v178
  v_mul_f32 v179, v163, v179
  v_mul_f32 v180, v164, v180
  v_mul_f32 v181, v165, v181
  v_mfma_f32_32x32x16_bf16 v[144:159], v[212:215], v[192:195], v[144:159]
  v_mul_f32 v182, v166, v182
  v_mul_f32 v183, v167, v183
  v_exp_f32 v176, v176
  v_mul_f32 v160, v160, v168
  v_exp_f32 v177, v177
  v_mul_f32 v161, v161, v169
  v_add_u32 v3, 73728, v7
  v_add_u32 v4, 73728, v8
  v_add_u32 v5, 73728, v9
  s_waitcnt vmcnt(8) lgkmcnt(0)
  s_barrier
  v_mfma_f32_32x32x16_bf16 v[32:47], v[224:227], v[220:223], v[32:47]
  ds_read_b64_tr_b16 v[200:201], v4 offset:0
  ds_read_b64_tr_b16 v[202:203], v4 offset:1024
  v_exp_f32 v178, v178
  v_mul_f32 v162, v162, v170
  v_exp_f32 v179, v179
  v_mul_f32 v163, v163, v171
  v_exp_f32 v180, v180
  v_mul_f32 v164, v164, v172
  v_mfma_f32_32x32x16_bf16 v[96:111], v[224:227], v[216:219], v[96:111]
  ds_read_b128 v[192:195], v3 offset:0
  ds_read_b128 v[196:199], v3 offset:2048
  s_add_u32 m0, s47, 24576
  s_nop 0
  buffer_load_dwordx4 v11, s[56:59], 0 offen sc1 lds
  v_exp_f32 v181, v181
  v_mul_f32 v165, v165, v173
  v_exp_f32 v182, v182
  v_mul_f32 v166, v166, v174
  v_exp_f32 v183, v183
  v_mfma_f32_32x32x16_bf16 v[48:63], v[228:231], v[220:223], v[48:63]
  ds_read_b64_tr_b16 v[204:205], v5 offset:0
  ds_read_b64_tr_b16 v[206:207], v5 offset:1024
  buffer_load_dwordx4 v11, s[56:59], 0 offen offset:1024 sc1 lds
  v_mul_f32 v167, v167, v175
  v_add_f32 v176, 1.0, v176
  v_add_f32 v177, 1.0, v177
  v_add_f32 v178, 1.0, v178
  v_add_f32 v179, 1.0, v179
  v_add_f32 v180, 1.0, v180
  v_mfma_f32_32x32x16_bf16 v[112:127], v[228:231], v[216:219], v[112:127]
  ds_read_b64_tr_b16 v[208:209], v4 offset:512
  ds_read_b64_tr_b16 v[210:211], v4 offset:1536
  buffer_load_dwordx4 v11, s[56:59], s45 offen offset:2048 sc1 lds
  v_add_f32 v181, 1.0, v181
  v_add_f32 v182, 1.0, v182
  v_add_f32 v183, 1.0, v183
  v_rcp_f32 v176, v176
  v_rcp_f32 v177, v177
  v_mfma_f32_32x32x16_bf16 v[64:79], v[232:235], v[220:223], v[64:79]
  ds_read_b64_tr_b16 v[212:213], v5 offset:512
  ds_read_b64_tr_b16 v[214:215], v5 offset:1536
  buffer_load_dwordx4 v11, s[56:59], s45 offen offset:3072 sc1 lds
  v_add_u32 v11, 2048, v11
  v_rcp_f32 v178, v178
  v_rcp_f32 v179, v179
  v_rcp_f32 v180, v180
  v_rcp_f32 v181, v181
  v_rcp_f32 v182, v182
  v_rcp_f32 v183, v183
  v_mfma_f32_32x32x16_bf16 v[128:143], v[232:235], v[216:219], v[128:143]
  s_add_u32 m0, s49, 24576
  s_nop 0
  buffer_load_dwordx4 v12, s[12:15], 0 offen lds
  v_mul_f32 v160, v160, v176
  v_mul_f32 v161, v161, v177
  v_mul_f32 v162, v162, v178
  v_mul_f32 v163, v163, v179
  v_mul_f32 v164, v164, v180
  v_mfma_f32_32x32x16_bf16 v[80:95], v[236:239], v[220:223], v[80:95]
  buffer_load_dwordx4 v12, s[12:15], s46 offen offset:1024 lds
  v_add_u32 v12, 262144, v12
  v_mul_f32 v165, v165, v181
  v_mul_f32 v166, v166, v182
  v_mul_f32 v167, v167, v183
  v_mfma_f32_32x32x16_bf16 v[144:159], v[236:239], v[216:219], v[144:159]
  v_cvt_pk_bf16_f32 v184, v160, v161
  v_cvt_pk_bf16_f32 v185, v162, v163
  v_cvt_pk_bf16_f32 v186, v164, v165
  v_cvt_pk_bf16_f32 v187, v166, v167
  s_nop 1
  v_permlane32_swap_b32 v184, v186
  v_permlane32_swap_b32 v185, v187
  s_add_u32 s4, s37, 4096
  buffer_store_dwordx4 v[184:187], v10, s[96:99], s4 offen sc1
  s_waitcnt lgkmcnt(0)
  v_mfma_f32_32x32x16_bf16 v[32:47], v[200:203], v[196:199], v[32:47]
  ds_read_b64_tr_b16 v[224:225], v4 offset:4096
  ds_read_b64_tr_b16 v[226:227], v4 offset:5120
  v_accvgpr_read_b32 v160, a80
  v_accvgpr_read_b32 v161, a81
  v_accvgpr_read_b32 v162, a82
  v_accvgpr_read_b32 v163, a83
  v_accvgpr_read_b32 v164, a84
  v_mfma_f32_32x32x16_bf16 v[96:111], v[200:203], v[192:195], v[96:111]
  ds_read_b128 v[216:219], v3 offset:1024
  ds_read_b128 v[220:223], v3 offset:3072
  v_accvgpr_read_b32 v165, a85
  v_accvgpr_read_b32 v166, a86
  v_accvgpr_read_b32 v167, a87
  v_mul_f32 v176, v160, v160
  v_mul_f32 v177, v161, v161
  v_mul_f32 v178, v162, v162
  v_mfma_f32_32x32x16_bf16 v[48:63], v[204:207], v[196:199], v[48:63]
  ds_read_b64_tr_b16 v[228:229], v5 offset:4096
  ds_read_b64_tr_b16 v[230:231], v5 offset:5120
  v_mul_f32 v179, v163, v163
  v_mul_f32 v180, v164, v164
  v_mul_f32 v181, v165, v165
  v_mul_f32 v182, v166, v166
  v_mul_f32 v183, v167, v167
  v_mfma_f32_32x32x16_bf16 v[112:127], v[204:207], v[192:195], v[112:127]
  ds_read_b64_tr_b16 v[232:233], v4 offset:4608
  ds_read_b64_tr_b16 v[234:235], v4 offset:5632
  v_accvgpr_read_b32 v168, a208
  v_accvgpr_read_b32 v169, a209
  v_accvgpr_read_b32 v170, a210
  v_accvgpr_read_b32 v171, a211
  v_accvgpr_read_b32 v172, a212
  v_accvgpr_read_b32 v173, a213
  v_mfma_f32_32x32x16_bf16 v[64:79], v[208:211], v[196:199], v[64:79]
  ds_read_b64_tr_b16 v[236:237], v5 offset:4608
  ds_read_b64_tr_b16 v[238:239], v5 offset:5632
  v_accvgpr_read_b32 v174, a214
  v_accvgpr_read_b32 v175, a215
  v_fma_f32 v176, v176, s101, v29
  v_fma_f32 v177, v177, s101, v29
  v_fma_f32 v178, v178, s101, v29
  v_mfma_f32_32x32x16_bf16 v[128:143], v[208:211], v[192:195], v[128:143]
  v_fma_f32 v179, v179, s101, v29
  v_fma_f32 v180, v180, s101, v29
  v_fma_f32 v181, v181, s101, v29
  v_fma_f32 v182, v182, s101, v29
  v_fma_f32 v183, v183, s101, v29
  v_mul_f32 v176, v160, v176
  v_mfma_f32_32x32x16_bf16 v[80:95], v[212:215], v[196:199], v[80:95]
  v_mul_f32 v177, v161, v177
  v_mul_f32 v178, v162, v178
  v_mul_f32 v179, v163, v179
  v_mul_f32 v180, v164, v180
  v_mul_f32 v181, v165, v181
  v_mfma_f32_32x32x16_bf16 v[144:159], v[212:215], v[192:195], v[144:159]
  v_mul_f32 v182, v166, v182
  v_mul_f32 v183, v167, v183
  v_exp_f32 v176, v176
  v_mul_f32 v160, v160, v168
  v_exp_f32 v177, v177
  v_mul_f32 v161, v161, v169
  v_add_u32 v3, 0, v7
  v_add_u32 v4, 0, v8
  v_add_u32 v5, 0, v9
  s_waitcnt vmcnt(8) lgkmcnt(0)
  s_barrier
  v_mfma_f32_32x32x16_bf16 v[32:47], v[224:227], v[220:223], v[32:47]
  ds_read_b64_tr_b16 v[200:201], v4 offset:0
  ds_read_b64_tr_b16 v[202:203], v4 offset:1024
  v_exp_f32 v178, v178
  v_mul_f32 v162, v162, v170
  v_exp_f32 v179, v179
  v_mul_f32 v163, v163, v171
  v_exp_f32 v180, v180
  v_mul_f32 v164, v164, v172
  v_mfma_f32_32x32x16_bf16 v[96:111], v[224:227], v[216:219], v[96:111]
  ds_read_b128 v[192:195], v3 offset:0
  ds_read_b128 v[196:199], v3 offset:2048
  s_add_u32 m0, s47, 49152
  s_nop 0
  buffer_load_dwordx4 v11, s[56:59], 0 offen sc1 lds
  v_exp_f32 v181, v181
  v_mul_f32 v165, v165, v173
  v_exp_f32 v182, v182
  v_mul_f32 v166, v166, v174
  v_exp_f32 v183, v183
  v_mfma_f32_32x32x16_bf16 v[48:63], v[228:231], v[220:223], v[48:63]
  ds_read_b64_tr_b16 v[204:205], v5 offset:0
  ds_read_b64_tr_b16 v[206:207], v5 offset:1024
  buffer_load_dwordx4 v11, s[56:59], 0 offen offset:1024 sc1 lds
  v_mul_f32 v167, v167, v175
  v_add_f32 v176, 1.0, v176
  v_add_f32 v177, 1.0, v177
  v_add_f32 v178, 1.0, v178
  v_add_f32 v179, 1.0, v179
  v_add_f32 v180, 1.0, v180
  v_mfma_f32_32x32x16_bf16 v[112:127], v[228:231], v[216:219], v[112:127]
  ds_read_b64_tr_b16 v[208:209], v4 offset:512
  ds_read_b64_tr_b16 v[210:211], v4 offset:1536
  buffer_load_dwordx4 v11, s[56:59], s45 offen offset:2048 sc1 lds
  v_add_f32 v181, 1.0, v181
  v_add_f32 v182, 1.0, v182
  v_add_f32 v183, 1.0, v183
  v_rcp_f32 v176, v176
  v_rcp_f32 v177, v177
  v_mfma_f32_32x32x16_bf16 v[64:79], v[232:235], v[220:223], v[64:79]
  ds_read_b64_tr_b16 v[212:213], v5 offset:512
  ds_read_b64_tr_b16 v[214:215], v5 offset:1536
  buffer_load_dwordx4 v11, s[56:59], s45 offen offset:3072 sc1 lds
  v_add_u32 v11, 2048, v11
  v_rcp_f32 v178, v178
  v_rcp_f32 v179, v179
  v_rcp_f32 v180, v180
  v_rcp_f32 v181, v181
  v_rcp_f32 v182, v182
  v_rcp_f32 v183, v183
  v_mfma_f32_32x32x16_bf16 v[128:143], v[232:235], v[216:219], v[128:143]
  s_add_u32 m0, s49, 49152
  s_nop 0
  buffer_load_dwordx4 v12, s[12:15], 0 offen lds
  v_mul_f32 v160, v160, v176
  v_mul_f32 v161, v161, v177
  v_mul_f32 v162, v162, v178
  v_mul_f32 v163, v163, v179
  v_mul_f32 v164, v164, v180
  v_mfma_f32_32x32x16_bf16 v[80:95], v[236:239], v[220:223], v[80:95]
  buffer_load_dwordx4 v12, s[12:15], s46 offen offset:1024 lds
  v_add_u32 v12, 262144, v12
  v_mul_f32 v165, v165, v181
  v_mul_f32 v166, v166, v182
  v_mul_f32 v167, v167, v183
  v_mfma_f32_32x32x16_bf16 v[144:159], v[236:239], v[216:219], v[144:159]
  v_cvt_pk_bf16_f32 v188, v160, v161
  v_cvt_pk_bf16_f32 v189, v162, v163
  v_cvt_pk_bf16_f32 v190, v164, v165
  v_cvt_pk_bf16_f32 v191, v166, v167
  s_nop 1
  v_permlane32_swap_b32 v188, v190
  v_permlane32_swap_b32 v189, v191
  s_add_u32 s4, s37, 5120
  buffer_store_dwordx4 v[188:191], v10, s[96:99], s4 offen sc1
  s_waitcnt lgkmcnt(0)
  v_mfma_f32_32x32x16_bf16 v[32:47], v[200:203], v[196:199], v[32:47]
  ds_read_b64_tr_b16 v[224:225], v4 offset:4096
  ds_read_b64_tr_b16 v[226:227], v4 offset:5120
  v_accvgpr_read_b32 v160, a96
  v_accvgpr_read_b32 v161, a97
  v_accvgpr_read_b32 v162, a98
  v_accvgpr_read_b32 v163, a99
  v_accvgpr_read_b32 v164, a100
  v_mfma_f32_32x32x16_bf16 v[96:111], v[200:203], v[192:195], v[96:111]
  ds_read_b128 v[216:219], v3 offset:1024
  ds_read_b128 v[220:223], v3 offset:3072
  v_accvgpr_read_b32 v165, a101
  v_accvgpr_read_b32 v166, a102
  v_accvgpr_read_b32 v167, a103
  v_mul_f32 v176, v160, v160
  v_mul_f32 v177, v161, v161
  v_mul_f32 v178, v162, v162
  v_mfma_f32_32x32x16_bf16 v[48:63], v[204:207], v[196:199], v[48:63]
  ds_read_b64_tr_b16 v[228:229], v5 offset:4096
  ds_read_b64_tr_b16 v[230:231], v5 offset:5120
  v_mul_f32 v179, v163, v163
  v_mul_f32 v180, v164, v164
  v_mul_f32 v181, v165, v165
  v_mul_f32 v182, v166, v166
  v_mul_f32 v183, v167, v167
  v_mfma_f32_32x32x16_bf16 v[112:127], v[204:207], v[192:195], v[112:127]
  ds_read_b64_tr_b16 v[232:233], v4 offset:4608
  ds_read_b64_tr_b16 v[234:235], v4 offset:5632
  v_accvgpr_read_b32 v168, a224
  v_accvgpr_read_b32 v169, a225
  v_accvgpr_read_b32 v170, a226
  v_accvgpr_read_b32 v171, a227
  v_accvgpr_read_b32 v172, a228
  v_accvgpr_read_b32 v173, a229
  v_mfma_f32_32x32x16_bf16 v[64:79], v[208:211], v[196:199], v[64:79]
  ds_read_b64_tr_b16 v[236:237], v5 offset:4608
  ds_read_b64_tr_b16 v[238:239], v5 offset:5632
  v_accvgpr_read_b32 v174, a230
  v_accvgpr_read_b32 v175, a231
  v_fma_f32 v176, v176, s101, v29
  v_fma_f32 v177, v177, s101, v29
  v_fma_f32 v178, v178, s101, v29
  v_mfma_f32_32x32x16_bf16 v[128:143], v[208:211], v[192:195], v[128:143]
  v_fma_f32 v179, v179, s101, v29
  v_fma_f32 v180, v180, s101, v29
  v_fma_f32 v181, v181, s101, v29
  v_fma_f32 v182, v182, s101, v29
  v_fma_f32 v183, v183, s101, v29
  v_mul_f32 v176, v160, v176
  v_mfma_f32_32x32x16_bf16 v[80:95], v[212:215], v[196:199], v[80:95]
  v_mul_f32 v177, v161, v177
  v_mul_f32 v178, v162, v178
  v_mul_f32 v179, v163, v179
  v_mul_f32 v180, v164, v180
  v_mul_f32 v181, v165, v181
  v_mfma_f32_32x32x16_bf16 v[144:159], v[212:215], v[192:195], v[144:159]
  v_mul_f32 v182, v166, v182
  v_mul_f32 v183, v167, v183
  v_exp_f32 v176, v176
  v_mul_f32 v160, v160, v168
  v_exp_f32 v177, v177
  v_mul_f32 v161, v161, v169
  v_add_u32 v3, 24576, v7
  v_add_u32 v4, 24576, v8
  v_add_u32 v5, 24576, v9
  s_waitcnt vmcnt(8) lgkmcnt(0)
  s_barrier
  v_mfma_f32_32x32x16_bf16 v[32:47], v[224:227], v[220:223], v[32:47]
  ds_read_b64_tr_b16 v[200:201], v4 offset:0
  ds_read_b64_tr_b16 v[202:203], v4 offset:1024
  v_exp_f32 v178, v178
  v_mul_f32 v162, v162, v170
  v_exp_f32 v179, v179
  v_mul_f32 v163, v163, v171
  v_exp_f32 v180, v180
  v_mul_f32 v164, v164, v172
  v_mfma_f32_32x32x16_bf16 v[96:111], v[224:227], v[216:219], v[96:111]
  ds_read_b128 v[192:195], v3 offset:0
  ds_read_b128 v[196:199], v3 offset:2048
  s_add_u32 m0, s47, 73728
  s_nop 0
  buffer_load_dwordx4 v11, s[56:59], 0 offen sc1 lds
  v_exp_f32 v181, v181
  v_mul_f32 v165, v165, v173
  v_exp_f32 v182, v182
  v_mul_f32 v166, v166, v174
  v_exp_f32 v183, v183
  v_mfma_f32_32x32x16_bf16 v[48:63], v[228:231], v[220:223], v[48:63]
  ds_read_b64_tr_b16 v[204:205], v5 offset:0
  ds_read_b64_tr_b16 v[206:207], v5 offset:1024
  buffer_load_dwordx4 v11, s[56:59], 0 offen offset:1024 sc1 lds
  v_mul_f32 v167, v167, v175
  v_add_f32 v176, 1.0, v176
  v_add_f32 v177, 1.0, v177
  v_add_f32 v178, 1.0, v178
  v_add_f32 v179, 1.0, v179
  v_add_f32 v180, 1.0, v180
  v_mfma_f32_32x32x16_bf16 v[112:127], v[228:231], v[216:219], v[112:127]
  ds_read_b64_tr_b16 v[208:209], v4 offset:512
  ds_read_b64_tr_b16 v[210:211], v4 offset:1536
  buffer_load_dwordx4 v11, s[56:59], s45 offen offset:2048 sc1 lds
  v_add_f32 v181, 1.0, v181
  v_add_f32 v182, 1.0, v182
  v_add_f32 v183, 1.0, v183
  v_rcp_f32 v176, v176
  v_rcp_f32 v177, v177
  v_mfma_f32_32x32x16_bf16 v[64:79], v[232:235], v[220:223], v[64:79]
  ds_read_b64_tr_b16 v[212:213], v5 offset:512
  ds_read_b64_tr_b16 v[214:215], v5 offset:1536
  buffer_load_dwordx4 v11, s[56:59], s45 offen offset:3072 sc1 lds
  v_add_u32 v11, 2048, v11
  v_rcp_f32 v178, v178
  v_rcp_f32 v179, v179
  v_rcp_f32 v180, v180
  v_rcp_f32 v181, v181
  v_rcp_f32 v182, v182
  v_rcp_f32 v183, v183
  v_mfma_f32_32x32x16_bf16 v[128:143], v[232:235], v[216:219], v[128:143]
  s_add_u32 m0, s49, 73728
  s_nop 0
  buffer_load_dwordx4 v12, s[12:15], 0 offen lds
  v_mul_f32 v160, v160, v176
  v_mul_f32 v161, v161, v177
  v_mul_f32 v162, v162, v178
  v_mul_f32 v163, v163, v179
  v_mul_f32 v164, v164, v180
  v_mfma_f32_32x32x16_bf16 v[80:95], v[236:239], v[220:223], v[80:95]
  buffer_load_dwordx4 v12, s[12:15], s46 offen offset:1024 lds
  v_add_u32 v12, 262144, v12
  v_mul_f32 v165, v165, v181
  v_mul_f32 v166, v166, v182
  v_mul_f32 v167, v167, v183
  v_mfma_f32_32x32x16_bf16 v[144:159], v[236:239], v[216:219], v[144:159]
  v_cvt_pk_bf16_f32 v184, v160, v161
  v_cvt_pk_bf16_f32 v185, v162, v163
  v_cvt_pk_bf16_f32 v186, v164, v165
  v_cvt_pk_bf16_f32 v187, v166, v167
  s_nop 1
  v_permlane32_swap_b32 v184, v186
  v_permlane32_swap_b32 v185, v187
  s_add_u32 s4, s37, 6144
  buffer_store_dwordx4 v[184:187], v10, s[96:99], s4 offen sc1
  s_waitcnt lgkmcnt(0)
  v_mfma_f32_32x32x16_bf16 v[32:47], v[200:203], v[196:199], v[32:47]
  ds_read_b64_tr_b16 v[224:225], v4 offset:4096
  ds_read_b64_tr_b16 v[226:227], v4 offset:5120
  v_accvgpr_read_b32 v160, a112
  v_accvgpr_read_b32 v161, a113
  v_accvgpr_read_b32 v162, a114
  v_accvgpr_read_b32 v163, a115
  v_accvgpr_read_b32 v164, a116
  v_mfma_f32_32x32x16_bf16 v[96:111], v[200:203], v[192:195], v[96:111]
  ds_read_b128 v[216:219], v3 offset:1024
  ds_read_b128 v[220:223], v3 offset:3072
  v_accvgpr_read_b32 v165, a117
  v_accvgpr_read_b32 v166, a118
  v_accvgpr_read_b32 v167, a119
  v_mul_f32 v176, v160, v160
  v_mul_f32 v177, v161, v161
  v_mul_f32 v178, v162, v162
  v_mfma_f32_32x32x16_bf16 v[48:63], v[204:207], v[196:199], v[48:63]
  ds_read_b64_tr_b16 v[228:229], v5 offset:4096
  ds_read_b64_tr_b16 v[230:231], v5 offset:5120
  v_mul_f32 v179, v163, v163
  v_mul_f32 v180, v164, v164
  v_mul_f32 v181, v165, v165
  v_mul_f32 v182, v166, v166
  v_mul_f32 v183, v167, v167
  v_mfma_f32_32x32x16_bf16 v[112:127], v[204:207], v[192:195], v[112:127]
  ds_read_b64_tr_b16 v[232:233], v4 offset:4608
  ds_read_b64_tr_b16 v[234:235], v4 offset:5632
  v_accvgpr_read_b32 v168, a240
  v_accvgpr_read_b32 v169, a241
  v_accvgpr_read_b32 v170, a242
  v_accvgpr_read_b32 v171, a243
  v_accvgpr_read_b32 v172, a244
  v_accvgpr_read_b32 v173, a245
  v_mfma_f32_32x32x16_bf16 v[64:79], v[208:211], v[196:199], v[64:79]
  ds_read_b64_tr_b16 v[236:237], v5 offset:4608
  ds_read_b64_tr_b16 v[238:239], v5 offset:5632
  v_accvgpr_read_b32 v174, a246
  v_accvgpr_read_b32 v175, a247
  v_fma_f32 v176, v176, s101, v29
  v_fma_f32 v177, v177, s101, v29
  v_fma_f32 v178, v178, s101, v29
  v_mfma_f32_32x32x16_bf16 v[128:143], v[208:211], v[192:195], v[128:143]
  v_fma_f32 v179, v179, s101, v29
  v_fma_f32 v180, v180, s101, v29
  v_fma_f32 v181, v181, s101, v29
  v_fma_f32 v182, v182, s101, v29
  v_fma_f32 v183, v183, s101, v29
  v_mul_f32 v176, v160, v176
  v_mfma_f32_32x32x16_bf16 v[80:95], v[212:215], v[196:199], v[80:95]
  v_mul_f32 v177, v161, v177
  v_mul_f32 v178, v162, v178
  v_mul_f32 v179, v163, v179
  v_mul_f32 v180, v164, v180
  v_mul_f32 v181, v165, v181
  v_mfma_f32_32x32x16_bf16 v[144:159], v[212:215], v[192:195], v[144:159]
  v_mul_f32 v182, v166, v182
  v_mul_f32 v183, v167, v183
  v_exp_f32 v176, v176
  v_mul_f32 v160, v160, v168
  v_exp_f32 v177, v177
  v_mul_f32 v161, v161, v169
  v_add_u32 v3, 49152, v7
  v_add_u32 v4, 49152, v8
  v_add_u32 v5, 49152, v9
  s_waitcnt vmcnt(8) lgkmcnt(0)
  s_barrier
  v_mfma_f32_32x32x16_bf16 v[32:47], v[224:227], v[220:223], v[32:47]
  ds_read_b64_tr_b16 v[200:201], v4 offset:0
  ds_read_b64_tr_b16 v[202:203], v4 offset:1024
  v_exp_f32 v178, v178
  v_mul_f32 v162, v162, v170
  v_exp_f32 v179, v179
  v_mul_f32 v163, v163, v171
  v_exp_f32 v180, v180
  v_mul_f32 v164, v164, v172
  v_mfma_f32_32x32x16_bf16 v[96:111], v[224:227], v[216:219], v[96:111]
  ds_read_b128 v[192:195], v3 offset:0
  ds_read_b128 v[196:199], v3 offset:2048
  s_add_u32 m0, s47, 0
  s_nop 0
  buffer_load_dwordx4 v11, s[56:59], 0 offen sc1 lds
  v_exp_f32 v181, v181
  v_mul_f32 v165, v165, v173
  v_exp_f32 v182, v182
  v_mul_f32 v166, v166, v174
  v_exp_f32 v183, v183
  v_mfma_f32_32x32x16_bf16 v[48:63], v[228:231], v[220:223], v[48:63]
  ds_read_b64_tr_b16 v[204:205], v5 offset:0
  ds_read_b64_tr_b16 v[206:207], v5 offset:1024
  buffer_load_dwordx4 v11, s[56:59], 0 offen offset:1024 sc1 lds
  v_mul_f32 v167, v167, v175
  v_add_f32 v176, 1.0, v176
  v_add_f32 v177, 1.0, v177
  v_add_f32 v178, 1.0, v178
  v_add_f32 v179, 1.0, v179
  v_add_f32 v180, 1.0, v180
  v_mfma_f32_32x32x16_bf16 v[112:127], v[228:231], v[216:219], v[112:127]
  ds_read_b64_tr_b16 v[208:209], v4 offset:512
  ds_read_b64_tr_b16 v[210:211], v4 offset:1536
  buffer_load_dwordx4 v11, s[56:59], s45 offen offset:2048 sc1 lds
  v_add_f32 v181, 1.0, v181
  v_add_f32 v182, 1.0, v182
  v_add_f32 v183, 1.0, v183
  v_rcp_f32 v176, v176
  v_rcp_f32 v177, v177
  v_mfma_f32_32x32x16_bf16 v[64:79], v[232:235], v[220:223], v[64:79]
  ds_read_b64_tr_b16 v[212:213], v5 offset:512
  ds_read_b64_tr_b16 v[214:215], v5 offset:1536
  buffer_load_dwordx4 v11, s[56:59], s45 offen offset:3072 sc1 lds
  v_add_u32 v11, 2048, v11
  v_rcp_f32 v178, v178
  v_rcp_f32 v179, v179
  v_rcp_f32 v180, v180
  v_rcp_f32 v181, v181
  v_rcp_f32 v182, v182
  v_rcp_f32 v183, v183
  v_mfma_f32_32x32x16_bf16 v[128:143], v[232:235], v[216:219], v[128:143]
  s_add_u32 m0, s49, 0
  s_nop 0
  buffer_load_dwordx4 v12, s[12:15], 0 offen lds
  v_mul_f32 v160, v160, v176
  v_mul_f32 v161, v161, v177
  v_mul_f32 v162, v162, v178
  v_mul_f32 v163, v163, v179
  v_mul_f32 v164, v164, v180
  v_mfma_f32_32x32x16_bf16 v[80:95], v[236:239], v[220:223], v[80:95]
  buffer_load_dwordx4 v12, s[12:15], s46 offen offset:1024 lds
  v_add_u32 v12, 262144, v12
  v_mul_f32 v165, v165, v181
  v_mul_f32 v166, v166, v182
  v_mul_f32 v167, v167, v183
  v_mfma_f32_32x32x16_bf16 v[144:159], v[236:239], v[216:219], v[144:159]
  v_cvt_pk_bf16_f32 v188, v160, v161
  v_cvt_pk_bf16_f32 v189, v162, v163
  v_cvt_pk_bf16_f32 v190, v164, v165
  v_cvt_pk_bf16_f32 v191, v166, v167
  s_nop 1
  v_permlane32_swap_b32 v188, v190
  v_permlane32_swap_b32 v189, v191
  s_add_u32 s4, s37, 7168
  buffer_store_dwordx4 v[188:191], v10, s[96:99], s4 offen sc1
  s_waitcnt lgkmcnt(0)
  v_mfma_f32_32x32x16_bf16 v[32:47], v[200:203], v[196:199], v[32:47]
  ds_read_b64_tr_b16 v[224:225], v4 offset:4096
  ds_read_b64_tr_b16 v[226:227], v4 offset:5120
  v_accvgpr_read_b32 v160, a8
  v_accvgpr_read_b32 v161, a9
  v_accvgpr_read_b32 v162, a10
  v_accvgpr_read_b32 v163, a11
  v_accvgpr_read_b32 v164, a12
  v_mfma_f32_32x32x16_bf16 v[96:111], v[200:203], v[192:195], v[96:111]
  ds_read_b128 v[216:219], v3 offset:1024
  ds_read_b128 v[220:223], v3 offset:3072
  v_accvgpr_read_b32 v165, a13
  v_accvgpr_read_b32 v166, a14
  v_accvgpr_read_b32 v167, a15
  v_mul_f32 v176, v160, v160
  v_mul_f32 v177, v161, v161
  v_mul_f32 v178, v162, v162
  v_mfma_f32_32x32x16_bf16 v[48:63], v[204:207], v[196:199], v[48:63]
  ds_read_b64_tr_b16 v[228:229], v5 offset:4096
  ds_read_b64_tr_b16 v[230:231], v5 offset:5120
  v_mul_f32 v179, v163, v163
  v_mul_f32 v180, v164, v164
  v_mul_f32 v181, v165, v165
  v_mul_f32 v182, v166, v166
  v_mul_f32 v183, v167, v167
  v_mfma_f32_32x32x16_bf16 v[112:127], v[204:207], v[192:195], v[112:127]
  ds_read_b64_tr_b16 v[232:233], v4 offset:4608
  ds_read_b64_tr_b16 v[234:235], v4 offset:5632
  v_accvgpr_read_b32 v168, a136
  v_accvgpr_read_b32 v169, a137
  v_accvgpr_read_b32 v170, a138
  v_accvgpr_read_b32 v171, a139
  v_accvgpr_read_b32 v172, a140
  v_accvgpr_read_b32 v173, a141
  v_mfma_f32_32x32x16_bf16 v[64:79], v[208:211], v[196:199], v[64:79]
  ds_read_b64_tr_b16 v[236:237], v5 offset:4608
  ds_read_b64_tr_b16 v[238:239], v5 offset:5632
  v_accvgpr_read_b32 v174, a142
  v_accvgpr_read_b32 v175, a143
  v_fma_f32 v176, v176, s101, v29
  v_fma_f32 v177, v177, s101, v29
  v_fma_f32 v178, v178, s101, v29
  v_mfma_f32_32x32x16_bf16 v[128:143], v[208:211], v[192:195], v[128:143]
  v_fma_f32 v179, v179, s101, v29
  v_fma_f32 v180, v180, s101, v29
  v_fma_f32 v181, v181, s101, v29
  v_fma_f32 v182, v182, s101, v29
  v_fma_f32 v183, v183, s101, v29
  v_mul_f32 v176, v160, v176
  v_mfma_f32_32x32x16_bf16 v[80:95], v[212:215], v[196:199], v[80:95]
  v_mul_f32 v177, v161, v177
  v_mul_f32 v178, v162, v178
  v_mul_f32 v179, v163, v179
  v_mul_f32 v180, v164, v180
  v_mul_f32 v181, v165, v181
  v_mfma_f32_32x32x16_bf16 v[144:159], v[212:215], v[192:195], v[144:159]
  v_mul_f32 v182, v166, v182
  v_mul_f32 v183, v167, v183
  v_exp_f32 v176, v176
  v_mul_f32 v160, v160, v168
  v_exp_f32 v177, v177
  v_mul_f32 v161, v161, v169
  v_and_b32 v17, 7, v1
  v_lshlrev_b32 v17, 2, v17
  v_lshrrev_b32 v30, 3, v1
  v_and_b32 v30, 1, v30
  v_lshlrev_b32 v30, 9, v30
  v_add_u32 v17, v17, v30
  s_lshr_b32 s5, s50, 1
  s_lshl_b32 s5, s5, 5
  s_add_u32 s100, s5, 1024
  buffer_load_dword v30, v17, s[8:11], s100 offen sc1
  v_add_u32 v3, 73728, v7
  v_add_u32 v4, 73728, v8
  v_add_u32 v5, 73728, v9
  s_waitcnt vmcnt(9) lgkmcnt(0)
  s_barrier
  v_mfma_f32_32x32x16_bf16 v[32:47], v[224:227], v[220:223], v[32:47]
  ds_read_b64_tr_b16 v[200:201], v4 offset:0
  ds_read_b64_tr_b16 v[202:203], v4 offset:1024
  v_exp_f32 v178, v178
  v_mul_f32 v162, v162, v170
  v_exp_f32 v179, v179
  v_mul_f32 v163, v163, v171
  v_exp_f32 v180, v180
  v_mul_f32 v164, v164, v172
  v_mfma_f32_32x32x16_bf16 v[96:111], v[224:227], v[216:219], v[96:111]
  ds_read_b128 v[192:195], v3 offset:0
  ds_read_b128 v[196:199], v3 offset:2048
  s_add_u32 m0, s47, 24576
  s_nop 0
  buffer_load_dwordx4 v11, s[56:59], 0 offen sc1 lds
  v_exp_f32 v181, v181
  v_mul_f32 v165, v165, v173
  v_exp_f32 v182, v182
  v_mul_f32 v166, v166, v174
  v_exp_f32 v183, v183
  v_mfma_f32_32x32x16_bf16 v[48:63], v[228:231], v[220:223], v[48:63]
  ds_read_b64_tr_b16 v[204:205], v5 offset:0
  ds_read_b64_tr_b16 v[206:207], v5 offset:1024
  buffer_load_dwordx4 v11, s[56:59], 0 offen offset:1024 sc1 lds
  v_mul_f32 v167, v167, v175
  v_add_f32 v176, 1.0, v176
  v_add_f32 v177, 1.0, v177
  v_add_f32 v178, 1.0, v178
  v_add_f32 v179, 1.0, v179
  v_add_f32 v180, 1.0, v180
  v_mfma_f32_32x32x16_bf16 v[112:127], v[228:231], v[216:219], v[112:127]
  ds_read_b64_tr_b16 v[208:209], v4 offset:512
  ds_read_b64_tr_b16 v[210:211], v4 offset:1536
  buffer_load_dwordx4 v11, s[56:59], s45 offen offset:2048 sc1 lds
  v_add_f32 v181, 1.0, v181
  v_add_f32 v182, 1.0, v182
  v_add_f32 v183, 1.0, v183
  v_rcp_f32 v176, v176
  v_rcp_f32 v177, v177
  v_mfma_f32_32x32x16_bf16 v[64:79], v[232:235], v[220:223], v[64:79]
  ds_read_b64_tr_b16 v[212:213], v5 offset:512
  ds_read_b64_tr_b16 v[214:215], v5 offset:1536
  buffer_load_dwordx4 v11, s[56:59], s45 offen offset:3072 sc1 lds
  v_add_u32 v11, 2048, v11
  v_rcp_f32 v178, v178
  v_rcp_f32 v179, v179
  v_rcp_f32 v180, v180
  v_rcp_f32 v181, v181
  v_rcp_f32 v182, v182
  v_rcp_f32 v183, v183
  v_mfma_f32_32x32x16_bf16 v[128:143], v[232:235], v[216:219], v[128:143]
  s_add_u32 m0, s49, 24576
  s_nop 0
  buffer_load_dwordx4 v12, s[12:15], 0 offen lds
  v_mul_f32 v160, v160, v176
  v_mul_f32 v161, v161, v177
  v_mul_f32 v162, v162, v178
  v_mul_f32 v163, v163, v179
  v_mul_f32 v164, v164, v180
  v_mfma_f32_32x32x16_bf16 v[80:95], v[236:239], v[220:223], v[80:95]
  buffer_load_dwordx4 v12, s[12:15], s46 offen offset:1024 lds
  v_add_u32 v12, 262144, v12
  v_mul_f32 v165, v165, v181
  v_mul_f32 v166, v166, v182
  v_mul_f32 v167, v167, v183
  v_mfma_f32_32x32x16_bf16 v[144:159], v[236:239], v[216:219], v[144:159]
  v_cvt_pk_bf16_f32 v184, v160, v161
  v_cvt_pk_bf16_f32 v185, v162, v163
  v_cvt_pk_bf16_f32 v186, v164, v165
  v_cvt_pk_bf16_f32 v187, v166, v167
  s_nop 1
  v_permlane32_swap_b32 v184, v186
  v_permlane32_swap_b32 v185, v187
  s_add_u32 s4, s37, 557056
  buffer_store_dwordx4 v[184:187], v10, s[96:99], s4 offen sc1
  s_waitcnt lgkmcnt(0)
  v_mfma_f32_32x32x16_bf16 v[32:47], v[200:203], v[196:199], v[32:47]
  ds_read_b64_tr_b16 v[224:225], v4 offset:4096
  ds_read_b64_tr_b16 v[226:227], v4 offset:5120
  v_accvgpr_read_b32 v160, a24
  v_accvgpr_read_b32 v161, a25
  v_accvgpr_read_b32 v162, a26
  v_accvgpr_read_b32 v163, a27
  v_accvgpr_read_b32 v164, a28
  v_mfma_f32_32x32x16_bf16 v[96:111], v[200:203], v[192:195], v[96:111]
  ds_read_b128 v[216:219], v3 offset:1024
  ds_read_b128 v[220:223], v3 offset:3072
  v_accvgpr_read_b32 v165, a29
  v_accvgpr_read_b32 v166, a30
  v_accvgpr_read_b32 v167, a31
  v_mul_f32 v176, v160, v160
  v_mul_f32 v177, v161, v161
  v_mul_f32 v178, v162, v162
  v_mfma_f32_32x32x16_bf16 v[48:63], v[204:207], v[196:199], v[48:63]
  ds_read_b64_tr_b16 v[228:229], v5 offset:4096
  ds_read_b64_tr_b16 v[230:231], v5 offset:5120
  v_mul_f32 v179, v163, v163
  v_mul_f32 v180, v164, v164
  v_mul_f32 v181, v165, v165
  v_mul_f32 v182, v166, v166
  v_mul_f32 v183, v167, v167
  v_mfma_f32_32x32x16_bf16 v[112:127], v[204:207], v[192:195], v[112:127]
  ds_read_b64_tr_b16 v[232:233], v4 offset:4608
  ds_read_b64_tr_b16 v[234:235], v4 offset:5632
  v_accvgpr_read_b32 v168, a152
  v_accvgpr_read_b32 v169, a153
  v_accvgpr_read_b32 v170, a154
  v_accvgpr_read_b32 v171, a155
  v_accvgpr_read_b32 v172, a156
  v_accvgpr_read_b32 v173, a157
  v_mfma_f32_32x32x16_bf16 v[64:79], v[208:211], v[196:199], v[64:79]
  ds_read_b64_tr_b16 v[236:237], v5 offset:4608
  ds_read_b64_tr_b16 v[238:239], v5 offset:5632
  v_accvgpr_read_b32 v174, a158
  v_accvgpr_read_b32 v175, a159
  v_fma_f32 v176, v176, s101, v29
  v_fma_f32 v177, v177, s101, v29
  v_fma_f32 v178, v178, s101, v29
  v_mfma_f32_32x32x16_bf16 v[128:143], v[208:211], v[192:195], v[128:143]
  v_fma_f32 v179, v179, s101, v29
  v_fma_f32 v180, v180, s101, v29
  v_fma_f32 v181, v181, s101, v29
  v_fma_f32 v182, v182, s101, v29
  v_fma_f32 v183, v183, s101, v29
  v_mul_f32 v176, v160, v176
  v_mfma_f32_32x32x16_bf16 v[80:95], v[212:215], v[196:199], v[80:95]
  v_mul_f32 v177, v161, v177
  v_mul_f32 v178, v162, v178
  v_mul_f32 v179, v163, v179
  v_mul_f32 v180, v164, v180
  v_mul_f32 v181, v165, v181
  v_mfma_f32_32x32x16_bf16 v[144:159], v[212:215], v[192:195], v[144:159]
  v_mul_f32 v182, v166, v182
  v_mul_f32 v183, v167, v183
  v_exp_f32 v176, v176
  v_mul_f32 v160, v160, v168
  v_exp_f32 v177, v177
  v_mul_f32 v161, v161, v169
  v_add_u32 v3, 0, v7
  v_add_u32 v4, 0, v8
  v_add_u32 v5, 0, v9
  s_waitcnt vmcnt(9) lgkmcnt(0)
  s_barrier
  v_mfma_f32_32x32x16_bf16 v[32:47], v[224:227], v[220:223], v[32:47]
  ds_read_b64_tr_b16 v[200:201], v4 offset:0
  ds_read_b64_tr_b16 v[202:203], v4 offset:1024
  v_exp_f32 v178, v178
  v_mul_f32 v162, v162, v170
  v_exp_f32 v179, v179
  v_mul_f32 v163, v163, v171
  v_exp_f32 v180, v180
  v_mul_f32 v164, v164, v172
  v_mfma_f32_32x32x16_bf16 v[96:111], v[224:227], v[216:219], v[96:111]
  ds_read_b128 v[192:195], v3 offset:0
  ds_read_b128 v[196:199], v3 offset:2048
  s_add_u32 m0, s47, 49152
  s_nop 0
  buffer_load_dwordx4 v11, s[56:59], 0 offen sc1 lds
  v_exp_f32 v181, v181
  v_mul_f32 v165, v165, v173
  v_exp_f32 v182, v182
  v_mul_f32 v166, v166, v174
  v_exp_f32 v183, v183
  v_mfma_f32_32x32x16_bf16 v[48:63], v[228:231], v[220:223], v[48:63]
  ds_read_b64_tr_b16 v[204:205], v5 offset:0
  ds_read_b64_tr_b16 v[206:207], v5 offset:1024
  buffer_load_dwordx4 v11, s[56:59], 0 offen offset:1024 sc1 lds
  v_mul_f32 v167, v167, v175
  v_add_f32 v176, 1.0, v176
  v_add_f32 v177, 1.0, v177
  v_add_f32 v178, 1.0, v178
  v_add_f32 v179, 1.0, v179
  v_add_f32 v180, 1.0, v180
  v_mfma_f32_32x32x16_bf16 v[112:127], v[228:231], v[216:219], v[112:127]
  ds_read_b64_tr_b16 v[208:209], v4 offset:512
  ds_read_b64_tr_b16 v[210:211], v4 offset:1536
  buffer_load_dwordx4 v11, s[56:59], s45 offen offset:2048 sc1 lds
  v_add_f32 v181, 1.0, v181
  v_add_f32 v182, 1.0, v182
  v_add_f32 v183, 1.0, v183
  v_rcp_f32 v176, v176
  v_rcp_f32 v177, v177
  v_mfma_f32_32x32x16_bf16 v[64:79], v[232:235], v[220:223], v[64:79]
  ds_read_b64_tr_b16 v[212:213], v5 offset:512
  ds_read_b64_tr_b16 v[214:215], v5 offset:1536
  buffer_load_dwordx4 v11, s[56:59], s45 offen offset:3072 sc1 lds
  v_add_u32 v11, 2048, v11
  v_rcp_f32 v178, v178
  v_rcp_f32 v179, v179
  v_rcp_f32 v180, v180
  v_rcp_f32 v181, v181
  v_rcp_f32 v182, v182
  v_rcp_f32 v183, v183
  v_mfma_f32_32x32x16_bf16 v[128:143], v[232:235], v[216:219], v[128:143]
  s_add_u32 m0, s49, 49152
  s_nop 0
  buffer_load_dwordx4 v12, s[12:15], 0 offen lds
  v_mul_f32 v160, v160, v176
  v_mul_f32 v161, v161, v177
  v_mul_f32 v162, v162, v178
  v_mul_f32 v163, v163, v179
  v_mul_f32 v164, v164, v180
  v_mfma_f32_32x32x16_bf16 v[80:95], v[236:239], v[220:223], v[80:95]
  buffer_load_dwordx4 v12, s[12:15], s46 offen offset:1024 lds
  v_add_u32 v12, 262144, v12
  v_mul_f32 v165, v165, v181
  v_mul_f32 v166, v166, v182
  v_mul_f32 v167, v167, v183
  v_mfma_f32_32x32x16_bf16 v[144:159], v[236:239], v[216:219], v[144:159]
  v_cvt_pk_bf16_f32 v188, v160, v161
  v_cvt_pk_bf16_f32 v189, v162, v163
  v_cvt_pk_bf16_f32 v190, v164, v165
  v_cvt_pk_bf16_f32 v191, v166, v167
  s_nop 1
  v_permlane32_swap_b32 v188, v190
  v_permlane32_swap_b32 v189, v191
  s_add_u32 s4, s37, 558080
  buffer_store_dwordx4 v[188:191], v10, s[96:99], s4 offen sc1
  s_waitcnt lgkmcnt(0)
  v_mfma_f32_32x32x16_bf16 v[32:47], v[200:203], v[196:199], v[32:47]
  ds_read_b64_tr_b16 v[224:225], v4 offset:4096
  ds_read_b64_tr_b16 v[226:227], v4 offset:5120
  v_accvgpr_read_b32 v160, a40
  v_accvgpr_read_b32 v161, a41
  v_accvgpr_read_b32 v162, a42
  v_accvgpr_read_b32 v163, a43
  v_accvgpr_read_b32 v164, a44
  v_mfma_f32_32x32x16_bf16 v[96:111], v[200:203], v[192:195], v[96:111]
  ds_read_b128 v[216:219], v3 offset:1024
  ds_read_b128 v[220:223], v3 offset:3072
  v_accvgpr_read_b32 v165, a45
  v_accvgpr_read_b32 v166, a46
  v_accvgpr_read_b32 v167, a47
  v_mul_f32 v176, v160, v160
  v_mul_f32 v177, v161, v161
  v_mul_f32 v178, v162, v162
  v_mfma_f32_32x32x16_bf16 v[48:63], v[204:207], v[196:199], v[48:63]
  ds_read_b64_tr_b16 v[228:229], v5 offset:4096
  ds_read_b64_tr_b16 v[230:231], v5 offset:5120
  v_mul_f32 v179, v163, v163
  v_mul_f32 v180, v164, v164
  v_mul_f32 v181, v165, v165
  v_mul_f32 v182, v166, v166
  v_mul_f32 v183, v167, v167
  v_mfma_f32_32x32x16_bf16 v[112:127], v[204:207], v[192:195], v[112:127]
  ds_read_b64_tr_b16 v[232:233], v4 offset:4608
  ds_read_b64_tr_b16 v[234:235], v4 offset:5632
  v_accvgpr_read_b32 v168, a168
  v_accvgpr_read_b32 v169, a169
  v_accvgpr_read_b32 v170, a170
  v_accvgpr_read_b32 v171, a171
  v_accvgpr_read_b32 v172, a172
  v_accvgpr_read_b32 v173, a173
  v_mfma_f32_32x32x16_bf16 v[64:79], v[208:211], v[196:199], v[64:79]
  ds_read_b64_tr_b16 v[236:237], v5 offset:4608
  ds_read_b64_tr_b16 v[238:239], v5 offset:5632
  v_accvgpr_read_b32 v174, a174
  v_accvgpr_read_b32 v175, a175
  v_fma_f32 v176, v176, s101, v29
  v_fma_f32 v177, v177, s101, v29
  v_fma_f32 v178, v178, s101, v29
  v_mfma_f32_32x32x16_bf16 v[128:143], v[208:211], v[192:195], v[128:143]
  v_fma_f32 v179, v179, s101, v29
  v_fma_f32 v180, v180, s101, v29
  v_fma_f32 v181, v181, s101, v29
  v_fma_f32 v182, v182, s101, v29
  v_fma_f32 v183, v183, s101, v29
  v_mul_f32 v176, v160, v176
  v_mfma_f32_32x32x16_bf16 v[80:95], v[212:215], v[196:199], v[80:95]
  v_mul_f32 v177, v161, v177
  v_mul_f32 v178, v162, v178
  v_mul_f32 v179, v163, v179
  v_mul_f32 v180, v164, v180
  v_mul_f32 v181, v165, v181
  v_mfma_f32_32x32x16_bf16 v[144:159], v[212:215], v[192:195], v[144:159]
  v_mul_f32 v182, v166, v182
  v_mul_f32 v183, v167, v183
  v_exp_f32 v176, v176
  v_mul_f32 v160, v160, v168
  v_exp_f32 v177, v177
  v_mul_f32 v161, v161, v169
  v_add_u32 v3, 24576, v7
  v_add_u32 v4, 24576, v8
  v_add_u32 v5, 24576, v9
  s_waitcnt vmcnt(8) lgkmcnt(0)
  s_barrier
  v_mfma_f32_32x32x16_bf16 v[32:47], v[224:227], v[220:223], v[32:47]
  ds_read_b64_tr_b16 v[200:201], v4 offset:0
  ds_read_b64_tr_b16 v[202:203], v4 offset:1024
  v_exp_f32 v178, v178
  v_mul_f32 v162, v162, v170
  v_exp_f32 v179, v179
  v_mul_f32 v163, v163, v171
  v_exp_f32 v180, v180
  v_mul_f32 v164, v164, v172
  v_mfma_f32_32x32x16_bf16 v[96:111], v[224:227], v[216:219], v[96:111]
  ds_read_b128 v[192:195], v3 offset:0
  ds_read_b128 v[196:199], v3 offset:2048
  s_add_u32 m0, s47, 73728
  s_nop 0
  buffer_load_dwordx4 v11, s[56:59], 0 offen sc1 lds
  v_exp_f32 v181, v181
  v_mul_f32 v165, v165, v173
  v_exp_f32 v182, v182
  v_mul_f32 v166, v166, v174
  v_exp_f32 v183, v183
  v_mfma_f32_32x32x16_bf16 v[48:63], v[228:231], v[220:223], v[48:63]
  ds_read_b64_tr_b16 v[204:205], v5 offset:0
  ds_read_b64_tr_b16 v[206:207], v5 offset:1024
  buffer_load_dwordx4 v11, s[56:59], 0 offen offset:1024 sc1 lds
  v_mul_f32 v167, v167, v175
  v_add_f32 v176, 1.0, v176
  v_add_f32 v177, 1.0, v177
  v_add_f32 v178, 1.0, v178
  v_add_f32 v179, 1.0, v179
  v_add_f32 v180, 1.0, v180
  v_mfma_f32_32x32x16_bf16 v[112:127], v[228:231], v[216:219], v[112:127]
  ds_read_b64_tr_b16 v[208:209], v4 offset:512
  ds_read_b64_tr_b16 v[210:211], v4 offset:1536
  buffer_load_dwordx4 v11, s[56:59], s45 offen offset:2048 sc1 lds
  v_add_f32 v181, 1.0, v181
  v_add_f32 v182, 1.0, v182
  v_add_f32 v183, 1.0, v183
  v_rcp_f32 v176, v176
  v_rcp_f32 v177, v177
  v_mfma_f32_32x32x16_bf16 v[64:79], v[232:235], v[220:223], v[64:79]
  ds_read_b64_tr_b16 v[212:213], v5 offset:512
  ds_read_b64_tr_b16 v[214:215], v5 offset:1536
  buffer_load_dwordx4 v11, s[56:59], s45 offen offset:3072 sc1 lds
  v_add_u32 v11, 2048, v11
  v_rcp_f32 v178, v178
  v_rcp_f32 v179, v179
  v_rcp_f32 v180, v180
  v_rcp_f32 v181, v181
  v_rcp_f32 v182, v182
  v_rcp_f32 v183, v183
  v_mfma_f32_32x32x16_bf16 v[128:143], v[232:235], v[216:219], v[128:143]
  s_add_u32 m0, s49, 73728
  s_nop 0
  buffer_load_dwordx4 v12, s[12:15], 0 offen lds
  v_mul_f32 v160, v160, v176
  v_mul_f32 v161, v161, v177
  v_mul_f32 v162, v162, v178
  v_mul_f32 v163, v163, v179
  v_mul_f32 v164, v164, v180
  v_mfma_f32_32x32x16_bf16 v[80:95], v[236:239], v[220:223], v[80:95]
  buffer_load_dwordx4 v12, s[12:15], s46 offen offset:1024 lds
  v_add_u32 v12, 262144, v12
  v_mul_f32 v165, v165, v181
  v_mul_f32 v166, v166, v182
  v_mul_f32 v167, v167, v183
  v_mfma_f32_32x32x16_bf16 v[144:159], v[236:239], v[216:219], v[144:159]
  v_cvt_pk_bf16_f32 v184, v160, v161
  v_cvt_pk_bf16_f32 v185, v162, v163
  v_cvt_pk_bf16_f32 v186, v164, v165
  v_cvt_pk_bf16_f32 v187, v166, v167
  s_nop 1
  v_permlane32_swap_b32 v184, v186
  v_permlane32_swap_b32 v185, v187
  s_add_u32 s4, s37, 559104
  buffer_store_dwordx4 v[184:187], v10, s[96:99], s4 offen sc1
  s_waitcnt lgkmcnt(0)
  v_mfma_f32_32x32x16_bf16 v[32:47], v[200:203], v[196:199], v[32:47]
  ds_read_b64_tr_b16 v[224:225], v4 offset:4096
  ds_read_b64_tr_b16 v[226:227], v4 offset:5120
  v_accvgpr_read_b32 v160, a56
  v_accvgpr_read_b32 v161, a57
  v_accvgpr_read_b32 v162, a58
  v_accvgpr_read_b32 v163, a59
  v_accvgpr_read_b32 v164, a60
  v_mfma_f32_32x32x16_bf16 v[96:111], v[200:203], v[192:195], v[96:111]
  ds_read_b128 v[216:219], v3 offset:1024
  ds_read_b128 v[220:223], v3 offset:3072
  v_accvgpr_read_b32 v165, a61
  v_accvgpr_read_b32 v166, a62
  v_accvgpr_read_b32 v167, a63
  v_mul_f32 v176, v160, v160
  v_mul_f32 v177, v161, v161
  v_mul_f32 v178, v162, v162
  v_mfma_f32_32x32x16_bf16 v[48:63], v[204:207], v[196:199], v[48:63]
  ds_read_b64_tr_b16 v[228:229], v5 offset:4096
  ds_read_b64_tr_b16 v[230:231], v5 offset:5120
  v_mul_f32 v179, v163, v163
  v_mul_f32 v180, v164, v164
  v_mul_f32 v181, v165, v165
  v_mul_f32 v182, v166, v166
  v_mul_f32 v183, v167, v167
  v_mfma_f32_32x32x16_bf16 v[112:127], v[204:207], v[192:195], v[112:127]
  ds_read_b64_tr_b16 v[232:233], v4 offset:4608
  ds_read_b64_tr_b16 v[234:235], v4 offset:5632
  v_accvgpr_read_b32 v168, a184
  v_accvgpr_read_b32 v169, a185
  v_accvgpr_read_b32 v170, a186
  v_accvgpr_read_b32 v171, a187
  v_accvgpr_read_b32 v172, a188
  v_accvgpr_read_b32 v173, a189
  v_mfma_f32_32x32x16_bf16 v[64:79], v[208:211], v[196:199], v[64:79]
  ds_read_b64_tr_b16 v[236:237], v5 offset:4608
  ds_read_b64_tr_b16 v[238:239], v5 offset:5632
  v_accvgpr_read_b32 v174, a190
  v_accvgpr_read_b32 v175, a191
  v_fma_f32 v176, v176, s101, v29
  v_fma_f32 v177, v177, s101, v29
  v_fma_f32 v178, v178, s101, v29
  v_mfma_f32_32x32x16_bf16 v[128:143], v[208:211], v[192:195], v[128:143]
  v_fma_f32 v179, v179, s101, v29
  v_fma_f32 v180, v180, s101, v29
  v_fma_f32 v181, v181, s101, v29
  v_fma_f32 v182, v182, s101, v29
  v_fma_f32 v183, v183, s101, v29
  v_mul_f32 v176, v160, v176
  v_mfma_f32_32x32x16_bf16 v[80:95], v[212:215], v[196:199], v[80:95]
  v_mul_f32 v177, v161, v177
  v_mul_f32 v178, v162, v178
  v_mul_f32 v179, v163, v179
  v_mul_f32 v180, v164, v180
  v_mul_f32 v181, v165, v181
  v_mfma_f32_32x32x16_bf16 v[144:159], v[212:215], v[192:195], v[144:159]
  v_mul_f32 v182, v166, v182
  v_mul_f32 v183, v167, v183
  v_exp_f32 v176, v176
  v_mul_f32 v160, v160, v168
  v_exp_f32 v177, v177
  v_mul_f32 v161, v161, v169
  v_add_u32 v3, 49152, v7
  v_add_u32 v4, 49152, v8
  v_add_u32 v5, 49152, v9
  s_waitcnt vmcnt(8) lgkmcnt(0)
  s_barrier
  s_mov_b32 s6, 0xffff
  s_mov_b32 s7, 0x0
  s_mov_b32 s5, 100000
LFL3:
  v_cmp_ne_u32 vcc, s88, v30
  s_nop 1
  s_and_b64 vcc, vcc, s[6:7]
  s_cbranch_vccz LFL3_ok
  s_sub_u32 s5, s5, 1
  s_cmp_eq_u32 s5, 0
  s_cbranch_scc1 LFL3_ok
  s_sleep 1
  buffer_load_dword v30, v17, s[8:11], s100 offen sc1
  s_waitcnt vmcnt(0)
  s_branch LFL3
LFL3_ok:
  v_mfma_f32_32x32x16_bf16 v[32:47], v[224:227], v[220:223], v[32:47]
  ds_read_b64_tr_b16 v[200:201], v4 offset:0
  ds_read_b64_tr_b16 v[202:203], v4 offset:1024
  v_exp_f32 v178, v178
  v_mul_f32 v162, v162, v170
  v_exp_f32 v179, v179
  v_mul_f32 v163, v163, v171
  v_exp_f32 v180, v180
  v_mul_f32 v164, v164, v172
  v_mfma_f32_32x32x16_bf16 v[96:111], v[224:227], v[216:219], v[96:111]
  ds_read_b128 v[192:195], v3 offset:0
  ds_read_b128 v[196:199], v3 offset:2048
  s_add_u32 m0, s47, 0
  s_nop 0
  buffer_load_dwordx4 v11, s[56:59], 0 offen sc1 lds
  v_exp_f32 v181, v181
  v_mul_f32 v165, v165, v173
  v_exp_f32 v182, v182
  v_mul_f32 v166, v166, v174
  v_exp_f32 v183, v183
  v_mfma_f32_32x32x16_bf16 v[48:63], v[228:231], v[220:223], v[48:63]
  ds_read_b64_tr_b16 v[204:205], v5 offset:0
  ds_read_b64_tr_b16 v[206:207], v5 offset:1024
  buffer_load_dwordx4 v11, s[56:59], 0 offen offset:1024 sc1 lds
  v_mul_f32 v167, v167, v175
  v_add_f32 v176, 1.0, v176
  v_add_f32 v177, 1.0, v177
  v_add_f32 v178, 1.0, v178
  v_add_f32 v179, 1.0, v179
  v_add_f32 v180, 1.0, v180
  v_mfma_f32_32x32x16_bf16 v[112:127], v[228:231], v[216:219], v[112:127]
  ds_read_b64_tr_b16 v[208:209], v4 offset:512
  ds_read_b64_tr_b16 v[210:211], v4 offset:1536
  buffer_load_dwordx4 v11, s[56:59], s45 offen offset:2048 sc1 lds
  v_add_f32 v181, 1.0, v181
  v_add_f32 v182, 1.0, v182
  v_add_f32 v183, 1.0, v183
  v_rcp_f32 v176, v176
  v_rcp_f32 v177, v177
  v_mfma_f32_32x32x16_bf16 v[64:79], v[232:235], v[220:223], v[64:79]
  ds_read_b64_tr_b16 v[212:213], v5 offset:512
  ds_read_b64_tr_b16 v[214:215], v5 offset:1536
  buffer_load_dwordx4 v11, s[56:59], s45 offen offset:3072 sc1 lds
  v_add_u32 v11, 2048, v11
  v_rcp_f32 v178, v178
  v_rcp_f32 v179, v179
  v_rcp_f32 v180, v180
  v_rcp_f32 v181, v181
  v_rcp_f32 v182, v182
  v_rcp_f32 v183, v183
  v_mfma_f32_32x32x16_bf16 v[128:143], v[232:235], v[216:219], v[128:143]
  s_add_u32 m0, s49, 0
  s_nop 0
  buffer_load_dwordx4 v12, s[12:15], 0 offen lds
  v_mul_f32 v160, v160, v176
  v_mul_f32 v161, v161, v177
  v_mul_f32 v162, v162, v178
  v_mul_f32 v163, v163, v179
  v_mul_f32 v164, v164, v180
  v_mfma_f32_32x32x16_bf16 v[80:95], v[236:239], v[220:223], v[80:95]
  buffer_load_dwordx4 v12, s[12:15], s46 offen offset:1024 lds
  v_add_u32 v12, 262144, v12
  v_mul_f32 v165, v165, v181
  v_mul_f32 v166, v166, v182
  v_mul_f32 v167, v167, v183
  v_mfma_f32_32x32x16_bf16 v[144:159], v[236:239], v[216:219], v[144:159]
  v_cvt_pk_bf16_f32 v188, v160, v161
  v_cvt_pk_bf16_f32 v189, v162, v163
  v_cvt_pk_bf16_f32 v190, v164, v165
  v_cvt_pk_bf16_f32 v191, v166, v167
  s_nop 1
  v_permlane32_swap_b32 v188, v190
  v_permlane32_swap_b32 v189, v191
  s_add_u32 s4, s37, 560128
  buffer_store_dwordx4 v[188:191], v10, s[96:99], s4 offen sc1
  s_waitcnt lgkmcnt(0)
  v_mfma_f32_32x32x16_bf16 v[32:47], v[200:203], v[196:199], v[32:47]
  ds_read_b64_tr_b16 v[224:225], v4 offset:4096
  ds_read_b64_tr_b16 v[226:227], v4 offset:5120
  v_accvgpr_read_b32 v160, a72
  v_accvgpr_read_b32 v161, a73
  v_accvgpr_read_b32 v162, a74
  v_accvgpr_read_b32 v163, a75
  v_accvgpr_read_b32 v164, a76
  v_mfma_f32_32x32x16_bf16 v[96:111], v[200:203], v[192:195], v[96:111]
  ds_read_b128 v[216:219], v3 offset:1024
  ds_read_b128 v[220:223], v3 offset:3072
  v_accvgpr_read_b32 v165, a77
  v_accvgpr_read_b32 v166, a78
  v_accvgpr_read_b32 v167, a79
  v_mul_f32 v176, v160, v160
  v_mul_f32 v177, v161, v161
  v_mul_f32 v178, v162, v162
  v_mfma_f32_32x32x16_bf16 v[48:63], v[204:207], v[196:199], v[48:63]
  ds_read_b64_tr_b16 v[228:229], v5 offset:4096
  ds_read_b64_tr_b16 v[230:231], v5 offset:5120
  v_mul_f32 v179, v163, v163
  v_mul_f32 v180, v164, v164
  v_mul_f32 v181, v165, v165
  v_mul_f32 v182, v166, v166
  v_mul_f32 v183, v167, v167
  v_mfma_f32_32x32x16_bf16 v[112:127], v[204:207], v[192:195], v[112:127]
  ds_read_b64_tr_b16 v[232:233], v4 offset:4608
  ds_read_b64_tr_b16 v[234:235], v4 offset:5632
  v_accvgpr_read_b32 v168, a200
  v_accvgpr_read_b32 v169, a201
  v_accvgpr_read_b32 v170, a202
  v_accvgpr_read_b32 v171, a203
  v_accvgpr_read_b32 v172, a204
  v_accvgpr_read_b32 v173, a205
  v_mfma_f32_32x32x16_bf16 v[64:79], v[208:211], v[196:199], v[64:79]
  ds_read_b64_tr_b16 v[236:237], v5 offset:4608
  ds_read_b64_tr_b16 v[238:239], v5 offset:5632
  v_accvgpr_read_b32 v174, a206
  v_accvgpr_read_b32 v175, a207
  v_fma_f32 v176, v176, s101, v29
  v_fma_f32 v177, v177, s101, v29
  v_fma_f32 v178, v178, s101, v29
  v_mfma_f32_32x32x16_bf16 v[128:143], v[208:211], v[192:195], v[128:143]
  v_fma_f32 v179, v179, s101, v29
  v_fma_f32 v180, v180, s101, v29
  v_fma_f32 v181, v181, s101, v29
  v_fma_f32 v182, v182, s101, v29
  v_fma_f32 v183, v183, s101, v29
  v_mul_f32 v176, v160, v176
  v_mfma_f32_32x32x16_bf16 v[80:95], v[212:215], v[196:199], v[80:95]
  v_mul_f32 v177, v161, v177
  v_mul_f32 v178, v162, v178
  v_mul_f32 v179, v163, v179
  v_mul_f32 v180, v164, v180
  v_mul_f32 v181, v165, v181
  v_mfma_f32_32x32x16_bf16 v[144:159], v[212:215], v[192:195], v[144:159]
  v_mul_f32 v182, v166, v182
  v_mul_f32 v183, v167, v183
  v_exp_f32 v176, v176
  v_mul_f32 v160, v160, v168
  v_exp_f32 v177, v177
  v_mul_f32 v161, v161, v169
  v_add_u32 v3, 73728, v7
  v_add_u32 v4, 73728, v8
  v_add_u32 v5, 73728, v9
  s_waitcnt vmcnt(8) lgkmcnt(0)
  s_barrier
  v_mfma_f32_32x32x16_bf16 v[32:47], v[224:227], v[220:223], v[32:47]
  ds_read_b64_tr_b16 v[200:201], v4 offset:0
  ds_read_b64_tr_b16 v[202:203], v4 offset:1024
  v_exp_f32 v178, v178
  v_mul_f32 v162, v162, v170
  v_exp_f32 v179, v179
  v_mul_f32 v163, v163, v171
  v_exp_f32 v180, v180
  v_mul_f32 v164, v164, v172
  v_mfma_f32_32x32x16_bf16 v[96:111], v[224:227], v[216:219], v[96:111]
  ds_read_b128 v[192:195], v3 offset:0
  ds_read_b128 v[196:199], v3 offset:2048
  s_add_u32 m0, s47, 24576
  s_nop 0
  buffer_load_dwordx4 v11, s[56:59], 0 offen sc1 lds
  buffer_load_dwordx4 v11, s[56:59], 0 offen offset:1024 sc1 lds
  v_exp_f32 v181, v181
  v_mul_f32 v165, v165, v173
  v_exp_f32 v182, v182
  v_mul_f32 v166, v166, v174
  v_exp_f32 v183, v183
  v_mfma_f32_32x32x16_bf16 v[48:63], v[228:231], v[220:223], v[48:63]
  ds_read_b64_tr_b16 v[204:205], v5 offset:0
  ds_read_b64_tr_b16 v[206:207], v5 offset:1024
  buffer_load_dwordx4 v11, s[56:59], s45 offen offset:2048 sc1 lds
  v_mul_f32 v167, v167, v175
  v_add_f32 v176, 1.0, v176
  v_add_f32 v177, 1.0, v177
  v_add_f32 v178, 1.0, v178
  v_add_f32 v179, 1.0, v179
  v_add_f32 v180, 1.0, v180
  v_mfma_f32_32x32x16_bf16 v[112:127], v[228:231], v[216:219], v[112:127]
  ds_read_b64_tr_b16 v[208:209], v4 offset:512
  ds_read_b64_tr_b16 v[210:211], v4 offset:1536
  buffer_load_dwordx4 v11, s[56:59], s45 offen offset:3072 sc1 lds
  v_add_u32 v11, 2048, v11
  s_add_u32 m0, s49, 24576
  s_nop 0
  buffer_load_dwordx4 v12, s[12:15], 0 offen lds
  v_add_f32 v181, 1.0, v181
  v_add_f32 v182, 1.0, v182
  v_add_f32 v183, 1.0, v183
  v_rcp_f32 v176, v176
  v_rcp_f32 v177, v177
  v_mfma_f32_32x32x16_bf16 v[64:79], v[232:235], v[220:223], v[64:79]
  ds_read_b64_tr_b16 v[212:213], v5 offset:512
  ds_read_b64_tr_b16 v[214:215], v5 offset:1536
  buffer_load_dwordx4 v12, s[12:15], s46 offen offset:1024 lds
  v_add_u32 v12, 262144, v12
  v_rcp_f32 v178, v178
  v_rcp_f32 v179, v179
  v_rcp_f32 v180, v180
  v_rcp_f32 v181, v181
  v_rcp_f32 v182, v182
  v_rcp_f32 v183, v183
  v_mfma_f32_32x32x16_bf16 v[128:143], v[232:235], v[216:219], v[128:143]
  s_add_u32 m0, s43, 98304
  s_nop 0
  buffer_load_dwordx4 v13, s[16:19], s39 offen offset:0 sc1 lds
  buffer_load_dwordx4 v13, s[16:19], s39 offen offset:1024 sc1 lds
  v_mul_f32 v160, v160, v176
  v_mul_f32 v161, v161, v177
  v_mul_f32 v162, v162, v178
  v_mul_f32 v163, v163, v179
  v_mul_f32 v164, v164, v180
  v_mfma_f32_32x32x16_bf16 v[80:95], v[236:239], v[220:223], v[80:95]
  buffer_load_dwordx4 v13, s[16:19], s39 offen offset:2048 sc1 lds
  v_mul_f32 v165, v165, v181
  v_mul_f32 v166, v166, v182
  v_mul_f32 v167, v167, v183
  v_mfma_f32_32x32x16_bf16 v[144:159], v[236:239], v[216:219], v[144:159]
  buffer_load_dwordx4 v13, s[16:19], s39 offen offset:3072 sc1 lds
  s_add_u32 s39, s39, 16384
  v_cvt_pk_bf16_f32 v184, v160, v161
  v_cvt_pk_bf16_f32 v185, v162, v163
  v_cvt_pk_bf16_f32 v186, v164, v165
  v_cvt_pk_bf16_f32 v187, v166, v167
  s_nop 1
  v_permlane32_swap_b32 v184, v186
  v_permlane32_swap_b32 v185, v187
  s_add_u32 s4, s37, 561152
  buffer_store_dwordx4 v[184:187], v10, s[96:99], s4 offen sc1
  s_waitcnt lgkmcnt(0)
  v_mfma_f32_32x32x16_bf16 v[32:47], v[200:203], v[196:199], v[32:47]
  ds_read_b64_tr_b16 v[224:225], v4 offset:4096
  ds_read_b64_tr_b16 v[226:227], v4 offset:5120
  v_accvgpr_read_b32 v160, a88
  v_accvgpr_read_b32 v161, a89
  v_accvgpr_read_b32 v162, a90
  v_accvgpr_read_b32 v163, a91
  v_accvgpr_read_b32 v164, a92
  v_mfma_f32_32x32x16_bf16 v[96:111], v[200:203], v[192:195], v[96:111]
  ds_read_b128 v[216:219], v3 offset:1024
  ds_read_b128 v[220:223], v3 offset:3072
  v_accvgpr_read_b32 v165, a93
  v_accvgpr_read_b32 v166, a94
  v_accvgpr_read_b32 v167, a95
  v_mul_f32 v176, v160, v160
  v_mul_f32 v177, v161, v161
  v_mul_f32 v178, v162, v162
  v_mfma_f32_32x32x16_bf16 v[48:63], v[204:207], v[196:199], v[48:63]
  ds_read_b64_tr_b16 v[228:229], v5 offset:4096
  ds_read_b64_tr_b16 v[230:231], v5 offset:5120
  v_mul_f32 v179, v163, v163
  v_mul_f32 v180, v164, v164
  v_mul_f32 v181, v165, v165
  v_mul_f32 v182, v166, v166
  v_mul_f32 v183, v167, v167
  v_mfma_f32_32x32x16_bf16 v[112:127], v[204:207], v[192:195], v[112:127]
  ds_read_b64_tr_b16 v[232:233], v4 offset:4608
  ds_read_b64_tr_b16 v[234:235], v4 offset:5632
  v_accvgpr_read_b32 v168, a216
  v_accvgpr_read_b32 v169, a217
  v_accvgpr_read_b32 v170, a218
  v_accvgpr_read_b32 v171, a219
  v_accvgpr_read_b32 v172, a220
  v_accvgpr_read_b32 v173, a221
  v_mfma_f32_32x32x16_bf16 v[64:79], v[208:211], v[196:199], v[64:79]
  ds_read_b64_tr_b16 v[236:237], v5 offset:4608
  ds_read_b64_tr_b16 v[238:239], v5 offset:5632
  v_accvgpr_read_b32 v174, a222
  v_accvgpr_read_b32 v175, a223
  v_fma_f32 v176, v176, s101, v29
  v_fma_f32 v177, v177, s101, v29
  v_fma_f32 v178, v178, s101, v29
  v_mfma_f32_32x32x16_bf16 v[128:143], v[208:211], v[192:195], v[128:143]
  v_fma_f32 v179, v179, s101, v29
  v_fma_f32 v180, v180, s101, v29
  v_fma_f32 v181, v181, s101, v29
  v_fma_f32 v182, v182, s101, v29
  v_fma_f32 v183, v183, s101, v29
  v_mul_f32 v176, v160, v176
  v_mfma_f32_32x32x16_bf16 v[80:95], v[212:215], v[196:199], v[80:95]
  v_mul_f32 v177, v161, v177
  v_mul_f32 v178, v162, v178
  v_mul_f32 v179, v163, v179
  v_mul_f32 v180, v164, v180
  v_mul_f32 v181, v165, v181
  v_mfma_f32_32x32x16_bf16 v[144:159], v[212:215], v[192:195], v[144:159]
  v_mul_f32 v182, v166, v182
  v_mul_f32 v183, v167, v183
  v_exp_f32 v176, v176
  v_mul_f32 v160, v160, v168
  v_exp_f32 v177, v177
  v_mul_f32 v161, v161, v169
  v_add_u32 v3, 0, v7
  v_add_u32 v4, 0, v8
  v_add_u32 v5, 0, v9
  s_waitcnt vmcnt(12) lgkmcnt(0)
  s_barrier
  v_mfma_f32_32x32x16_bf16 v[32:47], v[224:227], v[220:223], v[32:47]
  ds_read_b64_tr_b16 v[200:201], v4 offset:0
  ds_read_b64_tr_b16 v[202:203], v4 offset:1024
  v_exp_f32 v178, v178
  v_mul_f32 v162, v162, v170
  v_exp_f32 v179, v179
  v_mul_f32 v163, v163, v171
  v_exp_f32 v180, v180
  v_mul_f32 v164, v164, v172
  v_mfma_f32_32x32x16_bf16 v[96:111], v[224:227], v[216:219], v[96:111]
  ds_read_b128 v[192:195], v3 offset:0
  ds_read_b128 v[196:199], v3 offset:2048
  s_add_u32 m0, s43, 114688
  s_nop 0
  buffer_load_dwordx4 v13, s[16:19], s39 offen offset:0 sc1 lds
  buffer_load_dwordx4 v13, s[16:19], s39 offen offset:1024 sc1 lds
  v_exp_f32 v181, v181
  v_mul_f32 v165, v165, v173
  v_exp_f32 v182, v182
  v_mul_f32 v166, v166, v174
  v_exp_f32 v183, v183
  v_mfma_f32_32x32x16_bf16 v[48:63], v[228:231], v[220:223], v[48:63]
  ds_read_b64_tr_b16 v[204:205], v5 offset:0
  ds_read_b64_tr_b16 v[206:207], v5 offset:1024
  buffer_load_dwordx4 v13, s[16:19], s39 offen offset:2048 sc1 lds
  v_mul_f32 v167, v167, v175
  v_add_f32 v176, 1.0, v176
  v_add_f32 v177, 1.0, v177
  v_add_f32 v178, 1.0, v178
  v_add_f32 v179, 1.0, v179
  v_add_f32 v180, 1.0, v180
  v_mfma_f32_32x32x16_bf16 v[112:127], v[228:231], v[216:219], v[112:127]
  ds_read_b64_tr_b16 v[208:209], v4 offset:512
  ds_read_b64_tr_b16 v[210:211], v4 offset:1536
  buffer_load_dwordx4 v13, s[16:19], s39 offen offset:3072 sc1 lds
  s_add_u32 s39, s39, 16384
  v_add_f32 v181, 1.0, v181
  v_add_f32 v182, 1.0, v182
  v_add_f32 v183, 1.0, v183
  v_rcp_f32 v176, v176
  v_rcp_f32 v177, v177
  v_mfma_f32_32x32x16_bf16 v[64:79], v[232:235], v[220:223], v[64:79]
  ds_read_b64_tr_b16 v[212:213], v5 offset:512
  ds_read_b64_tr_b16 v[214:215], v5 offset:1536
  s_add_u32 m0, s43, 131072
  s_nop 0
  buffer_load_dwordx4 v13, s[16:19], s39 offen offset:0 sc1 lds
  v_rcp_f32 v178, v178
  v_rcp_f32 v179, v179
  v_rcp_f32 v180, v180
  v_rcp_f32 v181, v181
  v_rcp_f32 v182, v182
  v_rcp_f32 v183, v183
  v_mfma_f32_32x32x16_bf16 v[128:143], v[232:235], v[216:219], v[128:143]
  buffer_load_dwordx4 v13, s[16:19], s39 offen offset:1024 sc1 lds
  v_mul_f32 v160, v160, v176
  v_mul_f32 v161, v161, v177
  v_mul_f32 v162, v162, v178
  v_mul_f32 v163, v163, v179
  v_mul_f32 v164, v164, v180
  v_mfma_f32_32x32x16_bf16 v[80:95], v[236:239], v[220:223], v[80:95]
  buffer_load_dwordx4 v13, s[16:19], s39 offen offset:2048 sc1 lds
  v_mul_f32 v165, v165, v181
  v_mul_f32 v166, v166, v182
  v_mul_f32 v167, v167, v183
  v_mfma_f32_32x32x16_bf16 v[144:159], v[236:239], v[216:219], v[144:159]
  buffer_load_dwordx4 v13, s[16:19], s39 offen offset:3072 sc1 lds
  s_add_u32 s39, s39, 16384
  v_cvt_pk_bf16_f32 v188, v160, v161
  v_cvt_pk_bf16_f32 v189, v162, v163
  v_cvt_pk_bf16_f32 v190, v164, v165
  v_cvt_pk_bf16_f32 v191, v166, v167
  s_nop 1
  v_permlane32_swap_b32 v188, v190
  v_permlane32_swap_b32 v189, v191
  s_add_u32 s4, s37, 562176
  buffer_store_dwordx4 v[188:191], v10, s[96:99], s4 offen sc1
  s_waitcnt lgkmcnt(0)
  v_mfma_f32_32x32x16_bf16 v[32:47], v[200:203], v[196:199], v[32:47]
  ds_read_b64_tr_b16 v[224:225], v4 offset:4096
  ds_read_b64_tr_b16 v[226:227], v4 offset:5120
  v_accvgpr_read_b32 v160, a104
  v_accvgpr_read_b32 v161, a105
  v_accvgpr_read_b32 v162, a106
  v_accvgpr_read_b32 v163, a107
  v_accvgpr_read_b32 v164, a108
  v_mfma_f32_32x32x16_bf16 v[96:111], v[200:203], v[192:195], v[96:111]
  ds_read_b128 v[216:219], v3 offset:1024
  ds_read_b128 v[220:223], v3 offset:3072
  v_accvgpr_read_b32 v165, a109
  v_accvgpr_read_b32 v166, a110
  v_accvgpr_read_b32 v167, a111
  v_mul_f32 v176, v160, v160
  v_mul_f32 v177, v161, v161
  v_mul_f32 v178, v162, v162
  v_mfma_f32_32x32x16_bf16 v[48:63], v[204:207], v[196:199], v[48:63]
  ds_read_b64_tr_b16 v[228:229], v5 offset:4096
  ds_read_b64_tr_b16 v[230:231], v5 offset:5120
  v_mul_f32 v179, v163, v163
  v_mul_f32 v180, v164, v164
  v_mul_f32 v181, v165, v165
  v_mul_f32 v182, v166, v166
  v_mul_f32 v183, v167, v167
  v_mfma_f32_32x32x16_bf16 v[112:127], v[204:207], v[192:195], v[112:127]
  ds_read_b64_tr_b16 v[232:233], v4 offset:4608
  ds_read_b64_tr_b16 v[234:235], v4 offset:5632
  v_accvgpr_read_b32 v168, a232
  v_accvgpr_read_b32 v169, a233
  v_accvgpr_read_b32 v170, a234
  v_accvgpr_read_b32 v171, a235
  v_accvgpr_read_b32 v172, a236
  v_accvgpr_read_b32 v173, a237
  v_mfma_f32_32x32x16_bf16 v[64:79], v[208:211], v[196:199], v[64:79]
  ds_read_b64_tr_b16 v[236:237], v5 offset:4608
  ds_read_b64_tr_b16 v[238:239], v5 offset:5632
  v_accvgpr_read_b32 v174, a238
  v_accvgpr_read_b32 v175, a239
  v_fma_f32 v176, v176, s101, v29
  v_fma_f32 v177, v177, s101, v29
  v_fma_f32 v178, v178, s101, v29
  v_mfma_f32_32x32x16_bf16 v[128:143], v[208:211], v[192:195], v[128:143]
  v_fma_f32 v179, v179, s101, v29
  v_fma_f32 v180, v180, s101, v29
  v_fma_f32 v181, v181, s101, v29
  v_fma_f32 v182, v182, s101, v29
  v_fma_f32 v183, v183, s101, v29
  v_mul_f32 v176, v160, v176
  v_mfma_f32_32x32x16_bf16 v[80:95], v[212:215], v[196:199], v[80:95]
  v_mul_f32 v177, v161, v177
  v_mul_f32 v178, v162, v178
  v_mul_f32 v179, v163, v179
  v_mul_f32 v180, v164, v180
  v_mul_f32 v181, v165, v181
  v_mfma_f32_32x32x16_bf16 v[144:159], v[212:215], v[192:195], v[144:159]
  v_mul_f32 v182, v166, v182
  v_mul_f32 v183, v167, v183
  v_exp_f32 v176, v176
  v_mul_f32 v160, v160, v168
  v_exp_f32 v177, v177
  v_mul_f32 v161, v161, v169
  v_add_u32 v3, 24576, v7
  v_add_u32 v4, 24576, v8
  v_add_u32 v5, 24576, v9
  s_waitcnt vmcnt(14) lgkmcnt(0)
  s_barrier
  v_mfma_f32_32x32x16_bf16 v[32:47], v[224:227], v[220:223], v[32:47]
  ds_read_b64_tr_b16 v[200:201], v4 offset:0
  ds_read_b64_tr_b16 v[202:203], v4 offset:1024
  v_exp_f32 v178, v178
  v_mul_f32 v162, v162, v170
  v_exp_f32 v179, v179
  v_mul_f32 v163, v163, v171
  v_exp_f32 v180, v180
  v_mul_f32 v164, v164, v172
  v_mfma_f32_32x32x16_bf16 v[96:111], v[224:227], v[216:219], v[96:111]
  ds_read_b128 v[192:195], v3 offset:0
  ds_read_b128 v[196:199], v3 offset:2048
  s_add_u32 m0, s43, 147456
  s_nop 0
  buffer_load_dwordx4 v13, s[16:19], s39 offen offset:0 sc1 lds
  buffer_load_dwordx4 v13, s[16:19], s39 offen offset:1024 sc1 lds
  v_exp_f32 v181, v181
  v_mul_f32 v165, v165, v173
  v_exp_f32 v182, v182
  v_mul_f32 v166, v166, v174
  v_exp_f32 v183, v183
  v_mfma_f32_32x32x16_bf16 v[48:63], v[228:231], v[220:223], v[48:63]
  ds_read_b64_tr_b16 v[204:205], v5 offset:0
  ds_read_b64_tr_b16 v[206:207], v5 offset:1024
  buffer_load_dwordx4 v13, s[16:19], s39 offen offset:2048 sc1 lds
  v_mul_f32 v167, v167, v175
  v_add_f32 v176, 1.0, v176
  v_add_f32 v177, 1.0, v177
  v_add_f32 v178, 1.0, v178
  v_add_f32 v179, 1.0, v179
  v_add_f32 v180, 1.0, v180
  v_mfma_f32_32x32x16_bf16 v[112:127], v[228:231], v[216:219], v[112:127]
  ds_read_b64_tr_b16 v[208:209], v4 offset:512
  ds_read_b64_tr_b16 v[210:211], v4 offset:1536
  buffer_load_dwordx4 v13, s[16:19], s39 offen offset:3072 sc1 lds
  s_add_u32 s39, s39, 16384
  v_add_f32 v181, 1.0, v181
  v_add_f32 v182, 1.0, v182
  v_add_f32 v183, 1.0, v183
  v_rcp_f32 v176, v176
  v_rcp_f32 v177, v177
  v_mfma_f32_32x32x16_bf16 v[64:79], v[232:235], v[220:223], v[64:79]
  ds_read_b64_tr_b16 v[212:213], v5 offset:512
  ds_read_b64_tr_b16 v[214:215], v5 offset:1536
  s_add_u32 m0, s43, 0
  s_nop 0
  buffer_load_dwordx4 v13, s[20:23], s41 offen offset:0 sc1 lds
  v_rcp_f32 v178, v178
  v_rcp_f32 v179, v179
  v_rcp_f32 v180, v180
  v_rcp_f32 v181, v181
  v_rcp_f32 v182, v182
  v_rcp_f32 v183, v183
  v_mfma_f32_32x32x16_bf16 v[128:143], v[232:235], v[216:219], v[128:143]
  buffer_load_dwordx4 v13, s[20:23], s41 offen offset:1024 sc1 lds
  v_mul_f32 v160, v160, v176
  v_mul_f32 v161, v161, v177
  v_mul_f32 v162, v162, v178
  v_mul_f32 v163, v163, v179
  v_mul_f32 v164, v164, v180
  v_mfma_f32_32x32x16_bf16 v[80:95], v[236:239], v[220:223], v[80:95]
  buffer_load_dwordx4 v13, s[20:23], s41 offen offset:2048 sc1 lds
  v_mul_f32 v165, v165, v181
  v_mul_f32 v166, v166, v182
  v_mul_f32 v167, v167, v183
  v_mfma_f32_32x32x16_bf16 v[144:159], v[236:239], v[216:219], v[144:159]
  buffer_load_dwordx4 v13, s[20:23], s41 offen offset:3072 sc1 lds
  s_add_u32 s41, s41, 16384
  v_cvt_pk_bf16_f32 v184, v160, v161
  v_cvt_pk_bf16_f32 v185, v162, v163
  v_cvt_pk_bf16_f32 v186, v164, v165
  v_cvt_pk_bf16_f32 v187, v166, v167
  s_nop 1
  v_permlane32_swap_b32 v184, v186
  v_permlane32_swap_b32 v185, v187
  s_add_u32 s4, s37, 563200
  buffer_store_dwordx4 v[184:187], v10, s[96:99], s4 offen sc1
  s_waitcnt lgkmcnt(0)
  v_mfma_f32_32x32x16_bf16 v[32:47], v[200:203], v[196:199], v[32:47]
  ds_read_b64_tr_b16 v[224:225], v4 offset:4096
  ds_read_b64_tr_b16 v[226:227], v4 offset:5120
  v_accvgpr_read_b32 v160, a120
  v_accvgpr_read_b32 v161, a121
  v_accvgpr_read_b32 v162, a122
  v_accvgpr_read_b32 v163, a123
  v_accvgpr_read_b32 v164, a124
  v_mfma_f32_32x32x16_bf16 v[96:111], v[200:203], v[192:195], v[96:111]
  ds_read_b128 v[216:219], v3 offset:1024
  ds_read_b128 v[220:223], v3 offset:3072
  v_accvgpr_read_b32 v165, a125
  v_accvgpr_read_b32 v166, a126
  v_accvgpr_read_b32 v167, a127
  v_mul_f32 v176, v160, v160
  v_mul_f32 v177, v161, v161
  v_mul_f32 v178, v162, v162
  v_mfma_f32_32x32x16_bf16 v[48:63], v[204:207], v[196:199], v[48:63]
  ds_read_b64_tr_b16 v[228:229], v5 offset:4096
  ds_read_b64_tr_b16 v[230:231], v5 offset:5120
  v_mul_f32 v179, v163, v163
  v_mul_f32 v180, v164, v164
  v_mul_f32 v181, v165, v165
  v_mul_f32 v182, v166, v166
  v_mul_f32 v183, v167, v167
  v_mfma_f32_32x32x16_bf16 v[112:127], v[204:207], v[192:195], v[112:127]
  ds_read_b64_tr_b16 v[232:233], v4 offset:4608
  ds_read_b64_tr_b16 v[234:235], v4 offset:5632
  v_accvgpr_read_b32 v168, a248
  v_accvgpr_read_b32 v169, a249
  v_accvgpr_read_b32 v170, a250
  v_accvgpr_read_b32 v171, a251
  v_accvgpr_read_b32 v172, a252
  v_accvgpr_read_b32 v173, a253
  v_mfma_f32_32x32x16_bf16 v[64:79], v[208:211], v[196:199], v[64:79]
  ds_read_b64_tr_b16 v[236:237], v5 offset:4608
  ds_read_b64_tr_b16 v[238:239], v5 offset:5632
  v_accvgpr_read_b32 v174, a254
  v_accvgpr_read_b32 v175, a255
  v_fma_f32 v176, v176, s101, v29
  v_fma_f32 v177, v177, s101, v29
  v_fma_f32 v178, v178, s101, v29
  v_mfma_f32_32x32x16_bf16 v[128:143], v[208:211], v[192:195], v[128:143]
  v_fma_f32 v179, v179, s101, v29
  v_fma_f32 v180, v180, s101, v29
  v_fma_f32 v181, v181, s101, v29
  v_fma_f32 v182, v182, s101, v29
  v_fma_f32 v183, v183, s101, v29
  v_mul_f32 v176, v160, v176
  v_mfma_f32_32x32x16_bf16 v[80:95], v[212:215], v[196:199], v[80:95]
  v_mul_f32 v177, v161, v177
  v_mul_f32 v178, v162, v178
  v_mul_f32 v179, v163, v179
  v_mul_f32 v180, v164, v180
  v_mul_f32 v181, v165, v181
  v_mfma_f32_32x32x16_bf16 v[144:159], v[212:215], v[192:195], v[144:159]
  v_mul_f32 v182, v166, v182
  v_mul_f32 v183, v167, v183
  v_exp_f32 v176, v176
  v_mul_f32 v160, v160, v168
  v_exp_f32 v177, v177
  v_mul_f32 v161, v161, v169
  s_waitcnt lgkmcnt(0)
  v_mfma_f32_32x32x16_bf16 v[32:47], v[224:227], v[220:223], v[32:47]
  v_exp_f32 v178, v178
  v_mul_f32 v162, v162, v170
  v_exp_f32 v179, v179
  v_mul_f32 v163, v163, v171
  v_exp_f32 v180, v180
  v_mul_f32 v164, v164, v172
  v_mfma_f32_32x32x16_bf16 v[96:111], v[224:227], v[216:219], v[96:111]
  v_exp_f32 v181, v181
  v_mul_f32 v165, v165, v173
  v_exp_f32 v182, v182
  v_mul_f32 v166, v166, v174
  v_exp_f32 v183, v183
  v_mfma_f32_32x32x16_bf16 v[48:63], v[228:231], v[220:223], v[48:63]
  v_mul_f32 v167, v167, v175
  v_add_f32 v176, 1.0, v176
  v_add_f32 v177, 1.0, v177
  v_add_f32 v178, 1.0, v178
  v_add_f32 v179, 1.0, v179
  v_add_f32 v180, 1.0, v180
  v_mfma_f32_32x32x16_bf16 v[112:127], v[228:231], v[216:219], v[112:127]
  v_add_f32 v181, 1.0, v181
  v_add_f32 v182, 1.0, v182
  v_add_f32 v183, 1.0, v183
  v_rcp_f32 v176, v176
  v_rcp_f32 v177, v177
  v_mfma_f32_32x32x16_bf16 v[64:79], v[232:235], v[220:223], v[64:79]
  v_rcp_f32 v178, v178
  v_rcp_f32 v179, v179
  v_rcp_f32 v180, v180
  v_rcp_f32 v181, v181
  v_rcp_f32 v182, v182
  v_rcp_f32 v183, v183
  v_mfma_f32_32x32x16_bf16 v[128:143], v[232:235], v[216:219], v[128:143]
  v_mul_f32 v160, v160, v176
  v_mul_f32 v161, v161, v177
  v_mul_f32 v162, v162, v178
  v_mul_f32 v163, v163, v179
  v_mul_f32 v164, v164, v180
  v_mfma_f32_32x32x16_bf16 v[80:95], v[236:239], v[220:223], v[80:95]
  v_mul_f32 v165, v165, v181
  v_mul_f32 v166, v166, v182
  v_mul_f32 v167, v167, v183
  v_mfma_f32_32x32x16_bf16 v[144:159], v[236:239], v[216:219], v[144:159]
  v_cvt_pk_bf16_f32 v188, v160, v161
  v_cvt_pk_bf16_f32 v189, v162, v163
  v_cvt_pk_bf16_f32 v190, v164, v165
  v_cvt_pk_bf16_f32 v191, v166, v167
  s_nop 1
  v_permlane32_swap_b32 v188, v190
  v_permlane32_swap_b32 v189, v191
  s_add_u32 s4, s37, 564224
  buffer_store_dwordx4 v[188:191], v10, s[96:99], s4 offen sc1
  s_waitcnt vmcnt(20) lgkmcnt(0)
  s_barrier
  s_add_u32 m0, s43, 16384
  s_nop 0
  buffer_load_dwordx4 v13, s[20:23], s41 offen offset:0 sc1 lds
  buffer_load_dwordx4 v13, s[20:23], s41 offen offset:1024 sc1 lds
  buffer_load_dwordx4 v13, s[20:23], s41 offen offset:2048 sc1 lds
  buffer_load_dwordx4 v13, s[20:23], s41 offen offset:3072 sc1 lds
  s_add_u32 s41, s41, 16384
  v_add_u32 v16, 98304, v2
  ds_read_b128 a[128:131], v16 offset:0
  ds_read_b128 a[132:135], v16 offset:1024
  ds_read_b128 a[136:139], v16 offset:2048
  ds_read_b128 a[140:143], v16 offset:3072
  ds_read_b128 a[144:147], v16 offset:4096
  ds_read_b128 a[148:151], v16 offset:5120
  ds_read_b128 a[152:155], v16 offset:6144
  ds_read_b128 a[156:159], v16 offset:7168
  ds_read_b128 a[160:163], v16 offset:8192
  ds_read_b128 a[164:167], v16 offset:9216
  ds_read_b128 a[168:171], v16 offset:10240
  ds_read_b128 a[172:175], v16 offset:11264
  ds_read_b128 a[176:179], v16 offset:12288
  ds_read_b128 a[180:183], v16 offset:13312
  ds_read_b128 a[184:187], v16 offset:14336
  ds_read_b128 a[188:191], v16 offset:15360
  s_mov_b32 s34, 0x3e0293ee
  s_nop 7
  v_mul_f32 v32, s34, v32
  v_mul_f32 v33, s34, v33
  v_mul_f32 v34, s34, v34
  v_mul_f32 v35, s34, v35
  v_mul_f32 v36, s34, v36
  v_mul_f32 v37, s34, v37
  v_mul_f32 v38, s34, v38
  v_mul_f32 v39, s34, v39
  v_mul_f32 v40, s34, v40
  v_mul_f32 v41, s34, v41
  v_mul_f32 v42, s34, v42
  v_mul_f32 v43, s34, v43
  v_mul_f32 v44, s34, v44
  v_mul_f32 v45, s34, v45
  v_mul_f32 v46, s34, v46
  v_mul_f32 v47, s34, v47
  v_cvt_pk_bf16_f32 v32, v32, v33
  v_cvt_pk_bf16_f32 v33, v34, v35
  v_cvt_pk_bf16_f32 v34, v36, v37
  v_cvt_pk_bf16_f32 v35, v38, v39
  v_cvt_pk_bf16_f32 v36, v40, v41
  v_cvt_pk_bf16_f32 v37, v42, v43
  v_cvt_pk_bf16_f32 v38, v44, v45
  v_cvt_pk_bf16_f32 v39, v46, v47
  v_mul_f32 v48, s34, v48
  v_mul_f32 v49, s34, v49
  v_mul_f32 v50, s34, v50
  v_mul_f32 v51, s34, v51
  v_mul_f32 v52, s34, v52
  v_mul_f32 v53, s34, v53
  v_mul_f32 v54, s34, v54
  v_mul_f32 v55, s34, v55
  v_mul_f32 v56, s34, v56
  v_mul_f32 v57, s34, v57
  v_mul_f32 v58, s34, v58
  v_mul_f32 v59, s34, v59
  v_mul_f32 v60, s34, v60
  v_mul_f32 v61, s34, v61
  v_mul_f32 v62, s34, v62
  v_mul_f32 v63, s34, v63
  v_cvt_pk_bf16_f32 v40, v48, v49
  v_cvt_pk_bf16_f32 v41, v50, v51
  v_cvt_pk_bf16_f32 v42, v52, v53
  v_cvt_pk_bf16_f32 v43, v54, v55
  v_cvt_pk_bf16_f32 v44, v56, v57
  v_cvt_pk_bf16_f32 v45, v58, v59
  v_cvt_pk_bf16_f32 v46, v60, v61
  v_cvt_pk_bf16_f32 v47, v62, v63
  v_mul_f32 v64, s34, v64
  v_mul_f32 v65, s34, v65
  v_mul_f32 v66, s34, v66
  v_mul_f32 v67, s34, v67
  v_mul_f32 v68, s34, v68
  v_mul_f32 v69, s34, v69
  v_mul_f32 v70, s34, v70
  v_mul_f32 v71, s34, v71
  v_mul_f32 v72, s34, v72
  v_mul_f32 v73, s34, v73
  v_mul_f32 v74, s34, v74
  v_mul_f32 v75, s34, v75
  v_mul_f32 v76, s34, v76
  v_mul_f32 v77, s34, v77
  v_mul_f32 v78, s34, v78
  v_mul_f32 v79, s34, v79
  v_cvt_pk_bf16_f32 v48, v64, v65
  v_cvt_pk_bf16_f32 v49, v66, v67
  v_cvt_pk_bf16_f32 v50, v68, v69
  v_cvt_pk_bf16_f32 v51, v70, v71
  v_cvt_pk_bf16_f32 v52, v72, v73
  v_cvt_pk_bf16_f32 v53, v74, v75
  v_cvt_pk_bf16_f32 v54, v76, v77
  v_cvt_pk_bf16_f32 v55, v78, v79
  v_mul_f32 v80, s34, v80
  v_mul_f32 v81, s34, v81
  v_mul_f32 v82, s34, v82
  v_mul_f32 v83, s34, v83
  v_mul_f32 v84, s34, v84
  v_mul_f32 v85, s34, v85
  v_mul_f32 v86, s34, v86
  v_mul_f32 v87, s34, v87
  v_mul_f32 v88, s34, v88
  v_mul_f32 v89, s34, v89
  v_mul_f32 v90, s34, v90
  v_mul_f32 v91, s34, v91
  v_mul_f32 v92, s34, v92
  v_mul_f32 v93, s34, v93
  v_mul_f32 v94, s34, v94
  v_mul_f32 v95, s34, v95
  v_cvt_pk_bf16_f32 v56, v80, v81
  v_cvt_pk_bf16_f32 v57, v82, v83
  v_cvt_pk_bf16_f32 v58, v84, v85
  v_cvt_pk_bf16_f32 v59, v86, v87
  v_cvt_pk_bf16_f32 v60, v88, v89
  v_cvt_pk_bf16_f32 v61, v90, v91
  v_cvt_pk_bf16_f32 v62, v92, v93
  v_cvt_pk_bf16_f32 v63, v94, v95
  v_mul_f32 v96, s34, v96
  v_mul_f32 v97, s34, v97
  v_mul_f32 v98, s34, v98
  v_mul_f32 v99, s34, v99
  v_mul_f32 v100, s34, v100
  v_mul_f32 v101, s34, v101
  v_mul_f32 v102, s34, v102
  v_mul_f32 v103, s34, v103
  v_mul_f32 v104, s34, v104
  v_mul_f32 v105, s34, v105
  v_mul_f32 v106, s34, v106
  v_mul_f32 v107, s34, v107
  v_mul_f32 v108, s34, v108
  v_mul_f32 v109, s34, v109
  v_mul_f32 v110, s34, v110
  v_mul_f32 v111, s34, v111
  v_cvt_pk_bf16_f32 v64, v96, v97
  v_cvt_pk_bf16_f32 v65, v98, v99
  v_cvt_pk_bf16_f32 v66, v100, v101
  v_cvt_pk_bf16_f32 v67, v102, v103
  v_cvt_pk_bf16_f32 v68, v104, v105
  v_cvt_pk_bf16_f32 v69, v106, v107
  v_cvt_pk_bf16_f32 v70, v108, v109
  v_cvt_pk_bf16_f32 v71, v110, v111
  v_mul_f32 v112, s34, v112
  v_mul_f32 v113, s34, v113
  v_mul_f32 v114, s34, v114
  v_mul_f32 v115, s34, v115
  v_mul_f32 v116, s34, v116
  v_mul_f32 v117, s34, v117
  v_mul_f32 v118, s34, v118
  v_mul_f32 v119, s34, v119
  v_mul_f32 v120, s34, v120
  v_mul_f32 v121, s34, v121
  v_mul_f32 v122, s34, v122
  v_mul_f32 v123, s34, v123
  v_mul_f32 v124, s34, v124
  v_mul_f32 v125, s34, v125
  v_mul_f32 v126, s34, v126
  v_mul_f32 v127, s34, v127
  v_cvt_pk_bf16_f32 v72, v112, v113
  v_cvt_pk_bf16_f32 v73, v114, v115
  v_cvt_pk_bf16_f32 v74, v116, v117
  v_cvt_pk_bf16_f32 v75, v118, v119
  v_cvt_pk_bf16_f32 v76, v120, v121
  v_cvt_pk_bf16_f32 v77, v122, v123
  v_cvt_pk_bf16_f32 v78, v124, v125
  v_cvt_pk_bf16_f32 v79, v126, v127
  v_and_b32 v14, 31, v1
  v_lshrrev_b32 v15, 5, v1
  v_lshlrev_b32 v15, 2, v15
  v_sub_u32 v14, v14, v15
  s_lshl_b32 s34, s3, 5
  s_sub_u32 s95, 15, s51
  s_lshl_b32 s95, s95, 7
  s_add_u32 s95, s95, s34
  v_add_u32 v17, s95, v14
  s_lshl_b32 s95, s51, 7
  s_add_u32 s95, s95, s34
  v_add_u32 v18, s95, v14
  v_mov_b32 v29, 0xff800000
  s_mov_b32 s66, 0
  s_mov_b32 s33, 0x3e0293ee
  s_waitcnt lgkmcnt(15)
  v_mfma_f32_32x32x16_bf16 v[96:111], a[128:131], v[32:35], 0
  v_mul_f32 v128, s33, v128
  v_mul_f32 v129, s33, v129
  v_mul_f32 v130, s33, v130
  v_accvgpr_write_b32 a16, 0
  v_accvgpr_write_b32 a17, 0
  v_accvgpr_write_b32 a18, 0
  v_accvgpr_write_b32 a19, 0
  s_waitcnt lgkmcnt(14)
  v_mfma_f32_32x32x16_bf16 v[96:111], a[132:135], v[36:39], v[96:111]
  v_mul_f32 v131, s33, v131
  v_mul_f32 v132, s33, v132
  v_mul_f32 v133, s33, v133
  v_accvgpr_write_b32 a20, 0
  v_accvgpr_write_b32 a21, 0
  v_accvgpr_write_b32 a22, 0
  v_accvgpr_write_b32 a23, 0
  s_waitcnt lgkmcnt(13)
  v_mfma_f32_32x32x16_bf16 v[96:111], a[136:139], v[40:43], v[96:111]
  v_mul_f32 v134, s33, v134
  v_mul_f32 v135, s33, v135
  v_mul_f32 v136, s33, v136
  v_accvgpr_write_b32 a24, 0
  v_accvgpr_write_b32 a25, 0
  v_accvgpr_write_b32 a26, 0
  v_accvgpr_write_b32 a27, 0
  s_waitcnt lgkmcnt(0)
  v_mfma_f32_32x32x16_bf16 v[96:111], a[140:143], v[44:47], v[96:111]
  v_mul_f32 v137, s33, v137
  v_mul_f32 v138, s33, v138
  v_mul_f32 v139, s33, v139
  v_accvgpr_write_b32 a28, 0
  v_accvgpr_write_b32 a29, 0
  v_accvgpr_write_b32 a30, 0
  v_accvgpr_write_b32 a31, 0
  v_mfma_f32_32x32x16_bf16 v[96:111], a[144:147], v[48:51], v[96:111]
  v_mul_f32 v140, s33, v140
  v_mul_f32 v141, s33, v141
  v_mul_f32 v142, s33, v142
  v_accvgpr_write_b32 a32, 0
  v_accvgpr_write_b32 a33, 0
  v_accvgpr_write_b32 a34, 0
  v_accvgpr_write_b32 a35, 0
  v_mfma_f32_32x32x16_bf16 v[96:111], a[148:151], v[52:55], v[96:111]
  v_mul_f32 v143, s33, v143
  v_cvt_pk_bf16_f32 v80, v128, v129
  v_cvt_pk_bf16_f32 v81, v130, v131
  v_accvgpr_write_b32 a36, 0
  v_accvgpr_write_b32 a37, 0
  v_accvgpr_write_b32 a38, 0
  v_accvgpr_write_b32 a39, 0
  v_mfma_f32_32x32x16_bf16 v[96:111], a[152:155], v[56:59], v[96:111]
  v_cvt_pk_bf16_f32 v82, v132, v133
  v_cvt_pk_bf16_f32 v83, v134, v135
  v_cvt_pk_bf16_f32 v84, v136, v137
  v_accvgpr_write_b32 a40, 0
  v_accvgpr_write_b32 a41, 0
  v_accvgpr_write_b32 a42, 0
  v_accvgpr_write_b32 a43, 0
  v_mfma_f32_32x32x16_bf16 v[96:111], a[156:159], v[60:63], v[96:111]
  v_cvt_pk_bf16_f32 v85, v138, v139
  v_cvt_pk_bf16_f32 v86, v140, v141
  v_cvt_pk_bf16_f32 v87, v142, v143
  v_accvgpr_write_b32 a44, 0
  v_accvgpr_write_b32 a45, 0
  v_accvgpr_write_b32 a46, 0
  v_accvgpr_write_b32 a47, 0
  v_mfma_f32_32x32x16_bf16 v[112:127], a[160:163], v[32:35], 0
  v_mul_f32 v144, s33, v144
  v_mul_f32 v145, s33, v145
  v_mul_f32 v146, s33, v146
  v_accvgpr_write_b32 a48, 0
  v_accvgpr_write_b32 a49, 0
  v_accvgpr_write_b32 a50, 0
  v_accvgpr_write_b32 a51, 0
  v_mfma_f32_32x32x16_bf16 v[112:127], a[164:167], v[36:39], v[112:127]
  v_mul_f32 v147, s33, v147
  v_mul_f32 v148, s33, v148
  v_mul_f32 v149, s33, v149
  v_accvgpr_write_b32 a52, 0
  v_accvgpr_write_b32 a53, 0
  v_accvgpr_write_b32 a54, 0
  v_accvgpr_write_b32 a55, 0
  v_mfma_f32_32x32x16_bf16 v[112:127], a[168:171], v[40:43], v[112:127]
  v_mul_f32 v150, s33, v150
  v_mul_f32 v151, s33, v151
  v_mul_f32 v152, s33, v152
  v_accvgpr_write_b32 a56, 0
  v_accvgpr_write_b32 a57, 0
  v_accvgpr_write_b32 a58, 0
  v_accvgpr_write_b32 a59, 0
  v_mfma_f32_32x32x16_bf16 v[112:127], a[172:175], v[44:47], v[112:127]
  v_mul_f32 v153, s33, v153
  v_mul_f32 v154, s33, v154
  v_mul_f32 v155, s33, v155
  v_accvgpr_write_b32 a60, 0
  v_accvgpr_write_b32 a61, 0
  v_accvgpr_write_b32 a62, 0
  v_accvgpr_write_b32 a63, 0
  v_mfma_f32_32x32x16_bf16 v[112:127], a[176:179], v[48:51], v[112:127]
  v_mul_f32 v156, s33, v156
  v_mul_f32 v157, s33, v157
  v_mul_f32 v158, s33, v158
  v_accvgpr_write_b32 a64, 0
  v_accvgpr_write_b32 a65, 0
  v_accvgpr_write_b32 a66, 0
  v_accvgpr_write_b32 a67, 0
  v_mfma_f32_32x32x16_bf16 v[112:127], a[180:183], v[52:55], v[112:127]
  v_mul_f32 v159, s33, v159
  v_cvt_pk_bf16_f32 v88, v144, v145
  v_cvt_pk_bf16_f32 v89, v146, v147
  v_accvgpr_write_b32 a68, 0
  v_accvgpr_write_b32 a69, 0
  v_accvgpr_write_b32 a70, 0
  v_accvgpr_write_b32 a71, 0
  v_mfma_f32_32x32x16_bf16 v[112:127], a[184:187], v[56:59], v[112:127]
  v_cvt_pk_bf16_f32 v90, v148, v149
  v_cvt_pk_bf16_f32 v91, v150, v151
  v_cvt_pk_bf16_f32 v92, v152, v153
  v_accvgpr_write_b32 a72, 0
  v_accvgpr_write_b32 a73, 0
  v_accvgpr_write_b32 a74, 0
  v_accvgpr_write_b32 a75, 0
  v_mfma_f32_32x32x16_bf16 v[112:127], a[188:191], v[60:63], v[112:127]
  v_cvt_pk_bf16_f32 v93, v154, v155
  v_cvt_pk_bf16_f32 v94, v156, v157
  v_cvt_pk_bf16_f32 v95, v158, v159
  v_accvgpr_write_b32 a76, 0
  v_accvgpr_write_b32 a77, 0
  v_accvgpr_write_b32 a78, 0
  v_accvgpr_write_b32 a79, 0
  v_mfma_f32_32x32x16_bf16 v[128:143], a[128:131], v[64:67], 0
  v_accvgpr_write_b32 a0, 0
  v_accvgpr_write_b32 a1, 0
  v_accvgpr_write_b32 a2, 0
  v_accvgpr_write_b32 a3, 0
  v_accvgpr_write_b32 a4, 0
  v_accvgpr_write_b32 a5, 0
  v_accvgpr_write_b32 a6, 0
  v_accvgpr_write_b32 a7, 0
  v_mfma_f32_32x32x16_bf16 v[128:143], a[132:135], v[68:71], v[128:143]
  v_accvgpr_write_b32 a8, 0
  v_accvgpr_write_b32 a9, 0
  v_accvgpr_write_b32 a10, 0
  v_accvgpr_write_b32 a11, 0
  v_accvgpr_write_b32 a12, 0
  v_accvgpr_write_b32 a13, 0
  v_accvgpr_write_b32 a14, 0
  v_accvgpr_write_b32 a15, 0
  v_mfma_f32_32x32x16_bf16 v[128:143], a[136:139], v[72:75], v[128:143]
  v_max3_f32 v224, v96, v97, v98
  v_max3_f32 v224, v224, v99, v100
  v_max3_f32 v224, v224, v101, v102
  v_max3_f32 v224, v224, v103, v104
  v_max3_f32 v224, v224, v105, v106
  v_max3_f32 v224, v224, v107, v108
  v_max3_f32 v224, v224, v109, v110
  v_mfma_f32_32x32x16_bf16 v[128:143], a[140:143], v[76:79], v[128:143]
  v_max3_f32 v224, v224, v111, v112
  v_max3_f32 v224, v224, v113, v114
  v_max3_f32 v224, v224, v115, v116
  v_max3_f32 v224, v224, v117, v118
  v_max3_f32 v224, v224, v119, v120
  v_max3_f32 v224, v224, v121, v122
  v_max3_f32 v224, v224, v123, v124
  v_mfma_f32_32x32x16_bf16 v[128:143], a[144:147], v[80:83], v[128:143]
  v_max3_f32 v224, v224, v125, v126
  v_max_f32 v224, v224, v127
  v_mov_b32 v225, v224
  s_nop 1
  v_permlane32_swap_b32 v224, v225
  s_nop 1
  v_max_f32 v224, v224, v225
  v_mfma_f32_32x32x16_bf16 v[128:143], a[148:151], v[84:87], v[128:143]
  v_sub_f32 v192, 0, v224
  v_mov_b32 v193, v192
  v_mov_b32 v194, v192
  v_mov_b32 v195, v192
  v_mov_b32 v196, v192
  v_mov_b32 v197, v192
  v_mov_b32 v198, v192
  v_mfma_f32_32x32x16_bf16 v[128:143], a[152:155], v[88:91], v[128:143]
  v_mov_b32 v199, v192
  v_mov_b32 v200, v192
  v_mov_b32 v201, v192
  v_mov_b32 v202, v192
  v_mov_b32 v203, v192
  v_mov_b32 v204, v192
  v_mov_b32 v205, v192
  v_mfma_f32_32x32x16_bf16 v[128:143], a[156:159], v[92:95], v[128:143]
  v_mov_b32 v206, v192
  v_mov_b32 v207, v192
  v_add_f32 v96, v96, v192
  v_add_f32 v97, v97, v192
  v_add_f32 v98, v98, v192
  v_add_f32 v99, v99, v192
  v_add_f32 v100, v100, v192
  v_mfma_f32_32x32x16_bf16 v[144:159], a[160:163], v[64:67], 0
  v_add_f32 v101, v101, v192
  v_add_f32 v102, v102, v192
  v_add_f32 v103, v103, v192
  v_add_f32 v104, v104, v192
  v_add_f32 v105, v105, v192
  v_add_f32 v106, v106, v192
  v_add_f32 v107, v107, v192
  v_mfma_f32_32x32x16_bf16 v[144:159], a[164:167], v[68:71], v[144:159]
  v_add_f32 v108, v108, v192
  v_add_f32 v109, v109, v192
  v_add_f32 v110, v110, v192
  v_add_f32 v111, v111, v192
  v_add_f32 v112, v112, v192
  v_add_f32 v113, v113, v192
  v_add_f32 v114, v114, v192
  v_mfma_f32_32x32x16_bf16 v[144:159], a[168:171], v[72:75], v[144:159]
  v_add_f32 v115, v115, v192
  v_add_f32 v116, v116, v192
  v_add_f32 v117, v117, v192
  v_add_f32 v118, v118, v192
  v_add_f32 v119, v119, v192
  v_add_f32 v120, v120, v192
  v_add_f32 v121, v121, v192
  v_mfma_f32_32x32x16_bf16 v[144:159], a[172:175], v[76:79], v[144:159]
  v_add_f32 v122, v122, v192
  v_add_f32 v123, v123, v192
  v_add_f32 v124, v124, v192
  v_add_f32 v125, v125, v192
  v_add_f32 v126, v126, v192
  v_add_f32 v127, v127, v192
  v_exp_f32 v96, v96
  v_mfma_f32_32x32x16_bf16 v[144:159], a[176:179], v[80:83], v[144:159]
  v_exp_f32 v97, v97
  v_exp_f32 v98, v98
  v_exp_f32 v99, v99
  v_exp_f32 v100, v100
  v_exp_f32 v101, v101
  v_exp_f32 v102, v102
  v_exp_f32 v103, v103
  v_mfma_f32_32x32x16_bf16 v[144:159], a[180:183], v[84:87], v[144:159]
  v_exp_f32 v104, v104
  v_exp_f32 v105, v105
  v_exp_f32 v106, v106
  v_exp_f32 v107, v107
  v_exp_f32 v108, v108
  v_exp_f32 v109, v109
  v_exp_f32 v110, v110
  v_mfma_f32_32x32x16_bf16 v[144:159], a[184:187], v[88:91], v[144:159]
  v_exp_f32 v111, v111
  v_exp_f32 v112, v112
  v_exp_f32 v113, v113
  v_exp_f32 v114, v114
  v_exp_f32 v115, v115
  v_exp_f32 v116, v116
  v_exp_f32 v117, v117
  v_mfma_f32_32x32x16_bf16 v[144:159], a[188:191], v[92:95], v[144:159]
  v_mov_b32 v19, v96
  v_add_f32 v19, v19, v97
  v_add_f32 v19, v19, v98
  v_add_f32 v19, v19, v99
  v_add_f32 v19, v19, v100
  v_add_f32 v19, v19, v101
  v_add_f32 v19, v19, v102
  v_add_f32 v19, v19, v103
  v_add_f32 v19, v19, v104
  v_add_f32 v19, v19, v105
  v_add_f32 v19, v19, v106
  v_add_f32 v19, v19, v107
  v_add_f32 v19, v19, v108
  v_add_f32 v19, v19, v109
  v_add_f32 v19, v19, v110
  v_add_f32 v19, v19, v111
  v_add_f32 v19, v19, v112
  v_add_f32 v19, v19, v113
  v_add_f32 v19, v19, v114
  v_add_f32 v19, v19, v115
  v_add_f32 v19, v19, v116
  v_cvt_pk_bf16_f32 v160, v96, v97
  v_cvt_pk_bf16_f32 v161, v98, v99
  v_cvt_pk_bf16_f32 v162, v100, v101
  v_cvt_pk_bf16_f32 v163, v102, v103
  v_cvt_pk_bf16_f32 v164, v104, v105
  v_cvt_pk_bf16_f32 v165, v106, v107
  v_cvt_pk_bf16_f32 v166, v108, v109
  v_cvt_pk_bf16_f32 v167, v110, v111
  s_cmp_lg_u32 s51, 0
  s_cbranch_scc1 L_t0nomask
  s_add_u32 s100, s66, 0
  v_subrev_u32 v21, s100, v18
  v_cmp_ge_i32 s[60:61], v21, 0
  v_cmp_ge_i32 s[62:63], v21, 1
  v_cmp_ge_i32 s[4:5], v21, 2
  v_cndmask_b32 v128, v29, v128, s[60:61]
  v_cmp_ge_i32 s[6:7], v21, 3
  v_cndmask_b32 v129, v29, v129, s[62:63]
  v_cmp_ge_i32 s[60:61], v21, 8
  v_cndmask_b32 v130, v29, v130, s[4:5]
  v_cmp_ge_i32 s[62:63], v21, 9
  v_cndmask_b32 v131, v29, v131, s[6:7]
  v_cmp_ge_i32 s[4:5], v21, 10
  v_cndmask_b32 v132, v29, v132, s[60:61]
  v_cmp_ge_i32 s[6:7], v21, 11
  v_cndmask_b32 v133, v29, v133, s[62:63]
  v_cmp_ge_i32 s[60:61], v21, 16
  v_cndmask_b32 v134, v29, v134, s[4:5]
  v_cmp_ge_i32 s[62:63], v21, 17
  v_cndmask_b32 v135, v29, v135, s[6:7]
  v_cmp_ge_i32 s[4:5], v21, 18
  v_cndmask_b32 v136, v29, v136, s[60:61]
  v_cmp_ge_i32 s[6:7], v21, 19
  v_cndmask_b32 v137, v29, v137, s[62:63]
  v_cmp_ge_i32 s[60:61], v21, 24
  v_cndmask_b32 v138, v29, v138, s[4:5]
  v_cmp_ge_i32 s[62:63], v21, 25
  v_cndmask_b32 v139, v29, v139, s[6:7]
  v_cmp_ge_i32 s[4:5], v21, 26
  v_cndmask_b32 v140, v29, v140, s[60:61]
  v_cmp_ge_i32 s[6:7], v21, 27
  v_cndmask_b32 v141, v29, v141, s[62:63]
  v_cndmask_b32 v142, v29, v142, s[4:5]
  v_cndmask_b32 v143, v29, v143, s[6:7]
  s_add_u32 s100, s66, 32
  v_subrev_u32 v21, s100, v18
  v_cmp_ge_i32 s[60:61], v21, 0
  v_cmp_ge_i32 s[62:63], v21, 1
  v_cmp_ge_i32 s[4:5], v21, 2
  v_cndmask_b32 v144, v29, v144, s[60:61]
  v_cmp_ge_i32 s[6:7], v21, 3
  v_cndmask_b32 v145, v29, v145, s[62:63]
  v_cmp_ge_i32 s[60:61], v21, 8
  v_cndmask_b32 v146, v29, v146, s[4:5]
  v_cmp_ge_i32 s[62:63], v21, 9
  v_cndmask_b32 v147, v29, v147, s[6:7]
  v_cmp_ge_i32 s[4:5], v21, 10
  v_cndmask_b32 v148, v29, v148, s[60:61]
  v_cmp_ge_i32 s[6:7], v21, 11
  v_cndmask_b32 v149, v29, v149, s[62:63]
  v_cmp_ge_i32 s[60:61], v21, 16
  v_cndmask_b32 v150, v29, v150, s[4:5]
  v_cmp_ge_i32 s[62:63], v21, 17
  v_cndmask_b32 v151, v29, v151, s[6:7]
  v_cmp_ge_i32 s[4:5], v21, 18
  v_cndmask_b32 v152, v29, v152, s[60:61]
  v_cmp_ge_i32 s[6:7], v21, 19
  v_cndmask_b32 v153, v29, v153, s[62:63]
  v_cmp_ge_i32 s[60:61], v21, 24
  v_cndmask_b32 v154, v29, v154, s[4:5]
  v_cmp_ge_i32 s[62:63], v21, 25
  v_cndmask_b32 v155, v29, v155, s[6:7]
  v_cmp_ge_i32 s[4:5], v21, 26
  v_cndmask_b32 v156, v29, v156, s[60:61]
  v_cmp_ge_i32 s[6:7], v21, 27
  v_cndmask_b32 v157, v29, v157, s[62:63]
  v_cndmask_b32 v158, v29, v158, s[4:5]
  v_cndmask_b32 v159, v29, v159, s[6:7]
L_t0nomask:
  v_max3_f32 v226, v128, v129, v130
  v_max3_f32 v226, v226, v131, v132
  v_max3_f32 v226, v226, v133, v134
  v_max3_f32 v226, v226, v135, v136
  v_max3_f32 v226, v226, v137, v138
  v_max3_f32 v226, v226, v139, v140
  v_max3_f32 v226, v226, v141, v142
  v_max3_f32 v226, v226, v143, v144
  v_max3_f32 v226, v226, v145, v146
  v_max3_f32 v226, v226, v147, v148
  v_max3_f32 v226, v226, v149, v150
  v_max3_f32 v226, v226, v151, v152
  v_max3_f32 v226, v226, v153, v154
  v_max3_f32 v226, v226, v155, v156
  v_max3_f32 v226, v226, v157, v158
  v_max_f32 v226, v226, v159
  v_mov_b32 v227, v226
  s_nop 1
  v_permlane32_swap_b32 v226, v227
  s_nop 1
  v_max_f32 v226, v226, v227
  v_sub_f32 v208, 0, v226
  v_mov_b32 v209, v208
  v_mov_b32 v210, v208
  v_mov_b32 v211, v208
  v_mov_b32 v212, v208
  v_mov_b32 v213, v208
  v_mov_b32 v214, v208
  v_mov_b32 v215, v208
  v_mov_b32 v216, v208
  v_mov_b32 v217, v208
  v_mov_b32 v218, v208
  v_mov_b32 v219, v208
  v_mov_b32 v220, v208
  v_mov_b32 v221, v208
  v_mov_b32 v222, v208
  v_mov_b32 v223, v208
  v_add_f32 v128, v128, v208
  v_add_f32 v129, v129, v208
  v_add_f32 v130, v130, v208
  v_add_f32 v131, v131, v208
  v_add_f32 v132, v132, v208
  v_add_f32 v133, v133, v208
  v_add_f32 v134, v134, v208
  v_add_f32 v135, v135, v208
  v_add_f32 v136, v136, v208
  v_add_f32 v137, v137, v208
  v_add_f32 v138, v138, v208
  v_add_f32 v139, v139, v208
  v_add_f32 v140, v140, v208
  v_add_f32 v141, v141, v208
  v_add_f32 v142, v142, v208
  v_add_f32 v143, v143, v208
  v_add_f32 v144, v144, v208
  v_add_f32 v145, v145, v208
  v_add_f32 v146, v146, v208
  v_add_f32 v147, v147, v208
  v_add_f32 v148, v148, v208
  v_add_f32 v149, v149, v208
  v_add_f32 v150, v150, v208
  v_add_f32 v151, v151, v208
  v_add_f32 v152, v152, v208
  v_add_f32 v153, v153, v208
  v_add_f32 v154, v154, v208
  v_add_f32 v155, v155, v208
  v_add_f32 v156, v156, v208
  v_add_f32 v157, v157, v208
  v_add_f32 v158, v158, v208
  v_add_f32 v159, v159, v208
  v_exp_f32 v128, v128
  v_exp_f32 v129, v129
  v_exp_f32 v130, v130
  v_exp_f32 v131, v131
  v_exp_f32 v132, v132
  v_exp_f32 v133, v133
  v_exp_f32 v134, v134
  v_exp_f32 v135, v135
  v_exp_f32 v136, v136
  v_exp_f32 v137, v137
  v_exp_f32 v138, v138
  v_exp_f32 v139, v139
  v_exp_f32 v140, v140
  v_exp_f32 v141, v141
  v_exp_f32 v142, v142
  v_exp_f32 v143, v143
  v_exp_f32 v144, v144
  v_exp_f32 v145, v145
  v_exp_f32 v146, v146
  v_exp_f32 v147, v147
  v_exp_f32 v148, v148
  v_exp_f32 v149, v149
  v_mov_b32 v22, v128
  v_add_f32 v22, v22, v129
  v_add_f32 v22, v22, v130
  v_add_f32 v22, v22, v131
  v_add_f32 v22, v22, v132
  v_add_f32 v22, v22, v133
  v_add_f32 v22, v22, v134
  v_add_f32 v22, v22, v135
  v_add_f32 v22, v22, v136
  v_add_f32 v22, v22, v137
  v_add_f32 v22, v22, v138
  v_add_f32 v22, v22, v139
  v_add_f32 v22, v22, v140
  v_add_f32 v22, v22, v141
  v_add_f32 v22, v22, v142
  v_add_f32 v22, v22, v143
  v_add_f32 v22, v22, v144
  v_add_f32 v22, v22, v145
  v_add_f32 v22, v22, v146
  v_add_f32 v22, v22, v147
  v_add_f32 v22, v22, v148
  v_cvt_pk_bf16_f32 v176, v128, v129
  v_cvt_pk_bf16_f32 v177, v130, v131
  v_cvt_pk_bf16_f32 v178, v132, v133
  v_cvt_pk_bf16_f32 v179, v134, v135
  v_cvt_pk_bf16_f32 v180, v136, v137
  v_cvt_pk_bf16_f32 v181, v138, v139
  v_cvt_pk_bf16_f32 v182, v140, v141
  v_cvt_pk_bf16_f32 v183, v142, v143
  v_accvgpr_write_b32 a80, 0
  v_accvgpr_write_b32 a81, 0
  v_accvgpr_write_b32 a82, 0
  v_accvgpr_write_b32 a83, 0
  v_accvgpr_write_b32 a84, 0
  v_accvgpr_write_b32 a85, 0
  v_accvgpr_write_b32 a86, 0
  v_accvgpr_write_b32 a87, 0
  v_accvgpr_write_b32 a88, 0
  v_accvgpr_write_b32 a89, 0
  v_accvgpr_write_b32 a90, 0
  v_accvgpr_write_b32 a91, 0
  v_accvgpr_write_b32 a92, 0
  v_accvgpr_write_b32 a93, 0
  v_accvgpr_write_b32 a94, 0
  v_accvgpr_write_b32 a95, 0
  v_accvgpr_write_b32 a96, 0
  v_accvgpr_write_b32 a97, 0
  v_accvgpr_write_b32 a98, 0
  v_accvgpr_write_b32 a99, 0
  v_accvgpr_write_b32 a100, 0
  v_accvgpr_write_b32 a101, 0
  v_accvgpr_write_b32 a102, 0
  v_accvgpr_write_b32 a103, 0
  v_accvgpr_write_b32 a104, 0
  v_accvgpr_write_b32 a105, 0
  v_accvgpr_write_b32 a106, 0
  v_accvgpr_write_b32 a107, 0
  v_accvgpr_write_b32 a108, 0
  v_accvgpr_write_b32 a109, 0
  v_accvgpr_write_b32 a110, 0
  v_accvgpr_write_b32 a111, 0
  v_accvgpr_write_b32 a112, 0
  v_accvgpr_write_b32 a113, 0
  v_accvgpr_write_b32 a114, 0
  v_accvgpr_write_b32 a115, 0
  v_accvgpr_write_b32 a116, 0
  v_accvgpr_write_b32 a117, 0
  v_accvgpr_write_b32 a118, 0
  v_accvgpr_write_b32 a119, 0
  v_accvgpr_write_b32 a120, 0
  v_accvgpr_write_b32 a121, 0
  v_accvgpr_write_b32 a122, 0
  v_accvgpr_write_b32 a123, 0
  v_accvgpr_write_b32 a124, 0
  v_accvgpr_write_b32 a125, 0
  v_accvgpr_write_b32 a126, 0
  v_accvgpr_write_b32 a127, 0
  s_waitcnt vmcnt(0) lgkmcnt(0)
  s_barrier
  s_cmp_lg_u32 s3, 0
  s_cbranch_scc1 L_pubgu
  v_mov_b32 v14, s88
  v_mov_b32 v15, 0
  s_lshl_b32 s4, s35, 5
  s_add_u32 s4, s4, s36
  s_lshl_b32 s4, s4, 2
  s_add_u32 s4, s4, 2048
  s_mov_b64 exec, 1
  buffer_store_dword v14, v15, s[8:11], s4 offen sc1
  s_mov_b64 exec, -1
L_pubgu:
  s_add_u32 m0, s43, 98304
  s_nop 0
  buffer_load_dwordx4 v13, s[16:19], s39 offen offset:0 sc1 lds
  buffer_load_dwordx4 v13, s[16:19], s39 offen offset:1024 sc1 lds
  buffer_load_dwordx4 v13, s[16:19], s39 offen offset:2048 sc1 lds
  buffer_load_dwordx4 v13, s[16:19], s39 offen offset:3072 sc1 lds
  s_add_u32 s39, s39, 16384
  s_add_u32 m0, s43, 32768
  s_nop 0
  buffer_load_dwordx4 v13, s[20:23], s41 offen offset:0 sc1 lds
  buffer_load_dwordx4 v13, s[20:23], s41 offen offset:1024 sc1 lds
  buffer_load_dwordx4 v13, s[20:23], s41 offen offset:2048 sc1 lds
  buffer_load_dwordx4 v13, s[20:23], s41 offen offset:3072 sc1 lds
  s_add_u32 s41, s41, 16384
  s_mov_b32 s55, 16384
  s_mov_b32 s38, 32768
  s_mov_b32 s42, 49152
  s_mov_b32 s66, 64
  s_add_u32 s44, s43, 98304
  v_add_u32 v3, 98304, v2
  v_add_u32 v16, 114688, v2
  v_mov_b32 v6, v2
  ds_read_b128 a[128:131], v16 offset:0
  ds_read_b128 a[132:135], v16 offset:1024
  ds_read_b128 a[136:139], v16 offset:2048
  ds_read_b128 a[140:143], v16 offset:3072
  ds_read_b128 a[144:147], v16 offset:4096
  ds_read_b128 a[148:151], v16 offset:5120
  ds_read_b128 a[152:155], v16 offset:6144
  ds_read_b128 a[156:159], v16 offset:7168
  ds_read_b128 a[160:163], v6 offset:0
  ds_read_b128 a[164:167], v6 offset:1024
  ds_read_b128 a[168:171], v6 offset:2048
  ds_read_b128 a[172:175], v6 offset:3072
  s_sub_u32 s54, s52, 3
  s_max_i32 s54, s54, 0
  s_cmp_eq_u32 s54, 0
  s_cbranch_scc1 LAT_A_end
  s_sub_u32 s54, 0, s54
.p2align 6
LAT_A:
  s_waitcnt lgkmcnt(4)
  v_mfma_f32_32x32x16_bf16 v[96:111], a[128:131], v[32:35], v[192:207]
  ds_read_b128 a[176:179], v6 offset:4096
  v_exp_f32 v118, v118
  v_add_f32 v19, v19, v117
  v_cvt_pk_bf16_f32 v168, v112, v113
  v_mfma_f32_32x32x16_bf16 v[128:143], a[128:131], v[64:67], v[208:223]
  v_exp_f32 v150, v150
  v_add_f32 v22, v22, v149
  v_cvt_pk_bf16_f32 v184, v144, v145
  v_mfma_f32_32x32x16_bf16 v[96:111], a[132:135], v[36:39], v[96:111]
  ds_read_b128 a[180:183], v6 offset:5120
  v_exp_f32 v119, v119
  v_add_f32 v19, v19, v118
  v_mfma_f32_32x32x16_bf16 v[128:143], a[132:135], v[68:71], v[128:143]
  v_exp_f32 v151, v151
  v_add_f32 v22, v22, v150
  v_mfma_f32_32x32x16_bf16 v[96:111], a[136:139], v[40:43], v[96:111]
  ds_read_b128 a[184:187], v6 offset:6144
  v_exp_f32 v120, v120
  v_add_f32 v19, v19, v119
  v_cvt_pk_bf16_f32 v169, v114, v115
  v_mfma_f32_32x32x16_bf16 v[128:143], a[136:139], v[72:75], v[128:143]
  v_exp_f32 v152, v152
  v_add_f32 v22, v22, v151
  v_cvt_pk_bf16_f32 v185, v146, v147
  v_mfma_f32_32x32x16_bf16 v[96:111], a[140:143], v[44:47], v[96:111]
  ds_read_b128 a[188:191], v6 offset:7168
  v_exp_f32 v121, v121
  v_add_f32 v19, v19, v120
  v_mfma_f32_32x32x16_bf16 v[128:143], a[140:143], v[76:79], v[128:143]
  v_exp_f32 v153, v153
  v_add_f32 v22, v22, v152
  v_mfma_f32_32x32x16_bf16 v[96:111], a[144:147], v[48:51], v[96:111]
  ds_read_b128 a[128:131], v16 offset:8192
  v_exp_f32 v122, v122
  v_add_f32 v19, v19, v121
  v_cvt_pk_bf16_f32 v170, v116, v117
  v_mfma_f32_32x32x16_bf16 v[128:143], a[144:147], v[80:83], v[128:143]
  v_exp_f32 v154, v154
  v_add_f32 v22, v22, v153
  v_cvt_pk_bf16_f32 v186, v148, v149
  v_mfma_f32_32x32x16_bf16 v[96:111], a[148:151], v[52:55], v[96:111]
  ds_read_b128 a[132:135], v16 offset:9216
  v_exp_f32 v123, v123
  v_add_f32 v19, v19, v122
  v_mfma_f32_32x32x16_bf16 v[128:143], a[148:151], v[84:87], v[128:143]
  v_exp_f32 v155, v155
  v_add_f32 v22, v22, v154
  v_mfma_f32_32x32x16_bf16 v[96:111], a[152:155], v[56:59], v[96:111]
  ds_read_b128 a[136:139], v16 offset:10240
  v_exp_f32 v124, v124
  v_add_f32 v19, v19, v123
  v_cvt_pk_bf16_f32 v171, v118, v119
  v_mfma_f32_32x32x16_bf16 v[128:143], a[152:155], v[88:91], v[128:143]
  v_exp_f32 v156, v156
  v_add_f32 v22, v22, v155
  v_cvt_pk_bf16_f32 v187, v150, v151
  v_mfma_f32_32x32x16_bf16 v[96:111], a[156:159], v[60:63], v[96:111]
  ds_read_b128 a[140:143], v16 offset:11264
  v_exp_f32 v125, v125
  v_add_f32 v19, v19, v124
  v_mfma_f32_32x32x16_bf16 v[128:143], a[156:159], v[92:95], v[128:143]
  v_exp_f32 v157, v157
  v_add_f32 v22, v22, v156
  s_waitcnt lgkmcnt(4)
  v_mfma_f32_32x32x16_bf16 a[0:15], a[160:163], v[160:163], a[0:15]
  ds_read_b128 a[144:147], v16 offset:12288
  v_exp_f32 v126, v126
  v_add_f32 v19, v19, v125
  v_cvt_pk_bf16_f32 v172, v120, v121
  v_mfma_f32_32x32x16_bf16 a[64:79], a[160:163], v[176:179], a[64:79]
  v_exp_f32 v158, v158
  v_add_f32 v22, v22, v157
  v_cvt_pk_bf16_f32 v188, v152, v153
  v_mfma_f32_32x32x16_bf16 a[16:31], a[164:167], v[160:163], a[16:31]
  ds_read_b128 a[148:151], v16 offset:13312
  v_exp_f32 v127, v127
  v_add_f32 v19, v19, v126
  v_mfma_f32_32x32x16_bf16 a[80:95], a[164:167], v[176:179], a[80:95]
  v_exp_f32 v159, v159
  v_add_f32 v22, v22, v158
  v_mfma_f32_32x32x16_bf16 a[32:47], a[168:171], v[160:163], a[32:47]
  ds_read_b128 a[152:155], v16 offset:14336
  v_exp_f32 v96, v96
  v_add_f32 v19, v19, v127
  v_cvt_pk_bf16_f32 v173, v122, v123
  v_mfma_f32_32x32x16_bf16 a[96:111], a[168:171], v[176:179], a[96:111]
  v_exp_f32 v128, v128
  v_add_f32 v22, v22, v159
  v_cvt_pk_bf16_f32 v189, v154, v155
  v_mfma_f32_32x32x16_bf16 a[48:63], a[172:175], v[160:163], a[48:63]
  ds_read_b128 a[156:159], v16 offset:15360
  v_exp_f32 v97, v97
  v_add_f32 v19, v19, v96
  v_mfma_f32_32x32x16_bf16 a[112:127], a[172:175], v[176:179], a[112:127]
  v_exp_f32 v129, v129
  v_add_f32 v22, v22, v128
  v_mfma_f32_32x32x16_bf16 a[0:15], a[176:179], v[164:167], a[0:15]
  ds_read_b128 a[160:163], v6 offset:8192
  v_exp_f32 v98, v98
  v_add_f32 v19, v19, v97
  v_cvt_pk_bf16_f32 v174, v124, v125
  v_mfma_f32_32x32x16_bf16 a[64:79], a[176:179], v[180:183], a[64:79]
  v_exp_f32 v130, v130
  v_add_f32 v22, v22, v129
  v_cvt_pk_bf16_f32 v190, v156, v157
  v_mfma_f32_32x32x16_bf16 a[16:31], a[180:183], v[164:167], a[16:31]
  ds_read_b128 a[164:167], v6 offset:9216
  v_exp_f32 v99, v99
  v_add_f32 v19, v19, v98
  v_mfma_f32_32x32x16_bf16 a[80:95], a[180:183], v[180:183], a[80:95]
  v_exp_f32 v131, v131
  v_add_f32 v22, v22, v130
  v_mfma_f32_32x32x16_bf16 a[32:47], a[184:187], v[164:167], a[32:47]
  ds_read_b128 a[168:171], v6 offset:10240
  v_exp_f32 v100, v100
  v_add_f32 v19, v19, v99
  v_cvt_pk_bf16_f32 v175, v126, v127
  v_mfma_f32_32x32x16_bf16 a[96:111], a[184:187], v[180:183], a[96:111]
  v_exp_f32 v132, v132
  v_add_f32 v22, v22, v131
  v_cvt_pk_bf16_f32 v191, v158, v159
  v_mfma_f32_32x32x16_bf16 a[48:63], a[188:191], v[164:167], a[48:63]
  ds_read_b128 a[172:175], v6 offset:11264
  v_exp_f32 v101, v101
  v_add_f32 v19, v19, v100
  v_mfma_f32_32x32x16_bf16 a[112:127], a[188:191], v[180:183], a[112:127]
  v_exp_f32 v133, v133
  v_add_f32 v22, v22, v132
  s_waitcnt lgkmcnt(4)
  v_mfma_f32_32x32x16_bf16 v[112:127], a[128:131], v[32:35], v[192:207]
  ds_read_b128 a[176:179], v6 offset:12288
  v_exp_f32 v102, v102
  v_add_f32 v19, v19, v101
  v_cvt_pk_bf16_f32 v160, v96, v97
  v_mfma_f32_32x32x16_bf16 v[144:159], a[128:131], v[64:67], v[208:223]
  v_exp_f32 v134, v134
  v_add_f32 v22, v22, v133
  v_cvt_pk_bf16_f32 v176, v128, v129
  v_mfma_f32_32x32x16_bf16 v[112:127], a[132:135], v[36:39], v[112:127]
  ds_read_b128 a[180:183], v6 offset:13312
  v_exp_f32 v103, v103
  v_add_f32 v19, v19, v102
  v_mfma_f32_32x32x16_bf16 v[144:159], a[132:135], v[68:71], v[144:159]
  v_exp_f32 v135, v135
  v_add_f32 v22, v22, v134
  v_mfma_f32_32x32x16_bf16 v[112:127], a[136:139], v[40:43], v[112:127]
  ds_read_b128 a[184:187], v6 offset:14336
  v_add_u32 v16, s38, v3
  v_exp_f32 v104, v104
  v_add_f32 v19, v19, v103
  v_cvt_pk_bf16_f32 v161, v98, v99
  v_mfma_f32_32x32x16_bf16 v[144:159], a[136:139], v[72:75], v[144:159]
  v_exp_f32 v136, v136
  v_add_f32 v22, v22, v135
  v_cvt_pk_bf16_f32 v177, v130, v131
  v_mfma_f32_32x32x16_bf16 v[112:127], a[140:143], v[44:47], v[112:127]
  ds_read_b128 a[188:191], v6 offset:15360
  v_exp_f32 v105, v105
  v_add_f32 v19, v19, v104
  v_mfma_f32_32x32x16_bf16 v[144:159], a[140:143], v[76:79], v[144:159]
  v_exp_f32 v137, v137
  v_add_f32 v22, v22, v136
  s_waitcnt vmcnt(8)
  s_barrier
  v_mfma_f32_32x32x16_bf16 v[112:127], a[144:147], v[48:51], v[112:127]
  ds_read_b128 a[128:131], v16 offset:0
  s_add_u32 m0, s55, s44
  s_nop 0
  buffer_load_dwordx4 v13, s[16:19], s39 offen offset:0 sc1 lds
  v_exp_f32 v106, v106
  v_add_f32 v19, v19, v105
  v_cvt_pk_bf16_f32 v162, v100, v101
  v_mfma_f32_32x32x16_bf16 v[144:159], a[144:147], v[80:83], v[144:159]
  v_exp_f32 v138, v138
  v_add_f32 v22, v22, v137
  v_cvt_pk_bf16_f32 v178, v132, v133
  v_mfma_f32_32x32x16_bf16 v[112:127], a[148:151], v[52:55], v[112:127]
  ds_read_b128 a[132:135], v16 offset:1024
  buffer_load_dwordx4 v13, s[16:19], s39 offen offset:1024 sc1 lds
  v_exp_f32 v107, v107
  v_add_f32 v19, v19, v106
  v_mfma_f32_32x32x16_bf16 v[144:159], a[148:151], v[84:87], v[144:159]
  v_exp_f32 v139, v139
  v_add_f32 v22, v22, v138
  v_mfma_f32_32x32x16_bf16 v[112:127], a[152:155], v[56:59], v[112:127]
  ds_read_b128 a[136:139], v16 offset:2048
  v_add_u32 v6, s55, v2
  buffer_load_dwordx4 v13, s[16:19], s39 offen offset:2048 sc1 lds
  v_exp_f32 v108, v108
  v_add_f32 v19, v19, v107
  v_cvt_pk_bf16_f32 v163, v102, v103
  v_mfma_f32_32x32x16_bf16 v[144:159], a[152:155], v[88:91], v[144:159]
  v_exp_f32 v140, v140
  v_add_f32 v22, v22, v139
  v_cvt_pk_bf16_f32 v179, v134, v135
  v_mfma_f32_32x32x16_bf16 v[112:127], a[156:159], v[60:63], v[112:127]
  ds_read_b128 a[140:143], v16 offset:3072
  buffer_load_dwordx4 v13, s[16:19], s39 offen offset:3072 sc1 lds
  s_add_u32 m0, s42, s43
  s_add_u32 s39, s39, 16384
  v_exp_f32 v109, v109
  v_add_f32 v19, v19, v108
  v_mfma_f32_32x32x16_bf16 v[144:159], a[156:159], v[92:95], v[144:159]
  v_exp_f32 v141, v141
  v_add_f32 v22, v22, v140
  s_waitcnt lgkmcnt(4)
  v_mfma_f32_32x32x16_bf16 a[0:15], a[160:163], v[168:171], a[0:15]
  ds_read_b128 a[144:147], v16 offset:4096
  buffer_load_dwordx4 v13, s[20:23], s41 offen offset:0 sc1 lds
  v_exp_f32 v110, v110
  v_add_f32 v19, v19, v109
  v_cvt_pk_bf16_f32 v164, v104, v105
  v_mfma_f32_32x32x16_bf16 a[64:79], a[160:163], v[184:187], a[64:79]
  v_exp_f32 v142, v142
  v_add_f32 v22, v22, v141
  v_cvt_pk_bf16_f32 v180, v136, v137
  v_mfma_f32_32x32x16_bf16 a[16:31], a[164:167], v[168:171], a[16:31]
  ds_read_b128 a[148:151], v16 offset:5120
  buffer_load_dwordx4 v13, s[20:23], s41 offen offset:1024 sc1 lds
  v_exp_f32 v111, v111
  v_add_f32 v19, v19, v110
  v_mfma_f32_32x32x16_bf16 a[80:95], a[164:167], v[184:187], a[80:95]
  v_exp_f32 v143, v143
  v_add_f32 v22, v22, v142
  v_mfma_f32_32x32x16_bf16 a[32:47], a[168:171], v[168:171], a[32:47]
  ds_read_b128 a[152:155], v16 offset:6144
  buffer_load_dwordx4 v13, s[20:23], s41 offen offset:2048 sc1 lds
  v_exp_f32 v112, v112
  v_add_f32 v19, v19, v111
  v_cvt_pk_bf16_f32 v165, v106, v107
  v_mfma_f32_32x32x16_bf16 a[96:111], a[168:171], v[184:187], a[96:111]
  v_exp_f32 v144, v144
  v_add_f32 v22, v22, v143
  v_cvt_pk_bf16_f32 v181, v138, v139
  v_mfma_f32_32x32x16_bf16 a[48:63], a[172:175], v[168:171], a[48:63]
  ds_read_b128 a[156:159], v16 offset:7168
  buffer_load_dwordx4 v13, s[20:23], s41 offen offset:3072 sc1 lds
  s_add_u32 s41, s41, 16384
  v_exp_f32 v113, v113
  v_add_f32 v19, v19, v112
  v_mfma_f32_32x32x16_bf16 a[112:127], a[172:175], v[184:187], a[112:127]
  v_exp_f32 v145, v145
  v_add_f32 v22, v22, v144
  v_mfma_f32_32x32x16_bf16 a[0:15], a[176:179], v[172:175], a[0:15]
  ds_read_b128 a[160:163], v6 offset:0
  v_exp_f32 v114, v114
  v_add_f32 v19, v19, v113
  v_cvt_pk_bf16_f32 v166, v108, v109
  v_mfma_f32_32x32x16_bf16 a[64:79], a[176:179], v[188:191], a[64:79]
  v_exp_f32 v146, v146
  v_add_f32 v22, v22, v145
  v_cvt_pk_bf16_f32 v182, v140, v141
  v_mfma_f32_32x32x16_bf16 a[16:31], a[180:183], v[172:175], a[16:31]
  ds_read_b128 a[164:167], v6 offset:1024
  s_mov_b32 s55, s38
  s_mov_b32 s38, s42
  v_exp_f32 v115, v115
  v_add_f32 v19, v19, v114
  v_mfma_f32_32x32x16_bf16 a[80:95], a[180:183], v[188:191], a[80:95]
  v_exp_f32 v147, v147
  v_add_f32 v22, v22, v146
  v_mfma_f32_32x32x16_bf16 a[32:47], a[184:187], v[172:175], a[32:47]
  ds_read_b128 a[168:171], v6 offset:2048
  s_add_u32 s42, s42, 16384
  s_and_b32 s42, s42, 0xffff
  v_exp_f32 v116, v116
  v_add_f32 v19, v19, v115
  v_cvt_pk_bf16_f32 v167, v110, v111
  v_mfma_f32_32x32x16_bf16 a[96:111], a[184:187], v[188:191], a[96:111]
  v_exp_f32 v148, v148
  v_add_f32 v22, v22, v147
  v_cvt_pk_bf16_f32 v183, v142, v143
  v_mfma_f32_32x32x16_bf16 a[48:63], a[188:191], v[172:175], a[48:63]
  ds_read_b128 a[172:175], v6 offset:3072
  v_exp_f32 v117, v117
  v_add_f32 v19, v19, v116
  v_mfma_f32_32x32x16_bf16 a[112:127], a[188:191], v[188:191], a[112:127]
  v_exp_f32 v149, v149
  v_add_f32 v22, v22, v148
  s_add_u32 s54, s54, 1
  s_cbranch_scc0 LAT_A
LAT_A_end:
  s_sub_u32 s54, s52, 1
  s_min_u32 s54, s54, 2
  s_sub_u32 s66, s52, s54
  s_lshl_b32 s66, s66, 6
  s_cmp_eq_u32 s54, 0
  s_cbranch_scc1 LAT_B_end
  s_sub_u32 s54, 0, s54
.p2align 6
LAT_B:
  s_waitcnt lgkmcnt(4)
  v_mfma_f32_32x32x16_bf16 v[96:111], a[128:131], v[32:35], v[192:207]
  ds_read_b128 a[176:179], v6 offset:4096
  v_exp_f32 v118, v118
  v_add_f32 v19, v19, v117
  v_cvt_pk_bf16_f32 v168, v112, v113
  v_mfma_f32_32x32x16_bf16 v[128:143], a[128:131], v[64:67], v[208:223]
  v_exp_f32 v150, v150
  v_add_f32 v22, v22, v149
  v_cvt_pk_bf16_f32 v184, v144, v145
  v_mfma_f32_32x32x16_bf16 v[96:111], a[132:135], v[36:39], v[96:111]
  ds_read_b128 a[180:183], v6 offset:5120
  v_exp_f32 v119, v119
  v_add_f32 v19, v19, v118
  v_mfma_f32_32x32x16_bf16 v[128:143], a[132:135], v[68:71], v[128:143]
  v_exp_f32 v151, v151
  v_add_f32 v22, v22, v150
  v_mfma_f32_32x32x16_bf16 v[96:111], a[136:139], v[40:43], v[96:111]
  ds_read_b128 a[184:187], v6 offset:6144
  v_exp_f32 v120, v120
  v_add_f32 v19, v19, v119
  v_cvt_pk_bf16_f32 v169, v114, v115
  v_mfma_f32_32x32x16_bf16 v[128:143], a[136:139], v[72:75], v[128:143]
  v_exp_f32 v152, v152
  v_add_f32 v22, v22, v151
  v_cvt_pk_bf16_f32 v185, v146, v147
  v_mfma_f32_32x32x16_bf16 v[96:111], a[140:143], v[44:47], v[96:111]
  ds_read_b128 a[188:191], v6 offset:7168
  v_exp_f32 v121, v121
  v_add_f32 v19, v19, v120
  v_mfma_f32_32x32x16_bf16 v[128:143], a[140:143], v[76:79], v[128:143]
  v_exp_f32 v153, v153
  v_add_f32 v22, v22, v152
  v_mfma_f32_32x32x16_bf16 v[96:111], a[144:147], v[48:51], v[96:111]
  ds_read_b128 a[128:131], v16 offset:8192
  v_exp_f32 v122, v122
  v_add_f32 v19, v19, v121
  v_cvt_pk_bf16_f32 v170, v116, v117
  v_mfma_f32_32x32x16_bf16 v[128:143], a[144:147], v[80:83], v[128:143]
  v_exp_f32 v154, v154
  v_add_f32 v22, v22, v153
  v_cvt_pk_bf16_f32 v186, v148, v149
  v_mfma_f32_32x32x16_bf16 v[96:111], a[148:151], v[52:55], v[96:111]
  ds_read_b128 a[132:135], v16 offset:9216
  v_exp_f32 v123, v123
  v_add_f32 v19, v19, v122
  v_mfma_f32_32x32x16_bf16 v[128:143], a[148:151], v[84:87], v[128:143]
  v_exp_f32 v155, v155
  v_add_f32 v22, v22, v154
  v_mfma_f32_32x32x16_bf16 v[96:111], a[152:155], v[56:59], v[96:111]
  ds_read_b128 a[136:139], v16 offset:10240
  v_exp_f32 v124, v124
  v_add_f32 v19, v19, v123
  v_cvt_pk_bf16_f32 v171, v118, v119
  v_mfma_f32_32x32x16_bf16 v[128:143], a[152:155], v[88:91], v[128:143]
  v_exp_f32 v156, v156
  v_add_f32 v22, v22, v155
  v_cvt_pk_bf16_f32 v187, v150, v151
  v_mfma_f32_32x32x16_bf16 v[96:111], a[156:159], v[60:63], v[96:111]
  ds_read_b128 a[140:143], v16 offset:11264
  v_exp_f32 v125, v125
  v_add_f32 v19, v19, v124
  v_mfma_f32_32x32x16_bf16 v[128:143], a[156:159], v[92:95], v[128:143]
  v_exp_f32 v157, v157
  v_add_f32 v22, v22, v156
  s_waitcnt lgkmcnt(4)
  v_mfma_f32_32x32x16_bf16 a[0:15], a[160:163], v[160:163], a[0:15]
  ds_read_b128 a[144:147], v16 offset:12288
  v_exp_f32 v126, v126
  v_add_f32 v19, v19, v125
  v_cvt_pk_bf16_f32 v172, v120, v121
  v_mfma_f32_32x32x16_bf16 a[64:79], a[160:163], v[176:179], a[64:79]
  v_exp_f32 v158, v158
  v_add_f32 v22, v22, v157
  v_cvt_pk_bf16_f32 v188, v152, v153
  v_mfma_f32_32x32x16_bf16 a[16:31], a[164:167], v[160:163], a[16:31]
  ds_read_b128 a[148:151], v16 offset:13312
  v_exp_f32 v127, v127
  v_add_f32 v19, v19, v126
  v_mfma_f32_32x32x16_bf16 a[80:95], a[164:167], v[176:179], a[80:95]
  v_exp_f32 v159, v159
  v_add_f32 v22, v22, v158
  v_mfma_f32_32x32x16_bf16 a[32:47], a[168:171], v[160:163], a[32:47]
  ds_read_b128 a[152:155], v16 offset:14336
  s_add_u32 s100, s66, 0
  v_subrev_u32 v21, s100, v18
  v_cmp_ge_i32 s[60:61], v21, 0
  v_cmp_ge_i32 s[62:63], v21, 1
  v_cmp_ge_i32 s[4:5], v21, 2
  v_cndmask_b32 v128, v29, v128, s[60:61]
  v_cmp_ge_i32 s[6:7], v21, 3
  v_cndmask_b32 v129, v29, v129, s[62:63]
  v_cmp_ge_i32 s[60:61], v21, 8
  v_cndmask_b32 v130, v29, v130, s[4:5]
  v_cmp_ge_i32 s[62:63], v21, 9
  v_cndmask_b32 v131, v29, v131, s[6:7]
  v_cmp_ge_i32 s[4:5], v21, 10
  v_cndmask_b32 v132, v29, v132, s[60:61]
  v_cmp_ge_i32 s[6:7], v21, 11
  v_cndmask_b32 v133, v29, v133, s[62:63]
  v_cmp_ge_i32 s[60:61], v21, 16
  v_cndmask_b32 v134, v29, v134, s[4:5]
  v_cmp_ge_i32 s[62:63], v21, 17
  v_cndmask_b32 v135, v29, v135, s[6:7]
  v_cmp_ge_i32 s[4:5], v21, 18
  v_cndmask_b32 v136, v29, v136, s[60:61]
  v_cmp_ge_i32 s[6:7], v21, 19
  v_cndmask_b32 v137, v29, v137, s[62:63]
  v_cmp_ge_i32 s[60:61], v21, 24
  v_cndmask_b32 v138, v29, v138, s[4:5]
  v_cmp_ge_i32 s[62:63], v21, 25
  v_cndmask_b32 v139, v29, v139, s[6:7]
  v_cmp_ge_i32 s[4:5], v21, 26
  v_cndmask_b32 v140, v29, v140, s[60:61]
  v_cmp_ge_i32 s[6:7], v21, 27
  v_cndmask_b32 v141, v29, v141, s[62:63]
  v_cndmask_b32 v142, v29, v142, s[4:5]
  v_cndmask_b32 v143, v29, v143, s[6:7]
  v_exp_f32 v96, v96
  v_add_f32 v19, v19, v127
  v_cvt_pk_bf16_f32 v173, v122, v123
  v_mfma_f32_32x32x16_bf16 a[96:111], a[168:171], v[176:179], a[96:111]
  v_exp_f32 v128, v128
  v_add_f32 v22, v22, v159
  v_cvt_pk_bf16_f32 v189, v154, v155
  v_mfma_f32_32x32x16_bf16 a[48:63], a[172:175], v[160:163], a[48:63]
  ds_read_b128 a[156:159], v16 offset:15360
  v_exp_f32 v97, v97
  v_add_f32 v19, v19, v96
  v_mfma_f32_32x32x16_bf16 a[112:127], a[172:175], v[176:179], a[112:127]
  v_exp_f32 v129, v129
  v_add_f32 v22, v22, v128
  v_mfma_f32_32x32x16_bf16 a[0:15], a[176:179], v[164:167], a[0:15]
  ds_read_b128 a[160:163], v6 offset:8192
  v_exp_f32 v98, v98
  v_add_f32 v19, v19, v97
  v_cvt_pk_bf16_f32 v174, v124, v125
  v_mfma_f32_32x32x16_bf16 a[64:79], a[176:179], v[180:183], a[64:79]
  v_exp_f32 v130, v130
  v_add_f32 v22, v22, v129
  v_cvt_pk_bf16_f32 v190, v156, v157
  v_mfma_f32_32x32x16_bf16 a[16:31], a[180:183], v[164:167], a[16:31]
  ds_read_b128 a[164:167], v6 offset:9216
  v_exp_f32 v99, v99
  v_add_f32 v19, v19, v98
  v_mfma_f32_32x32x16_bf16 a[80:95], a[180:183], v[180:183], a[80:95]
  v_exp_f32 v131, v131
  v_add_f32 v22, v22, v130
  v_mfma_f32_32x32x16_bf16 a[32:47], a[184:187], v[164:167], a[32:47]
  ds_read_b128 a[168:171], v6 offset:10240
  v_exp_f32 v100, v100
  v_add_f32 v19, v19, v99
  v_cvt_pk_bf16_f32 v175, v126, v127
  v_mfma_f32_32x32x16_bf16 a[96:111], a[184:187], v[180:183], a[96:111]
  v_exp_f32 v132, v132
  v_add_f32 v22, v22, v131
  v_cvt_pk_bf16_f32 v191, v158, v159
  v_mfma_f32_32x32x16_bf16 a[48:63], a[188:191], v[164:167], a[48:63]
  ds_read_b128 a[172:175], v6 offset:11264
  v_exp_f32 v101, v101
  v_add_f32 v19, v19, v100
  v_mfma_f32_32x32x16_bf16 a[112:127], a[188:191], v[180:183], a[112:127]
  v_exp_f32 v133, v133
  v_add_f32 v22, v22, v132
  s_waitcnt lgkmcnt(4)
  v_mfma_f32_32x32x16_bf16 v[112:127], a[128:131], v[32:35], v[192:207]
  ds_read_b128 a[176:179], v6 offset:12288
  v_exp_f32 v102, v102
  v_add_f32 v19, v19, v101
  v_cvt_pk_bf16_f32 v160, v96, v97
  v_mfma_f32_32x32x16_bf16 v[144:159], a[128:131], v[64:67], v[208:223]
  v_exp_f32 v134, v134
  v_add_f32 v22, v22, v133
  v_cvt_pk_bf16_f32 v176, v128, v129
  v_mfma_f32_32x32x16_bf16 v[112:127], a[132:135], v[36:39], v[112:127]
  ds_read_b128 a[180:183], v6 offset:13312
  v_exp_f32 v103, v103
  v_add_f32 v19, v19, v102
  v_mfma_f32_32x32x16_bf16 v[144:159], a[132:135], v[68:71], v[144:159]
  v_exp_f32 v135, v135
  v_add_f32 v22, v22, v134
  v_mfma_f32_32x32x16_bf16 v[112:127], a[136:139], v[40:43], v[112:127]
  ds_read_b128 a[184:187], v6 offset:14336
  v_add_u32 v16, s38, v3
  v_exp_f32 v104, v104
  v_add_f32 v19, v19, v103
  v_cvt_pk_bf16_f32 v161, v98, v99
  v_mfma_f32_32x32x16_bf16 v[144:159], a[136:139], v[72:75], v[144:159]
  v_exp_f32 v136, v136
  v_add_f32 v22, v22, v135
  v_cvt_pk_bf16_f32 v177, v130, v131
  v_mfma_f32_32x32x16_bf16 v[112:127], a[140:143], v[44:47], v[112:127]
  ds_read_b128 a[188:191], v6 offset:15360
  v_exp_f32 v105, v105
  v_add_f32 v19, v19, v104
  v_mfma_f32_32x32x16_bf16 v[144:159], a[140:143], v[76:79], v[144:159]
  v_exp_f32 v137, v137
  v_add_f32 v22, v22, v136
  s_waitcnt vmcnt(8)
  s_barrier
  v_mfma_f32_32x32x16_bf16 v[112:127], a[144:147], v[48:51], v[112:127]
  ds_read_b128 a[128:131], v16 offset:0
  s_add_u32 m0, s55, s44
  s_nop 0
  buffer_load_dwordx4 v13, s[16:19], s39 offen offset:0 sc1 lds
  v_exp_f32 v106, v106
  v_add_f32 v19, v19, v105
  v_cvt_pk_bf16_f32 v162, v100, v101
  v_mfma_f32_32x32x16_bf16 v[144:159], a[144:147], v[80:83], v[144:159]
  v_exp_f32 v138, v138
  v_add_f32 v22, v22, v137
  v_cvt_pk_bf16_f32 v178, v132, v133
  v_mfma_f32_32x32x16_bf16 v[112:127], a[148:151], v[52:55], v[112:127]
  ds_read_b128 a[132:135], v16 offset:1024
  buffer_load_dwordx4 v13, s[16:19], s39 offen offset:1024 sc1 lds
  v_exp_f32 v107, v107
  v_add_f32 v19, v19, v106
  v_mfma_f32_32x32x16_bf16 v[144:159], a[148:151], v[84:87], v[144:159]
  v_exp_f32 v139, v139
  v_add_f32 v22, v22, v138
  v_mfma_f32_32x32x16_bf16 v[112:127], a[152:155], v[56:59], v[112:127]
  ds_read_b128 a[136:139], v16 offset:2048
  v_add_u32 v6, s55, v2
  buffer_load_dwordx4 v13, s[16:19], s39 offen offset:2048 sc1 lds
  v_exp_f32 v108, v108
  v_add_f32 v19, v19, v107
  v_cvt_pk_bf16_f32 v163, v102, v103
  v_mfma_f32_32x32x16_bf16 v[144:159], a[152:155], v[88:91], v[144:159]
  v_exp_f32 v140, v140
  v_add_f32 v22, v22, v139
  v_cvt_pk_bf16_f32 v179, v134, v135
  v_mfma_f32_32x32x16_bf16 v[112:127], a[156:159], v[60:63], v[112:127]
  ds_read_b128 a[140:143], v16 offset:3072
  buffer_load_dwordx4 v13, s[16:19], s39 offen offset:3072 sc1 lds
  s_add_u32 m0, s42, s43
  s_add_u32 s39, s39, 16384
  v_exp_f32 v109, v109
  v_add_f32 v19, v19, v108
  v_mfma_f32_32x32x16_bf16 v[144:159], a[156:159], v[92:95], v[144:159]
  v_exp_f32 v141, v141
  v_add_f32 v22, v22, v140
  s_waitcnt lgkmcnt(4)
  v_mfma_f32_32x32x16_bf16 a[0:15], a[160:163], v[168:171], a[0:15]
  ds_read_b128 a[144:147], v16 offset:4096
  buffer_load_dwordx4 v13, s[20:23], s41 offen offset:0 sc1 lds
  v_exp_f32 v110, v110
  v_add_f32 v19, v19, v109
  v_cvt_pk_bf16_f32 v164, v104, v105
  v_mfma_f32_32x32x16_bf16 a[64:79], a[160:163], v[184:187], a[64:79]
  v_exp_f32 v142, v142
  v_add_f32 v22, v22, v141
  v_cvt_pk_bf16_f32 v180, v136, v137
  v_mfma_f32_32x32x16_bf16 a[16:31], a[164:167], v[168:171], a[16:31]
  ds_read_b128 a[148:151], v16 offset:5120
  buffer_load_dwordx4 v13, s[20:23], s41 offen offset:1024 sc1 lds
  v_exp_f32 v111, v111
  v_add_f32 v19, v19, v110
  v_mfma_f32_32x32x16_bf16 a[80:95], a[164:167], v[184:187], a[80:95]
  v_exp_f32 v143, v143
  v_add_f32 v22, v22, v142
  v_mfma_f32_32x32x16_bf16 a[32:47], a[168:171], v[168:171], a[32:47]
  ds_read_b128 a[152:155], v16 offset:6144
  buffer_load_dwordx4 v13, s[20:23], s41 offen offset:2048 sc1 lds
  s_add_u32 s100, s66, 32
  v_subrev_u32 v21, s100, v18
  v_cmp_ge_i32 s[60:61], v21, 0
  v_cmp_ge_i32 s[62:63], v21, 1
  v_cmp_ge_i32 s[4:5], v21, 2
  v_cndmask_b32 v144, v29, v144, s[60:61]
  v_cmp_ge_i32 s[6:7], v21, 3
  v_cndmask_b32 v145, v29, v145, s[62:63]
  v_cmp_ge_i32 s[60:61], v21, 8
  v_cndmask_b32 v146, v29, v146, s[4:5]
  v_cmp_ge_i32 s[62:63], v21, 9
  v_cndmask_b32 v147, v29, v147, s[6:7]
  v_cmp_ge_i32 s[4:5], v21, 10
  v_cndmask_b32 v148, v29, v148, s[60:61]
  v_cmp_ge_i32 s[6:7], v21, 11
  v_cndmask_b32 v149, v29, v149, s[62:63]
  v_cmp_ge_i32 s[60:61], v21, 16
  v_cndmask_b32 v150, v29, v150, s[4:5]
  v_cmp_ge_i32 s[62:63], v21, 17
  v_cndmask_b32 v151, v29, v151, s[6:7]
  v_cmp_ge_i32 s[4:5], v21, 18
  v_cndmask_b32 v152, v29, v152, s[60:61]
  v_cmp_ge_i32 s[6:7], v21, 19
  v_cndmask_b32 v153, v29, v153, s[62:63]
  v_cmp_ge_i32 s[60:61], v21, 24
  v_cndmask_b32 v154, v29, v154, s[4:5]
  v_cmp_ge_i32 s[62:63], v21, 25
  v_cndmask_b32 v155, v29, v155, s[6:7]
  v_cmp_ge_i32 s[4:5], v21, 26
  v_cndmask_b32 v156, v29, v156, s[60:61]
  v_cmp_ge_i32 s[6:7], v21, 27
  v_cndmask_b32 v157, v29, v157, s[62:63]
  v_cndmask_b32 v158, v29, v158, s[4:5]
  v_cndmask_b32 v159, v29, v159, s[6:7]
  v_exp_f32 v112, v112
  v_add_f32 v19, v19, v111
  v_cvt_pk_bf16_f32 v165, v106, v107
  v_mfma_f32_32x32x16_bf16 a[96:111], a[168:171], v[184:187], a[96:111]
  v_exp_f32 v144, v144
  v_add_f32 v22, v22, v143
  v_cvt_pk_bf16_f32 v181, v138, v139
  v_mfma_f32_32x32x16_bf16 a[48:63], a[172:175], v[168:171], a[48:63]
  ds_read_b128 a[156:159], v16 offset:7168
  buffer_load_dwordx4 v13, s[20:23], s41 offen offset:3072 sc1 lds
  s_add_u32 s41, s41, 16384
  v_exp_f32 v113, v113
  v_add_f32 v19, v19, v112
  v_mfma_f32_32x32x16_bf16 a[112:127], a[172:175], v[184:187], a[112:127]
  v_exp_f32 v145, v145
  v_add_f32 v22, v22, v144
  v_mfma_f32_32x32x16_bf16 a[0:15], a[176:179], v[172:175], a[0:15]
  ds_read_b128 a[160:163], v6 offset:0
  v_exp_f32 v114, v114
  v_add_f32 v19, v19, v113
  v_cvt_pk_bf16_f32 v166, v108, v109
  v_mfma_f32_32x32x16_bf16 a[64:79], a[176:179], v[188:191], a[64:79]
  v_exp_f32 v146, v146
  v_add_f32 v22, v22, v145
  v_cvt_pk_bf16_f32 v182, v140, v141
  v_mfma_f32_32x32x16_bf16 a[16:31], a[180:183], v[172:175], a[16:31]
  ds_read_b128 a[164:167], v6 offset:1024
  s_mov_b32 s55, s38
  s_mov_b32 s38, s42
  v_exp_f32 v115, v115
  v_add_f32 v19, v19, v114
  v_mfma_f32_32x32x16_bf16 a[80:95], a[180:183], v[188:191], a[80:95]
  v_exp_f32 v147, v147
  v_add_f32 v22, v22, v146
  v_mfma_f32_32x32x16_bf16 a[32:47], a[184:187], v[172:175], a[32:47]
  ds_read_b128 a[168:171], v6 offset:2048
  s_add_u32 s42, s42, 16384
  s_and_b32 s42, s42, 0xffff
  v_exp_f32 v116, v116
  v_add_f32 v19, v19, v115
  v_cvt_pk_bf16_f32 v167, v110, v111
  v_mfma_f32_32x32x16_bf16 a[96:111], a[184:187], v[188:191], a[96:111]
  v_exp_f32 v148, v148
  v_add_f32 v22, v22, v147
  v_cvt_pk_bf16_f32 v183, v142, v143
  v_mfma_f32_32x32x16_bf16 a[48:63], a[188:191], v[172:175], a[48:63]
  ds_read_b128 a[172:175], v6 offset:3072
  s_add_u32 s66, s66, 64
  v_exp_f32 v117, v117
  v_add_f32 v19, v19, v116
  v_mfma_f32_32x32x16_bf16 a[112:127], a[188:191], v[188:191], a[112:127]
  v_exp_f32 v149, v149
  v_add_f32 v22, v22, v148
  s_add_u32 s54, s54, 1
  s_cbranch_scc0 LAT_B
LAT_B_end:
  s_waitcnt lgkmcnt(4)
  v_mfma_f32_32x32x16_bf16 v[96:111], a[128:131], v[32:35], v[192:207]
  ds_read_b128 a[176:179], v6 offset:4096
  s_mov_b32 s4, s78
  s_mov_b32 s5, s79
  s_mov_b32 s6, 0x510000
  s_mov_b32 s7, 0x20000
  s_lshl_b32 s33, s2, 2
  s_add_u32 s33, s33, s3
  s_mul_i32 s33, s33, 5184
  s_add_u32 s33, s33, 0
  v_lshlrev_b32 v23, 7, v1
  s_mov_b32 exec_lo, 0x1fffff
  s_mov_b32 exec_hi, 0x0
  buffer_load_dword v24, v23, s[4:7], s33 offen
  s_mov_b64 exec, -1
  v_exp_f32 v150, v150
  v_add_f32 v22, v22, v149
  v_cvt_pk_bf16_f32 v184, v144, v145
  v_exp_f32 v118, v118
  v_add_f32 v19, v19, v117
  v_cvt_pk_bf16_f32 v168, v112, v113
  v_mfma_f32_32x32x16_bf16 v[96:111], a[132:135], v[36:39], v[96:111]
  ds_read_b128 a[180:183], v6 offset:5120
  s_sub_u32 s33, s90, 2
  s_max_i32 s33, s33, 0
  s_mul_i32 s101, s33, 43
  v_exp_f32 v151, v151
  v_add_f32 v22, v22, v150
  v_exp_f32 v119, v119
  v_add_f32 v19, v19, v118
  v_mfma_f32_32x32x16_bf16 v[96:111], a[136:139], v[40:43], v[96:111]
  ds_read_b128 a[184:187], v6 offset:6144
  s_lshr_b32 s40, s101, 8
  s_mul_i32 s101, s40, 6
  s_sub_u32 s33, s33, s101
  v_exp_f32 v152, v152
  v_add_f32 v22, v22, v151
  v_cvt_pk_bf16_f32 v185, v146, v147
  v_exp_f32 v120, v120
  v_add_f32 v19, v19, v119
  v_cvt_pk_bf16_f32 v169, v114, v115
  v_mfma_f32_32x32x16_bf16 v[96:111], a[140:143], v[44:47], v[96:111]
  ds_read_b128 a[188:191], v6 offset:7168
  s_cmp_ge_u32 s33, 3
  s_cselect_b32 s32, 1, 0
  s_mul_i32 s101, s32, 3
  v_exp_f32 v153, v153
  v_add_f32 v22, v22, v152
  v_exp_f32 v121, v121
  v_add_f32 v19, v19, v120
  v_mfma_f32_32x32x16_bf16 v[96:111], a[144:147], v[48:51], v[96:111]
  ds_read_b128 a[128:131], v16 offset:8192
  s_sub_u32 s37, s33, s101
  s_lshl_b32 s101, s89, 1
  s_add_u32 s36, s101, s32
  v_exp_f32 v154, v154
  v_add_f32 v22, v22, v153
  v_cvt_pk_bf16_f32 v186, v148, v149
  v_exp_f32 v122, v122
  v_add_f32 v19, v19, v121
  v_cvt_pk_bf16_f32 v170, v116, v117
  v_mfma_f32_32x32x16_bf16 v[96:111], a[148:151], v[52:55], v[96:111]
  ds_read_b128 a[132:135], v16 offset:9216
  s_mov_b32 s45, 0
  s_mov_b32 s46, 13
  s_mov_b32 s47, 0
  v_exp_f32 v155, v155
  v_add_f32 v22, v22, v154
  v_exp_f32 v123, v123
  v_add_f32 v19, v19, v122
  v_mfma_f32_32x32x16_bf16 v[96:111], a[152:155], v[56:59], v[96:111]
  ds_read_b128 a[136:139], v16 offset:10240
  s_mov_b32 s49, 12
  s_cmp_eq_u32 s40, 1
  s_cselect_b32 s45, 13, s45
  s_cselect_b32 s46, 14, s46
  s_cselect_b32 s47, 12, s47
  s_cselect_b32 s49, 12, s49
  v_exp_f32 v156, v156
  v_add_f32 v22, v22, v155
  v_cvt_pk_bf16_f32 v187, v150, v151
  v_exp_f32 v124, v124
  v_add_f32 v19, v19, v123
  v_cvt_pk_bf16_f32 v171, v118, v119
  v_mfma_f32_32x32x16_bf16 v[96:111], a[156:159], v[60:63], v[96:111]
  ds_read_b128 a[140:143], v16 offset:11264
  s_cmp_eq_u32 s40, 2
  s_cselect_b32 s45, 27, s45
  s_cselect_b32 s46, 14, s46
  s_cselect_b32 s47, 24, s47
  s_cselect_b32 s49, 13, s49
  v_exp_f32 v157, v157
  v_add_f32 v22, v22, v156
  v_exp_f32 v125, v125
  v_add_f32 v19, v19, v124
  s_waitcnt lgkmcnt(4)
  v_mfma_f32_32x32x16_bf16 a[0:15], a[160:163], v[160:163], a[0:15]
  ds_read_b128 a[144:147], v16 offset:12288
  s_cmp_eq_u32 s40, 3
  s_cselect_b32 s45, 41, s45
  s_cselect_b32 s46, 15, s46
  s_cselect_b32 s47, 37, s47
  s_cselect_b32 s49, 14, s49
  v_exp_f32 v126, v126
  v_add_f32 v19, v19, v125
  v_cvt_pk_bf16_f32 v172, v120, v121
  v_mfma_f32_32x32x16_bf16 a[64:79], a[160:163], v[176:179], a[64:79]
  v_exp_f32 v158, v158
  v_add_f32 v22, v22, v157
  v_cvt_pk_bf16_f32 v188, v152, v153
  v_mfma_f32_32x32x16_bf16 a[16:31], a[164:167], v[160:163], a[16:31]
  ds_read_b128 a[148:151], v16 offset:13312
  s_cmp_eq_u32 s40, 4
  s_cselect_b32 s45, 56, s45
  s_cselect_b32 s46, 16, s46
  s_cselect_b32 s47, 51, s47
  s_cselect_b32 s49, 13, s49
  v_exp_f32 v127, v127
  v_add_f32 v19, v19, v126
  v_mfma_f32_32x32x16_bf16 a[80:95], a[164:167], v[176:179], a[80:95]
  v_exp_f32 v159, v159
  v_add_f32 v22, v22, v158
  v_mfma_f32_32x32x16_bf16 a[32:47], a[168:171], v[160:163], a[32:47]
  ds_read_b128 a[152:155], v16 offset:14336
  s_add_u32 s100, s66, 0
  v_subrev_u32 v21, s100, v17
  v_cmp_ge_i32 s[60:61], v21, 0
  v_cmp_ge_i32 s[62:63], v21, 1
  v_cmp_ge_i32 s[4:5], v21, 2
  v_cndmask_b32 v96, v29, v96, s[60:61]
  v_cmp_ge_i32 s[6:7], v21, 3
  v_cndmask_b32 v97, v29, v97, s[62:63]
  v_cmp_ge_i32 s[60:61], v21, 8
  v_cndmask_b32 v98, v29, v98, s[4:5]
  v_cmp_ge_i32 s[62:63], v21, 9
  v_cndmask_b32 v99, v29, v99, s[6:7]
  v_cmp_ge_i32 s[4:5], v21, 10
  v_cndmask_b32 v100, v29, v100, s[60:61]
  v_cmp_ge_i32 s[6:7], v21, 11
  v_cndmask_b32 v101, v29, v101, s[62:63]
  v_cmp_ge_i32 s[60:61], v21, 16
  v_cndmask_b32 v102, v29, v102, s[4:5]
  v_cmp_ge_i32 s[62:63], v21, 17
  v_cndmask_b32 v103, v29, v103, s[6:7]
  v_cmp_ge_i32 s[4:5], v21, 18
  v_cndmask_b32 v104, v29, v104, s[60:61]
  v_cmp_ge_i32 s[6:7], v21, 19
  v_cndmask_b32 v105, v29, v105, s[62:63]
  v_cmp_ge_i32 s[60:61], v21, 24
  v_cndmask_b32 v106, v29, v106, s[4:5]
  v_cmp_ge_i32 s[62:63], v21, 25
  v_cndmask_b32 v107, v29, v107, s[6:7]
  v_cmp_ge_i32 s[4:5], v21, 26
  v_cndmask_b32 v108, v29, v108, s[60:61]
  v_cmp_ge_i32 s[6:7], v21, 27
  v_cndmask_b32 v109, v29, v109, s[62:63]
  v_cndmask_b32 v110, v29, v110, s[4:5]
  v_cndmask_b32 v111, v29, v111, s[6:7]
  v_exp_f32 v96, v96
  v_add_f32 v19, v19, v127
  v_cvt_pk_bf16_f32 v173, v122, v123
  v_mfma_f32_32x32x16_bf16 a[96:111], a[168:171], v[176:179], a[96:111]
  v_add_f32 v22, v22, v159
  v_cvt_pk_bf16_f32 v189, v154, v155
  v_mfma_f32_32x32x16_bf16 a[48:63], a[172:175], v[160:163], a[48:63]
  ds_read_b128 a[156:159], v16 offset:15360
  s_add_u32 s32, s45, s46
  s_lshl_b32 s33, s32, 2
  s_add_u32 s33, s33, 256
  v_exp_f32 v97, v97
  v_add_f32 v19, v19, v96
  v_mfma_f32_32x32x16_bf16 a[112:127], a[172:175], v[176:179], a[112:127]
  v_mfma_f32_32x32x16_bf16 a[0:15], a[176:179], v[164:167], a[0:15]
  ds_read_b128 a[160:163], v6 offset:8192
  s_lshl_b32 s101, s47, 2
  s_sub_u32 s33, s101, s33
  s_lshl_b32 s83, s33, 10
  v_exp_f32 v98, v98
  v_add_f32 v19, v19, v97
  v_cvt_pk_bf16_f32 v174, v124, v125
  v_mfma_f32_32x32x16_bf16 a[64:79], a[176:179], v[180:183], a[64:79]
  v_cvt_pk_bf16_f32 v190, v156, v157
  v_mfma_f32_32x32x16_bf16 a[16:31], a[180:183], v[164:167], a[16:31]
  ds_read_b128 a[164:167], v6 offset:9216
  s_sub_u32 s32, s47, s32
  s_mul_i32 s86, s32, 73728
  s_mov_b32 s56, 8192
  v_exp_f32 v99, v99
  v_add_f32 v19, v19, v98
  v_mfma_f32_32x32x16_bf16 a[80:95], a[180:183], v[180:183], a[80:95]
  v_mfma_f32_32x32x16_bf16 a[32:47], a[184:187], v[164:167], a[32:47]
  ds_read_b128 a[168:171], v6 offset:10240
  s_mov_b32 s57, 128
  s_mov_b32 s58, 8320
  s_mov_b32 s59, 256
  v_exp_f32 v100, v100
  v_add_f32 v19, v19, v99
  v_cvt_pk_bf16_f32 v175, v126, v127
  v_mfma_f32_32x32x16_bf16 a[96:111], a[184:187], v[180:183], a[96:111]
  v_cvt_pk_bf16_f32 v191, v158, v159
  v_mfma_f32_32x32x16_bf16 a[48:63], a[188:191], v[164:167], a[48:63]
  ds_read_b128 a[172:175], v6 offset:11264
  s_mov_b32 s67, 8448
  s_lshl_b32 s70, s3, 12
  s_lshl_b32 s32, s3, 11
  v_exp_f32 v101, v101
  v_add_f32 v19, v19, v100
  v_mfma_f32_32x32x16_bf16 a[112:127], a[188:191], v[180:183], a[112:127]
  s_waitcnt lgkmcnt(4)
  v_mfma_f32_32x32x16_bf16 v[112:127], a[128:131], v[32:35], v[192:207]
  ds_read_b128 a[176:179], v6 offset:12288
  s_add_u32 s71, s32, 16384
  s_lshl_b32 s32, s36, 2
  s_add_u32 s32, s32, s3
  v_exp_f32 v102, v102
  v_add_f32 v19, v19, v101
  v_cvt_pk_bf16_f32 v160, v96, v97
  v_mfma_f32_32x32x16_bf16 v[112:127], a[132:135], v[36:39], v[112:127]
  ds_read_b128 a[180:183], v6 offset:13312
  s_mul_i32 s32, s32, 544
  s_lshl_b32 s33, s45, 2
  s_add_u32 s32, s32, s33
  v_exp_f32 v103, v103
  v_add_f32 v19, v19, v102
  v_mfma_f32_32x32x16_bf16 v[112:127], a[136:139], v[40:43], v[112:127]
  ds_read_b128 a[184:187], v6 offset:14336
  v_add_u32 v16, s38, v3
  s_add_u32 s32, s32, 256
  s_lshl_b32 s32, s32, 10
  v_add_u32 v11, s32, v2
  v_exp_f32 v104, v104
  v_add_f32 v19, v19, v103
  v_cvt_pk_bf16_f32 v161, v98, v99
  v_mfma_f32_32x32x16_bf16 v[112:127], a[140:143], v[44:47], v[112:127]
  ds_read_b128 a[188:191], v6 offset:15360
  v_lshrrev_b32 v20, 3, v1
  v_mul_u32_u24 v12, 1152, v20
  v_bfe_u32 v20, v1, 4, 1
  v_exp_f32 v105, v105
  v_add_f32 v19, v19, v104
  s_waitcnt vmcnt(8)
  s_barrier
  v_mfma_f32_32x32x16_bf16 v[112:127], a[144:147], v[48:51], v[112:127]
  ds_read_b128 a[128:131], v16 offset:0
  s_add_u32 m0, s55, s44
  s_nop 0
  buffer_load_dwordx4 v13, s[16:19], s39 offen offset:0 sc1 lds
  v_bfe_u32 v23, v1, 2, 1
  v_xor_b32 v20, v20, v23
  v_lshl_add_u32 v12, v20, 6, v12
  v_exp_f32 v106, v106
  v_add_f32 v19, v19, v105
  v_cvt_pk_bf16_f32 v162, v100, v101
  v_mfma_f32_32x32x16_bf16 v[112:127], a[148:151], v[52:55], v[112:127]
  ds_read_b128 a[132:135], v16 offset:1024
  buffer_load_dwordx4 v13, s[16:19], s39 offen offset:1024 sc1 lds
  v_and_b32 v20, 3, v1
  v_lshl_add_u32 v12, v20, 4, v12
  s_mul_i32 s32, s37, 384
  v_exp_f32 v107, v107
  v_add_f32 v19, v19, v106
  v_mfma_f32_32x32x16_bf16 v[112:127], a[152:155], v[56:59], v[112:127]
  ds_read_b128 a[136:139], v16 offset:2048
  v_add_u32 v6, s55, v2
  buffer_load_dwordx4 v13, s[16:19], s39 offen offset:2048 sc1 lds
  s_lshl_b32 s33, s45, 6
  s_lshl_b32 s101, s3, 4
  s_add_u32 s33, s33, s101
  v_exp_f32 v108, v108
  v_add_f32 v19, v19, v107
  v_cvt_pk_bf16_f32 v163, v102, v103
  v_mfma_f32_32x32x16_bf16 v[112:127], a[156:159], v[60:63], v[112:127]
  ds_read_b128 a[140:143], v16 offset:3072
  buffer_load_dwordx4 v13, s[16:19], s39 offen offset:3072 sc1 lds
  s_add_u32 m0, s42, s43
  s_add_u32 s39, s39, 16384
  s_mul_i32 s33, s33, 1152
  s_add_u32 s32, s32, s33
  v_add_u32 v12, s32, v12
  v_exp_f32 v109, v109
  v_add_f32 v19, v19, v108
  s_waitcnt lgkmcnt(4)
  v_mfma_f32_32x32x16_bf16 a[0:15], a[160:163], v[168:171], a[0:15]
  ds_read_b128 a[144:147], v16 offset:4096
  buffer_load_dwordx4 v13, s[20:23], s41 offen offset:0 sc1 lds
  s_mov_b32 s82, 0
  s_mov_b32 s12, s78
  s_mov_b32 s13, s79
  v_exp_f32 v110, v110
  v_add_f32 v19, v19, v109
  v_cvt_pk_bf16_f32 v164, v104, v105
  v_mfma_f32_32x32x16_bf16 a[64:79], a[160:163], v[184:187], a[64:79]
  v_mfma_f32_32x32x16_bf16 a[16:31], a[164:167], v[168:171], a[16:31]
  ds_read_b128 a[148:151], v16 offset:5120
  buffer_load_dwordx4 v13, s[20:23], s41 offen offset:1024 sc1 lds
  s_mov_b32 s14, 0x510000
  s_mov_b32 s15, 0x20000
  v_and_b32 v26, 31, v1
  v_exp_f32 v111, v111
  v_add_f32 v19, v19, v110
  v_mfma_f32_32x32x16_bf16 a[80:95], a[164:167], v[184:187], a[80:95]
  v_mfma_f32_32x32x16_bf16 a[32:47], a[168:171], v[168:171], a[32:47]
  ds_read_b128 a[152:155], v16 offset:6144
  buffer_load_dwordx4 v13, s[20:23], s41 offen offset:2048 sc1 lds
  s_add_u32 s100, s66, 32
  v_subrev_u32 v21, s100, v17
  v_cmp_ge_i32 s[60:61], v21, 0
  v_cmp_ge_i32 s[62:63], v21, 1
  v_cmp_ge_i32 s[4:5], v21, 2
  v_cndmask_b32 v112, v29, v112, s[60:61]
  v_cmp_ge_i32 s[6:7], v21, 3
  v_cndmask_b32 v113, v29, v113, s[62:63]
  v_cmp_ge_i32 s[60:61], v21, 8
  v_cndmask_b32 v114, v29, v114, s[4:5]
  v_cmp_ge_i32 s[62:63], v21, 9
  v_cndmask_b32 v115, v29, v115, s[6:7]
  v_cmp_ge_i32 s[4:5], v21, 10
  v_cndmask_b32 v116, v29, v116, s[60:61]
  v_cmp_ge_i32 s[6:7], v21, 11
  v_cndmask_b32 v117, v29, v117, s[62:63]
  v_cmp_ge_i32 s[60:61], v21, 16
  v_cndmask_b32 v118, v29, v118, s[4:5]
  v_cmp_ge_i32 s[62:63], v21, 17
  v_cndmask_b32 v119, v29, v119, s[6:7]
  v_cmp_ge_i32 s[4:5], v21, 18
  v_cndmask_b32 v120, v29, v120, s[60:61]
  v_cmp_ge_i32 s[6:7], v21, 19
  v_cndmask_b32 v121, v29, v121, s[62:63]
  v_cmp_ge_i32 s[60:61], v21, 24
  v_cndmask_b32 v122, v29, v122, s[4:5]
  v_cmp_ge_i32 s[62:63], v21, 25
  v_cndmask_b32 v123, v29, v123, s[6:7]
  v_cmp_ge_i32 s[4:5], v21, 26
  v_cndmask_b32 v124, v29, v124, s[60:61]
  v_cmp_ge_i32 s[6:7], v21, 27
  v_cndmask_b32 v125, v29, v125, s[62:63]
  v_cndmask_b32 v126, v29, v126, s[4:5]
  v_cndmask_b32 v127, v29, v127, s[6:7]
  v_exp_f32 v112, v112
  v_add_f32 v19, v19, v111
  v_cvt_pk_bf16_f32 v165, v106, v107
  v_mfma_f32_32x32x16_bf16 a[96:111], a[168:171], v[184:187], a[96:111]
  v_mfma_f32_32x32x16_bf16 a[48:63], a[172:175], v[168:171], a[48:63]
  ds_read_b128 a[156:159], v16 offset:7168
  buffer_load_dwordx4 v13, s[20:23], s41 offen offset:3072 sc1 lds
  s_add_u32 s41, s41, 16384
  v_lshlrev_b32 v26, 2, v26
  s_lshr_b32 s32, s36, 1
  s_lshl_b32 s32, s32, 7
  v_exp_f32 v113, v113
  v_add_f32 v19, v19, v112
  v_mfma_f32_32x32x16_bf16 a[112:127], a[172:175], v[184:187], a[112:127]
  v_mfma_f32_32x32x16_bf16 a[0:15], a[176:179], v[172:175], a[0:15]
  ds_read_b128 a[160:163], v6 offset:0
  s_add_u32 s29, s32, 2048
  buffer_load_dword v25, v26, s[8:11], s29 offen sc1
  v_exp_f32 v114, v114
  v_add_f32 v19, v19, v113
  v_cvt_pk_bf16_f32 v166, v108, v109
  v_mfma_f32_32x32x16_bf16 a[64:79], a[176:179], v[188:191], a[64:79]
  v_mfma_f32_32x32x16_bf16 a[16:31], a[180:183], v[172:175], a[16:31]
  ds_read_b128 a[164:167], v6 offset:1024
  s_mov_b32 s55, s38
  s_mov_b32 s38, s42
  v_exp_f32 v115, v115
  v_add_f32 v19, v19, v114
  v_mfma_f32_32x32x16_bf16 a[80:95], a[180:183], v[188:191], a[80:95]
  v_mfma_f32_32x32x16_bf16 a[32:47], a[184:187], v[172:175], a[32:47]
  ds_read_b128 a[168:171], v6 offset:2048
  s_add_u32 s42, s42, 16384
  s_and_b32 s42, s42, 0xffff
  v_exp_f32 v116, v116
  v_add_f32 v19, v19, v115
  v_cvt_pk_bf16_f32 v167, v110, v111
  v_mfma_f32_32x32x16_bf16 a[96:111], a[184:187], v[188:191], a[96:111]
  v_mfma_f32_32x32x16_bf16 a[48:63], a[188:191], v[172:175], a[48:63]
  ds_read_b128 a[172:175], v6 offset:3072
  s_add_u32 s66, s66, 64
  v_exp_f32 v117, v117
  v_add_f32 v19, v19, v116
  v_mfma_f32_32x32x16_bf16 a[112:127], a[188:191], v[188:191], a[112:127]
  s_nop 7
  s_nop 7
  s_mov_b32 s4, s78
  s_mov_b32 s5, s79
  s_mov_b32 s6, 0x510000
  s_mov_b32 s7, 0x20000
  s_lshl_b32 s33, s2, 2
  s_add_u32 s33, s33, s3
  s_mul_i32 s33, s33, 5184
  s_add_u32 s33, s33, 2688
  v_lshlrev_b32 v23, 7, v1
  s_mov_b32 exec_lo, 0xfffff
  s_mov_b32 exec_hi, 0x0
  buffer_load_dword v24, v23, s[4:7], s33 offen
  s_mov_b64 exec, -1
  v_mov_b32 v224, v22
  s_nop 1
  v_permlane32_swap_b32 v22, v224
  s_nop 1
  v_add_f32 v22, v22, v224
  v_mov_b32 v225, 0x5d800000
  v_cmp_nlt_f32 vcc, v22, v225
  v_rcp_f32 v224, v22
  s_nop 1
  s_or_b32 s91, s91, vcc_lo
  s_or_b32 s91, s91, vcc_hi
  s_lshl_b32 s34, s51, 2
  s_add_u32 s34, s34, s3
  s_mul_i32 s34, s34, 544
  s_lshl_b32 s95, s50, 3
  s_add_u32 s34, s34, s95
  s_lshl_b32 s34, s34, 10
  v_accvgpr_read_b32 v128, a64
  v_accvgpr_read_b32 v129, a65
  v_accvgpr_read_b32 v130, a66
  v_accvgpr_read_b32 v131, a67
  v_accvgpr_read_b32 v132, a68
  v_accvgpr_read_b32 v133, a69
  v_accvgpr_read_b32 v134, a70
  v_accvgpr_read_b32 v135, a71
  v_accvgpr_read_b32 v136, a72
  v_accvgpr_read_b32 v137, a73
  v_accvgpr_read_b32 v138, a74
  v_accvgpr_read_b32 v139, a75
  v_accvgpr_read_b32 v140, a76
  v_accvgpr_read_b32 v141, a77
  v_accvgpr_read_b32 v142, a78
  v_accvgpr_read_b32 v143, a79
  v_mul_f32 v128, v128, v224
  v_mul_f32 v129, v129, v224
  v_mul_f32 v130, v130, v224
  v_mul_f32 v131, v131, v224
  v_mul_f32 v132, v132, v224
  v_mul_f32 v133, v133, v224
  v_mul_f32 v134, v134, v224
  v_mul_f32 v135, v135, v224
  v_mul_f32 v136, v136, v224
  v_mul_f32 v137, v137, v224
  v_mul_f32 v138, v138, v224
  v_mul_f32 v139, v139, v224
  v_mul_f32 v140, v140, v224
  v_mul_f32 v141, v141, v224
  v_mul_f32 v142, v142, v224
  v_mul_f32 v143, v143, v224
  v_cvt_pk_bf16_f32 v128, v128, v129
  v_cvt_pk_bf16_f32 v129, v130, v131
  v_cvt_pk_bf16_f32 v130, v132, v133
  v_cvt_pk_bf16_f32 v131, v134, v135
  v_cvt_pk_bf16_f32 v132, v136, v137
  v_cvt_pk_bf16_f32 v133, v138, v139
  v_cvt_pk_bf16_f32 v134, v140, v141
  v_cvt_pk_bf16_f32 v135, v142, v143
  s_add_u32 s95, s34, 0
  buffer_store_dwordx4 v[128:131], v2, s[96:99], s95 offen sc1
  buffer_store_dwordx4 v[132:135], v2, s[96:99], s95 offen offset:1024 sc1
  v_accvgpr_read_b32 v144, a80
  v_accvgpr_read_b32 v145, a81
  v_accvgpr_read_b32 v146, a82
  v_accvgpr_read_b32 v147, a83
  v_accvgpr_read_b32 v148, a84
  v_accvgpr_read_b32 v149, a85
  v_accvgpr_read_b32 v150, a86
  v_accvgpr_read_b32 v151, a87
  v_accvgpr_read_b32 v152, a88
  v_accvgpr_read_b32 v153, a89
  v_accvgpr_read_b32 v154, a90
  v_accvgpr_read_b32 v155, a91
  v_accvgpr_read_b32 v156, a92
  v_accvgpr_read_b32 v157, a93
  v_accvgpr_read_b32 v158, a94
  v_accvgpr_read_b32 v159, a95
  v_mul_f32 v144, v144, v224
  v_mul_f32 v145, v145, v224
  v_mul_f32 v146, v146, v224
  v_mul_f32 v147, v147, v224
  v_mul_f32 v148, v148, v224
  v_mul_f32 v149, v149, v224
  v_mul_f32 v150, v150, v224
  v_mul_f32 v151, v151, v224
  v_mul_f32 v152, v152, v224
  v_mul_f32 v153, v153, v224
  v_mul_f32 v154, v154, v224
  v_mul_f32 v155, v155, v224
  v_mul_f32 v156, v156, v224
  v_mul_f32 v157, v157, v224
  v_mul_f32 v158, v158, v224
  v_mul_f32 v159, v159, v224
  v_cvt_pk_bf16_f32 v144, v144, v145
  v_cvt_pk_bf16_f32 v145, v146, v147
  v_cvt_pk_bf16_f32 v146, v148, v149
  v_cvt_pk_bf16_f32 v147, v150, v151
  v_cvt_pk_bf16_f32 v148, v152, v153
  v_cvt_pk_bf16_f32 v149, v154, v155
  v_cvt_pk_bf16_f32 v150, v156, v157
  v_cvt_pk_bf16_f32 v151, v158, v159
  s_add_u32 s95, s34, 2048
  buffer_store_dwordx4 v[144:147], v2, s[96:99], s95 offen sc1
  buffer_store_dwordx4 v[148:151], v2, s[96:99], s95 offen offset:1024 sc1
  v_accvgpr_read_b32 v128, a96
  v_accvgpr_read_b32 v129, a97
  v_accvgpr_read_b32 v130, a98
  v_accvgpr_read_b32 v131, a99
  v_accvgpr_read_b32 v132, a100
  v_accvgpr_read_b32 v133, a101
  v_accvgpr_read_b32 v134, a102
  v_accvgpr_read_b32 v135, a103
  v_accvgpr_read_b32 v136, a104
  v_accvgpr_read_b32 v137, a105
  v_accvgpr_read_b32 v138, a106
  v_accvgpr_read_b32 v139, a107
  v_accvgpr_read_b32 v140, a108
  v_accvgpr_read_b32 v141, a109
  v_accvgpr_read_b32 v142, a110
  v_accvgpr_read_b32 v143, a111
  v_mul_f32 v128, v128, v224
  v_mul_f32 v129, v129, v224
  v_mul_f32 v130, v130, v224
  v_mul_f32 v131, v131, v224
  v_mul_f32 v132, v132, v224
  v_mul_f32 v133, v133, v224
  v_mul_f32 v134, v134, v224
  v_mul_f32 v135, v135, v224
  v_mul_f32 v136, v136, v224
  v_mul_f32 v137, v137, v224
  v_mul_f32 v138, v138, v224
  v_mul_f32 v139, v139, v224
  v_mul_f32 v140, v140, v224
  v_mul_f32 v141, v141, v224
  v_mul_f32 v142, v142, v224
  v_mul_f32 v143, v143, v224
  v_cvt_pk_bf16_f32 v128, v128, v129
  v_cvt_pk_bf16_f32 v129, v130, v131
  v_cvt_pk_bf16_f32 v130, v132, v133
  v_cvt_pk_bf16_f32 v131, v134, v135
  v_cvt_pk_bf16_f32 v132, v136, v137
  v_cvt_pk_bf16_f32 v133, v138, v139
  v_cvt_pk_bf16_f32 v134, v140, v141
  v_cvt_pk_bf16_f32 v135, v142, v143
  s_add_u32 s95, s34, 4096
  buffer_store_dwordx4 v[128:131], v2, s[96:99], s95 offen sc1
  buffer_store_dwordx4 v[132:135], v2, s[96:99], s95 offen offset:1024 sc1
  v_accvgpr_read_b32 v144, a112
  v_accvgpr_read_b32 v145, a113
  v_accvgpr_read_b32 v146, a114
  v_accvgpr_read_b32 v147, a115
  v_accvgpr_read_b32 v148, a116
  v_accvgpr_read_b32 v149, a117
  v_accvgpr_read_b32 v150, a118
  v_accvgpr_read_b32 v151, a119
  v_accvgpr_read_b32 v152, a120
  v_accvgpr_read_b32 v153, a121
  v_accvgpr_read_b32 v154, a122
  v_accvgpr_read_b32 v155, a123
  v_accvgpr_read_b32 v156, a124
  v_accvgpr_read_b32 v157, a125
  v_accvgpr_read_b32 v158, a126
  v_accvgpr_read_b32 v159, a127
  v_mul_f32 v144, v144, v224
  v_mul_f32 v145, v145, v224
  v_mul_f32 v146, v146, v224
  v_mul_f32 v147, v147, v224
  v_mul_f32 v148, v148, v224
  v_mul_f32 v149, v149, v224
  v_mul_f32 v150, v150, v224
  v_mul_f32 v151, v151, v224
  v_mul_f32 v152, v152, v224
  v_mul_f32 v153, v153, v224
  v_mul_f32 v154, v154, v224
  v_mul_f32 v155, v155, v224
  v_mul_f32 v156, v156, v224
  v_mul_f32 v157, v157, v224
  v_mul_f32 v158, v158, v224
  v_mul_f32 v159, v159, v224
  v_cvt_pk_bf16_f32 v144, v144, v145
  v_cvt_pk_bf16_f32 v145, v146, v147
  v_cvt_pk_bf16_f32 v146, v148, v149
  v_cvt_pk_bf16_f32 v147, v150, v151
  v_cvt_pk_bf16_f32 v148, v152, v153
  v_cvt_pk_bf16_f32 v149, v154, v155
  v_cvt_pk_bf16_f32 v150, v156, v157
  v_cvt_pk_bf16_f32 v151, v158, v159
  s_add_u32 s95, s34, 6144
  buffer_store_dwordx4 v[144:147], v2, s[96:99], s95 offen sc1
  buffer_store_dwordx4 v[148:151], v2, s[96:99], s95 offen offset:1024 sc1
  s_mov_b32 s4, s72
  s_mov_b32 s5, s73
  s_mov_b32 s6, 0x480000
  s_mov_b32 s7, 0x20000
  s_lshl_b32 s33, s2, 2
  s_add_u32 s33, s33, s3
  s_mul_i32 s33, s33, 4608
  s_add_u32 s33, s33, 0
  v_lshlrev_b32 v23, 7, v1
  s_mov_b32 exec_lo, 0xffffffff
  s_mov_b32 exec_hi, 0xf
  buffer_load_dword v24, v23, s[4:7], s33 offen
  s_mov_b64 exec, -1
  s_sub_u32 s54, s53, s52
  s_sub_u32 s54, s54, 3
  s_max_i32 s54, s54, 0
  s_cmp_eq_u32 s54, 0
  s_cbranch_scc1 LAT_D_end
  s_sub_u32 s54, 0, s54
.p2align 6
LAT_D:
  s_waitcnt lgkmcnt(4)
  v_mfma_f32_32x32x16_bf16 v[96:111], a[128:131], v[32:35], v[192:207]
  ds_read_b128 a[176:179], v6 offset:4096
  v_exp_f32 v118, v118
  v_add_f32 v19, v19, v117
  v_cvt_pk_bf16_f32 v168, v112, v113
  v_mfma_f32_32x32x16_bf16 v[96:111], a[132:135], v[36:39], v[96:111]
  ds_read_b128 a[180:183], v6 offset:5120
  v_exp_f32 v119, v119
  v_add_f32 v19, v19, v118
  v_mfma_f32_32x32x16_bf16 v[96:111], a[136:139], v[40:43], v[96:111]
  ds_read_b128 a[184:187], v6 offset:6144
  v_exp_f32 v120, v120
  v_add_f32 v19, v19, v119
  v_cvt_pk_bf16_f32 v169, v114, v115
  v_mfma_f32_32x32x16_bf16 v[96:111], a[140:143], v[44:47], v[96:111]
  ds_read_b128 a[188:191], v6 offset:7168
  v_exp_f32 v121, v121
  v_add_f32 v19, v19, v120
  v_mfma_f32_32x32x16_bf16 v[96:111], a[144:147], v[48:51], v[96:111]
  ds_read_b128 a[128:131], v16 offset:8192
  v_exp_f32 v122, v122
  v_add_f32 v19, v19, v121
  v_cvt_pk_bf16_f32 v170, v116, v117
  v_mfma_f32_32x32x16_bf16 v[96:111], a[148:151], v[52:55], v[96:111]
  ds_read_b128 a[132:135], v16 offset:9216
  v_exp_f32 v123, v123
  v_add_f32 v19, v19, v122
  v_mfma_f32_32x32x16_bf16 v[96:111], a[152:155], v[56:59], v[96:111]
  ds_read_b128 a[136:139], v16 offset:10240
  v_exp_f32 v124, v124
  v_add_f32 v19, v19, v123
  v_cvt_pk_bf16_f32 v171, v118, v119
  v_mfma_f32_32x32x16_bf16 v[96:111], a[156:159], v[60:63], v[96:111]
  ds_read_b128 a[140:143], v16 offset:11264
  v_exp_f32 v125, v125
  v_add_f32 v19, v19, v124
  s_waitcnt lgkmcnt(4)
  v_mfma_f32_32x32x16_bf16 a[0:15], a[160:163], v[160:163], a[0:15]
  ds_read_b128 a[144:147], v16 offset:12288
  v_exp_f32 v126, v126
  v_add_f32 v19, v19, v125
  v_cvt_pk_bf16_f32 v172, v120, v121
  v_mfma_f32_32x32x16_bf16 a[16:31], a[164:167], v[160:163], a[16:31]
  ds_read_b128 a[148:151], v16 offset:13312
  v_exp_f32 v127, v127
  v_add_f32 v19, v19, v126
  v_mfma_f32_32x32x16_bf16 a[32:47], a[168:171], v[160:163], a[32:47]
  ds_read_b128 a[152:155], v16 offset:14336
  v_exp_f32 v96, v96
  v_add_f32 v19, v19, v127
  v_cvt_pk_bf16_f32 v173, v122, v123
  v_mfma_f32_32x32x16_bf16 a[48:63], a[172:175], v[160:163], a[48:63]
  ds_read_b128 a[156:159], v16 offset:15360
  v_exp_f32 v97, v97
  v_add_f32 v19, v19, v96
  v_mfma_f32_32x32x16_bf16 a[0:15], a[176:179], v[164:167], a[0:15]
  ds_read_b128 a[160:163], v6 offset:8192
  v_exp_f32 v98, v98
  v_add_f32 v19, v19, v97
  v_cvt_pk_bf16_f32 v174, v124, v125
  v_mfma_f32_32x32x16_bf16 a[16:31], a[180:183], v[164:167], a[16:31]
  ds_read_b128 a[164:167], v6 offset:9216
  v_exp_f32 v99, v99
  v_add_f32 v19, v19, v98
  v_mfma_f32_32x32x16_bf16 a[32:47], a[184:187], v[164:167], a[32:47]
  ds_read_b128 a[168:171], v6 offset:10240
  v_exp_f32 v100, v100
  v_add_f32 v19, v19, v99
  v_cvt_pk_bf16_f32 v175, v126, v127
  v_mfma_f32_32x32x16_bf16 a[48:63], a[188:191], v[164:167], a[48:63]
  ds_read_b128 a[172:175], v6 offset:11264
  v_exp_f32 v101, v101
  v_add_f32 v19, v19, v100
  s_waitcnt lgkmcnt(4)
  v_mfma_f32_32x32x16_bf16 v[112:127], a[128:131], v[32:35], v[192:207]
  ds_read_b128 a[176:179], v6 offset:12288
  v_exp_f32 v102, v102
  v_add_f32 v19, v19, v101
  v_cvt_pk_bf16_f32 v160, v96, v97
  v_mfma_f32_32x32x16_bf16 v[112:127], a[132:135], v[36:39], v[112:127]
  ds_read_b128 a[180:183], v6 offset:13312
  v_exp_f32 v103, v103
  v_add_f32 v19, v19, v102
  v_mfma_f32_32x32x16_bf16 v[112:127], a[136:139], v[40:43], v[112:127]
  ds_read_b128 a[184:187], v6 offset:14336
  v_add_u32 v16, s38, v3
  v_exp_f32 v104, v104
  v_add_f32 v19, v19, v103
  v_cvt_pk_bf16_f32 v161, v98, v99
  v_mfma_f32_32x32x16_bf16 v[112:127], a[140:143], v[44:47], v[112:127]
  ds_read_b128 a[188:191], v6 offset:15360
  v_exp_f32 v105, v105
  v_add_f32 v19, v19, v104
  s_waitcnt vmcnt(8)
  s_barrier
  v_mfma_f32_32x32x16_bf16 v[112:127], a[144:147], v[48:51], v[112:127]
  ds_read_b128 a[128:131], v16 offset:0
  s_add_u32 m0, s55, s44
  s_nop 0
  buffer_load_dwordx4 v13, s[16:19], s39 offen offset:0 sc1 lds
  v_exp_f32 v106, v106
  v_add_f32 v19, v19, v105
  v_cvt_pk_bf16_f32 v162, v100, v101
  v_mfma_f32_32x32x16_bf16 v[112:127], a[148:151], v[52:55], v[112:127]
  ds_read_b128 a[132:135], v16 offset:1024
  buffer_load_dwordx4 v13, s[16:19], s39 offen offset:1024 sc1 lds
  v_exp_f32 v107, v107
  v_add_f32 v19, v19, v106
  v_mfma_f32_32x32x16_bf16 v[112:127], a[152:155], v[56:59], v[112:127]
  ds_read_b128 a[136:139], v16 offset:2048
  v_add_u32 v6, s55, v2
  buffer_load_dwordx4 v13, s[16:19], s39 offen offset:2048 sc1 lds
  v_exp_f32 v108, v108
  v_add_f32 v19, v19, v107
  v_cvt_pk_bf16_f32 v163, v102, v103
  v_mfma_f32_32x32x16_bf16 v[112:127], a[156:159], v[60:63], v[112:127]
  ds_read_b128 a[140:143], v16 offset:3072
  buffer_load_dwordx4 v13, s[16:19], s39 offen offset:3072 sc1 lds
  s_add_u32 m0, s42, s43
  s_add_u32 s39, s39, 16384
  v_exp_f32 v109, v109
  v_add_f32 v19, v19, v108
  s_waitcnt lgkmcnt(4)
  v_mfma_f32_32x32x16_bf16 a[0:15], a[160:163], v[168:171], a[0:15]
  ds_read_b128 a[144:147], v16 offset:4096
  buffer_load_dwordx4 v13, s[20:23], s41 offen offset:0 sc1 lds
  v_exp_f32 v110, v110
  v_add_f32 v19, v19, v109
  v_cvt_pk_bf16_f32 v164, v104, v105
  v_mfma_f32_32x32x16_bf16 a[16:31], a[164:167], v[168:171], a[16:31]
  ds_read_b128 a[148:151], v16 offset:5120
  buffer_load_dwordx4 v13, s[20:23], s41 offen offset:1024 sc1 lds
  v_exp_f32 v111, v111
  v_add_f32 v19, v19, v110
  v_mfma_f32_32x32x16_bf16 a[32:47], a[168:171], v[168:171], a[32:47]
  ds_read_b128 a[152:155], v16 offset:6144
  buffer_load_dwordx4 v13, s[20:23], s41 offen offset:2048 sc1 lds
  v_exp_f32 v112, v112
  v_add_f32 v19, v19, v111
  v_cvt_pk_bf16_f32 v165, v106, v107
  v_mfma_f32_32x32x16_bf16 a[48:63], a[172:175], v[168:171], a[48:63]
  ds_read_b128 a[156:159], v16 offset:7168
  buffer_load_dwordx4 v13, s[20:23], s41 offen offset:3072 sc1 lds
  s_add_u32 s41, s41, 16384
  v_exp_f32 v113, v113
  v_add_f32 v19, v19, v112
  v_mfma_f32_32x32x16_bf16 a[0:15], a[176:179], v[172:175], a[0:15]
  ds_read_b128 a[160:163], v6 offset:0
  v_exp_f32 v114, v114
  v_add_f32 v19, v19, v113
  v_cvt_pk_bf16_f32 v166, v108, v109
  v_mfma_f32_32x32x16_bf16 a[16:31], a[180:183], v[172:175], a[16:31]
  ds_read_b128 a[164:167], v6 offset:1024
  s_mov_b32 s55, s38
  s_mov_b32 s38, s42
  v_exp_f32 v115, v115
  v_add_f32 v19, v19, v114
  v_mfma_f32_32x32x16_bf16 a[32:47], a[184:187], v[172:175], a[32:47]
  ds_read_b128 a[168:171], v6 offset:2048
  s_add_u32 s42, s42, 16384
  s_and_b32 s42, s42, 0xffff
  v_exp_f32 v116, v116
  v_add_f32 v19, v19, v115
  v_cvt_pk_bf16_f32 v167, v110, v111
  v_mfma_f32_32x32x16_bf16 a[48:63], a[188:191], v[172:175], a[48:63]
  ds_read_b128 a[172:175], v6 offset:3072
  v_exp_f32 v117, v117
  v_add_f32 v19, v19, v116
  s_add_u32 s54, s54, 1
  s_cbranch_scc0 LAT_D
LAT_D_end:
  s_cmp_eq_u32 s51, 7
  s_cselect_b32 s54, 1, 2
  s_sub_u32 s66, s53, s54
  s_lshl_b32 s66, s66, 6
  s_cmp_eq_u32 s54, 0
  s_cbranch_scc1 LAT_E_end
  s_sub_u32 s54, 0, s54
.p2align 6
LAT_E:
  s_waitcnt lgkmcnt(4)
  v_mfma_f32_32x32x16_bf16 v[96:111], a[128:131], v[32:35], v[192:207]
  ds_read_b128 a[176:179], v6 offset:4096
  v_exp_f32 v118, v118
  v_add_f32 v19, v19, v117
  v_cvt_pk_bf16_f32 v168, v112, v113
  v_mfma_f32_32x32x16_bf16 v[96:111], a[132:135], v[36:39], v[96:111]
  ds_read_b128 a[180:183], v6 offset:5120
  v_exp_f32 v119, v119
  v_add_f32 v19, v19, v118
  v_mfma_f32_32x32x16_bf16 v[96:111], a[136:139], v[40:43], v[96:111]
  ds_read_b128 a[184:187], v6 offset:6144
  v_exp_f32 v120, v120
  v_add_f32 v19, v19, v119
  v_cvt_pk_bf16_f32 v169, v114, v115
  v_mfma_f32_32x32x16_bf16 v[96:111], a[140:143], v[44:47], v[96:111]
  ds_read_b128 a[188:191], v6 offset:7168
  v_exp_f32 v121, v121
  v_add_f32 v19, v19, v120
  v_mfma_f32_32x32x16_bf16 v[96:111], a[144:147], v[48:51], v[96:111]
  ds_read_b128 a[128:131], v16 offset:8192
  v_exp_f32 v122, v122
  v_add_f32 v19, v19, v121
  v_cvt_pk_bf16_f32 v170, v116, v117
  v_mfma_f32_32x32x16_bf16 v[96:111], a[148:151], v[52:55], v[96:111]
  ds_read_b128 a[132:135], v16 offset:9216
  v_exp_f32 v123, v123
  v_add_f32 v19, v19, v122
  v_mfma_f32_32x32x16_bf16 v[96:111], a[152:155], v[56:59], v[96:111]
  ds_read_b128 a[136:139], v16 offset:10240
  v_exp_f32 v124, v124
  v_add_f32 v19, v19, v123
  v_cvt_pk_bf16_f32 v171, v118, v119
  v_mfma_f32_32x32x16_bf16 v[96:111], a[156:159], v[60:63], v[96:111]
  ds_read_b128 a[140:143], v16 offset:11264
  v_exp_f32 v125, v125
  v_add_f32 v19, v19, v124
  s_waitcnt lgkmcnt(4)
  v_mfma_f32_32x32x16_bf16 a[0:15], a[160:163], v[160:163], a[0:15]
  ds_read_b128 a[144:147], v16 offset:12288
  v_exp_f32 v126, v126
  v_add_f32 v19, v19, v125
  v_cvt_pk_bf16_f32 v172, v120, v121
  v_mfma_f32_32x32x16_bf16 a[16:31], a[164:167], v[160:163], a[16:31]
  ds_read_b128 a[148:151], v16 offset:13312
  v_exp_f32 v127, v127
  v_add_f32 v19, v19, v126
  v_mfma_f32_32x32x16_bf16 a[32:47], a[168:171], v[160:163], a[32:47]
  ds_read_b128 a[152:155], v16 offset:14336
  s_add_u32 s100, s66, 0
  v_subrev_u32 v21, s100, v17
  v_cmp_ge_i32 s[60:61], v21, 0
  v_cmp_ge_i32 s[62:63], v21, 1
  v_cmp_ge_i32 s[4:5], v21, 2
  v_cndmask_b32 v96, v29, v96, s[60:61]
  v_cmp_ge_i32 s[6:7], v21, 3
  v_cndmask_b32 v97, v29, v97, s[62:63]
  v_cmp_ge_i32 s[60:61], v21, 8
  v_cndmask_b32 v98, v29, v98, s[4:5]
  v_cmp_ge_i32 s[62:63], v21, 9
  v_cndmask_b32 v99, v29, v99, s[6:7]
  v_cmp_ge_i32 s[4:5], v21, 10
  v_cndmask_b32 v100, v29, v100, s[60:61]
  v_cmp_ge_i32 s[6:7], v21, 11
  v_cndmask_b32 v101, v29, v101, s[62:63]
  v_cmp_ge_i32 s[60:61], v21, 16
  v_cndmask_b32 v102, v29, v102, s[4:5]
  v_cmp_ge_i32 s[62:63], v21, 17
  v_cndmask_b32 v103, v29, v103, s[6:7]
  v_cmp_ge_i32 s[4:5], v21, 18
  v_cndmask_b32 v104, v29, v104, s[60:61]
  v_cmp_ge_i32 s[6:7], v21, 19
  v_cndmask_b32 v105, v29, v105, s[62:63]
  v_cmp_ge_i32 s[60:61], v21, 24
  v_cndmask_b32 v106, v29, v106, s[4:5]
  v_cmp_ge_i32 s[62:63], v21, 25
  v_cndmask_b32 v107, v29, v107, s[6:7]
  v_cmp_ge_i32 s[4:5], v21, 26
  v_cndmask_b32 v108, v29, v108, s[60:61]
  v_cmp_ge_i32 s[6:7], v21, 27
  v_cndmask_b32 v109, v29, v109, s[62:63]
  v_cndmask_b32 v110, v29, v110, s[4:5]
  v_cndmask_b32 v111, v29, v111, s[6:7]
  v_exp_f32 v96, v96
  v_add_f32 v19, v19, v127
  v_cvt_pk_bf16_f32 v173, v122, v123
  v_mfma_f32_32x32x16_bf16 a[48:63], a[172:175], v[160:163], a[48:63]
  ds_read_b128 a[156:159], v16 offset:15360
  v_exp_f32 v97, v97
  v_add_f32 v19, v19, v96
  v_mfma_f32_32x32x16_bf16 a[0:15], a[176:179], v[164:167], a[0:15]
  ds_read_b128 a[160:163], v6 offset:8192
  v_exp_f32 v98, v98
  v_add_f32 v19, v19, v97
  v_cvt_pk_bf16_f32 v174, v124, v125
  v_mfma_f32_32x32x16_bf16 a[16:31], a[180:183], v[164:167], a[16:31]
  ds_read_b128 a[164:167], v6 offset:9216
  v_exp_f32 v99, v99
  v_add_f32 v19, v19, v98
  v_mfma_f32_32x32x16_bf16 a[32:47], a[184:187], v[164:167], a[32:47]
  ds_read_b128 a[168:171], v6 offset:10240
  v_exp_f32 v100, v100
  v_add_f32 v19, v19, v99
  v_cvt_pk_bf16_f32 v175, v126, v127
  v_mfma_f32_32x32x16_bf16 a[48:63], a[188:191], v[164:167], a[48:63]
  ds_read_b128 a[172:175], v6 offset:11264
  v_exp_f32 v101, v101
  v_add_f32 v19, v19, v100
  s_waitcnt lgkmcnt(4)
  v_mfma_f32_32x32x16_bf16 v[112:127], a[128:131], v[32:35], v[192:207]
  ds_read_b128 a[176:179], v6 offset:12288
  v_exp_f32 v102, v102
  v_add_f32 v19, v19, v101
  v_cvt_pk_bf16_f32 v160, v96, v97
  v_mfma_f32_32x32x16_bf16 v[112:127], a[132:135], v[36:39], v[112:127]
  ds_read_b128 a[180:183], v6 offset:13312
  v_exp_f32 v103, v103
  v_add_f32 v19, v19, v102
  v_mfma_f32_32x32x16_bf16 v[112:127], a[136:139], v[40:43], v[112:127]
  ds_read_b128 a[184:187], v6 offset:14336
  v_add_u32 v16, s38, v3
  v_exp_f32 v104, v104
  v_add_f32 v19, v19, v103
  v_cvt_pk_bf16_f32 v161, v98, v99
  v_mfma_f32_32x32x16_bf16 v[112:127], a[140:143], v[44:47], v[112:127]
  ds_read_b128 a[188:191], v6 offset:15360
  v_exp_f32 v105, v105
  v_add_f32 v19, v19, v104
  s_waitcnt vmcnt(0)
  s_barrier
  v_mfma_f32_32x32x16_bf16 v[112:127], a[144:147], v[48:51], v[112:127]
  ds_read_b128 a[128:131], v16 offset:0
  v_exp_f32 v106, v106
  v_add_f32 v19, v19, v105
  v_cvt_pk_bf16_f32 v162, v100, v101
  v_mfma_f32_32x32x16_bf16 v[112:127], a[148:151], v[52:55], v[112:127]
  ds_read_b128 a[132:135], v16 offset:1024
  v_exp_f32 v107, v107
  v_add_f32 v19, v19, v106
  v_mfma_f32_32x32x16_bf16 v[112:127], a[152:155], v[56:59], v[112:127]
  ds_read_b128 a[136:139], v16 offset:2048
  v_add_u32 v6, s55, v2
  v_exp_f32 v108, v108
  v_add_f32 v19, v19, v107
  v_cvt_pk_bf16_f32 v163, v102, v103
  v_mfma_f32_32x32x16_bf16 v[112:127], a[156:159], v[60:63], v[112:127]
  ds_read_b128 a[140:143], v16 offset:3072
  v_exp_f32 v109, v109
  v_add_f32 v19, v19, v108
  s_waitcnt lgkmcnt(4)
  v_mfma_f32_32x32x16_bf16 a[0:15], a[160:163], v[168:171], a[0:15]
  ds_read_b128 a[144:147], v16 offset:4096
  v_exp_f32 v110, v110
  v_add_f32 v19, v19, v109
  v_cvt_pk_bf16_f32 v164, v104, v105
  v_mfma_f32_32x32x16_bf16 a[16:31], a[164:167], v[168:171], a[16:31]
  ds_read_b128 a[148:151], v16 offset:5120
  v_exp_f32 v111, v111
  v_add_f32 v19, v19, v110
  v_mfma_f32_32x32x16_bf16 a[32:47], a[168:171], v[168:171], a[32:47]
  ds_read_b128 a[152:155], v16 offset:6144
  s_add_u32 s100, s66, 32
  v_subrev_u32 v21, s100, v17
  v_cmp_ge_i32 s[60:61], v21, 0
  v_cmp_ge_i32 s[62:63], v21, 1
  v_cmp_ge_i32 s[4:5], v21, 2
  v_cndmask_b32 v112, v29, v112, s[60:61]
  v_cmp_ge_i32 s[6:7], v21, 3
  v_cndmask_b32 v113, v29, v113, s[62:63]
  v_cmp_ge_i32 s[60:61], v21, 8
  v_cndmask_b32 v114, v29, v114, s[4:5]
  v_cmp_ge_i32 s[62:63], v21, 9
  v_cndmask_b32 v115, v29, v115, s[6:7]
  v_cmp_ge_i32 s[4:5], v21, 10
  v_cndmask_b32 v116, v29, v116, s[60:61]
  v_cmp_ge_i32 s[6:7], v21, 11
  v_cndmask_b32 v117, v29, v117, s[62:63]
  v_cmp_ge_i32 s[60:61], v21, 16
  v_cndmask_b32 v118, v29, v118, s[4:5]
  v_cmp_ge_i32 s[62:63], v21, 17
  v_cndmask_b32 v119, v29, v119, s[6:7]
  v_cmp_ge_i32 s[4:5], v21, 18
  v_cndmask_b32 v120, v29, v120, s[60:61]
  v_cmp_ge_i32 s[6:7], v21, 19
  v_cndmask_b32 v121, v29, v121, s[62:63]
  v_cmp_ge_i32 s[60:61], v21, 24
  v_cndmask_b32 v122, v29, v122, s[4:5]
  v_cmp_ge_i32 s[62:63], v21, 25
  v_cndmask_b32 v123, v29, v123, s[6:7]
  v_cmp_ge_i32 s[4:5], v21, 26
  v_cndmask_b32 v124, v29, v124, s[60:61]
  v_cmp_ge_i32 s[6:7], v21, 27
  v_cndmask_b32 v125, v29, v125, s[62:63]
  v_cndmask_b32 v126, v29, v126, s[4:5]
  v_cndmask_b32 v127, v29, v127, s[6:7]
  v_exp_f32 v112, v112
  v_add_f32 v19, v19, v111
  v_cvt_pk_bf16_f32 v165, v106, v107
  v_mfma_f32_32x32x16_bf16 a[48:63], a[172:175], v[168:171], a[48:63]
  ds_read_b128 a[156:159], v16 offset:7168
  v_exp_f32 v113, v113
  v_add_f32 v19, v19, v112
  v_mfma_f32_32x32x16_bf16 a[0:15], a[176:179], v[172:175], a[0:15]
  ds_read_b128 a[160:163], v6 offset:0
  v_exp_f32 v114, v114
  v_add_f32 v19, v19, v113
  v_cvt_pk_bf16_f32 v166, v108, v109
  v_mfma_f32_32x32x16_bf16 a[16:31], a[180:183], v[172:175], a[16:31]
  ds_read_b128 a[164:167], v6 offset:1024
  s_mov_b32 s55, s38
  s_mov_b32 s38, s42
  v_exp_f32 v115, v115
  v_add_f32 v19, v19, v114
  v_mfma_f32_32x32x16_bf16 a[32:47], a[184:187], v[172:175], a[32:47]
  ds_read_b128 a[168:171], v6 offset:2048
  s_add_u32 s42, s42, 16384
  s_and_b32 s42, s42, 0xffff
  v_exp_f32 v116, v116
  v_add_f32 v19, v19, v115
  v_cvt_pk_bf16_f32 v167, v110, v111
  v_mfma_f32_32x32x16_bf16 a[48:63], a[188:191], v[172:175], a[48:63]
  ds_read_b128 a[172:175], v6 offset:3072
  s_add_u32 s66, s66, 64
  v_exp_f32 v117, v117
  v_add_f32 v19, v19, v116
  s_add_u32 s54, s54, 1
  s_cbranch_scc0 LAT_E
LAT_E_end:
  ds_read_b128 a[176:179], v6 offset:4096
  ds_read_b128 a[180:183], v6 offset:5120
  ds_read_b128 a[184:187], v6 offset:6144
  ds_read_b128 a[188:191], v6 offset:7168
  s_waitcnt lgkmcnt(4)
  v_mfma_f32_32x32x16_bf16 a[0:15], a[160:163], v[160:163], a[0:15]
  ds_read_b128 a[160:163], v6 offset:8192
  v_exp_f32 v118, v118
  v_add_f32 v19, v19, v117
  v_cvt_pk_bf16_f32 v168, v112, v113
  v_exp_f32 v119, v119
  v_mfma_f32_32x32x16_bf16 a[16:31], a[164:167], v[160:163], a[16:31]
  ds_read_b128 a[164:167], v6 offset:9216
  v_add_f32 v19, v19, v118
  v_exp_f32 v120, v120
  v_add_f32 v19, v19, v119
  v_cvt_pk_bf16_f32 v169, v114, v115
  v_mfma_f32_32x32x16_bf16 a[32:47], a[168:171], v[160:163], a[32:47]
  ds_read_b128 a[168:171], v6 offset:10240
  v_exp_f32 v121, v121
  v_add_f32 v19, v19, v120
  v_exp_f32 v122, v122
  v_add_f32 v19, v19, v121
  v_mfma_f32_32x32x16_bf16 a[48:63], a[172:175], v[160:163], a[48:63]
  ds_read_b128 a[172:175], v6 offset:11264
  v_cvt_pk_bf16_f32 v170, v116, v117
  v_exp_f32 v123, v123
  v_add_f32 v19, v19, v122
  v_exp_f32 v124, v124
  s_waitcnt lgkmcnt(4)
  v_mfma_f32_32x32x16_bf16 a[0:15], a[176:179], v[164:167], a[0:15]
  ds_read_b128 a[176:179], v6 offset:12288
  v_add_f32 v19, v19, v123
  v_cvt_pk_bf16_f32 v171, v118, v119
  v_exp_f32 v125, v125
  v_add_f32 v19, v19, v124
  v_mfma_f32_32x32x16_bf16 a[16:31], a[180:183], v[164:167], a[16:31]
  ds_read_b128 a[180:183], v6 offset:13312
  v_exp_f32 v126, v126
  v_add_f32 v19, v19, v125
  v_cvt_pk_bf16_f32 v172, v120, v121
  v_exp_f32 v127, v127
  v_mfma_f32_32x32x16_bf16 a[32:47], a[184:187], v[164:167], a[32:47]
  ds_read_b128 a[184:187], v6 offset:14336
  v_add_f32 v19, v19, v126
  v_add_f32 v19, v19, v127
  v_cvt_pk_bf16_f32 v173, v122, v123
  v_cvt_pk_bf16_f32 v174, v124, v125
  v_mfma_f32_32x32x16_bf16 a[48:63], a[188:191], v[164:167], a[48:63]
  ds_read_b128 a[188:191], v6 offset:15360
  v_cvt_pk_bf16_f32 v175, v126, v127
  s_waitcnt lgkmcnt(0)
  v_mfma_f32_32x32x16_bf16 a[0:15], a[160:163], v[168:171], a[0:15]
  v_mfma_f32_32x32x16_bf16 a[16:31], a[164:167], v[168:171], a[16:31]
  v_mfma_f32_32x32x16_bf16 a[32:47], a[168:171], v[168:171], a[32:47]
  v_mfma_f32_32x32x16_bf16 a[48:63], a[172:175], v[168:171], a[48:63]
  v_mfma_f32_32x32x16_bf16 a[0:15], a[176:179], v[172:175], a[0:15]
  v_mfma_f32_32x32x16_bf16 a[16:31], a[180:183], v[172:175], a[16:31]
  v_mfma_f32_32x32x16_bf16 a[32:47], a[184:187], v[172:175], a[32:47]
  v_mfma_f32_32x32x16_bf16 a[48:63], a[188:191], v[172:175], a[48:63]
  s_nop 7
  s_nop 7
  s_mov_b32 s6, 0xffffffff
  s_mov_b32 s7, 0x0
  s_mov_b32 s5, 100000
LFL4:
  v_cmp_ne_u32 vcc, s88, v25
  s_nop 1
  s_and_b64 vcc, vcc, s[6:7]
  s_cbranch_vccz LFL4_ok
  s_sub_u32 s5, s5, 1
  s_cmp_eq_u32 s5, 0
  s_cbranch_scc1 LFL4_ok
  s_sleep 1
  buffer_load_dword v25, v26, s[8:11], s29 offen sc1
  s_waitcnt vmcnt(0)
  s_branch LFL4
LFL4_ok:
  s_barrier
  v_mov_b32 v224, v19
  s_nop 1
  v_permlane32_swap_b32 v19, v224
  s_nop 1
  v_add_f32 v19, v19, v224
  v_mov_b32 v225, 0x5d800000
  v_cmp_nlt_f32 vcc, v19, v225
  v_rcp_f32 v224, v19
  s_nop 1
  s_or_b32 s91, s91, vcc_lo
  s_or_b32 s91, s91, vcc_hi
  s_sub_u32 s34, 15, s51
  s_lshl_b32 s34, s34, 2
  s_add_u32 s34, s34, s3
  s_mul_i32 s34, s34, 544
  s_lshl_b32 s95, s50, 3
  s_add_u32 s34, s34, s95
  s_lshl_b32 s34, s34, 10
  s_add_u32 m0, s82, s70
  s_add_u32 s87, s82, s71
  buffer_load_dwordx4 v11, s[96:99], 0 offen sc1 lds
  buffer_load_dwordx4 v11, s[96:99], 0 offen offset:1024 sc1 lds
  buffer_load_dwordx4 v11, s[96:99], 0 offen offset:2048 sc1 lds
  buffer_load_dwordx4 v11, s[96:99], 0 offen offset:3072 sc1 lds
  s_add_u32 m0, s87, 0
  s_nop 0
  buffer_load_dwordx4 v12, s[12:15], 0 offen lds
  v_accvgpr_read_b32 v128, a0
  v_accvgpr_read_b32 v129, a1
  v_accvgpr_read_b32 v130, a2
  v_accvgpr_read_b32 v131, a3
  v_accvgpr_read_b32 v132, a4
  v_accvgpr_read_b32 v133, a5
  v_accvgpr_read_b32 v134, a6
  v_accvgpr_read_b32 v135, a7
  v_accvgpr_read_b32 v136, a8
  v_accvgpr_read_b32 v137, a9
  v_accvgpr_read_b32 v138, a10
  v_accvgpr_read_b32 v139, a11
  v_accvgpr_read_b32 v140, a12
  v_accvgpr_read_b32 v141, a13
  v_accvgpr_read_b32 v142, a14
  v_accvgpr_read_b32 v143, a15
  v_mul_f32 v128, v128, v224
  v_mul_f32 v129, v129, v224
  v_mul_f32 v130, v130, v224
  v_mul_f32 v131, v131, v224
  v_mul_f32 v132, v132, v224
  v_mul_f32 v133, v133, v224
  v_mul_f32 v134, v134, v224
  v_mul_f32 v135, v135, v224
  v_mul_f32 v136, v136, v224
  v_mul_f32 v137, v137, v224
  v_mul_f32 v138, v138, v224
  v_mul_f32 v139, v139, v224
  v_mul_f32 v140, v140, v224
  v_mul_f32 v141, v141, v224
  v_mul_f32 v142, v142, v224
  v_mul_f32 v143, v143, v224
  v_cvt_pk_bf16_f32 v128, v128, v129
  v_cvt_pk_bf16_f32 v129, v130, v131
  v_cvt_pk_bf16_f32 v130, v132, v133
  v_cvt_pk_bf16_f32 v131, v134, v135
  v_cvt_pk_bf16_f32 v132, v136, v137
  v_cvt_pk_bf16_f32 v133, v138, v139
  v_cvt_pk_bf16_f32 v134, v140, v141
  v_cvt_pk_bf16_f32 v135, v142, v143
  s_add_u32 s95, s34, 0
  buffer_store_dwordx4 v[128:131], v2, s[96:99], s95 offen sc1
  buffer_store_dwordx4 v[132:135], v2, s[96:99], s95 offen offset:1024 sc1
  buffer_load_dwordx4 v12, s[12:15], s56 offen offset:1024 lds
  s_add_u32 m0, s87, 8192
  s_nop 0
  buffer_load_dwordx4 v12, s[12:15], s57 offen lds
  buffer_load_dwordx4 v12, s[12:15], s58 offen offset:1024 lds
  s_add_u32 m0, s87, 16384
  s_nop 0
  buffer_load_dwordx4 v12, s[12:15], s59 offen lds
  buffer_load_dwordx4 v12, s[12:15], s67 offen offset:1024 lds
  v_add_u32 v11, 4096, v11
  v_add_u32 v12, 73728, v12
  s_add_u32 s82, s82, 40960
  s_cmp_ge_u32 s82, 163840
  s_cselect_b32 s82, 0, s82
  v_accvgpr_read_b32 v144, a16
  v_accvgpr_read_b32 v145, a17
  v_accvgpr_read_b32 v146, a18
  v_accvgpr_read_b32 v147, a19
  v_accvgpr_read_b32 v148, a20
  v_accvgpr_read_b32 v149, a21
  v_accvgpr_read_b32 v150, a22
  v_accvgpr_read_b32 v151, a23
  v_accvgpr_read_b32 v152, a24
  v_accvgpr_read_b32 v153, a25
  v_accvgpr_read_b32 v154, a26
  v_accvgpr_read_b32 v155, a27
  v_accvgpr_read_b32 v156, a28
  v_accvgpr_read_b32 v157, a29
  v_accvgpr_read_b32 v158, a30
  v_accvgpr_read_b32 v159, a31
  v_mul_f32 v144, v144, v224
  v_mul_f32 v145, v145, v224
  v_mul_f32 v146, v146, v224
  v_mul_f32 v147, v147, v224
  v_mul_f32 v148, v148, v224
  v_mul_f32 v149, v149, v224
  v_mul_f32 v150, v150, v224
  v_mul_f32 v151, v151, v224
  v_mul_f32 v152, v152, v224
  v_mul_f32 v153, v153, v224
  v_mul_f32 v154, v154, v224
  v_mul_f32 v155, v155, v224
  v_mul_f32 v156, v156, v224
  v_mul_f32 v157, v157, v224
  v_mul_f32 v158, v158, v224
  v_mul_f32 v159, v159, v224
  v_cvt_pk_bf16_f32 v144, v144, v145
  v_cvt_pk_bf16_f32 v145, v146, v147
  v_cvt_pk_bf16_f32 v146, v148, v149
  v_cvt_pk_bf16_f32 v147, v150, v151
  v_cvt_pk_bf16_f32 v148, v152, v153
  v_cvt_pk_bf16_f32 v149, v154, v155
  v_cvt_pk_bf16_f32 v150, v156, v157
  v_cvt_pk_bf16_f32 v151, v158, v159
  s_add_u32 s95, s34, 2048
  buffer_store_dwordx4 v[144:147], v2, s[96:99], s95 offen sc1
  buffer_store_dwordx4 v[148:151], v2, s[96:99], s95 offen offset:1024 sc1
  s_add_u32 m0, s82, s70
  s_add_u32 s87, s82, s71
  buffer_load_dwordx4 v11, s[96:99], 0 offen sc1 lds
  buffer_load_dwordx4 v11, s[96:99], 0 offen offset:1024 sc1 lds
  buffer_load_dwordx4 v11, s[96:99], 0 offen offset:2048 sc1 lds
  buffer_load_dwordx4 v11, s[96:99], 0 offen offset:3072 sc1 lds
  s_add_u32 m0, s87, 0
  s_nop 0
  buffer_load_dwordx4 v12, s[12:15], 0 offen lds
  v_accvgpr_read_b32 v128, a32
  v_accvgpr_read_b32 v129, a33
  v_accvgpr_read_b32 v130, a34
  v_accvgpr_read_b32 v131, a35
  v_accvgpr_read_b32 v132, a36
  v_accvgpr_read_b32 v133, a37
  v_accvgpr_read_b32 v134, a38
  v_accvgpr_read_b32 v135, a39
  v_accvgpr_read_b32 v136, a40
  v_accvgpr_read_b32 v137, a41
  v_accvgpr_read_b32 v138, a42
  v_accvgpr_read_b32 v139, a43
  v_accvgpr_read_b32 v140, a44
  v_accvgpr_read_b32 v141, a45
  v_accvgpr_read_b32 v142, a46
  v_accvgpr_read_b32 v143, a47
  v_mul_f32 v128, v128, v224
  v_mul_f32 v129, v129, v224
  v_mul_f32 v130, v130, v224
  v_mul_f32 v131, v131, v224
  v_mul_f32 v132, v132, v224
  v_mul_f32 v133, v133, v224
  v_mul_f32 v134, v134, v224
  v_mul_f32 v135, v135, v224
  v_mul_f32 v136, v136, v224
  v_mul_f32 v137, v137, v224
  v_mul_f32 v138, v138, v224
  v_mul_f32 v139, v139, v224
  v_mul_f32 v140, v140, v224
  v_mul_f32 v141, v141, v224
  v_mul_f32 v142, v142, v224
  v_mul_f32 v143, v143, v224
  v_cvt_pk_bf16_f32 v128, v128, v129
  v_cvt_pk_bf16_f32 v129, v130, v131
  v_cvt_pk_bf16_f32 v130, v132, v133
  v_cvt_pk_bf16_f32 v131, v134, v135
  v_cvt_pk_bf16_f32 v132, v136, v137
  v_cvt_pk_bf16_f32 v133, v138, v139
  v_cvt_pk_bf16_f32 v134, v140, v141
  v_cvt_pk_bf16_f32 v135, v142, v143
  s_add_u32 s95, s34, 4096
  buffer_store_dwordx4 v[128:131], v2, s[96:99], s95 offen sc1
  buffer_store_dwordx4 v[132:135], v2, s[96:99], s95 offen offset:1024 sc1
  buffer_load_dwordx4 v12, s[12:15], s56 offen offset:1024 lds
  s_add_u32 m0, s87, 8192
  s_nop 0
  buffer_load_dwordx4 v12, s[12:15], s57 offen lds
  buffer_load_dwordx4 v12, s[12:15], s58 offen offset:1024 lds
  s_add_u32 m0, s87, 16384
  s_nop 0
  buffer_load_dwordx4 v12, s[12:15], s59 offen lds
  buffer_load_dwordx4 v12, s[12:15], s67 offen offset:1024 lds
  v_add_u32 v11, 4096, v11
  v_add_u32 v12, 73728, v12
  s_add_u32 s82, s82, 40960
  s_cmp_ge_u32 s82, 163840
  s_cselect_b32 s82, 0, s82
  v_accvgpr_read_b32 v144, a48
  v_accvgpr_read_b32 v145, a49
  v_accvgpr_read_b32 v146, a50
  v_accvgpr_read_b32 v147, a51
  v_accvgpr_read_b32 v148, a52
  v_accvgpr_read_b32 v149, a53
  v_accvgpr_read_b32 v150, a54
  v_accvgpr_read_b32 v151, a55
  v_accvgpr_read_b32 v152, a56
  v_accvgpr_read_b32 v153, a57
  v_accvgpr_read_b32 v154, a58
  v_accvgpr_read_b32 v155, a59
  v_accvgpr_read_b32 v156, a60
  v_accvgpr_read_b32 v157, a61
  v_accvgpr_read_b32 v158, a62
  v_accvgpr_read_b32 v159, a63
  v_mul_f32 v144, v144, v224
  v_mul_f32 v145, v145, v224
  v_mul_f32 v146, v146, v224
  v_mul_f32 v147, v147, v224
  v_mul_f32 v148, v148, v224
  v_mul_f32 v149, v149, v224
  v_mul_f32 v150, v150, v224
  v_mul_f32 v151, v151, v224
  v_mul_f32 v152, v152, v224
  v_mul_f32 v153, v153, v224
  v_mul_f32 v154, v154, v224
  v_mul_f32 v155, v155, v224
  v_mul_f32 v156, v156, v224
  v_mul_f32 v157, v157, v224
  v_mul_f32 v158, v158, v224
  v_mul_f32 v159, v159, v224
  v_cvt_pk_bf16_f32 v144, v144, v145
  v_cvt_pk_bf16_f32 v145, v146, v147
  v_cvt_pk_bf16_f32 v146, v148, v149
  v_cvt_pk_bf16_f32 v147, v150, v151
  v_cvt_pk_bf16_f32 v148, v152, v153
  v_cvt_pk_bf16_f32 v149, v154, v155
  v_cvt_pk_bf16_f32 v150, v156, v157
  v_cvt_pk_bf16_f32 v151, v158, v159
  s_add_u32 s95, s34, 6144
  buffer_store_dwordx4 v[144:147], v2, s[96:99], s95 offen sc1
  buffer_store_dwordx4 v[148:151], v2, s[96:99], s95 offen offset:1024 sc1
  v_mov_b32 v224, s91
  v_lshlrev_b32 v225, 2, v0
  v_and_b32 v225, 0x300, v225
  v_lshrrev_b32 v225, 6, v225
  v_add_u32 v225, 163824, v225
  ds_write_b32 v225, v224
  s_waitcnt lgkmcnt(0)
  s_barrier
  v_mov_b32 v225, 163824
  ds_read_b128 v[228:231], v225
  s_waitcnt lgkmcnt(0)
  v_or_b32 v228, v228, v229
  v_or_b32 v230, v230, v231
  v_or_b32 v228, v228, v230
  s_nop 0
  v_readfirstlane_b32 s91, v228
  s_nop 1
  s_cmp_eq_u32 s91, 0
  s_cbranch_scc1 L_noslow
  s_waitcnt vmcnt(0)
  s_barrier
  v_accvgpr_write_b32 a0, 0
  v_accvgpr_write_b32 a1, 0
  v_accvgpr_write_b32 a2, 0
  v_accvgpr_write_b32 a3, 0
  v_accvgpr_write_b32 a4, 0
  v_accvgpr_write_b32 a5, 0
  v_accvgpr_write_b32 a6, 0
  v_accvgpr_write_b32 a7, 0
  v_accvgpr_write_b32 a8, 0
  v_accvgpr_write_b32 a9, 0
  v_accvgpr_write_b32 a10, 0
  v_accvgpr_write_b32 a11, 0
  v_accvgpr_write_b32 a12, 0
  v_accvgpr_write_b32 a13, 0
  v_accvgpr_write_b32 a14, 0
  v_accvgpr_write_b32 a15, 0
  v_accvgpr_write_b32 a16, 0
  v_accvgpr_write_b32 a17, 0
  v_accvgpr_write_b32 a18, 0
  v_accvgpr_write_b32 a19, 0
  v_accvgpr_write_b32 a20, 0
  v_accvgpr_write_b32 a21, 0
  v_accvgpr_write_b32 a22, 0
  v_accvgpr_write_b32 a23, 0
  v_accvgpr_write_b32 a24, 0
  v_accvgpr_write_b32 a25, 0
  v_accvgpr_write_b32 a26, 0
  v_accvgpr_write_b32 a27, 0
  v_accvgpr_write_b32 a28, 0
  v_accvgpr_write_b32 a29, 0
  v_accvgpr_write_b32 a30, 0
  v_accvgpr_write_b32 a31, 0
  v_accvgpr_write_b32 a32, 0
  v_accvgpr_write_b32 a33, 0
  v_accvgpr_write_b32 a34, 0
  v_accvgpr_write_b32 a35, 0
  v_accvgpr_write_b32 a36, 0
  v_accvgpr_write_b32 a37, 0
  v_accvgpr_write_b32 a38, 0
  v_accvgpr_write_b32 a39, 0
  v_accvgpr_write_b32 a40, 0
  v_accvgpr_write_b32 a41, 0
  v_accvgpr_write_b32 a42, 0
  v_accvgpr_write_b32 a43, 0
  v_accvgpr_write_b32 a44, 0
  v_accvgpr_write_b32 a45, 0
  v_accvgpr_write_b32 a46, 0
  v_accvgpr_write_b32 a47, 0
  v_accvgpr_write_b32 a48, 0
  v_accvgpr_write_b32 a49, 0
  v_accvgpr_write_b32 a50, 0
  v_accvgpr_write_b32 a51, 0
  v_accvgpr_write_b32 a52, 0
  v_accvgpr_write_b32 a53, 0
  v_accvgpr_write_b32 a54, 0
  v_accvgpr_write_b32 a55, 0
  v_accvgpr_write_b32 a56, 0
  v_accvgpr_write_b32 a57, 0
  v_accvgpr_write_b32 a58, 0
  v_accvgpr_write_b32 a59, 0
  v_accvgpr_write_b32 a60, 0
  v_accvgpr_write_b32 a61, 0
  v_accvgpr_write_b32 a62, 0
  v_accvgpr_write_b32 a63, 0
  v_mov_b32 v236, v29
  v_mov_b32 v19, 0
  s_mov_b32 s39, 0
  s_mov_b32 s66, 0
  s_mov_b32 s54, s53
L_sl0:
  s_barrier
  s_mov_b32 m0, s43
  s_nop 0
  buffer_load_dwordx4 v13, s[16:19], s39 offen offset:0 sc1 lds
  buffer_load_dwordx4 v13, s[16:19], s39 offen offset:1024 sc1 lds
  buffer_load_dwordx4 v13, s[16:19], s39 offen offset:2048 sc1 lds
  buffer_load_dwordx4 v13, s[16:19], s39 offen offset:3072 sc1 lds
  s_add_u32 m0, s43, 16384
  s_nop 0
  buffer_load_dwordx4 v13, s[20:23], s39 offen offset:0 sc1 lds
  buffer_load_dwordx4 v13, s[20:23], s39 offen offset:1024 sc1 lds
  buffer_load_dwordx4 v13, s[20:23], s39 offen offset:2048 sc1 lds
  buffer_load_dwordx4 v13, s[20:23], s39 offen offset:3072 sc1 lds
  s_add_u32 s39, s39, 16384
  s_waitcnt vmcnt(0)
  s_barrier
  ds_read_b128 a[128:131], v2 offset:0
  ds_read_b128 a[132:135], v2 offset:1024
  ds_read_b128 a[136:139], v2 offset:2048
  ds_read_b128 a[140:143], v2 offset:3072
  ds_read_b128 a[144:147], v2 offset:4096
  ds_read_b128 a[148:151], v2 offset:5120
  ds_read_b128 a[152:155], v2 offset:6144
  ds_read_b128 a[156:159], v2 offset:7168
  ds_read_b128 a[160:163], v2 offset:8192
  ds_read_b128 a[164:167], v2 offset:9216
  ds_read_b128 a[168:171], v2 offset:10240
  ds_read_b128 a[172:175], v2 offset:11264
  ds_read_b128 a[176:179], v2 offset:12288
  ds_read_b128 a[180:183], v2 offset:13312
  ds_read_b128 a[184:187], v2 offset:14336
  ds_read_b128 a[188:191], v2 offset:15360
  s_waitcnt lgkmcnt(0)
  v_mfma_f32_32x32x16_bf16 v[96:111], a[128:131], v[32:35], 0
  v_mfma_f32_32x32x16_bf16 v[96:111], a[132:135], v[36:39], v[96:111]
  v_mfma_f32_32x32x16_bf16 v[96:111], a[136:139], v[40:43], v[96:111]
  v_mfma_f32_32x32x16_bf16 v[96:111], a[140:143], v[44:47], v[96:111]
  v_mfma_f32_32x32x16_bf16 v[96:111], a[144:147], v[48:51], v[96:111]
  v_mfma_f32_32x32x16_bf16 v[96:111], a[148:151], v[52:55], v[96:111]
  v_mfma_f32_32x32x16_bf16 v[96:111], a[152:155], v[56:59], v[96:111]
  v_mfma_f32_32x32x16_bf16 v[96:111], a[156:159], v[60:63], v[96:111]
  v_mfma_f32_32x32x16_bf16 v[112:127], a[160:163], v[32:35], 0
  v_mfma_f32_32x32x16_bf16 v[112:127], a[164:167], v[36:39], v[112:127]
  v_mfma_f32_32x32x16_bf16 v[112:127], a[168:171], v[40:43], v[112:127]
  v_mfma_f32_32x32x16_bf16 v[112:127], a[172:175], v[44:47], v[112:127]
  v_mfma_f32_32x32x16_bf16 v[112:127], a[176:179], v[48:51], v[112:127]
  v_mfma_f32_32x32x16_bf16 v[112:127], a[180:183], v[52:55], v[112:127]
  v_mfma_f32_32x32x16_bf16 v[112:127], a[184:187], v[56:59], v[112:127]
  v_mfma_f32_32x32x16_bf16 v[112:127], a[188:191], v[60:63], v[112:127]
  ds_read_b128 a[128:131], v2 offset:16384
  ds_read_b128 a[132:135], v2 offset:17408
  ds_read_b128 a[136:139], v2 offset:18432
  ds_read_b128 a[140:143], v2 offset:19456
  ds_read_b128 a[144:147], v2 offset:20480
  ds_read_b128 a[148:151], v2 offset:21504
  ds_read_b128 a[152:155], v2 offset:22528
  ds_read_b128 a[156:159], v2 offset:23552
  ds_read_b128 a[160:163], v2 offset:24576
  ds_read_b128 a[164:167], v2 offset:25600
  ds_read_b128 a[168:171], v2 offset:26624
  ds_read_b128 a[172:175], v2 offset:27648
  ds_read_b128 a[176:179], v2 offset:28672
  ds_read_b128 a[180:183], v2 offset:29696
  ds_read_b128 a[184:187], v2 offset:30720
  ds_read_b128 a[188:191], v2 offset:31744
  s_nop 7
  s_nop 7
  s_add_u32 s100, s66, 0
  v_subrev_u32 v21, s100, v17
  v_cmp_ge_i32 s[60:61], v21, 0
  v_cmp_ge_i32 s[62:63], v21, 1
  v_cmp_ge_i32 s[4:5], v21, 2
  v_cndmask_b32 v96, v29, v96, s[60:61]
  v_cmp_ge_i32 s[6:7], v21, 3
  v_cndmask_b32 v97, v29, v97, s[62:63]
  v_cmp_ge_i32 s[60:61], v21, 8
  v_cndmask_b32 v98, v29, v98, s[4:5]
  v_cmp_ge_i32 s[62:63], v21, 9
  v_cndmask_b32 v99, v29, v99, s[6:7]
  v_cmp_ge_i32 s[4:5], v21, 10
  v_cndmask_b32 v100, v29, v100, s[60:61]
  v_cmp_ge_i32 s[6:7], v21, 11
  v_cndmask_b32 v101, v29, v101, s[62:63]
  v_cmp_ge_i32 s[60:61], v21, 16
  v_cndmask_b32 v102, v29, v102, s[4:5]
  v_cmp_ge_i32 s[62:63], v21, 17
  v_cndmask_b32 v103, v29, v103, s[6:7]
  v_cmp_ge_i32 s[4:5], v21, 18
  v_cndmask_b32 v104, v29, v104, s[60:61]
  v_cmp_ge_i32 s[6:7], v21, 19
  v_cndmask_b32 v105, v29, v105, s[62:63]
  v_cmp_ge_i32 s[60:61], v21, 24
  v_cndmask_b32 v106, v29, v106, s[4:5]
  v_cmp_ge_i32 s[62:63], v21, 25
  v_cndmask_b32 v107, v29, v107, s[6:7]
  v_cmp_ge_i32 s[4:5], v21, 26
  v_cndmask_b32 v108, v29, v108, s[60:61]
  v_cmp_ge_i32 s[6:7], v21, 27
  v_cndmask_b32 v109, v29, v109, s[62:63]
  v_cndmask_b32 v110, v29, v110, s[4:5]
  v_cndmask_b32 v111, v29, v111, s[6:7]
  s_add_u32 s100, s66, 32
  v_subrev_u32 v21, s100, v17
  v_cmp_ge_i32 s[60:61], v21, 0
  v_cmp_ge_i32 s[62:63], v21, 1
  v_cmp_ge_i32 s[4:5], v21, 2
  v_cndmask_b32 v112, v29, v112, s[60:61]
  v_cmp_ge_i32 s[6:7], v21, 3
  v_cndmask_b32 v113, v29, v113, s[62:63]
  v_cmp_ge_i32 s[60:61], v21, 8
  v_cndmask_b32 v114, v29, v114, s[4:5]
  v_cmp_ge_i32 s[62:63], v21, 9
  v_cndmask_b32 v115, v29, v115, s[6:7]
  v_cmp_ge_i32 s[4:5], v21, 10
  v_cndmask_b32 v116, v29, v116, s[60:61]
  v_cmp_ge_i32 s[6:7], v21, 11
  v_cndmask_b32 v117, v29, v117, s[62:63]
  v_cmp_ge_i32 s[60:61], v21, 16
  v_cndmask_b32 v118, v29, v118, s[4:5]
  v_cmp_ge_i32 s[62:63], v21, 17
  v_cndmask_b32 v119, v29, v119, s[6:7]
  v_cmp_ge_i32 s[4:5], v21, 18
  v_cndmask_b32 v120, v29, v120, s[60:61]
  v_cmp_ge_i32 s[6:7], v21, 19
  v_cndmask_b32 v121, v29, v121, s[62:63]
  v_cmp_ge_i32 s[60:61], v21, 24
  v_cndmask_b32 v122, v29, v122, s[4:5]
  v_cmp_ge_i32 s[62:63], v21, 25
  v_cndmask_b32 v123, v29, v123, s[6:7]
  v_cmp_ge_i32 s[4:5], v21, 26
  v_cndmask_b32 v124, v29, v124, s[60:61]
  v_cmp_ge_i32 s[6:7], v21, 27
  v_cndmask_b32 v125, v29, v125, s[62:63]
  v_cndmask_b32 v126, v29, v126, s[4:5]
  v_cndmask_b32 v127, v29, v127, s[6:7]
  v_max3_f32 v224, v96, v97, v98
  v_max3_f32 v224, v224, v99, v100
  v_max3_f32 v224, v224, v101, v102
  v_max3_f32 v224, v224, v103, v104
  v_max3_f32 v224, v224, v105, v106
  v_max3_f32 v224, v224, v107, v108
  v_max3_f32 v224, v224, v109, v110
  v_max3_f32 v224, v224, v111, v112
  v_max3_f32 v224, v224, v113, v114
  v_max3_f32 v224, v224, v115, v116
  v_max3_f32 v224, v224, v117, v118
  v_max3_f32 v224, v224, v119, v120
  v_max3_f32 v224, v224, v121, v122
  v_max3_f32 v224, v224, v123, v124
  v_max3_f32 v224, v224, v125, v126
  v_max3_f32 v224, v224, v127, v236
  v_mov_b32 v225, v224
  s_nop 1
  v_permlane32_swap_b32 v224, v225
  s_nop 1
  v_max_f32 v224, v224, v225
  v_sub_f32 v225, v236, v224
  v_exp_f32 v225, v225
  v_mov_b32 v236, v224
  v_sub_f32 v96, v96, v224
  v_sub_f32 v97, v97, v224
  v_sub_f32 v98, v98, v224
  v_sub_f32 v99, v99, v224
  v_sub_f32 v100, v100, v224
  v_sub_f32 v101, v101, v224
  v_sub_f32 v102, v102, v224
  v_sub_f32 v103, v103, v224
  v_sub_f32 v104, v104, v224
  v_sub_f32 v105, v105, v224
  v_sub_f32 v106, v106, v224
  v_sub_f32 v107, v107, v224
  v_sub_f32 v108, v108, v224
  v_sub_f32 v109, v109, v224
  v_sub_f32 v110, v110, v224
  v_sub_f32 v111, v111, v224
  v_sub_f32 v112, v112, v224
  v_sub_f32 v113, v113, v224
  v_sub_f32 v114, v114, v224
  v_sub_f32 v115, v115, v224
  v_sub_f32 v116, v116, v224
  v_sub_f32 v117, v117, v224
  v_sub_f32 v118, v118, v224
  v_sub_f32 v119, v119, v224
  v_sub_f32 v120, v120, v224
  v_sub_f32 v121, v121, v224
  v_sub_f32 v122, v122, v224
  v_sub_f32 v123, v123, v224
  v_sub_f32 v124, v124, v224
  v_sub_f32 v125, v125, v224
  v_sub_f32 v126, v126, v224
  v_sub_f32 v127, v127, v224
  v_exp_f32 v96, v96
  v_exp_f32 v97, v97
  v_exp_f32 v98, v98
  v_exp_f32 v99, v99
  v_exp_f32 v100, v100
  v_exp_f32 v101, v101
  v_exp_f32 v102, v102
  v_exp_f32 v103, v103
  v_exp_f32 v104, v104
  v_exp_f32 v105, v105
  v_exp_f32 v106, v106
  v_exp_f32 v107, v107
  v_exp_f32 v108, v108
  v_exp_f32 v109, v109
  v_exp_f32 v110, v110
  v_exp_f32 v111, v111
  v_exp_f32 v112, v112
  v_exp_f32 v113, v113
  v_exp_f32 v114, v114
  v_exp_f32 v115, v115
  v_exp_f32 v116, v116
  v_exp_f32 v117, v117
  v_exp_f32 v118, v118
  v_exp_f32 v119, v119
  v_exp_f32 v120, v120
  v_exp_f32 v121, v121
  v_exp_f32 v122, v122
  v_exp_f32 v123, v123
  v_exp_f32 v124, v124
  v_exp_f32 v125, v125
  v_exp_f32 v126, v126
  v_exp_f32 v127, v127
  v_mul_f32 v19, v19, v225
  v_add_f32 v19, v19, v96
  v_add_f32 v19, v19, v97
  v_add_f32 v19, v19, v98
  v_add_f32 v19, v19, v99
  v_add_f32 v19, v19, v100
  v_add_f32 v19, v19, v101
  v_add_f32 v19, v19, v102
  v_add_f32 v19, v19, v103
  v_add_f32 v19, v19, v104
  v_add_f32 v19, v19, v105
  v_add_f32 v19, v19, v106
  v_add_f32 v19, v19, v107
  v_add_f32 v19, v19, v108
  v_add_f32 v19, v19, v109
  v_add_f32 v19, v19, v110
  v_add_f32 v19, v19, v111
  v_add_f32 v19, v19, v112
  v_add_f32 v19, v19, v113
  v_add_f32 v19, v19, v114
  v_add_f32 v19, v19, v115
  v_add_f32 v19, v19, v116
  v_add_f32 v19, v19, v117
  v_add_f32 v19, v19, v118
  v_add_f32 v19, v19, v119
  v_add_f32 v19, v19, v120
  v_add_f32 v19, v19, v121
  v_add_f32 v19, v19, v122
  v_add_f32 v19, v19, v123
  v_add_f32 v19, v19, v124
  v_add_f32 v19, v19, v125
  v_add_f32 v19, v19, v126
  v_add_f32 v19, v19, v127
  v_cvt_pk_bf16_f32 v160, v96, v97
  v_cvt_pk_bf16_f32 v161, v98, v99
  v_cvt_pk_bf16_f32 v162, v100, v101
  v_cvt_pk_bf16_f32 v163, v102, v103
  v_cvt_pk_bf16_f32 v164, v104, v105
  v_cvt_pk_bf16_f32 v165, v106, v107
  v_cvt_pk_bf16_f32 v166, v108, v109
  v_cvt_pk_bf16_f32 v167, v110, v111
  v_cvt_pk_bf16_f32 v168, v112, v113
  v_cvt_pk_bf16_f32 v169, v114, v115
  v_cvt_pk_bf16_f32 v170, v116, v117
  v_cvt_pk_bf16_f32 v171, v118, v119
  v_cvt_pk_bf16_f32 v172, v120, v121
  v_cvt_pk_bf16_f32 v173, v122, v123
  v_cvt_pk_bf16_f32 v174, v124, v125
  v_cvt_pk_bf16_f32 v175, v126, v127
  v_accvgpr_read_b32 v226, a0
  v_mul_f32 v226, v226, v225
  v_accvgpr_write_b32 a0, v226
  v_accvgpr_read_b32 v226, a1
  v_mul_f32 v226, v226, v225
  v_accvgpr_write_b32 a1, v226
  v_accvgpr_read_b32 v226, a2
  v_mul_f32 v226, v226, v225
  v_accvgpr_write_b32 a2, v226
  v_accvgpr_read_b32 v226, a3
  v_mul_f32 v226, v226, v225
  v_accvgpr_write_b32 a3, v226
  v_accvgpr_read_b32 v226, a4
  v_mul_f32 v226, v226, v225
  v_accvgpr_write_b32 a4, v226
  v_accvgpr_read_b32 v226, a5
  v_mul_f32 v226, v226, v225
  v_accvgpr_write_b32 a5, v226
  v_accvgpr_read_b32 v226, a6
  v_mul_f32 v226, v226, v225
  v_accvgpr_write_b32 a6, v226
  v_accvgpr_read_b32 v226, a7
  v_mul_f32 v226, v226, v225
  v_accvgpr_write_b32 a7, v226
  v_accvgpr_read_b32 v226, a8
  v_mul_f32 v226, v226, v225
  v_accvgpr_write_b32 a8, v226
  v_accvgpr_read_b32 v226, a9
  v_mul_f32 v226, v226, v225
  v_accvgpr_write_b32 a9, v226
  v_accvgpr_read_b32 v226, a10
  v_mul_f32 v226, v226, v225
  v_accvgpr_write_b32 a10, v226
  v_accvgpr_read_b32 v226, a11
  v_mul_f32 v226, v226, v225
  v_accvgpr_write_b32 a11, v226
  v_accvgpr_read_b32 v226, a12
  v_mul_f32 v226, v226, v225
  v_accvgpr_write_b32 a12, v226
  v_accvgpr_read_b32 v226, a13
  v_mul_f32 v226, v226, v225
  v_accvgpr_write_b32 a13, v226
  v_accvgpr_read_b32 v226, a14
  v_mul_f32 v226, v226, v225
  v_accvgpr_write_b32 a14, v226
  v_accvgpr_read_b32 v226, a15
  v_mul_f32 v226, v226, v225
  v_accvgpr_write_b32 a15, v226
  v_accvgpr_read_b32 v226, a16
  v_mul_f32 v226, v226, v225
  v_accvgpr_write_b32 a16, v226
  v_accvgpr_read_b32 v226, a17
  v_mul_f32 v226, v226, v225
  v_accvgpr_write_b32 a17, v226
  v_accvgpr_read_b32 v226, a18
  v_mul_f32 v226, v226, v225
  v_accvgpr_write_b32 a18, v226
  v_accvgpr_read_b32 v226, a19
  v_mul_f32 v226, v226, v225
  v_accvgpr_write_b32 a19, v226
  v_accvgpr_read_b32 v226, a20
  v_mul_f32 v226, v226, v225
  v_accvgpr_write_b32 a20, v226
  v_accvgpr_read_b32 v226, a21
  v_mul_f32 v226, v226, v225
  v_accvgpr_write_b32 a21, v226
  v_accvgpr_read_b32 v226, a22
  v_mul_f32 v226, v226, v225
  v_accvgpr_write_b32 a22, v226
  v_accvgpr_read_b32 v226, a23
  v_mul_f32 v226, v226, v225
  v_accvgpr_write_b32 a23, v226
  v_accvgpr_read_b32 v226, a24
  v_mul_f32 v226, v226, v225
  v_accvgpr_write_b32 a24, v226
  v_accvgpr_read_b32 v226, a25
  v_mul_f32 v226, v226, v225
  v_accvgpr_write_b32 a25, v226
  v_accvgpr_read_b32 v226, a26
  v_mul_f32 v226, v226, v225
  v_accvgpr_write_b32 a26, v226
  v_accvgpr_read_b32 v226, a27
  v_mul_f32 v226, v226, v225
  v_accvgpr_write_b32 a27, v226
  v_accvgpr_read_b32 v226, a28
  v_mul_f32 v226, v226, v225
  v_accvgpr_write_b32 a28, v226
  v_accvgpr_read_b32 v226, a29
  v_mul_f32 v226, v226, v225
  v_accvgpr_write_b32 a29, v226
  v_accvgpr_read_b32 v226, a30
  v_mul_f32 v226, v226, v225
  v_accvgpr_write_b32 a30, v226
  v_accvgpr_read_b32 v226, a31
  v_mul_f32 v226, v226, v225
  v_accvgpr_write_b32 a31, v226
  v_accvgpr_read_b32 v226, a32
  v_mul_f32 v226, v226, v225
  v_accvgpr_write_b32 a32, v226
  v_accvgpr_read_b32 v226, a33
  v_mul_f32 v226, v226, v225
  v_accvgpr_write_b32 a33, v226
  v_accvgpr_read_b32 v226, a34
  v_mul_f32 v226, v226, v225
  v_accvgpr_write_b32 a34, v226
  v_accvgpr_read_b32 v226, a35
  v_mul_f32 v226, v226, v225
  v_accvgpr_write_b32 a35, v226
  v_accvgpr_read_b32 v226, a36
  v_mul_f32 v226, v226, v225
  v_accvgpr_write_b32 a36, v226
  v_accvgpr_read_b32 v226, a37
  v_mul_f32 v226, v226, v225
  v_accvgpr_write_b32 a37, v226
  v_accvgpr_read_b32 v226, a38
  v_mul_f32 v226, v226, v225
  v_accvgpr_write_b32 a38, v226
  v_accvgpr_read_b32 v226, a39
  v_mul_f32 v226, v226, v225
  v_accvgpr_write_b32 a39, v226
  v_accvgpr_read_b32 v226, a40
  v_mul_f32 v226, v226, v225
  v_accvgpr_write_b32 a40, v226
  v_accvgpr_read_b32 v226, a41
  v_mul_f32 v226, v226, v225
  v_accvgpr_write_b32 a41, v226
  v_accvgpr_read_b32 v226, a42
  v_mul_f32 v226, v226, v225
  v_accvgpr_write_b32 a42, v226
  v_accvgpr_read_b32 v226, a43
  v_mul_f32 v226, v226, v225
  v_accvgpr_write_b32 a43, v226
  v_accvgpr_read_b32 v226, a44
  v_mul_f32 v226, v226, v225
  v_accvgpr_write_b32 a44, v226
  v_accvgpr_read_b32 v226, a45
  v_mul_f32 v226, v226, v225
  v_accvgpr_write_b32 a45, v226
  v_accvgpr_read_b32 v226, a46
  v_mul_f32 v226, v226, v225
  v_accvgpr_write_b32 a46, v226
  v_accvgpr_read_b32 v226, a47
  v_mul_f32 v226, v226, v225
  v_accvgpr_write_b32 a47, v226
  v_accvgpr_read_b32 v226, a48
  v_mul_f32 v226, v226, v225
  v_accvgpr_write_b32 a48, v226
  v_accvgpr_read_b32 v226, a49
  v_mul_f32 v226, v226, v225
  v_accvgpr_write_b32 a49, v226
  v_accvgpr_read_b32 v226, a50
  v_mul_f32 v226, v226, v225
  v_accvgpr_write_b32 a50, v226
  v_accvgpr_read_b32 v226, a51
  v_mul_f32 v226, v226, v225
  v_accvgpr_write_b32 a51, v226
  v_accvgpr_read_b32 v226, a52
  v_mul_f32 v226, v226, v225
  v_accvgpr_write_b32 a52, v226
  v_accvgpr_read_b32 v226, a53
  v_mul_f32 v226, v226, v225
  v_accvgpr_write_b32 a53, v226
  v_accvgpr_read_b32 v226, a54
  v_mul_f32 v226, v226, v225
  v_accvgpr_write_b32 a54, v226
  v_accvgpr_read_b32 v226, a55
  v_mul_f32 v226, v226, v225
  v_accvgpr_write_b32 a55, v226
  v_accvgpr_read_b32 v226, a56
  v_mul_f32 v226, v226, v225
  v_accvgpr_write_b32 a56, v226
  v_accvgpr_read_b32 v226, a57
  v_mul_f32 v226, v226, v225
  v_accvgpr_write_b32 a57, v226
  v_accvgpr_read_b32 v226, a58
  v_mul_f32 v226, v226, v225
  v_accvgpr_write_b32 a58, v226
  v_accvgpr_read_b32 v226, a59
  v_mul_f32 v226, v226, v225
  v_accvgpr_write_b32 a59, v226
  v_accvgpr_read_b32 v226, a60
  v_mul_f32 v226, v226, v225
  v_accvgpr_write_b32 a60, v226
  v_accvgpr_read_b32 v226, a61
  v_mul_f32 v226, v226, v225
  v_accvgpr_write_b32 a61, v226
  v_accvgpr_read_b32 v226, a62
  v_mul_f32 v226, v226, v225
  v_accvgpr_write_b32 a62, v226
  v_accvgpr_read_b32 v226, a63
  v_mul_f32 v226, v226, v225
  v_accvgpr_write_b32 a63, v226
  s_waitcnt lgkmcnt(0)
  s_nop 1
  v_mfma_f32_32x32x16_bf16 a[0:15], a[128:131], v[160:163], a[0:15]
  v_mfma_f32_32x32x16_bf16 a[16:31], a[132:135], v[160:163], a[16:31]
  v_mfma_f32_32x32x16_bf16 a[32:47], a[136:139], v[160:163], a[32:47]
  v_mfma_f32_32x32x16_bf16 a[48:63], a[140:143], v[160:163], a[48:63]
  v_mfma_f32_32x32x16_bf16 a[0:15], a[144:147], v[164:167], a[0:15]
  v_mfma_f32_32x32x16_bf16 a[16:31], a[148:151], v[164:167], a[16:31]
  v_mfma_f32_32x32x16_bf16 a[32:47], a[152:155], v[164:167], a[32:47]
  v_mfma_f32_32x32x16_bf16 a[48:63], a[156:159], v[164:167], a[48:63]
  v_mfma_f32_32x32x16_bf16 a[0:15], a[160:163], v[168:171], a[0:15]
  v_mfma_f32_32x32x16_bf16 a[16:31], a[164:167], v[168:171], a[16:31]
  v_mfma_f32_32x32x16_bf16 a[32:47], a[168:171], v[168:171], a[32:47]
  v_mfma_f32_32x32x16_bf16 a[48:63], a[172:175], v[168:171], a[48:63]
  v_mfma_f32_32x32x16_bf16 a[0:15], a[176:179], v[172:175], a[0:15]
  v_mfma_f32_32x32x16_bf16 a[16:31], a[180:183], v[172:175], a[16:31]
  v_mfma_f32_32x32x16_bf16 a[32:47], a[184:187], v[172:175], a[32:47]
  v_mfma_f32_32x32x16_bf16 a[48:63], a[188:191], v[172:175], a[48:63]
  s_add_u32 s66, s66, 64
  s_sub_u32 s54, s54, 1
  s_cmp_lg_u32 s54, 0
  s_cbranch_scc1 L_sl0
  s_nop 7
  s_nop 7
  v_mov_b32 v224, v19
  s_nop 1
  v_permlane32_swap_b32 v19, v224
  s_nop 1
  v_add_f32 v19, v19, v224
  v_rcp_f32 v224, v19
  s_nop 1
  s_sub_u32 s34, 15, s51
  s_lshl_b32 s34, s34, 2
  s_add_u32 s34, s34, s3
  s_mul_i32 s34, s34, 544
  s_lshl_b32 s95, s50, 3
  s_add_u32 s34, s34, s95
  s_lshl_b32 s34, s34, 10
  v_accvgpr_read_b32 v128, a0
  v_accvgpr_read_b32 v129, a1
  v_accvgpr_read_b32 v130, a2
  v_accvgpr_read_b32 v131, a3
  v_accvgpr_read_b32 v132, a4
  v_accvgpr_read_b32 v133, a5
  v_accvgpr_read_b32 v134, a6
  v_accvgpr_read_b32 v135, a7
  v_accvgpr_read_b32 v136, a8
  v_accvgpr_read_b32 v137, a9
  v_accvgpr_read_b32 v138, a10
  v_accvgpr_read_b32 v139, a11
  v_accvgpr_read_b32 v140, a12
  v_accvgpr_read_b32 v141, a13
  v_accvgpr_read_b32 v142, a14
  v_accvgpr_read_b32 v143, a15
  v_mul_f32 v128, v128, v224
  v_mul_f32 v129, v129, v224
  v_mul_f32 v130, v130, v224
  v_mul_f32 v131, v131, v224
  v_mul_f32 v132, v132, v224
  v_mul_f32 v133, v133, v224
  v_mul_f32 v134, v134, v224
  v_mul_f32 v135, v135, v224
  v_mul_f32 v136, v136, v224
  v_mul_f32 v137, v137, v224
  v_mul_f32 v138, v138, v224
  v_mul_f32 v139, v139, v224
  v_mul_f32 v140, v140, v224
  v_mul_f32 v141, v141, v224
  v_mul_f32 v142, v142, v224
  v_mul_f32 v143, v143, v224
  v_cvt_pk_bf16_f32 v128, v128, v129
  v_cvt_pk_bf16_f32 v129, v130, v131
  v_cvt_pk_bf16_f32 v130, v132, v133
  v_cvt_pk_bf16_f32 v131, v134, v135
  v_cvt_pk_bf16_f32 v132, v136, v137
  v_cvt_pk_bf16_f32 v133, v138, v139
  v_cvt_pk_bf16_f32 v134, v140, v141
  v_cvt_pk_bf16_f32 v135, v142, v143
  s_add_u32 s95, s34, 0
  buffer_store_dwordx4 v[128:131], v2, s[96:99], s95 offen sc1
  buffer_store_dwordx4 v[132:135], v2, s[96:99], s95 offen offset:1024 sc1
  v_accvgpr_read_b32 v144, a16
  v_accvgpr_read_b32 v145, a17
  v_accvgpr_read_b32 v146, a18
  v_accvgpr_read_b32 v147, a19
  v_accvgpr_read_b32 v148, a20
  v_accvgpr_read_b32 v149, a21
  v_accvgpr_read_b32 v150, a22
  v_accvgpr_read_b32 v151, a23
  v_accvgpr_read_b32 v152, a24
  v_accvgpr_read_b32 v153, a25
  v_accvgpr_read_b32 v154, a26
  v_accvgpr_read_b32 v155, a27
  v_accvgpr_read_b32 v156, a28
  v_accvgpr_read_b32 v157, a29
  v_accvgpr_read_b32 v158, a30
  v_accvgpr_read_b32 v159, a31
  v_mul_f32 v144, v144, v224
  v_mul_f32 v145, v145, v224
  v_mul_f32 v146, v146, v224
  v_mul_f32 v147, v147, v224
  v_mul_f32 v148, v148, v224
  v_mul_f32 v149, v149, v224
  v_mul_f32 v150, v150, v224
  v_mul_f32 v151, v151, v224
  v_mul_f32 v152, v152, v224
  v_mul_f32 v153, v153, v224
  v_mul_f32 v154, v154, v224
  v_mul_f32 v155, v155, v224
  v_mul_f32 v156, v156, v224
  v_mul_f32 v157, v157, v224
  v_mul_f32 v158, v158, v224
  v_mul_f32 v159, v159, v224
  v_cvt_pk_bf16_f32 v144, v144, v145
  v_cvt_pk_bf16_f32 v145, v146, v147
  v_cvt_pk_bf16_f32 v146, v148, v149
  v_cvt_pk_bf16_f32 v147, v150, v151
  v_cvt_pk_bf16_f32 v148, v152, v153
  v_cvt_pk_bf16_f32 v149, v154, v155
  v_cvt_pk_bf16_f32 v150, v156, v157
  v_cvt_pk_bf16_f32 v151, v158, v159
  s_add_u32 s95, s34, 2048
  buffer_store_dwordx4 v[144:147], v2, s[96:99], s95 offen sc1
  buffer_store_dwordx4 v[148:151], v2, s[96:99], s95 offen offset:1024 sc1
  v_accvgpr_read_b32 v128, a32
  v_accvgpr_read_b32 v129, a33
  v_accvgpr_read_b32 v130, a34
  v_accvgpr_read_b32 v131, a35
  v_accvgpr_read_b32 v132, a36
  v_accvgpr_read_b32 v133, a37
  v_accvgpr_read_b32 v134, a38
  v_accvgpr_read_b32 v135, a39
  v_accvgpr_read_b32 v136, a40
  v_accvgpr_read_b32 v137, a41
  v_accvgpr_read_b32 v138, a42
  v_accvgpr_read_b32 v139, a43
  v_accvgpr_read_b32 v140, a44
  v_accvgpr_read_b32 v141, a45
  v_accvgpr_read_b32 v142, a46
  v_accvgpr_read_b32 v143, a47
  v_mul_f32 v128, v128, v224
  v_mul_f32 v129, v129, v224
  v_mul_f32 v130, v130, v224
  v_mul_f32 v131, v131, v224
  v_mul_f32 v132, v132, v224
  v_mul_f32 v133, v133, v224
  v_mul_f32 v134, v134, v224
  v_mul_f32 v135, v135, v224
  v_mul_f32 v136, v136, v224
  v_mul_f32 v137, v137, v224
  v_mul_f32 v138, v138, v224
  v_mul_f32 v139, v139, v224
  v_mul_f32 v140, v140, v224
  v_mul_f32 v141, v141, v224
  v_mul_f32 v142, v142, v224
  v_mul_f32 v143, v143, v224
  v_cvt_pk_bf16_f32 v128, v128, v129
  v_cvt_pk_bf16_f32 v129, v130, v131
  v_cvt_pk_bf16_f32 v130, v132, v133
  v_cvt_pk_bf16_f32 v131, v134, v135
  v_cvt_pk_bf16_f32 v132, v136, v137
  v_cvt_pk_bf16_f32 v133, v138, v139
  v_cvt_pk_bf16_f32 v134, v140, v141
  v_cvt_pk_bf16_f32 v135, v142, v143
  s_add_u32 s95, s34, 4096
  buffer_store_dwordx4 v[128:131], v2, s[96:99], s95 offen sc1
  buffer_store_dwordx4 v[132:135], v2, s[96:99], s95 offen offset:1024 sc1
  v_accvgpr_read_b32 v144, a48
  v_accvgpr_read_b32 v145, a49
  v_accvgpr_read_b32 v146, a50
  v_accvgpr_read_b32 v147, a51
  v_accvgpr_read_b32 v148, a52
  v_accvgpr_read_b32 v149, a53
  v_accvgpr_read_b32 v150, a54
  v_accvgpr_read_b32 v151, a55
  v_accvgpr_read_b32 v152, a56
  v_accvgpr_read_b32 v153, a57
  v_accvgpr_read_b32 v154, a58
  v_accvgpr_read_b32 v155, a59
  v_accvgpr_read_b32 v156, a60
  v_accvgpr_read_b32 v157, a61
  v_accvgpr_read_b32 v158, a62
  v_accvgpr_read_b32 v159, a63
  v_mul_f32 v144, v144, v224
  v_mul_f32 v145, v145, v224
  v_mul_f32 v146, v146, v224
  v_mul_f32 v147, v147, v224
  v_mul_f32 v148, v148, v224
  v_mul_f32 v149, v149, v224
  v_mul_f32 v150, v150, v224
  v_mul_f32 v151, v151, v224
  v_mul_f32 v152, v152, v224
  v_mul_f32 v153, v153, v224
  v_mul_f32 v154, v154, v224
  v_mul_f32 v155, v155, v224
  v_mul_f32 v156, v156, v224
  v_mul_f32 v157, v157, v224
  v_mul_f32 v158, v158, v224
  v_mul_f32 v159, v159, v224
  v_cvt_pk_bf16_f32 v144, v144, v145
  v_cvt_pk_bf16_f32 v145, v146, v147
  v_cvt_pk_bf16_f32 v146, v148, v149
  v_cvt_pk_bf16_f32 v147, v150, v151
  v_cvt_pk_bf16_f32 v148, v152, v153
  v_cvt_pk_bf16_f32 v149, v154, v155
  v_cvt_pk_bf16_f32 v150, v156, v157
  v_cvt_pk_bf16_f32 v151, v158, v159
  s_add_u32 s95, s34, 6144
  buffer_store_dwordx4 v[144:147], v2, s[96:99], s95 offen sc1
  buffer_store_dwordx4 v[148:151], v2, s[96:99], s95 offen offset:1024 sc1
  v_accvgpr_write_b32 a0, 0
  v_accvgpr_write_b32 a1, 0
  v_accvgpr_write_b32 a2, 0
  v_accvgpr_write_b32 a3, 0
  v_accvgpr_write_b32 a4, 0
  v_accvgpr_write_b32 a5, 0
  v_accvgpr_write_b32 a6, 0
  v_accvgpr_write_b32 a7, 0
  v_accvgpr_write_b32 a8, 0
  v_accvgpr_write_b32 a9, 0
  v_accvgpr_write_b32 a10, 0
  v_accvgpr_write_b32 a11, 0
  v_accvgpr_write_b32 a12, 0
  v_accvgpr_write_b32 a13, 0
  v_accvgpr_write_b32 a14, 0
  v_accvgpr_write_b32 a15, 0
  v_accvgpr_write_b32 a16, 0
  v_accvgpr_write_b32 a17, 0
  v_accvgpr_write_b32 a18, 0
  v_accvgpr_write_b32 a19, 0
  v_accvgpr_write_b32 a20, 0
  v_accvgpr_write_b32 a21, 0
  v_accvgpr_write_b32 a22, 0
  v_accvgpr_write_b32 a23, 0
  v_accvgpr_write_b32 a24, 0
  v_accvgpr_write_b32 a25, 0
  v_accvgpr_write_b32 a26, 0
  v_accvgpr_write_b32 a27, 0
  v_accvgpr_write_b32 a28, 0
  v_accvgpr_write_b32 a29, 0
  v_accvgpr_write_b32 a30, 0
  v_accvgpr_write_b32 a31, 0
  v_accvgpr_write_b32 a32, 0
  v_accvgpr_write_b32 a33, 0
  v_accvgpr_write_b32 a34, 0
  v_accvgpr_write_b32 a35, 0
  v_accvgpr_write_b32 a36, 0
  v_accvgpr_write_b32 a37, 0
  v_accvgpr_write_b32 a38, 0
  v_accvgpr_write_b32 a39, 0
  v_accvgpr_write_b32 a40, 0
  v_accvgpr_write_b32 a41, 0
  v_accvgpr_write_b32 a42, 0
  v_accvgpr_write_b32 a43, 0
  v_accvgpr_write_b32 a44, 0
  v_accvgpr_write_b32 a45, 0
  v_accvgpr_write_b32 a46, 0
  v_accvgpr_write_b32 a47, 0
  v_accvgpr_write_b32 a48, 0
  v_accvgpr_write_b32 a49, 0
  v_accvgpr_write_b32 a50, 0
  v_accvgpr_write_b32 a51, 0
  v_accvgpr_write_b32 a52, 0
  v_accvgpr_write_b32 a53, 0
  v_accvgpr_write_b32 a54, 0
  v_accvgpr_write_b32 a55, 0
  v_accvgpr_write_b32 a56, 0
  v_accvgpr_write_b32 a57, 0
  v_accvgpr_write_b32 a58, 0
  v_accvgpr_write_b32 a59, 0
  v_accvgpr_write_b32 a60, 0
  v_accvgpr_write_b32 a61, 0
  v_accvgpr_write_b32 a62, 0
  v_accvgpr_write_b32 a63, 0
  v_mov_b32 v236, v29
  v_mov_b32 v22, 0
  s_mov_b32 s39, 0
  s_mov_b32 s66, 0
  s_mov_b32 s54, s52
L_sl1:
  s_barrier
  s_mov_b32 m0, s43
  s_nop 0
  buffer_load_dwordx4 v13, s[16:19], s39 offen offset:0 sc1 lds
  buffer_load_dwordx4 v13, s[16:19], s39 offen offset:1024 sc1 lds
  buffer_load_dwordx4 v13, s[16:19], s39 offen offset:2048 sc1 lds
  buffer_load_dwordx4 v13, s[16:19], s39 offen offset:3072 sc1 lds
  s_add_u32 m0, s43, 16384
  s_nop 0
  buffer_load_dwordx4 v13, s[20:23], s39 offen offset:0 sc1 lds
  buffer_load_dwordx4 v13, s[20:23], s39 offen offset:1024 sc1 lds
  buffer_load_dwordx4 v13, s[20:23], s39 offen offset:2048 sc1 lds
  buffer_load_dwordx4 v13, s[20:23], s39 offen offset:3072 sc1 lds
  s_add_u32 s39, s39, 16384
  s_waitcnt vmcnt(0)
  s_barrier
  ds_read_b128 a[128:131], v2 offset:0
  ds_read_b128 a[132:135], v2 offset:1024
  ds_read_b128 a[136:139], v2 offset:2048
  ds_read_b128 a[140:143], v2 offset:3072
  ds_read_b128 a[144:147], v2 offset:4096
  ds_read_b128 a[148:151], v2 offset:5120
  ds_read_b128 a[152:155], v2 offset:6144
  ds_read_b128 a[156:159], v2 offset:7168
  ds_read_b128 a[160:163], v2 offset:8192
  ds_read_b128 a[164:167], v2 offset:9216
  ds_read_b128 a[168:171], v2 offset:10240
  ds_read_b128 a[172:175], v2 offset:11264
  ds_read_b128 a[176:179], v2 offset:12288
  ds_read_b128 a[180:183], v2 offset:13312
  ds_read_b128 a[184:187], v2 offset:14336
  ds_read_b128 a[188:191], v2 offset:15360
  s_waitcnt lgkmcnt(0)
  v_mfma_f32_32x32x16_bf16 v[96:111], a[128:131], v[64:67], 0
  v_mfma_f32_32x32x16_bf16 v[96:111], a[132:135], v[68:71], v[96:111]
  v_mfma_f32_32x32x16_bf16 v[96:111], a[136:139], v[72:75], v[96:111]
  v_mfma_f32_32x32x16_bf16 v[96:111], a[140:143], v[76:79], v[96:111]
  v_mfma_f32_32x32x16_bf16 v[96:111], a[144:147], v[80:83], v[96:111]
  v_mfma_f32_32x32x16_bf16 v[96:111], a[148:151], v[84:87], v[96:111]
  v_mfma_f32_32x32x16_bf16 v[96:111], a[152:155], v[88:91], v[96:111]
  v_mfma_f32_32x32x16_bf16 v[96:111], a[156:159], v[92:95], v[96:111]
  v_mfma_f32_32x32x16_bf16 v[112:127], a[160:163], v[64:67], 0
  v_mfma_f32_32x32x16_bf16 v[112:127], a[164:167], v[68:71], v[112:127]
  v_mfma_f32_32x32x16_bf16 v[112:127], a[168:171], v[72:75], v[112:127]
  v_mfma_f32_32x32x16_bf16 v[112:127], a[172:175], v[76:79], v[112:127]
  v_mfma_f32_32x32x16_bf16 v[112:127], a[176:179], v[80:83], v[112:127]
  v_mfma_f32_32x32x16_bf16 v[112:127], a[180:183], v[84:87], v[112:127]
  v_mfma_f32_32x32x16_bf16 v[112:127], a[184:187], v[88:91], v[112:127]
  v_mfma_f32_32x32x16_bf16 v[112:127], a[188:191], v[92:95], v[112:127]
  ds_read_b128 a[128:131], v2 offset:16384
  ds_read_b128 a[132:135], v2 offset:17408
  ds_read_b128 a[136:139], v2 offset:18432
  ds_read_b128 a[140:143], v2 offset:19456
  ds_read_b128 a[144:147], v2 offset:20480
  ds_read_b128 a[148:151], v2 offset:21504
  ds_read_b128 a[152:155], v2 offset:22528
  ds_read_b128 a[156:159], v2 offset:23552
  ds_read_b128 a[160:163], v2 offset:24576
  ds_read_b128 a[164:167], v2 offset:25600
  ds_read_b128 a[168:171], v2 offset:26624
  ds_read_b128 a[172:175], v2 offset:27648
  ds_read_b128 a[176:179], v2 offset:28672
  ds_read_b128 a[180:183], v2 offset:29696
  ds_read_b128 a[184:187], v2 offset:30720
  ds_read_b128 a[188:191], v2 offset:31744
  s_nop 7
  s_nop 7
  s_add_u32 s100, s66, 0
  v_subrev_u32 v21, s100, v18
  v_cmp_ge_i32 s[60:61], v21, 0
  v_cmp_ge_i32 s[62:63], v21, 1
  v_cmp_ge_i32 s[4:5], v21, 2
  v_cndmask_b32 v96, v29, v96, s[60:61]
  v_cmp_ge_i32 s[6:7], v21, 3
  v_cndmask_b32 v97, v29, v97, s[62:63]
  v_cmp_ge_i32 s[60:61], v21, 8
  v_cndmask_b32 v98, v29, v98, s[4:5]
  v_cmp_ge_i32 s[62:63], v21, 9
  v_cndmask_b32 v99, v29, v99, s[6:7]
  v_cmp_ge_i32 s[4:5], v21, 10
  v_cndmask_b32 v100, v29, v100, s[60:61]
  v_cmp_ge_i32 s[6:7], v21, 11
  v_cndmask_b32 v101, v29, v101, s[62:63]
  v_cmp_ge_i32 s[60:61], v21, 16
  v_cndmask_b32 v102, v29, v102, s[4:5]
  v_cmp_ge_i32 s[62:63], v21, 17
  v_cndmask_b32 v103, v29, v103, s[6:7]
  v_cmp_ge_i32 s[4:5], v21, 18
  v_cndmask_b32 v104, v29, v104, s[60:61]
  v_cmp_ge_i32 s[6:7], v21, 19
  v_cndmask_b32 v105, v29, v105, s[62:63]
  v_cmp_ge_i32 s[60:61], v21, 24
  v_cndmask_b32 v106, v29, v106, s[4:5]
  v_cmp_ge_i32 s[62:63], v21, 25
  v_cndmask_b32 v107, v29, v107, s[6:7]
  v_cmp_ge_i32 s[4:5], v21, 26
  v_cndmask_b32 v108, v29, v108, s[60:61]
  v_cmp_ge_i32 s[6:7], v21, 27
  v_cndmask_b32 v109, v29, v109, s[62:63]
  v_cndmask_b32 v110, v29, v110, s[4:5]
  v_cndmask_b32 v111, v29, v111, s[6:7]
  s_add_u32 s100, s66, 32
  v_subrev_u32 v21, s100, v18
  v_cmp_ge_i32 s[60:61], v21, 0
  v_cmp_ge_i32 s[62:63], v21, 1
  v_cmp_ge_i32 s[4:5], v21, 2
  v_cndmask_b32 v112, v29, v112, s[60:61]
  v_cmp_ge_i32 s[6:7], v21, 3
  v_cndmask_b32 v113, v29, v113, s[62:63]
  v_cmp_ge_i32 s[60:61], v21, 8
  v_cndmask_b32 v114, v29, v114, s[4:5]
  v_cmp_ge_i32 s[62:63], v21, 9
  v_cndmask_b32 v115, v29, v115, s[6:7]
  v_cmp_ge_i32 s[4:5], v21, 10
  v_cndmask_b32 v116, v29, v116, s[60:61]
  v_cmp_ge_i32 s[6:7], v21, 11
  v_cndmask_b32 v117, v29, v117, s[62:63]
  v_cmp_ge_i32 s[60:61], v21, 16
  v_cndmask_b32 v118, v29, v118, s[4:5]
  v_cmp_ge_i32 s[62:63], v21, 17
  v_cndmask_b32 v119, v29, v119, s[6:7]
  v_cmp_ge_i32 s[4:5], v21, 18
  v_cndmask_b32 v120, v29, v120, s[60:61]
  v_cmp_ge_i32 s[6:7], v21, 19
  v_cndmask_b32 v121, v29, v121, s[62:63]
  v_cmp_ge_i32 s[60:61], v21, 24
  v_cndmask_b32 v122, v29, v122, s[4:5]
  v_cmp_ge_i32 s[62:63], v21, 25
  v_cndmask_b32 v123, v29, v123, s[6:7]
  v_cmp_ge_i32 s[4:5], v21, 26
  v_cndmask_b32 v124, v29, v124, s[60:61]
  v_cmp_ge_i32 s[6:7], v21, 27
  v_cndmask_b32 v125, v29, v125, s[62:63]
  v_cndmask_b32 v126, v29, v126, s[4:5]
  v_cndmask_b32 v127, v29, v127, s[6:7]
  v_max3_f32 v224, v96, v97, v98
  v_max3_f32 v224, v224, v99, v100
  v_max3_f32 v224, v224, v101, v102
  v_max3_f32 v224, v224, v103, v104
  v_max3_f32 v224, v224, v105, v106
  v_max3_f32 v224, v224, v107, v108
  v_max3_f32 v224, v224, v109, v110
  v_max3_f32 v224, v224, v111, v112
  v_max3_f32 v224, v224, v113, v114
  v_max3_f32 v224, v224, v115, v116
  v_max3_f32 v224, v224, v117, v118
  v_max3_f32 v224, v224, v119, v120
  v_max3_f32 v224, v224, v121, v122
  v_max3_f32 v224, v224, v123, v124
  v_max3_f32 v224, v224, v125, v126
  v_max3_f32 v224, v224, v127, v236
  v_mov_b32 v225, v224
  s_nop 1
  v_permlane32_swap_b32 v224, v225
  s_nop 1
  v_max_f32 v224, v224, v225
  v_sub_f32 v225, v236, v224
  v_exp_f32 v225, v225
  v_mov_b32 v236, v224
  v_sub_f32 v96, v96, v224
  v_sub_f32 v97, v97, v224
  v_sub_f32 v98, v98, v224
  v_sub_f32 v99, v99, v224
  v_sub_f32 v100, v100, v224
  v_sub_f32 v101, v101, v224
  v_sub_f32 v102, v102, v224
  v_sub_f32 v103, v103, v224
  v_sub_f32 v104, v104, v224
  v_sub_f32 v105, v105, v224
  v_sub_f32 v106, v106, v224
  v_sub_f32 v107, v107, v224
  v_sub_f32 v108, v108, v224
  v_sub_f32 v109, v109, v224
  v_sub_f32 v110, v110, v224
  v_sub_f32 v111, v111, v224
  v_sub_f32 v112, v112, v224
  v_sub_f32 v113, v113, v224
  v_sub_f32 v114, v114, v224
  v_sub_f32 v115, v115, v224
  v_sub_f32 v116, v116, v224
  v_sub_f32 v117, v117, v224
  v_sub_f32 v118, v118, v224
  v_sub_f32 v119, v119, v224
  v_sub_f32 v120, v120, v224
  v_sub_f32 v121, v121, v224
  v_sub_f32 v122, v122, v224
  v_sub_f32 v123, v123, v224
  v_sub_f32 v124, v124, v224
  v_sub_f32 v125, v125, v224
  v_sub_f32 v126, v126, v224
  v_sub_f32 v127, v127, v224
  v_exp_f32 v96, v96
  v_exp_f32 v97, v97
  v_exp_f32 v98, v98
  v_exp_f32 v99, v99
  v_exp_f32 v100, v100
  v_exp_f32 v101, v101
  v_exp_f32 v102, v102
  v_exp_f32 v103, v103
  v_exp_f32 v104, v104
  v_exp_f32 v105, v105
  v_exp_f32 v106, v106
  v_exp_f32 v107, v107
  v_exp_f32 v108, v108
  v_exp_f32 v109, v109
  v_exp_f32 v110, v110
  v_exp_f32 v111, v111
  v_exp_f32 v112, v112
  v_exp_f32 v113, v113
  v_exp_f32 v114, v114
  v_exp_f32 v115, v115
  v_exp_f32 v116, v116
  v_exp_f32 v117, v117
  v_exp_f32 v118, v118
  v_exp_f32 v119, v119
  v_exp_f32 v120, v120
  v_exp_f32 v121, v121
  v_exp_f32 v122, v122
  v_exp_f32 v123, v123
  v_exp_f32 v124, v124
  v_exp_f32 v125, v125
  v_exp_f32 v126, v126
  v_exp_f32 v127, v127
  v_mul_f32 v22, v22, v225
  v_add_f32 v22, v22, v96
  v_add_f32 v22, v22, v97
  v_add_f32 v22, v22, v98
  v_add_f32 v22, v22, v99
  v_add_f32 v22, v22, v100
  v_add_f32 v22, v22, v101
  v_add_f32 v22, v22, v102
  v_add_f32 v22, v22, v103
  v_add_f32 v22, v22, v104
  v_add_f32 v22, v22, v105
  v_add_f32 v22, v22, v106
  v_add_f32 v22, v22, v107
  v_add_f32 v22, v22, v108
  v_add_f32 v22, v22, v109
  v_add_f32 v22, v22, v110
  v_add_f32 v22, v22, v111
  v_add_f32 v22, v22, v112
  v_add_f32 v22, v22, v113
  v_add_f32 v22, v22, v114
  v_add_f32 v22, v22, v115
  v_add_f32 v22, v22, v116
  v_add_f32 v22, v22, v117
  v_add_f32 v22, v22, v118
  v_add_f32 v22, v22, v119
  v_add_f32 v22, v22, v120
  v_add_f32 v22, v22, v121
  v_add_f32 v22, v22, v122
  v_add_f32 v22, v22, v123
  v_add_f32 v22, v22, v124
  v_add_f32 v22, v22, v125
  v_add_f32 v22, v22, v126
  v_add_f32 v22, v22, v127
  v_cvt_pk_bf16_f32 v160, v96, v97
  v_cvt_pk_bf16_f32 v161, v98, v99
  v_cvt_pk_bf16_f32 v162, v100, v101
  v_cvt_pk_bf16_f32 v163, v102, v103
  v_cvt_pk_bf16_f32 v164, v104, v105
  v_cvt_pk_bf16_f32 v165, v106, v107
  v_cvt_pk_bf16_f32 v166, v108, v109
  v_cvt_pk_bf16_f32 v167, v110, v111
  v_cvt_pk_bf16_f32 v168, v112, v113
  v_cvt_pk_bf16_f32 v169, v114, v115
  v_cvt_pk_bf16_f32 v170, v116, v117
  v_cvt_pk_bf16_f32 v171, v118, v119
  v_cvt_pk_bf16_f32 v172, v120, v121
  v_cvt_pk_bf16_f32 v173, v122, v123
  v_cvt_pk_bf16_f32 v174, v124, v125
  v_cvt_pk_bf16_f32 v175, v126, v127
  v_accvgpr_read_b32 v226, a0
  v_mul_f32 v226, v226, v225
  v_accvgpr_write_b32 a0, v226
  v_accvgpr_read_b32 v226, a1
  v_mul_f32 v226, v226, v225
  v_accvgpr_write_b32 a1, v226
  v_accvgpr_read_b32 v226, a2
  v_mul_f32 v226, v226, v225
  v_accvgpr_write_b32 a2, v226
  v_accvgpr_read_b32 v226, a3
  v_mul_f32 v226, v226, v225
  v_accvgpr_write_b32 a3, v226
  v_accvgpr_read_b32 v226, a4
  v_mul_f32 v226, v226, v225
  v_accvgpr_write_b32 a4, v226
  v_accvgpr_read_b32 v226, a5
  v_mul_f32 v226, v226, v225
  v_accvgpr_write_b32 a5, v226
  v_accvgpr_read_b32 v226, a6
  v_mul_f32 v226, v226, v225
  v_accvgpr_write_b32 a6, v226
  v_accvgpr_read_b32 v226, a7
  v_mul_f32 v226, v226, v225
  v_accvgpr_write_b32 a7, v226
  v_accvgpr_read_b32 v226, a8
  v_mul_f32 v226, v226, v225
  v_accvgpr_write_b32 a8, v226
  v_accvgpr_read_b32 v226, a9
  v_mul_f32 v226, v226, v225
  v_accvgpr_write_b32 a9, v226
  v_accvgpr_read_b32 v226, a10
  v_mul_f32 v226, v226, v225
  v_accvgpr_write_b32 a10, v226
  v_accvgpr_read_b32 v226, a11
  v_mul_f32 v226, v226, v225
  v_accvgpr_write_b32 a11, v226
  v_accvgpr_read_b32 v226, a12
  v_mul_f32 v226, v226, v225
  v_accvgpr_write_b32 a12, v226
  v_accvgpr_read_b32 v226, a13
  v_mul_f32 v226, v226, v225
  v_accvgpr_write_b32 a13, v226
  v_accvgpr_read_b32 v226, a14
  v_mul_f32 v226, v226, v225
  v_accvgpr_write_b32 a14, v226
  v_accvgpr_read_b32 v226, a15
  v_mul_f32 v226, v226, v225
  v_accvgpr_write_b32 a15, v226
  v_accvgpr_read_b32 v226, a16
  v_mul_f32 v226, v226, v225
  v_accvgpr_write_b32 a16, v226
  v_accvgpr_read_b32 v226, a17
  v_mul_f32 v226, v226, v225
  v_accvgpr_write_b32 a17, v226
  v_accvgpr_read_b32 v226, a18
  v_mul_f32 v226, v226, v225
  v_accvgpr_write_b32 a18, v226
  v_accvgpr_read_b32 v226, a19
  v_mul_f32 v226, v226, v225
  v_accvgpr_write_b32 a19, v226
  v_accvgpr_read_b32 v226, a20
  v_mul_f32 v226, v226, v225
  v_accvgpr_write_b32 a20, v226
  v_accvgpr_read_b32 v226, a21
  v_mul_f32 v226, v226, v225
  v_accvgpr_write_b32 a21, v226
  v_accvgpr_read_b32 v226, a22
  v_mul_f32 v226, v226, v225
  v_accvgpr_write_b32 a22, v226
  v_accvgpr_read_b32 v226, a23
  v_mul_f32 v226, v226, v225
  v_accvgpr_write_b32 a23, v226
  v_accvgpr_read_b32 v226, a24
  v_mul_f32 v226, v226, v225
  v_accvgpr_write_b32 a24, v226
  v_accvgpr_read_b32 v226, a25
  v_mul_f32 v226, v226, v225
  v_accvgpr_write_b32 a25, v226
  v_accvgpr_read_b32 v226, a26
  v_mul_f32 v226, v226, v225
  v_accvgpr_write_b32 a26, v226
  v_accvgpr_read_b32 v226, a27
  v_mul_f32 v226, v226, v225
  v_accvgpr_write_b32 a27, v226
  v_accvgpr_read_b32 v226, a28
  v_mul_f32 v226, v226, v225
  v_accvgpr_write_b32 a28, v226
  v_accvgpr_read_b32 v226, a29
  v_mul_f32 v226, v226, v225
  v_accvgpr_write_b32 a29, v226
  v_accvgpr_read_b32 v226, a30
  v_mul_f32 v226, v226, v225
  v_accvgpr_write_b32 a30, v226
  v_accvgpr_read_b32 v226, a31
  v_mul_f32 v226, v226, v225
  v_accvgpr_write_b32 a31, v226
  v_accvgpr_read_b32 v226, a32
  v_mul_f32 v226, v226, v225
  v_accvgpr_write_b32 a32, v226
  v_accvgpr_read_b32 v226, a33
  v_mul_f32 v226, v226, v225
  v_accvgpr_write_b32 a33, v226
  v_accvgpr_read_b32 v226, a34
  v_mul_f32 v226, v226, v225
  v_accvgpr_write_b32 a34, v226
  v_accvgpr_read_b32 v226, a35
  v_mul_f32 v226, v226, v225
  v_accvgpr_write_b32 a35, v226
  v_accvgpr_read_b32 v226, a36
  v_mul_f32 v226, v226, v225
  v_accvgpr_write_b32 a36, v226
  v_accvgpr_read_b32 v226, a37
  v_mul_f32 v226, v226, v225
  v_accvgpr_write_b32 a37, v226
  v_accvgpr_read_b32 v226, a38
  v_mul_f32 v226, v226, v225
  v_accvgpr_write_b32 a38, v226
  v_accvgpr_read_b32 v226, a39
  v_mul_f32 v226, v226, v225
  v_accvgpr_write_b32 a39, v226
  v_accvgpr_read_b32 v226, a40
  v_mul_f32 v226, v226, v225
  v_accvgpr_write_b32 a40, v226
  v_accvgpr_read_b32 v226, a41
  v_mul_f32 v226, v226, v225
  v_accvgpr_write_b32 a41, v226
  v_accvgpr_read_b32 v226, a42
  v_mul_f32 v226, v226, v225
  v_accvgpr_write_b32 a42, v226
  v_accvgpr_read_b32 v226, a43
  v_mul_f32 v226, v226, v225
  v_accvgpr_write_b32 a43, v226
  v_accvgpr_read_b32 v226, a44
  v_mul_f32 v226, v226, v225
  v_accvgpr_write_b32 a44, v226
  v_accvgpr_read_b32 v226, a45
  v_mul_f32 v226, v226, v225
  v_accvgpr_write_b32 a45, v226
  v_accvgpr_read_b32 v226, a46
  v_mul_f32 v226, v226, v225
  v_accvgpr_write_b32 a46, v226
  v_accvgpr_read_b32 v226, a47
  v_mul_f32 v226, v226, v225
  v_accvgpr_write_b32 a47, v226
  v_accvgpr_read_b32 v226, a48
  v_mul_f32 v226, v226, v225
  v_accvgpr_write_b32 a48, v226
  v_accvgpr_read_b32 v226, a49
  v_mul_f32 v226, v226, v225
  v_accvgpr_write_b32 a49, v226
  v_accvgpr_read_b32 v226, a50
  v_mul_f32 v226, v226, v225
  v_accvgpr_write_b32 a50, v226
  v_accvgpr_read_b32 v226, a51
  v_mul_f32 v226, v226, v225
  v_accvgpr_write_b32 a51, v226
  v_accvgpr_read_b32 v226, a52
  v_mul_f32 v226, v226, v225
  v_accvgpr_write_b32 a52, v226
  v_accvgpr_read_b32 v226, a53
  v_mul_f32 v226, v226, v225
  v_accvgpr_write_b32 a53, v226
  v_accvgpr_read_b32 v226, a54
  v_mul_f32 v226, v226, v225
  v_accvgpr_write_b32 a54, v226
  v_accvgpr_read_b32 v226, a55
  v_mul_f32 v226, v226, v225
  v_accvgpr_write_b32 a55, v226
  v_accvgpr_read_b32 v226, a56
  v_mul_f32 v226, v226, v225
  v_accvgpr_write_b32 a56, v226
  v_accvgpr_read_b32 v226, a57
  v_mul_f32 v226, v226, v225
  v_accvgpr_write_b32 a57, v226
  v_accvgpr_read_b32 v226, a58
  v_mul_f32 v226, v226, v225
  v_accvgpr_write_b32 a58, v226
  v_accvgpr_read_b32 v226, a59
  v_mul_f32 v226, v226, v225
  v_accvgpr_write_b32 a59, v226
  v_accvgpr_read_b32 v226, a60
  v_mul_f32 v226, v226, v225
  v_accvgpr_write_b32 a60, v226
  v_accvgpr_read_b32 v226, a61
  v_mul_f32 v226, v226, v225
  v_accvgpr_write_b32 a61, v226
  v_accvgpr_read_b32 v226, a62
  v_mul_f32 v226, v226, v225
  v_accvgpr_write_b32 a62, v226
  v_accvgpr_read_b32 v226, a63
  v_mul_f32 v226, v226, v225
  v_accvgpr_write_b32 a63, v226
  s_waitcnt lgkmcnt(0)
  s_nop 1
  v_mfma_f32_32x32x16_bf16 a[0:15], a[128:131], v[160:163], a[0:15]
  v_mfma_f32_32x32x16_bf16 a[16:31], a[132:135], v[160:163], a[16:31]
  v_mfma_f32_32x32x16_bf16 a[32:47], a[136:139], v[160:163], a[32:47]
  v_mfma_f32_32x32x16_bf16 a[48:63], a[140:143], v[160:163], a[48:63]
  v_mfma_f32_32x32x16_bf16 a[0:15], a[144:147], v[164:167], a[0:15]
  v_mfma_f32_32x32x16_bf16 a[16:31], a[148:151], v[164:167], a[16:31]
  v_mfma_f32_32x32x16_bf16 a[32:47], a[152:155], v[164:167], a[32:47]
  v_mfma_f32_32x32x16_bf16 a[48:63], a[156:159], v[164:167], a[48:63]
  v_mfma_f32_32x32x16_bf16 a[0:15], a[160:163], v[168:171], a[0:15]
  v_mfma_f32_32x32x16_bf16 a[16:31], a[164:167], v[168:171], a[16:31]
  v_mfma_f32_32x32x16_bf16 a[32:47], a[168:171], v[168:171], a[32:47]
  v_mfma_f32_32x32x16_bf16 a[48:63], a[172:175], v[168:171], a[48:63]
  v_mfma_f32_32x32x16_bf16 a[0:15], a[176:179], v[172:175], a[0:15]
  v_mfma_f32_32x32x16_bf16 a[16:31], a[180:183], v[172:175], a[16:31]
  v_mfma_f32_32x32x16_bf16 a[32:47], a[184:187], v[172:175], a[32:47]
  v_mfma_f32_32x32x16_bf16 a[48:63], a[188:191], v[172:175], a[48:63]
  s_add_u32 s66, s66, 64
  s_sub_u32 s54, s54, 1
  s_cmp_lg_u32 s54, 0
  s_cbranch_scc1 L_sl1
  s_nop 7
  s_nop 7
  v_mov_b32 v224, v22
  s_nop 1
  v_permlane32_swap_b32 v22, v224
  s_nop 1
  v_add_f32 v22, v22, v224
  v_rcp_f32 v224, v22
  s_nop 1
  s_lshl_b32 s34, s51, 2
  s_add_u32 s34, s34, s3
  s_mul_i32 s34, s34, 544
  s_lshl_b32 s95, s50, 3
  s_add_u32 s34, s34, s95
  s_lshl_b32 s34, s34, 10
  v_accvgpr_read_b32 v128, a0
  v_accvgpr_read_b32 v129, a1
  v_accvgpr_read_b32 v130, a2
  v_accvgpr_read_b32 v131, a3
  v_accvgpr_read_b32 v132, a4
  v_accvgpr_read_b32 v133, a5
  v_accvgpr_read_b32 v134, a6
  v_accvgpr_read_b32 v135, a7
  v_accvgpr_read_b32 v136, a8
  v_accvgpr_read_b32 v137, a9
  v_accvgpr_read_b32 v138, a10
  v_accvgpr_read_b32 v139, a11
  v_accvgpr_read_b32 v140, a12
  v_accvgpr_read_b32 v141, a13
  v_accvgpr_read_b32 v142, a14
  v_accvgpr_read_b32 v143, a15
  v_mul_f32 v128, v128, v224
  v_mul_f32 v129, v129, v224
  v_mul_f32 v130, v130, v224
  v_mul_f32 v131, v131, v224
  v_mul_f32 v132, v132, v224
  v_mul_f32 v133, v133, v224
  v_mul_f32 v134, v134, v224
  v_mul_f32 v135, v135, v224
  v_mul_f32 v136, v136, v224
  v_mul_f32 v137, v137, v224
  v_mul_f32 v138, v138, v224
  v_mul_f32 v139, v139, v224
  v_mul_f32 v140, v140, v224
  v_mul_f32 v141, v141, v224
  v_mul_f32 v142, v142, v224
  v_mul_f32 v143, v143, v224
  v_cvt_pk_bf16_f32 v128, v128, v129
  v_cvt_pk_bf16_f32 v129, v130, v131
  v_cvt_pk_bf16_f32 v130, v132, v133
  v_cvt_pk_bf16_f32 v131, v134, v135
  v_cvt_pk_bf16_f32 v132, v136, v137
  v_cvt_pk_bf16_f32 v133, v138, v139
  v_cvt_pk_bf16_f32 v134, v140, v141
  v_cvt_pk_bf16_f32 v135, v142, v143
  s_add_u32 s95, s34, 0
  buffer_store_dwordx4 v[128:131], v2, s[96:99], s95 offen sc1
  buffer_store_dwordx4 v[132:135], v2, s[96:99], s95 offen offset:1024 sc1
  v_accvgpr_read_b32 v144, a16
  v_accvgpr_read_b32 v145, a17
  v_accvgpr_read_b32 v146, a18
  v_accvgpr_read_b32 v147, a19
  v_accvgpr_read_b32 v148, a20
  v_accvgpr_read_b32 v149, a21
  v_accvgpr_read_b32 v150, a22
  v_accvgpr_read_b32 v151, a23
  v_accvgpr_read_b32 v152, a24
  v_accvgpr_read_b32 v153, a25
  v_accvgpr_read_b32 v154, a26
  v_accvgpr_read_b32 v155, a27
  v_accvgpr_read_b32 v156, a28
  v_accvgpr_read_b32 v157, a29
  v_accvgpr_read_b32 v158, a30
  v_accvgpr_read_b32 v159, a31
  v_mul_f32 v144, v144, v224
  v_mul_f32 v145, v145, v224
  v_mul_f32 v146, v146, v224
  v_mul_f32 v147, v147, v224
  v_mul_f32 v148, v148, v224
  v_mul_f32 v149, v149, v224
  v_mul_f32 v150, v150, v224
  v_mul_f32 v151, v151, v224
  v_mul_f32 v152, v152, v224
  v_mul_f32 v153, v153, v224
  v_mul_f32 v154, v154, v224
  v_mul_f32 v155, v155, v224
  v_mul_f32 v156, v156, v224
  v_mul_f32 v157, v157, v224
  v_mul_f32 v158, v158, v224
  v_mul_f32 v159, v159, v224
  v_cvt_pk_bf16_f32 v144, v144, v145
  v_cvt_pk_bf16_f32 v145, v146, v147
  v_cvt_pk_bf16_f32 v146, v148, v149
  v_cvt_pk_bf16_f32 v147, v150, v151
  v_cvt_pk_bf16_f32 v148, v152, v153
  v_cvt_pk_bf16_f32 v149, v154, v155
  v_cvt_pk_bf16_f32 v150, v156, v157
  v_cvt_pk_bf16_f32 v151, v158, v159
  s_add_u32 s95, s34, 2048
  buffer_store_dwordx4 v[144:147], v2, s[96:99], s95 offen sc1
  buffer_store_dwordx4 v[148:151], v2, s[96:99], s95 offen offset:1024 sc1
  v_accvgpr_read_b32 v128, a32
  v_accvgpr_read_b32 v129, a33
  v_accvgpr_read_b32 v130, a34
  v_accvgpr_read_b32 v131, a35
  v_accvgpr_read_b32 v132, a36
  v_accvgpr_read_b32 v133, a37
  v_accvgpr_read_b32 v134, a38
  v_accvgpr_read_b32 v135, a39
  v_accvgpr_read_b32 v136, a40
  v_accvgpr_read_b32 v137, a41
  v_accvgpr_read_b32 v138, a42
  v_accvgpr_read_b32 v139, a43
  v_accvgpr_read_b32 v140, a44
  v_accvgpr_read_b32 v141, a45
  v_accvgpr_read_b32 v142, a46
  v_accvgpr_read_b32 v143, a47
  v_mul_f32 v128, v128, v224
  v_mul_f32 v129, v129, v224
  v_mul_f32 v130, v130, v224
  v_mul_f32 v131, v131, v224
  v_mul_f32 v132, v132, v224
  v_mul_f32 v133, v133, v224
  v_mul_f32 v134, v134, v224
  v_mul_f32 v135, v135, v224
  v_mul_f32 v136, v136, v224
  v_mul_f32 v137, v137, v224
  v_mul_f32 v138, v138, v224
  v_mul_f32 v139, v139, v224
  v_mul_f32 v140, v140, v224
  v_mul_f32 v141, v141, v224
  v_mul_f32 v142, v142, v224
  v_mul_f32 v143, v143, v224
  v_cvt_pk_bf16_f32 v128, v128, v129
  v_cvt_pk_bf16_f32 v129, v130, v131
  v_cvt_pk_bf16_f32 v130, v132, v133
  v_cvt_pk_bf16_f32 v131, v134, v135
  v_cvt_pk_bf16_f32 v132, v136, v137
  v_cvt_pk_bf16_f32 v133, v138, v139
  v_cvt_pk_bf16_f32 v134, v140, v141
  v_cvt_pk_bf16_f32 v135, v142, v143
  s_add_u32 s95, s34, 4096
  buffer_store_dwordx4 v[128:131], v2, s[96:99], s95 offen sc1
  buffer_store_dwordx4 v[132:135], v2, s[96:99], s95 offen offset:1024 sc1
  v_accvgpr_read_b32 v144, a48
  v_accvgpr_read_b32 v145, a49
  v_accvgpr_read_b32 v146, a50
  v_accvgpr_read_b32 v147, a51
  v_accvgpr_read_b32 v148, a52
  v_accvgpr_read_b32 v149, a53
  v_accvgpr_read_b32 v150, a54
  v_accvgpr_read_b32 v151, a55
  v_accvgpr_read_b32 v152, a56
  v_accvgpr_read_b32 v153, a57
  v_accvgpr_read_b32 v154, a58
  v_accvgpr_read_b32 v155, a59
  v_accvgpr_read_b32 v156, a60
  v_accvgpr_read_b32 v157, a61
  v_accvgpr_read_b32 v158, a62
  v_accvgpr_read_b32 v159, a63
  v_mul_f32 v144, v144, v224
  v_mul_f32 v145, v145, v224
  v_mul_f32 v146, v146, v224
  v_mul_f32 v147, v147, v224
  v_mul_f32 v148, v148, v224
  v_mul_f32 v149, v149, v224
  v_mul_f32 v150, v150, v224
  v_mul_f32 v151, v151, v224
  v_mul_f32 v152, v152, v224
  v_mul_f32 v153, v153, v224
  v_mul_f32 v154, v154, v224
  v_mul_f32 v155, v155, v224
  v_mul_f32 v156, v156, v224
  v_mul_f32 v157, v157, v224
  v_mul_f32 v158, v158, v224
  v_mul_f32 v159, v159, v224
  v_cvt_pk_bf16_f32 v144, v144, v145
  v_cvt_pk_bf16_f32 v145, v146, v147
  v_cvt_pk_bf16_f32 v146, v148, v149
  v_cvt_pk_bf16_f32 v147, v150, v151
  v_cvt_pk_bf16_f32 v148, v152, v153
  v_cvt_pk_bf16_f32 v149, v154, v155
  v_cvt_pk_bf16_f32 v150, v156, v157
  v_cvt_pk_bf16_f32 v151, v158, v159
  s_add_u32 s95, s34, 6144
  buffer_store_dwordx4 v[144:147], v2, s[96:99], s95 offen sc1
  buffer_store_dwordx4 v[148:151], v2, s[96:99], s95 offen offset:1024 sc1
  s_waitcnt vmcnt(0)
  s_barrier
  s_lshl_b32 s4, s36, 2
  s_add_u32 s4, s4, s3
  s_mul_i32 s4, s4, 544
  s_lshl_b32 s5, s45, 2
  s_add_u32 s4, s4, s5
  s_add_u32 s4, s4, 256
  s_lshl_b32 s4, s4, 10
  v_add_u32 v11, s4, v2
  v_lshrrev_b32 v20, 3, v1
  v_mul_u32_u24 v12, 1152, v20
  v_bfe_u32 v20, v1, 4, 1
  v_bfe_u32 v23, v1, 2, 1
  v_xor_b32 v20, v20, v23
  v_lshl_add_u32 v12, v20, 6, v12
  v_and_b32 v20, 3, v1
  v_lshl_add_u32 v12, v20, 4, v12
  s_mul_i32 s4, s37, 384
  s_lshl_b32 s5, s45, 6
  s_lshl_b32 s6, s3, 4
  s_add_u32 s5, s5, s6
  s_mul_i32 s5, s5, 1152
  s_add_u32 s4, s4, s5
  v_add_u32 v12, s4, v12
  s_mov_b32 s82, 0
  s_mov_b32 s12, s78
  s_mov_b32 s13, s79
  s_mov_b32 s14, 0x510000
  s_mov_b32 s15, 0x20000
  s_add_u32 m0, s82, s70
  s_add_u32 s87, s82, s71
  buffer_load_dwordx4 v11, s[96:99], 0 offen sc1 lds
  buffer_load_dwordx4 v11, s[96:99], 0 offen offset:1024 sc1 lds
  buffer_load_dwordx4 v11, s[96:99], 0 offen offset:2048 sc1 lds
  buffer_load_dwordx4 v11, s[96:99], 0 offen offset:3072 sc1 lds
  s_add_u32 m0, s87, 0
  s_nop 0
  buffer_load_dwordx4 v12, s[12:15], 0 offen lds
  buffer_load_dwordx4 v12, s[12:15], s56 offen offset:1024 lds
  s_add_u32 m0, s87, 8192
  s_nop 0
  buffer_load_dwordx4 v12, s[12:15], s57 offen lds
  buffer_load_dwordx4 v12, s[12:15], s58 offen offset:1024 lds
  s_add_u32 m0, s87, 16384
  s_nop 0
  buffer_load_dwordx4 v12, s[12:15], s59 offen lds
  buffer_load_dwordx4 v12, s[12:15], s67 offen offset:1024 lds
  v_add_u32 v11, 4096, v11
  v_add_u32 v12, 73728, v12
  s_add_u32 s82, s82, 40960
  s_cmp_ge_u32 s82, 163840
  s_cselect_b32 s82, 0, s82
  s_add_u32 m0, s82, s70
  s_add_u32 s87, s82, s71
  buffer_load_dwordx4 v11, s[96:99], 0 offen sc1 lds
  buffer_load_dwordx4 v11, s[96:99], 0 offen offset:1024 sc1 lds
  buffer_load_dwordx4 v11, s[96:99], 0 offen offset:2048 sc1 lds
  buffer_load_dwordx4 v11, s[96:99], 0 offen offset:3072 sc1 lds
  s_add_u32 m0, s87, 0
  s_nop 0
  buffer_load_dwordx4 v12, s[12:15], 0 offen lds
  buffer_load_dwordx4 v12, s[12:15], s56 offen offset:1024 lds
  s_add_u32 m0, s87, 8192
  s_nop 0
  buffer_load_dwordx4 v12, s[12:15], s57 offen lds
  buffer_load_dwordx4 v12, s[12:15], s58 offen offset:1024 lds
  s_add_u32 m0, s87, 16384
  s_nop 0
  buffer_load_dwordx4 v12, s[12:15], s59 offen lds
  buffer_load_dwordx4 v12, s[12:15], s67 offen offset:1024 lds
  v_add_u32 v11, 4096, v11
  v_add_u32 v12, 73728, v12
  s_add_u32 s82, s82, 40960
  s_cmp_ge_u32 s82, 163840
  s_cselect_b32 s82, 0, s82
  s_waitcnt vmcnt(0)
L_noslow:
  s_cmp_ge_u32 s90, 2
  s_cbranch_scc1 LF_go
  s_waitcnt vmcnt(0)
  s_barrier
  s_cmp_lg_u32 s3, 0
  s_cbranch_scc1 L_pubclx
  v_mov_b32 v22, s88
  v_mov_b32 v23, 0
  s_sub_u32 s4, 15, s51
  s_lshl_b32 s4, s4, 5
  s_add_u32 s4, s4, s50
  s_lshl_b32 s4, s4, 2
  s_add_u32 s4, s4, 3072
  s_mov_b64 exec, 1
  buffer_store_dword v22, v23, s[8:11], s4 offen sc1
  s_mov_b64 exec, -1
L_pubclx:
  s_cmp_lg_u32 s3, 0
  s_cbranch_scc1 L_pubcsx
  v_mov_b32 v22, s88
  v_mov_b32 v23, 0
  s_mov_b32 s4, s51
  s_lshl_b32 s4, s4, 5
  s_add_u32 s4, s4, s50
  s_lshl_b32 s4, s4, 2
  s_add_u32 s4, s4, 3072
  s_mov_b64 exec, 1
  buffer_store_dword v22, v23, s[8:11], s4 offen sc1
  s_mov_b64 exec, -1
L_pubcsx:
  s_branch L_end
LF_go:
  s_and_b32 s4, s3, 1
  s_lshl_b32 s4, s4, 13
  v_add_u32 v4, s4, v2
  v_lshrrev_b32 v20, 5, v1
  v_mul_u32_u24 v8, 512, v20
  v_bfe_u32 v20, v1, 2, 2
  v_lshl_add_u32 v8, v20, 7, v8
  v_bfe_u32 v21, v1, 4, 1
  v_lshl_add_u32 v8, v21, 5, v8
  v_and_b32 v21, 3, v1
  v_lshl_add_u32 v8, v21, 3, v8
  v_lshrrev_b32 v20, 1, v20
  v_lshlrev_b32 v20, 6, v20
  v_xor_b32 v21, 64, v20
  v_add_u32 v9, v8, v21
  v_add_u32 v8, v8, v20
  v_add_u32 v8, 16384, v8
  v_add_u32 v9, 16384, v9
  s_lshr_b32 s4, s3, 1
  s_cmp_eq_u32 s4, 0
  s_cbranch_scc0 LF_wn1
  v_mov_b32 v16, v8
  v_mov_b32 v17, v9
  v_add_u32 v18, 8192, v8
  s_branch LF_wn2
LF_wn1:
  v_add_u32 v16, 8192, v9
  v_add_u32 v17, 16384, v8
  v_add_u32 v18, 16384, v9
LF_wn2:
  s_mov_b32 s28, 0
  v_mov_b32 v3, v4
  v_mov_b32 v13, v16
  v_mov_b32 v14, v17
  v_mov_b32 v15, v18
  s_waitcnt vmcnt(16)
  s_barrier
  ds_read_b64_tr_b16 v[168:169], v13 offset:0
  ds_read_b64_tr_b16 v[170:171], v13 offset:1024
  ds_read_b128 v[160:163], v3 offset:0
  ds_read_b128 v[164:167], v3 offset:4096
  ds_read_b64_tr_b16 v[172:173], v14 offset:0
  ds_read_b64_tr_b16 v[174:175], v14 offset:1024
  ds_read_b64_tr_b16 v[176:177], v15 offset:0
  ds_read_b64_tr_b16 v[178:179], v15 offset:1024
  ds_read_b64_tr_b16 v[188:189], v13 offset:2048
  ds_read_b64_tr_b16 v[190:191], v13 offset:3072
  ds_read_b128 v[180:183], v3 offset:1024
  ds_read_b128 v[184:187], v3 offset:5120
  ds_read_b64_tr_b16 v[192:193], v14 offset:2048
  ds_read_b64_tr_b16 v[194:195], v14 offset:3072
  ds_read_b64_tr_b16 v[196:197], v15 offset:2048
  ds_read_b64_tr_b16 v[198:199], v15 offset:3072
  s_waitcnt lgkmcnt(8)
  v_mfma_f32_32x32x16_bf16 v[64:79], v[168:171], v[160:163], 0
  ds_read_b64_tr_b16 v[208:209], v13 offset:4096
  ds_read_b64_tr_b16 v[210:211], v13 offset:5120
  s_add_u32 m0, s82, s70
  s_add_u32 s87, s82, s71
  buffer_load_dwordx4 v11, s[96:99], 0 offen sc1 lds
  buffer_load_dwordx4 v11, s[96:99], 0 offen offset:1024 sc1 lds
  v_mfma_f32_32x32x16_bf16 v[80:95], v[168:171], v[164:167], 0
  ds_read_b128 v[200:203], v3 offset:2048
  ds_read_b128 v[204:207], v3 offset:6144
  buffer_load_dwordx4 v11, s[96:99], 0 offen offset:2048 sc1 lds
  v_mfma_f32_32x32x16_bf16 v[96:111], v[172:175], v[160:163], 0
  ds_read_b64_tr_b16 v[212:213], v14 offset:4096
  ds_read_b64_tr_b16 v[214:215], v14 offset:5120
  buffer_load_dwordx4 v11, s[96:99], 0 offen offset:3072 sc1 lds
  v_mfma_f32_32x32x16_bf16 v[112:127], v[172:175], v[164:167], 0
  ds_read_b64_tr_b16 v[216:217], v15 offset:4096
  ds_read_b64_tr_b16 v[218:219], v15 offset:5120
  s_add_u32 m0, s87, 0
  s_nop 0
  buffer_load_dwordx4 v12, s[12:15], 0 offen lds
  buffer_load_dwordx4 v12, s[12:15], s56 offen offset:1024 lds
  v_mfma_f32_32x32x16_bf16 v[128:143], v[176:179], v[160:163], 0
  s_add_u32 m0, s87, 8192
  s_nop 0
  buffer_load_dwordx4 v12, s[12:15], s57 offen lds
  v_mfma_f32_32x32x16_bf16 v[144:159], v[176:179], v[164:167], 0
  buffer_load_dwordx4 v12, s[12:15], s58 offen offset:1024 lds
  s_waitcnt lgkmcnt(8)
  v_mfma_f32_32x32x16_bf16 v[64:79], v[188:191], v[180:183], v[64:79]
  ds_read_b64_tr_b16 v[228:229], v13 offset:6144
  ds_read_b64_tr_b16 v[230:231], v13 offset:7168
  s_add_u32 m0, s87, 16384
  s_nop 0
  buffer_load_dwordx4 v12, s[12:15], s59 offen lds
  buffer_load_dwordx4 v12, s[12:15], s67 offen offset:1024 lds
  v_add_u32 v11, 4096, v11
  v_add_u32 v12, 73728, v12
  s_add_u32 s82, s82, 40960
  s_cmp_ge_u32 s82, 163840
  s_cselect_b32 s82, 0, s82
  v_mfma_f32_32x32x16_bf16 v[80:95], v[188:191], v[184:187], v[80:95]
  ds_read_b128 v[220:223], v3 offset:3072
  ds_read_b128 v[224:227], v3 offset:7168
  s_add_u32 m0, s82, s70
  s_add_u32 s87, s82, s71
  buffer_load_dwordx4 v11, s[96:99], 0 offen sc1 lds
  v_mfma_f32_32x32x16_bf16 v[96:111], v[192:195], v[180:183], v[96:111]
  ds_read_b64_tr_b16 v[232:233], v14 offset:6144
  ds_read_b64_tr_b16 v[234:235], v14 offset:7168
  buffer_load_dwordx4 v11, s[96:99], 0 offen offset:1024 sc1 lds
  v_mfma_f32_32x32x16_bf16 v[112:127], v[192:195], v[184:187], v[112:127]
  ds_read_b64_tr_b16 v[236:237], v15 offset:6144
  ds_read_b64_tr_b16 v[238:239], v15 offset:7168
  buffer_load_dwordx4 v11, s[96:99], 0 offen offset:2048 sc1 lds
  v_mfma_f32_32x32x16_bf16 v[128:143], v[196:199], v[180:183], v[128:143]
  buffer_load_dwordx4 v11, s[96:99], 0 offen offset:3072 sc1 lds
  s_add_u32 s28, s28, 40960
  s_cmp_ge_u32 s28, 163840
  s_cselect_b32 s28, 0, s28
  v_add_u32 v3, s28, v4
  v_mfma_f32_32x32x16_bf16 v[144:159], v[196:199], v[184:187], v[144:159]
  s_add_u32 m0, s87, 0
  s_nop 0
  buffer_load_dwordx4 v12, s[12:15], 0 offen lds
  v_add_u32 v13, s28, v16
  v_add_u32 v14, s28, v17
  v_add_u32 v15, s28, v18
  s_waitcnt vmcnt(15) lgkmcnt(0)
  s_barrier
  v_mfma_f32_32x32x16_bf16 v[64:79], v[208:211], v[200:203], v[64:79]
  ds_read_b64_tr_b16 v[168:169], v13 offset:0
  ds_read_b64_tr_b16 v[170:171], v13 offset:1024
  buffer_load_dwordx4 v12, s[12:15], s56 offen offset:1024 lds
  v_mfma_f32_32x32x16_bf16 v[80:95], v[208:211], v[204:207], v[80:95]
  ds_read_b128 v[160:163], v3 offset:0
  ds_read_b128 v[164:167], v3 offset:4096
  s_add_u32 m0, s87, 8192
  s_nop 0
  buffer_load_dwordx4 v12, s[12:15], s57 offen lds
  v_mfma_f32_32x32x16_bf16 v[96:111], v[212:215], v[200:203], v[96:111]
  ds_read_b64_tr_b16 v[172:173], v14 offset:0
  ds_read_b64_tr_b16 v[174:175], v14 offset:1024
  buffer_load_dwordx4 v12, s[12:15], s58 offen offset:1024 lds
  v_mfma_f32_32x32x16_bf16 v[112:127], v[212:215], v[204:207], v[112:127]
  ds_read_b64_tr_b16 v[176:177], v15 offset:0
  ds_read_b64_tr_b16 v[178:179], v15 offset:1024
  s_add_u32 m0, s87, 16384
  s_nop 0
  buffer_load_dwordx4 v12, s[12:15], s59 offen lds
  v_mfma_f32_32x32x16_bf16 v[128:143], v[216:219], v[200:203], v[128:143]
  buffer_load_dwordx4 v12, s[12:15], s67 offen offset:1024 lds
  v_add_u32 v11, 4096, v11
  v_add_u32 v12, 73728, v12
  s_add_u32 s82, s82, 40960
  s_cmp_ge_u32 s82, 163840
  s_cselect_b32 s82, 0, s82
  v_mfma_f32_32x32x16_bf16 v[144:159], v[216:219], v[204:207], v[144:159]
  v_mfma_f32_32x32x16_bf16 v[64:79], v[228:231], v[220:223], v[64:79]
  ds_read_b64_tr_b16 v[188:189], v13 offset:2048
  ds_read_b64_tr_b16 v[190:191], v13 offset:3072
  s_add_u32 m0, s82, s70
  s_add_u32 s87, s82, s71
  buffer_load_dwordx4 v11, s[96:99], 0 offen sc1 lds
  v_mfma_f32_32x32x16_bf16 v[80:95], v[228:231], v[224:227], v[80:95]
  ds_read_b128 v[180:183], v3 offset:1024
  ds_read_b128 v[184:187], v3 offset:5120
  buffer_load_dwordx4 v11, s[96:99], 0 offen offset:1024 sc1 lds
  v_mfma_f32_32x32x16_bf16 v[96:111], v[232:235], v[220:223], v[96:111]
  ds_read_b64_tr_b16 v[192:193], v14 offset:2048
  ds_read_b64_tr_b16 v[194:195], v14 offset:3072
  buffer_load_dwordx4 v11, s[96:99], 0 offen offset:2048 sc1 lds
  v_mfma_f32_32x32x16_bf16 v[112:127], v[232:235], v[224:227], v[112:127]
  ds_read_b64_tr_b16 v[196:197], v15 offset:2048
  ds_read_b64_tr_b16 v[198:199], v15 offset:3072
  buffer_load_dwordx4 v11, s[96:99], 0 offen offset:3072 sc1 lds
  v_mfma_f32_32x32x16_bf16 v[128:143], v[236:239], v[220:223], v[128:143]
  s_add_u32 m0, s87, 0
  s_nop 0
  buffer_load_dwordx4 v12, s[12:15], 0 offen lds
  v_mfma_f32_32x32x16_bf16 v[144:159], v[236:239], v[224:227], v[144:159]
  s_sub_u32 s94, s46, 6
  s_sub_u32 s33, s94, 2
.p2align 6
LF_loop1:
  s_waitcnt lgkmcnt(8)
  v_mfma_f32_32x32x16_bf16 v[64:79], v[168:171], v[160:163], v[64:79]
  ds_read_b64_tr_b16 v[208:209], v13 offset:4096
  ds_read_b64_tr_b16 v[210:211], v13 offset:5120
  v_mfma_f32_32x32x16_bf16 v[80:95], v[168:171], v[164:167], v[80:95]
  ds_read_b128 v[200:203], v3 offset:2048
  ds_read_b128 v[204:207], v3 offset:6144
  v_mfma_f32_32x32x16_bf16 v[96:111], v[172:175], v[160:163], v[96:111]
  ds_read_b64_tr_b16 v[212:213], v14 offset:4096
  ds_read_b64_tr_b16 v[214:215], v14 offset:5120
  v_mfma_f32_32x32x16_bf16 v[112:127], v[172:175], v[164:167], v[112:127]
  ds_read_b64_tr_b16 v[216:217], v15 offset:4096
  ds_read_b64_tr_b16 v[218:219], v15 offset:5120
  buffer_load_dwordx4 v12, s[12:15], s56 offen offset:1024 lds
  v_mfma_f32_32x32x16_bf16 v[128:143], v[176:179], v[160:163], v[128:143]
  s_add_u32 m0, s87, 8192
  s_nop 0
  buffer_load_dwordx4 v12, s[12:15], s57 offen lds
  v_mfma_f32_32x32x16_bf16 v[144:159], v[176:179], v[164:167], v[144:159]
  buffer_load_dwordx4 v12, s[12:15], s58 offen offset:1024 lds
  s_waitcnt lgkmcnt(8)
  v_mfma_f32_32x32x16_bf16 v[64:79], v[188:191], v[180:183], v[64:79]
  ds_read_b64_tr_b16 v[228:229], v13 offset:6144
  ds_read_b64_tr_b16 v[230:231], v13 offset:7168
  v_mfma_f32_32x32x16_bf16 v[80:95], v[188:191], v[184:187], v[80:95]
  ds_read_b128 v[220:223], v3 offset:3072
  ds_read_b128 v[224:227], v3 offset:7168
  s_add_u32 m0, s87, 16384
  s_nop 0
  buffer_load_dwordx4 v12, s[12:15], s59 offen lds
  v_mfma_f32_32x32x16_bf16 v[96:111], v[192:195], v[180:183], v[96:111]
  ds_read_b64_tr_b16 v[232:233], v14 offset:6144
  ds_read_b64_tr_b16 v[234:235], v14 offset:7168
  v_mfma_f32_32x32x16_bf16 v[112:127], v[192:195], v[184:187], v[112:127]
  ds_read_b64_tr_b16 v[236:237], v15 offset:6144
  ds_read_b64_tr_b16 v[238:239], v15 offset:7168
  buffer_load_dwordx4 v12, s[12:15], s67 offen offset:1024 lds
  v_add_u32 v11, 4096, v11
  v_add_u32 v12, 73728, v12
  s_add_u32 s82, s82, 40960
  s_cmp_ge_u32 s82, 163840
  s_cselect_b32 s82, 0, s82
  v_mfma_f32_32x32x16_bf16 v[128:143], v[196:199], v[180:183], v[128:143]
  s_add_u32 s28, s28, 40960
  s_cmp_ge_u32 s28, 163840
  s_cselect_b32 s28, 0, s28
  v_add_u32 v3, s28, v4
  v_mfma_f32_32x32x16_bf16 v[144:159], v[196:199], v[184:187], v[144:159]
  v_add_u32 v13, s28, v16
  v_add_u32 v14, s28, v17
  v_add_u32 v15, s28, v18
  s_waitcnt vmcnt(20) lgkmcnt(0)
  s_barrier
  v_mfma_f32_32x32x16_bf16 v[64:79], v[208:211], v[200:203], v[64:79]
  ds_read_b64_tr_b16 v[168:169], v13 offset:0
  ds_read_b64_tr_b16 v[170:171], v13 offset:1024
  v_mfma_f32_32x32x16_bf16 v[80:95], v[208:211], v[204:207], v[80:95]
  ds_read_b128 v[160:163], v3 offset:0
  ds_read_b128 v[164:167], v3 offset:4096
  v_mfma_f32_32x32x16_bf16 v[96:111], v[212:215], v[200:203], v[96:111]
  ds_read_b64_tr_b16 v[172:173], v14 offset:0
  ds_read_b64_tr_b16 v[174:175], v14 offset:1024
  v_mfma_f32_32x32x16_bf16 v[112:127], v[212:215], v[204:207], v[112:127]
  ds_read_b64_tr_b16 v[176:177], v15 offset:0
  ds_read_b64_tr_b16 v[178:179], v15 offset:1024
  s_add_u32 m0, s82, s70
  s_add_u32 s87, s82, s71
  buffer_load_dwordx4 v11, s[96:99], 0 offen sc1 lds
  v_mfma_f32_32x32x16_bf16 v[128:143], v[216:219], v[200:203], v[128:143]
  buffer_load_dwordx4 v11, s[96:99], 0 offen offset:1024 sc1 lds
  v_mfma_f32_32x32x16_bf16 v[144:159], v[216:219], v[204:207], v[144:159]
  buffer_load_dwordx4 v11, s[96:99], 0 offen offset:2048 sc1 lds
  v_mfma_f32_32x32x16_bf16 v[64:79], v[228:231], v[220:223], v[64:79]
  ds_read_b64_tr_b16 v[188:189], v13 offset:2048
  ds_read_b64_tr_b16 v[190:191], v13 offset:3072
  s_cmp_lg_u32 s94, s33
  s_cbranch_scc1 LF_nohook
  s_cmp_lg_u32 s3, 0
  s_cbranch_scc1 L_pubcl
  v_mov_b32 v22, s88
  v_mov_b32 v23, 0
  s_sub_u32 s4, 15, s51
  s_lshl_b32 s4, s4, 5
  s_add_u32 s4, s4, s50
  s_lshl_b32 s4, s4, 2
  s_add_u32 s4, s4, 3072
  s_mov_b64 exec, 1
  buffer_store_dword v22, v23, s[8:11], s4 offen sc1
  s_mov_b64 exec, -1
L_pubcl:
  s_cmp_lg_u32 s3, 0
  s_cbranch_scc1 L_pubcs
  v_mov_b32 v22, s88
  v_mov_b32 v23, 0
  s_mov_b32 s4, s51
  s_lshl_b32 s4, s4, 5
  s_add_u32 s4, s4, s50
  s_lshl_b32 s4, s4, 2
  s_add_u32 s4, s4, 3072
  s_mov_b64 exec, 1
  buffer_store_dword v22, v23, s[8:11], s4 offen sc1
  s_mov_b64 exec, -1
L_pubcs:
LF_nohook:
  v_mfma_f32_32x32x16_bf16 v[80:95], v[228:231], v[224:227], v[80:95]
  ds_read_b128 v[180:183], v3 offset:1024
  ds_read_b128 v[184:187], v3 offset:5120
  v_mfma_f32_32x32x16_bf16 v[96:111], v[232:235], v[220:223], v[96:111]
  ds_read_b64_tr_b16 v[192:193], v14 offset:2048
  ds_read_b64_tr_b16 v[194:195], v14 offset:3072
  v_mfma_f32_32x32x16_bf16 v[112:127], v[232:235], v[224:227], v[112:127]
  ds_read_b64_tr_b16 v[196:197], v15 offset:2048
  ds_read_b64_tr_b16 v[198:199], v15 offset:3072
  v_mfma_f32_32x32x16_bf16 v[128:143], v[236:239], v[220:223], v[128:143]
  buffer_load_dwordx4 v11, s[96:99], 0 offen offset:3072 sc1 lds
  v_mfma_f32_32x32x16_bf16 v[144:159], v[236:239], v[224:227], v[144:159]
  s_add_u32 m0, s87, 0
  s_nop 0
  buffer_load_dwordx4 v12, s[12:15], 0 offen lds
  s_sub_u32 s94, s94, 1
  s_cmp_lg_u32 s94, 0
  s_cbranch_scc1 LF_loop1
  s_lshl_b32 s4, s36, 7
  s_add_u32 s29, s4, 3072
  buffer_load_dword v25, v26, s[8:11], s29 offen sc1
  s_waitcnt lgkmcnt(8)
  v_mfma_f32_32x32x16_bf16 v[64:79], v[168:171], v[160:163], v[64:79]
  ds_read_b64_tr_b16 v[208:209], v13 offset:4096
  ds_read_b64_tr_b16 v[210:211], v13 offset:5120
  v_mfma_f32_32x32x16_bf16 v[80:95], v[168:171], v[164:167], v[80:95]
  ds_read_b128 v[200:203], v3 offset:2048
  ds_read_b128 v[204:207], v3 offset:6144
  v_mfma_f32_32x32x16_bf16 v[96:111], v[172:175], v[160:163], v[96:111]
  ds_read_b64_tr_b16 v[212:213], v14 offset:4096
  ds_read_b64_tr_b16 v[214:215], v14 offset:5120
  v_mfma_f32_32x32x16_bf16 v[112:127], v[172:175], v[164:167], v[112:127]
  ds_read_b64_tr_b16 v[216:217], v15 offset:4096
  ds_read_b64_tr_b16 v[218:219], v15 offset:5120
  buffer_load_dwordx4 v12, s[12:15], s56 offen offset:1024 lds
  v_mfma_f32_32x32x16_bf16 v[128:143], v[176:179], v[160:163], v[128:143]
  s_add_u32 m0, s87, 8192
  s_nop 0
  buffer_load_dwordx4 v12, s[12:15], s57 offen lds
  v_mfma_f32_32x32x16_bf16 v[144:159], v[176:179], v[164:167], v[144:159]
  buffer_load_dwordx4 v12, s[12:15], s58 offen offset:1024 lds
  s_waitcnt lgkmcnt(8)
  v_mfma_f32_32x32x16_bf16 v[64:79], v[188:191], v[180:183], v[64:79]
  ds_read_b64_tr_b16 v[228:229], v13 offset:6144
  ds_read_b64_tr_b16 v[230:231], v13 offset:7168
  v_mfma_f32_32x32x16_bf16 v[80:95], v[188:191], v[184:187], v[80:95]
  ds_read_b128 v[220:223], v3 offset:3072
  ds_read_b128 v[224:227], v3 offset:7168
  s_add_u32 m0, s87, 16384
  s_nop 0
  buffer_load_dwordx4 v12, s[12:15], s59 offen lds
  v_mfma_f32_32x32x16_bf16 v[96:111], v[192:195], v[180:183], v[96:111]
  ds_read_b64_tr_b16 v[232:233], v14 offset:6144
  ds_read_b64_tr_b16 v[234:235], v14 offset:7168
  v_mfma_f32_32x32x16_bf16 v[112:127], v[192:195], v[184:187], v[112:127]
  ds_read_b64_tr_b16 v[236:237], v15 offset:6144
  ds_read_b64_tr_b16 v[238:239], v15 offset:7168
  buffer_load_dwordx4 v12, s[12:15], s67 offen offset:1024 lds
  v_add_u32 v11, 4096, v11
  v_add_u32 v12, 73728, v12
  s_add_u32 s82, s82, 40960
  s_cmp_ge_u32 s82, 163840
  s_cselect_b32 s82, 0, s82
  v_mfma_f32_32x32x16_bf16 v[128:143], v[196:199], v[180:183], v[128:143]
  s_add_u32 s28, s28, 40960
  s_cmp_ge_u32 s28, 163840
  s_cselect_b32 s28, 0, s28
  v_add_u32 v3, s28, v4
  v_mfma_f32_32x32x16_bf16 v[144:159], v[196:199], v[184:187], v[144:159]
  v_add_u32 v13, s28, v16
  v_add_u32 v14, s28, v17
  v_add_u32 v15, s28, v18
  s_waitcnt vmcnt(20) lgkmcnt(0)
  s_barrier
  v_mfma_f32_32x32x16_bf16 v[64:79], v[208:211], v[200:203], v[64:79]
  ds_read_b64_tr_b16 v[168:169], v13 offset:0
  ds_read_b64_tr_b16 v[170:171], v13 offset:1024
  v_mfma_f32_32x32x16_bf16 v[80:95], v[208:211], v[204:207], v[80:95]
  ds_read_b128 v[160:163], v3 offset:0
  ds_read_b128 v[164:167], v3 offset:4096
  v_mfma_f32_32x32x16_bf16 v[96:111], v[212:215], v[200:203], v[96:111]
  ds_read_b64_tr_b16 v[172:173], v14 offset:0
  ds_read_b64_tr_b16 v[174:175], v14 offset:1024
  v_mfma_f32_32x32x16_bf16 v[112:127], v[212:215], v[204:207], v[112:127]
  ds_read_b64_tr_b16 v[176:177], v15 offset:0
  ds_read_b64_tr_b16 v[178:179], v15 offset:1024
  s_add_u32 m0, s82, s70
  s_add_u32 s87, s82, s71
  buffer_load_dwordx4 v11, s[96:99], 0 offen sc1 lds
  v_mfma_f32_32x32x16_bf16 v[128:143], v[216:219], v[200:203], v[128:143]
  buffer_load_dwordx4 v11, s[96:99], 0 offen offset:1024 sc1 lds
  v_mfma_f32_32x32x16_bf16 v[144:159], v[216:219], v[204:207], v[144:159]
  buffer_load_dwordx4 v11, s[96:99], 0 offen offset:2048 sc1 lds
  v_mfma_f32_32x32x16_bf16 v[64:79], v[228:231], v[220:223], v[64:79]
  ds_read_b64_tr_b16 v[188:189], v13 offset:2048
  ds_read_b64_tr_b16 v[190:191], v13 offset:3072
  v_mfma_f32_32x32x16_bf16 v[80:95], v[228:231], v[224:227], v[80:95]
  ds_read_b128 v[180:183], v3 offset:1024
  ds_read_b128 v[184:187], v3 offset:5120
  v_mfma_f32_32x32x16_bf16 v[96:111], v[232:235], v[220:223], v[96:111]
  ds_read_b64_tr_b16 v[192:193], v14 offset:2048
  ds_read_b64_tr_b16 v[194:195], v14 offset:3072
  v_mfma_f32_32x32x16_bf16 v[112:127], v[232:235], v[224:227], v[112:127]
  ds_read_b64_tr_b16 v[196:197], v15 offset:2048
  ds_read_b64_tr_b16 v[198:199], v15 offset:3072
  v_mfma_f32_32x32x16_bf16 v[128:143], v[236:239], v[220:223], v[128:143]
  buffer_load_dwordx4 v11, s[96:99], 0 offen offset:3072 sc1 lds
  v_mfma_f32_32x32x16_bf16 v[144:159], v[236:239], v[224:227], v[144:159]
  s_add_u32 m0, s87, 0
  s_nop 0
  buffer_load_dwordx4 v12, s[12:15], 0 offen lds
  s_waitcnt vmcnt(10)
  s_mov_b32 s6, 0xffffffff
  s_mov_b32 s7, 0x0
  s_mov_b32 s5, 100000
LFL5:
  v_cmp_ne_u32 vcc, s88, v25
  s_nop 1
  s_and_b64 vcc, vcc, s[6:7]
  s_cbranch_vccz LFL5_ok
  s_sub_u32 s5, s5, 1
  s_cmp_eq_u32 s5, 0
  s_cbranch_scc1 LFL5_ok
  s_sleep 1
  buffer_load_dword v25, v26, s[8:11], s29 offen sc1
  s_waitcnt vmcnt(0)
  s_branch LFL5
LFL5_ok:
  s_waitcnt lgkmcnt(8)
  v_mfma_f32_32x32x16_bf16 v[64:79], v[168:171], v[160:163], v[64:79]
  ds_read_b64_tr_b16 v[208:209], v13 offset:4096
  ds_read_b64_tr_b16 v[210:211], v13 offset:5120
  v_mfma_f32_32x32x16_bf16 v[80:95], v[168:171], v[164:167], v[80:95]
  ds_read_b128 v[200:203], v3 offset:2048
  ds_read_b128 v[204:207], v3 offset:6144
  v_mfma_f32_32x32x16_bf16 v[96:111], v[172:175], v[160:163], v[96:111]
  ds_read_b64_tr_b16 v[212:213], v14 offset:4096
  ds_read_b64_tr_b16 v[214:215], v14 offset:5120
  v_mfma_f32_32x32x16_bf16 v[112:127], v[172:175], v[164:167], v[112:127]
  ds_read_b64_tr_b16 v[216:217], v15 offset:4096
  ds_read_b64_tr_b16 v[218:219], v15 offset:5120
  buffer_load_dwordx4 v12, s[12:15], s56 offen offset:1024 lds
  v_mfma_f32_32x32x16_bf16 v[128:143], v[176:179], v[160:163], v[128:143]
  s_add_u32 m0, s87, 8192
  s_nop 0
  buffer_load_dwordx4 v12, s[12:15], s57 offen lds
  v_mfma_f32_32x32x16_bf16 v[144:159], v[176:179], v[164:167], v[144:159]
  buffer_load_dwordx4 v12, s[12:15], s58 offen offset:1024 lds
  s_waitcnt lgkmcnt(8)
  v_mfma_f32_32x32x16_bf16 v[64:79], v[188:191], v[180:183], v[64:79]
  ds_read_b64_tr_b16 v[228:229], v13 offset:6144
  ds_read_b64_tr_b16 v[230:231], v13 offset:7168
  v_mfma_f32_32x32x16_bf16 v[80:95], v[188:191], v[184:187], v[80:95]
  ds_read_b128 v[220:223], v3 offset:3072
  ds_read_b128 v[224:227], v3 offset:7168
  s_add_u32 m0, s87, 16384
  s_nop 0
  buffer_load_dwordx4 v12, s[12:15], s59 offen lds
  v_mfma_f32_32x32x16_bf16 v[96:111], v[192:195], v[180:183], v[96:111]
  ds_read_b64_tr_b16 v[232:233], v14 offset:6144
  ds_read_b64_tr_b16 v[234:235], v14 offset:7168
  v_mfma_f32_32x32x16_bf16 v[112:127], v[192:195], v[184:187], v[112:127]
  ds_read_b64_tr_b16 v[236:237], v15 offset:6144
  ds_read_b64_tr_b16 v[238:239], v15 offset:7168
  buffer_load_dwordx4 v12, s[12:15], s67 offen offset:1024 lds
  v_add_u32 v11, 4096, v11
  v_add_u32 v12, 73728, v12
  s_add_u32 s82, s82, 40960
  s_cmp_ge_u32 s82, 163840
  s_cselect_b32 s82, 0, s82
  v_mfma_f32_32x32x16_bf16 v[128:143], v[196:199], v[180:183], v[128:143]
  s_add_u32 s28, s28, 40960
  s_cmp_ge_u32 s28, 163840
  s_cselect_b32 s28, 0, s28
  v_add_u32 v3, s28, v4
  v_mfma_f32_32x32x16_bf16 v[144:159], v[196:199], v[184:187], v[144:159]
  v_add_u32 v13, s28, v16
  v_add_u32 v14, s28, v17
  v_add_u32 v15, s28, v18
  s_waitcnt vmcnt(20) lgkmcnt(0)
  s_barrier
  v_mfma_f32_32x32x16_bf16 v[64:79], v[208:211], v[200:203], v[64:79]
  ds_read_b64_tr_b16 v[168:169], v13 offset:0
  ds_read_b64_tr_b16 v[170:171], v13 offset:1024
  v_add_u32 v11, s83, v11
  v_add_u32 v12, s86, v12
  s_mov_b32 s12, s72
  s_mov_b32 s13, s73
  s_mov_b32 s14, 0x480000
  v_mfma_f32_32x32x16_bf16 v[80:95], v[208:211], v[204:207], v[80:95]
  ds_read_b128 v[160:163], v3 offset:0
  ds_read_b128 v[164:167], v3 offset:4096
  v_mfma_f32_32x32x16_bf16 v[96:111], v[212:215], v[200:203], v[96:111]
  ds_read_b64_tr_b16 v[172:173], v14 offset:0
  ds_read_b64_tr_b16 v[174:175], v14 offset:1024
  v_mfma_f32_32x32x16_bf16 v[112:127], v[212:215], v[204:207], v[112:127]
  ds_read_b64_tr_b16 v[176:177], v15 offset:0
  ds_read_b64_tr_b16 v[178:179], v15 offset:1024
  s_add_u32 m0, s82, s70
  s_add_u32 s87, s82, s71
  buffer_load_dwordx4 v11, s[96:99], 0 offen sc1 lds
  v_mfma_f32_32x32x16_bf16 v[128:143], v[216:219], v[200:203], v[128:143]
  buffer_load_dwordx4 v11, s[96:99], 0 offen offset:1024 sc1 lds
  v_mfma_f32_32x32x16_bf16 v[144:159], v[216:219], v[204:207], v[144:159]
  buffer_load_dwordx4 v11, s[96:99], 0 offen offset:2048 sc1 lds
  v_mfma_f32_32x32x16_bf16 v[64:79], v[228:231], v[220:223], v[64:79]
  ds_read_b64_tr_b16 v[188:189], v13 offset:2048
  ds_read_b64_tr_b16 v[190:191], v13 offset:3072
  v_mfma_f32_32x32x16_bf16 v[80:95], v[228:231], v[224:227], v[80:95]
  ds_read_b128 v[180:183], v3 offset:1024
  ds_read_b128 v[184:187], v3 offset:5120
  v_mfma_f32_32x32x16_bf16 v[96:111], v[232:235], v[220:223], v[96:111]
  ds_read_b64_tr_b16 v[192:193], v14 offset:2048
  ds_read_b64_tr_b16 v[194:195], v14 offset:3072
  v_mfma_f32_32x32x16_bf16 v[112:127], v[232:235], v[224:227], v[112:127]
  ds_read_b64_tr_b16 v[196:197], v15 offset:2048
  ds_read_b64_tr_b16 v[198:199], v15 offset:3072
  v_mfma_f32_32x32x16_bf16 v[128:143], v[236:239], v[220:223], v[128:143]
  buffer_load_dwordx4 v11, s[96:99], 0 offen offset:3072 sc1 lds
  v_mfma_f32_32x32x16_bf16 v[144:159], v[236:239], v[224:227], v[144:159]
  s_add_u32 m0, s87, 0
  s_nop 0
  buffer_load_dwordx4 v12, s[12:15], 0 offen lds
  s_sub_u32 s94, s49, 1
.p2align 6
LF_loop2:
  s_waitcnt lgkmcnt(8)
  v_mfma_f32_32x32x16_bf16 v[64:79], v[168:171], v[160:163], v[64:79]
  ds_read_b64_tr_b16 v[208:209], v13 offset:4096
  ds_read_b64_tr_b16 v[210:211], v13 offset:5120
  v_mfma_f32_32x32x16_bf16 v[80:95], v[168:171], v[164:167], v[80:95]
  ds_read_b128 v[200:203], v3 offset:2048
  ds_read_b128 v[204:207], v3 offset:6144
  v_mfma_f32_32x32x16_bf16 v[96:111], v[172:175], v[160:163], v[96:111]
  ds_read_b64_tr_b16 v[212:213], v14 offset:4096
  ds_read_b64_tr_b16 v[214:215], v14 offset:5120
  v_mfma_f32_32x32x16_bf16 v[112:127], v[172:175], v[164:167], v[112:127]
  ds_read_b64_tr_b16 v[216:217], v15 offset:4096
  ds_read_b64_tr_b16 v[218:219], v15 offset:5120
  buffer_load_dwordx4 v12, s[12:15], s56 offen offset:1024 lds
  v_mfma_f32_32x32x16_bf16 v[128:143], v[176:179], v[160:163], v[128:143]
  s_add_u32 m0, s87, 8192
  s_nop 0
  buffer_load_dwordx4 v12, s[12:15], s57 offen lds
  v_mfma_f32_32x32x16_bf16 v[144:159], v[176:179], v[164:167], v[144:159]
  buffer_load_dwordx4 v12, s[12:15], s58 offen offset:1024 lds
  s_waitcnt lgkmcnt(8)
  v_mfma_f32_32x32x16_bf16 v[64:79], v[188:191], v[180:183], v[64:79]
  ds_read_b64_tr_b16 v[228:229], v13 offset:6144
  ds_read_b64_tr_b16 v[230:231], v13 offset:7168
  v_mfma_f32_32x32x16_bf16 v[80:95], v[188:191], v[184:187], v[80:95]
  ds_read_b128 v[220:223], v3 offset:3072
  ds_read_b128 v[224:227], v3 offset:7168
  s_add_u32 m0, s87, 16384
  s_nop 0
  buffer_load_dwordx4 v12, s[12:15], s59 offen lds
  v_mfma_f32_32x32x16_bf16 v[96:111], v[192:195], v[180:183], v[96:111]
  ds_read_b64_tr_b16 v[232:233], v14 offset:6144
  ds_read_b64_tr_b16 v[234:235], v14 offset:7168
  v_mfma_f32_32x32x16_bf16 v[112:127], v[192:195], v[184:187], v[112:127]
  ds_read_b64_tr_b16 v[236:237], v15 offset:6144
  ds_read_b64_tr_b16 v[238:239], v15 offset:7168
  buffer_load_dwordx4 v12, s[12:15], s67 offen offset:1024 lds
  v_add_u32 v11, 4096, v11
  v_add_u32 v12, 73728, v12
  s_add_u32 s82, s82, 40960
  s_cmp_ge_u32 s82, 163840
  s_cselect_b32 s82, 0, s82
  v_mfma_f32_32x32x16_bf16 v[128:143], v[196:199], v[180:183], v[128:143]
  s_add_u32 s28, s28, 40960
  s_cmp_ge_u32 s28, 163840
  s_cselect_b32 s28, 0, s28
  v_add_u32 v3, s28, v4
  v_mfma_f32_32x32x16_bf16 v[144:159], v[196:199], v[184:187], v[144:159]
  v_add_u32 v13, s28, v16
  v_add_u32 v14, s28, v17
  v_add_u32 v15, s28, v18
  s_waitcnt vmcnt(20) lgkmcnt(0)
  s_barrier
  v_mfma_f32_32x32x16_bf16 v[64:79], v[208:211], v[200:203], v[64:79]
  ds_read_b64_tr_b16 v[168:169], v13 offset:0
  ds_read_b64_tr_b16 v[170:171], v13 offset:1024
  v_mfma_f32_32x32x16_bf16 v[80:95], v[208:211], v[204:207], v[80:95]
  ds_read_b128 v[160:163], v3 offset:0
  ds_read_b128 v[164:167], v3 offset:4096
  v_mfma_f32_32x32x16_bf16 v[96:111], v[212:215], v[200:203], v[96:111]
  ds_read_b64_tr_b16 v[172:173], v14 offset:0
  ds_read_b64_tr_b16 v[174:175], v14 offset:1024
  v_mfma_f32_32x32x16_bf16 v[112:127], v[212:215], v[204:207], v[112:127]
  ds_read_b64_tr_b16 v[176:177], v15 offset:0
  ds_read_b64_tr_b16 v[178:179], v15 offset:1024
  s_add_u32 m0, s82, s70
  s_add_u32 s87, s82, s71
  buffer_load_dwordx4 v11, s[96:99], 0 offen sc1 lds
  v_mfma_f32_32x32x16_bf16 v[128:143], v[216:219], v[200:203], v[128:143]
  buffer_load_dwordx4 v11, s[96:99], 0 offen offset:1024 sc1 lds
  v_mfma_f32_32x32x16_bf16 v[144:159], v[216:219], v[204:207], v[144:159]
  buffer_load_dwordx4 v11, s[96:99], 0 offen offset:2048 sc1 lds
  v_mfma_f32_32x32x16_bf16 v[64:79], v[228:231], v[220:223], v[64:79]
  ds_read_b64_tr_b16 v[188:189], v13 offset:2048
  ds_read_b64_tr_b16 v[190:191], v13 offset:3072
  v_mfma_f32_32x32x16_bf16 v[80:95], v[228:231], v[224:227], v[80:95]
  ds_read_b128 v[180:183], v3 offset:1024
  ds_read_b128 v[184:187], v3 offset:5120
  v_mfma_f32_32x32x16_bf16 v[96:111], v[232:235], v[220:223], v[96:111]
  ds_read_b64_tr_b16 v[192:193], v14 offset:2048
  ds_read_b64_tr_b16 v[194:195], v14 offset:3072
  v_mfma_f32_32x32x16_bf16 v[112:127], v[232:235], v[224:227], v[112:127]
  ds_read_b64_tr_b16 v[196:197], v15 offset:2048
  ds_read_b64_tr_b16 v[198:199], v15 offset:3072
  v_mfma_f32_32x32x16_bf16 v[128:143], v[236:239], v[220:223], v[128:143]
  buffer_load_dwordx4 v11, s[96:99], 0 offen offset:3072 sc1 lds
  v_mfma_f32_32x32x16_bf16 v[144:159], v[236:239], v[224:227], v[144:159]
  s_add_u32 m0, s87, 0
  s_nop 0
  buffer_load_dwordx4 v12, s[12:15], 0 offen lds
  s_sub_u32 s94, s94, 1
  s_cmp_lg_u32 s94, 0
  s_cbranch_scc1 LF_loop2
  s_waitcnt lgkmcnt(8)
  v_mfma_f32_32x32x16_bf16 v[64:79], v[168:171], v[160:163], v[64:79]
  ds_read_b64_tr_b16 v[208:209], v13 offset:4096
  ds_read_b64_tr_b16 v[210:211], v13 offset:5120
  v_mfma_f32_32x32x16_bf16 v[80:95], v[168:171], v[164:167], v[80:95]
  ds_read_b128 v[200:203], v3 offset:2048
  ds_read_b128 v[204:207], v3 offset:6144
  v_mfma_f32_32x32x16_bf16 v[96:111], v[172:175], v[160:163], v[96:111]
  ds_read_b64_tr_b16 v[212:213], v14 offset:4096
  ds_read_b64_tr_b16 v[214:215], v14 offset:5120
  v_mfma_f32_32x32x16_bf16 v[112:127], v[172:175], v[164:167], v[112:127]
  ds_read_b64_tr_b16 v[216:217], v15 offset:4096
  ds_read_b64_tr_b16 v[218:219], v15 offset:5120
  buffer_load_dwordx4 v12, s[12:15], s56 offen offset:1024 lds
  v_mfma_f32_32x32x16_bf16 v[128:143], v[176:179], v[160:163], v[128:143]
  s_add_u32 m0, s87, 8192
  s_nop 0
  buffer_load_dwordx4 v12, s[12:15], s57 offen lds
  v_mfma_f32_32x32x16_bf16 v[144:159], v[176:179], v[164:167], v[144:159]
  buffer_load_dwordx4 v12, s[12:15], s58 offen offset:1024 lds
  s_waitcnt lgkmcnt(8)
  v_mfma_f32_32x32x16_bf16 v[64:79], v[188:191], v[180:183], v[64:79]
  ds_read_b64_tr_b16 v[228:229], v13 offset:6144
  ds_read_b64_tr_b16 v[230:231], v13 offset:7168
  v_mfma_f32_32x32x16_bf16 v[80:95], v[188:191], v[184:187], v[80:95]
  ds_read_b128 v[220:223], v3 offset:3072
  ds_read_b128 v[224:227], v3 offset:7168
  s_add_u32 m0, s87, 16384
  s_nop 0
  buffer_load_dwordx4 v12, s[12:15], s59 offen lds
  v_mfma_f32_32x32x16_bf16 v[96:111], v[192:195], v[180:183], v[96:111]
  ds_read_b64_tr_b16 v[232:233], v14 offset:6144
  ds_read_b64_tr_b16 v[234:235], v14 offset:7168
  v_mfma_f32_32x32x16_bf16 v[112:127], v[192:195], v[184:187], v[112:127]
  ds_read_b64_tr_b16 v[236:237], v15 offset:6144
  ds_read_b64_tr_b16 v[238:239], v15 offset:7168
  buffer_load_dwordx4 v12, s[12:15], s67 offen offset:1024 lds
  v_add_u32 v11, 4096, v11
  v_add_u32 v12, 73728, v12
  s_add_u32 s82, s82, 40960
  s_cmp_ge_u32 s82, 163840
  s_cselect_b32 s82, 0, s82
  v_mfma_f32_32x32x16_bf16 v[128:143], v[196:199], v[180:183], v[128:143]
  s_add_u32 s28, s28, 40960
  s_cmp_ge_u32 s28, 163840
  s_cselect_b32 s28, 0, s28
  v_add_u32 v3, s28, v4
  v_mfma_f32_32x32x16_bf16 v[144:159], v[196:199], v[184:187], v[144:159]
  v_add_u32 v13, s28, v16
  v_add_u32 v14, s28, v17
  v_add_u32 v15, s28, v18
  s_waitcnt vmcnt(20) lgkmcnt(0)
  s_barrier
  v_mfma_f32_32x32x16_bf16 v[64:79], v[208:211], v[200:203], v[64:79]
  ds_read_b64_tr_b16 v[168:169], v13 offset:0
  ds_read_b64_tr_b16 v[170:171], v13 offset:1024
  v_mfma_f32_32x32x16_bf16 v[80:95], v[208:211], v[204:207], v[80:95]
  ds_read_b128 v[160:163], v3 offset:0
  ds_read_b128 v[164:167], v3 offset:4096
  v_mfma_f32_32x32x16_bf16 v[96:111], v[212:215], v[200:203], v[96:111]
  ds_read_b64_tr_b16 v[172:173], v14 offset:0
  ds_read_b64_tr_b16 v[174:175], v14 offset:1024
  v_mfma_f32_32x32x16_bf16 v[112:127], v[212:215], v[204:207], v[112:127]
  ds_read_b64_tr_b16 v[176:177], v15 offset:0
  ds_read_b64_tr_b16 v[178:179], v15 offset:1024
  v_mfma_f32_32x32x16_bf16 v[128:143], v[216:219], v[200:203], v[128:143]
  v_mfma_f32_32x32x16_bf16 v[144:159], v[216:219], v[204:207], v[144:159]
  v_mfma_f32_32x32x16_bf16 v[64:79], v[228:231], v[220:223], v[64:79]
  ds_read_b64_tr_b16 v[188:189], v13 offset:2048
  ds_read_b64_tr_b16 v[190:191], v13 offset:3072
  v_mfma_f32_32x32x16_bf16 v[80:95], v[228:231], v[224:227], v[80:95]
  ds_read_b128 v[180:183], v3 offset:1024
  ds_read_b128 v[184:187], v3 offset:5120
  v_mfma_f32_32x32x16_bf16 v[96:111], v[232:235], v[220:223], v[96:111]
  ds_read_b64_tr_b16 v[192:193], v14 offset:2048
  ds_read_b64_tr_b16 v[194:195], v14 offset:3072
  v_mfma_f32_32x32x16_bf16 v[112:127], v[232:235], v[224:227], v[112:127]
  ds_read_b64_tr_b16 v[196:197], v15 offset:2048
  ds_read_b64_tr_b16 v[198:199], v15 offset:3072
  v_mfma_f32_32x32x16_bf16 v[128:143], v[236:239], v[220:223], v[128:143]
  v_mfma_f32_32x32x16_bf16 v[144:159], v[236:239], v[224:227], v[144:159]
  s_waitcnt lgkmcnt(8)
  v_mfma_f32_32x32x16_bf16 v[64:79], v[168:171], v[160:163], v[64:79]
  ds_read_b64_tr_b16 v[208:209], v13 offset:4096
  ds_read_b64_tr_b16 v[210:211], v13 offset:5120
  v_mfma_f32_32x32x16_bf16 v[80:95], v[168:171], v[164:167], v[80:95]
  ds_read_b128 v[200:203], v3 offset:2048
  ds_read_b128 v[204:207], v3 offset:6144
  v_mfma_f32_32x32x16_bf16 v[96:111], v[172:175], v[160:163], v[96:111]
  ds_read_b64_tr_b16 v[212:213], v14 offset:4096
  ds_read_b64_tr_b16 v[214:215], v14 offset:5120
  v_mfma_f32_32x32x16_bf16 v[112:127], v[172:175], v[164:167], v[112:127]
  ds_read_b64_tr_b16 v[216:217], v15 offset:4096
  ds_read_b64_tr_b16 v[218:219], v15 offset:5120
  v_mfma_f32_32x32x16_bf16 v[128:143], v[176:179], v[160:163], v[128:143]
  v_mfma_f32_32x32x16_bf16 v[144:159], v[176:179], v[164:167], v[144:159]
  s_waitcnt lgkmcnt(8)
  v_mfma_f32_32x32x16_bf16 v[64:79], v[188:191], v[180:183], v[64:79]
  ds_read_b64_tr_b16 v[228:229], v13 offset:6144
  ds_read_b64_tr_b16 v[230:231], v13 offset:7168
  v_mfma_f32_32x32x16_bf16 v[80:95], v[188:191], v[184:187], v[80:95]
  ds_read_b128 v[220:223], v3 offset:3072
  ds_read_b128 v[224:227], v3 offset:7168
  v_mfma_f32_32x32x16_bf16 v[96:111], v[192:195], v[180:183], v[96:111]
  ds_read_b64_tr_b16 v[232:233], v14 offset:6144
  ds_read_b64_tr_b16 v[234:235], v14 offset:7168
  v_mfma_f32_32x32x16_bf16 v[112:127], v[192:195], v[184:187], v[112:127]
  ds_read_b64_tr_b16 v[236:237], v15 offset:6144
  ds_read_b64_tr_b16 v[238:239], v15 offset:7168
  v_mfma_f32_32x32x16_bf16 v[128:143], v[196:199], v[180:183], v[128:143]
  s_add_u32 s28, s28, 40960
  s_cmp_ge_u32 s28, 163840
  s_cselect_b32 s28, 0, s28
  v_add_u32 v3, s28, v4
  v_mfma_f32_32x32x16_bf16 v[144:159], v[196:199], v[184:187], v[144:159]
  v_add_u32 v13, s28, v16
  v_add_u32 v14, s28, v17
  v_add_u32 v15, s28, v18
  s_waitcnt vmcnt(10) lgkmcnt(0)
  s_barrier
  v_mfma_f32_32x32x16_bf16 v[64:79], v[208:211], v[200:203], v[64:79]
  ds_read_b64_tr_b16 v[168:169], v13 offset:0
  ds_read_b64_tr_b16 v[170:171], v13 offset:1024
  v_mfma_f32_32x32x16_bf16 v[80:95], v[208:211], v[204:207], v[80:95]
  ds_read_b128 v[160:163], v3 offset:0
  ds_read_b128 v[164:167], v3 offset:4096
  v_mfma_f32_32x32x16_bf16 v[96:111], v[212:215], v[200:203], v[96:111]
  ds_read_b64_tr_b16 v[172:173], v14 offset:0
  ds_read_b64_tr_b16 v[174:175], v14 offset:1024
  v_mfma_f32_32x32x16_bf16 v[112:127], v[212:215], v[204:207], v[112:127]
  ds_read_b64_tr_b16 v[176:177], v15 offset:0
  ds_read_b64_tr_b16 v[178:179], v15 offset:1024
  v_mfma_f32_32x32x16_bf16 v[128:143], v[216:219], v[200:203], v[128:143]
  v_mfma_f32_32x32x16_bf16 v[144:159], v[216:219], v[204:207], v[144:159]
  v_mfma_f32_32x32x16_bf16 v[64:79], v[228:231], v[220:223], v[64:79]
  ds_read_b64_tr_b16 v[188:189], v13 offset:2048
  ds_read_b64_tr_b16 v[190:191], v13 offset:3072
  v_mfma_f32_32x32x16_bf16 v[80:95], v[228:231], v[224:227], v[80:95]
  ds_read_b128 v[180:183], v3 offset:1024
  ds_read_b128 v[184:187], v3 offset:5120
  v_mfma_f32_32x32x16_bf16 v[96:111], v[232:235], v[220:223], v[96:111]
  ds_read_b64_tr_b16 v[192:193], v14 offset:2048
  ds_read_b64_tr_b16 v[194:195], v14 offset:3072
  v_mfma_f32_32x32x16_bf16 v[112:127], v[232:235], v[224:227], v[112:127]
  ds_read_b64_tr_b16 v[196:197], v15 offset:2048
  ds_read_b64_tr_b16 v[198:199], v15 offset:3072
  v_mfma_f32_32x32x16_bf16 v[128:143], v[236:239], v[220:223], v[128:143]
  v_mfma_f32_32x32x16_bf16 v[144:159], v[236:239], v[224:227], v[144:159]
  s_waitcnt lgkmcnt(8)
  v_mfma_f32_32x32x16_bf16 v[64:79], v[168:171], v[160:163], v[64:79]
  ds_read_b64_tr_b16 v[208:209], v13 offset:4096
  ds_read_b64_tr_b16 v[210:211], v13 offset:5120
  v_mfma_f32_32x32x16_bf16 v[80:95], v[168:171], v[164:167], v[80:95]
  ds_read_b128 v[200:203], v3 offset:2048
  ds_read_b128 v[204:207], v3 offset:6144
  v_mfma_f32_32x32x16_bf16 v[96:111], v[172:175], v[160:163], v[96:111]
  ds_read_b64_tr_b16 v[212:213], v14 offset:4096
  ds_read_b64_tr_b16 v[214:215], v14 offset:5120
  v_mfma_f32_32x32x16_bf16 v[112:127], v[172:175], v[164:167], v[112:127]
  ds_read_b64_tr_b16 v[216:217], v15 offset:4096
  ds_read_b64_tr_b16 v[218:219], v15 offset:5120
  v_mfma_f32_32x32x16_bf16 v[128:143], v[176:179], v[160:163], v[128:143]
  v_mfma_f32_32x32x16_bf16 v[144:159], v[176:179], v[164:167], v[144:159]
  s_waitcnt lgkmcnt(8)
  v_mfma_f32_32x32x16_bf16 v[64:79], v[188:191], v[180:183], v[64:79]
  ds_read_b64_tr_b16 v[228:229], v13 offset:6144
  ds_read_b64_tr_b16 v[230:231], v13 offset:7168
  v_mfma_f32_32x32x16_bf16 v[80:95], v[188:191], v[184:187], v[80:95]
  ds_read_b128 v[220:223], v3 offset:3072
  ds_read_b128 v[224:227], v3 offset:7168
  v_mfma_f32_32x32x16_bf16 v[96:111], v[192:195], v[180:183], v[96:111]
  ds_read_b64_tr_b16 v[232:233], v14 offset:6144
  ds_read_b64_tr_b16 v[234:235], v14 offset:7168
  v_mfma_f32_32x32x16_bf16 v[112:127], v[192:195], v[184:187], v[112:127]
  ds_read_b64_tr_b16 v[236:237], v15 offset:6144
  ds_read_b64_tr_b16 v[238:239], v15 offset:7168
  v_mfma_f32_32x32x16_bf16 v[128:143], v[196:199], v[180:183], v[128:143]
  s_add_u32 s28, s28, 40960
  s_cmp_ge_u32 s28, 163840
  s_cselect_b32 s28, 0, s28
  v_add_u32 v3, s28, v4
  v_mfma_f32_32x32x16_bf16 v[144:159], v[196:199], v[184:187], v[144:159]
  v_add_u32 v13, s28, v16
  v_add_u32 v14, s28, v17
  v_add_u32 v15, s28, v18
  s_waitcnt vmcnt(0) lgkmcnt(0)
  s_barrier
  v_mfma_f32_32x32x16_bf16 v[64:79], v[208:211], v[200:203], v[64:79]
  ds_read_b64_tr_b16 v[168:169], v13 offset:0
  ds_read_b64_tr_b16 v[170:171], v13 offset:1024
  v_mfma_f32_32x32x16_bf16 v[80:95], v[208:211], v[204:207], v[80:95]
  ds_read_b128 v[160:163], v3 offset:0
  ds_read_b128 v[164:167], v3 offset:4096
  v_mfma_f32_32x32x16_bf16 v[96:111], v[212:215], v[200:203], v[96:111]
  ds_read_b64_tr_b16 v[172:173], v14 offset:0
  ds_read_b64_tr_b16 v[174:175], v14 offset:1024
  v_mfma_f32_32x32x16_bf16 v[112:127], v[212:215], v[204:207], v[112:127]
  ds_read_b64_tr_b16 v[176:177], v15 offset:0
  ds_read_b64_tr_b16 v[178:179], v15 offset:1024
  v_mfma_f32_32x32x16_bf16 v[128:143], v[216:219], v[200:203], v[128:143]
  v_mfma_f32_32x32x16_bf16 v[144:159], v[216:219], v[204:207], v[144:159]
  v_mfma_f32_32x32x16_bf16 v[64:79], v[228:231], v[220:223], v[64:79]
  ds_read_b64_tr_b16 v[188:189], v13 offset:2048
  ds_read_b64_tr_b16 v[190:191], v13 offset:3072
  v_mfma_f32_32x32x16_bf16 v[80:95], v[228:231], v[224:227], v[80:95]
  ds_read_b128 v[180:183], v3 offset:1024
  ds_read_b128 v[184:187], v3 offset:5120
  v_mfma_f32_32x32x16_bf16 v[96:111], v[232:235], v[220:223], v[96:111]
  ds_read_b64_tr_b16 v[192:193], v14 offset:2048
  ds_read_b64_tr_b16 v[194:195], v14 offset:3072
  v_mfma_f32_32x32x16_bf16 v[112:127], v[232:235], v[224:227], v[112:127]
  ds_read_b64_tr_b16 v[196:197], v15 offset:2048
  ds_read_b64_tr_b16 v[198:199], v15 offset:3072
  v_mfma_f32_32x32x16_bf16 v[128:143], v[236:239], v[220:223], v[128:143]
  v_mfma_f32_32x32x16_bf16 v[144:159], v[236:239], v[224:227], v[144:159]
  s_waitcnt lgkmcnt(8)
  v_mfma_f32_32x32x16_bf16 v[64:79], v[168:171], v[160:163], v[64:79]
  ds_read_b64_tr_b16 v[208:209], v13 offset:4096
  ds_read_b64_tr_b16 v[210:211], v13 offset:5120
  v_mfma_f32_32x32x16_bf16 v[80:95], v[168:171], v[164:167], v[80:95]
  ds_read_b128 v[200:203], v3 offset:2048
  ds_read_b128 v[204:207], v3 offset:6144
  v_mfma_f32_32x32x16_bf16 v[96:111], v[172:175], v[160:163], v[96:111]
  ds_read_b64_tr_b16 v[212:213], v14 offset:4096
  ds_read_b64_tr_b16 v[214:215], v14 offset:5120
  v_mfma_f32_32x32x16_bf16 v[112:127], v[172:175], v[164:167], v[112:127]
  ds_read_b64_tr_b16 v[216:217], v15 offset:4096
  ds_read_b64_tr_b16 v[218:219], v15 offset:5120
  v_mfma_f32_32x32x16_bf16 v[128:143], v[176:179], v[160:163], v[128:143]
  v_mfma_f32_32x32x16_bf16 v[144:159], v[176:179], v[164:167], v[144:159]
  s_waitcnt lgkmcnt(8)
  v_mfma_f32_32x32x16_bf16 v[64:79], v[188:191], v[180:183], v[64:79]
  ds_read_b64_tr_b16 v[228:229], v13 offset:6144
  ds_read_b64_tr_b16 v[230:231], v13 offset:7168
  v_mfma_f32_32x32x16_bf16 v[80:95], v[188:191], v[184:187], v[80:95]
  ds_read_b128 v[220:223], v3 offset:3072
  ds_read_b128 v[224:227], v3 offset:7168
  v_mfma_f32_32x32x16_bf16 v[96:111], v[192:195], v[180:183], v[96:111]
  ds_read_b64_tr_b16 v[232:233], v14 offset:6144
  ds_read_b64_tr_b16 v[234:235], v14 offset:7168
  v_mfma_f32_32x32x16_bf16 v[112:127], v[192:195], v[184:187], v[112:127]
  ds_read_b64_tr_b16 v[236:237], v15 offset:6144
  ds_read_b64_tr_b16 v[238:239], v15 offset:7168
  v_mfma_f32_32x32x16_bf16 v[128:143], v[196:199], v[180:183], v[128:143]
  v_mfma_f32_32x32x16_bf16 v[144:159], v[196:199], v[184:187], v[144:159]
  s_waitcnt lgkmcnt(0)
  v_mfma_f32_32x32x16_bf16 v[64:79], v[208:211], v[200:203], v[64:79]
  v_mfma_f32_32x32x16_bf16 v[80:95], v[208:211], v[204:207], v[80:95]
  v_mfma_f32_32x32x16_bf16 v[96:111], v[212:215], v[200:203], v[96:111]
  v_mfma_f32_32x32x16_bf16 v[112:127], v[212:215], v[204:207], v[112:127]
  v_mfma_f32_32x32x16_bf16 v[128:143], v[216:219], v[200:203], v[128:143]
  v_mfma_f32_32x32x16_bf16 v[144:159], v[216:219], v[204:207], v[144:159]
  v_mfma_f32_32x32x16_bf16 v[64:79], v[228:231], v[220:223], v[64:79]
  v_mfma_f32_32x32x16_bf16 v[80:95], v[228:231], v[224:227], v[80:95]
  v_mfma_f32_32x32x16_bf16 v[96:111], v[232:235], v[220:223], v[96:111]
  v_mfma_f32_32x32x16_bf16 v[112:127], v[232:235], v[224:227], v[112:127]
  v_mfma_f32_32x32x16_bf16 v[128:143], v[236:239], v[220:223], v[128:143]
  v_mfma_f32_32x32x16_bf16 v[144:159], v[236:239], v[224:227], v[144:159]
  s_add_u32 s24, s84, 0x6000000
  s_addc_u32 s25, s85, 0
  s_mov_b32 s26, 0x2400000
  s_mov_b32 s27, 0x20000
  s_mov_b32 s16, s64
  s_mov_b32 s17, s65
  s_mov_b32 s18, 0x240000
  s_mov_b32 s19, 0x20000
  s_mov_b32 s20, s80
  s_mov_b32 s21, s81
  s_mov_b32 s22, 0x240000
  s_mov_b32 s23, 0x20000
  s_mul_i32 s30, s36, 3
  s_add_u32 s30, s30, s37
  s_mul_i32 s31, s30, 245760
  s_lshl_b32 s4, s3, 10
  s_add_u32 s31, s31, s4
  s_lshl_b32 s4, s36, 7
  s_and_b32 s5, s3, 1
  s_lshl_b32 s5, s5, 6
  s_add_u32 s4, s4, s5
  v_and_b32 v7, 31, v1
  v_add_u32 v7, s4, v7
  s_movk_i32 s5, 1152
  v_mul_lo_u32 v7, v7, s5
  s_mul_i32 s4, s37, 384
  s_lshr_b32 s5, s3, 1
  s_mul_i32 s5, s5, 192
  s_add_u32 s4, s4, s5
  v_add_u32 v7, s4, v7
  v_lshrrev_b32 v8, 5, v1
  v_lshl_add_u32 v10, v8, 3, v7
  v_lshl_add_u32 v11, v8, 4, v7
  s_nop 7
  s_cmp_lg_u32 s40, 0
  s_cbranch_scc1 LX_n0
  v_cvt_pk_bf16_f32 v160, v72, v73
  v_cvt_pk_bf16_f32 v161, v74, v75
  v_cvt_pk_bf16_f32 v162, v76, v77
  v_cvt_pk_bf16_f32 v163, v78, v79
  s_add_u32 s4, s31, 20480
  buffer_store_dwordx4 v[160:163], v2, s[24:27], s4 offen sc1
  v_cvt_pk_bf16_f32 v164, v80, v81
  v_cvt_pk_bf16_f32 v165, v82, v83
  v_cvt_pk_bf16_f32 v166, v84, v85
  v_cvt_pk_bf16_f32 v167, v86, v87
  s_add_u32 s4, s31, 40960
  buffer_store_dwordx4 v[164:167], v2, s[24:27], s4 offen sc1
  v_cvt_pk_bf16_f32 v168, v88, v89
  v_cvt_pk_bf16_f32 v169, v90, v91
  v_cvt_pk_bf16_f32 v170, v92, v93
  v_cvt_pk_bf16_f32 v171, v94, v95
  s_add_u32 s4, s31, 61440
  buffer_store_dwordx4 v[168:171], v2, s[24:27], s4 offen sc1
  v_cvt_pk_bf16_f32 v172, v96, v97
  v_cvt_pk_bf16_f32 v173, v98, v99
  v_cvt_pk_bf16_f32 v174, v100, v101
  v_cvt_pk_bf16_f32 v175, v102, v103
  s_add_u32 s4, s31, 81920
  buffer_store_dwordx4 v[172:175], v2, s[24:27], s4 offen sc1
  v_cvt_pk_bf16_f32 v176, v112, v113
  v_cvt_pk_bf16_f32 v177, v114, v115
  v_cvt_pk_bf16_f32 v178, v116, v117
  v_cvt_pk_bf16_f32 v179, v118, v119
  s_add_u32 s4, s31, 122880
  buffer_store_dwordx4 v[176:179], v2, s[24:27], s4 offen sc1
  v_cvt_pk_bf16_f32 v180, v120, v121
  v_cvt_pk_bf16_f32 v181, v122, v123
  v_cvt_pk_bf16_f32 v182, v124, v125
  v_cvt_pk_bf16_f32 v183, v126, v127
  s_add_u32 s4, s31, 143360
  buffer_store_dwordx4 v[180:183], v2, s[24:27], s4 offen sc1
  v_cvt_pk_bf16_f32 v184, v128, v129
  v_cvt_pk_bf16_f32 v185, v130, v131
  v_cvt_pk_bf16_f32 v186, v132, v133
  v_cvt_pk_bf16_f32 v187, v134, v135
  s_add_u32 s4, s31, 163840
  buffer_store_dwordx4 v[184:187], v2, s[24:27], s4 offen sc1
  v_cvt_pk_bf16_f32 v188, v136, v137
  v_cvt_pk_bf16_f32 v189, v138, v139
  v_cvt_pk_bf16_f32 v190, v140, v141
  v_cvt_pk_bf16_f32 v191, v142, v143
  s_add_u32 s4, s31, 184320
  buffer_store_dwordx4 v[188:191], v2, s[24:27], s4 offen sc1
  v_cvt_pk_bf16_f32 v160, v152, v153
  v_cvt_pk_bf16_f32 v161, v154, v155
  v_cvt_pk_bf16_f32 v162, v156, v157
  v_cvt_pk_bf16_f32 v163, v158, v159
  s_add_u32 s4, s31, 225280
  buffer_store_dwordx4 v[160:163], v2, s[24:27], s4 offen sc1
  s_mov_b32 s4, 0
  buffer_load_dwordx2 v[20:21], v10, s[16:19], s4 offen
  buffer_load_dwordx2 v[22:23], v10, s[16:19], s4 offen offset:16
  s_mov_b32 s4, 96
  buffer_load_dwordx2 v[24:25], v10, s[16:19], s4 offen
  buffer_load_dwordx2 v[26:27], v10, s[16:19], s4 offen offset:16
  s_mov_b32 s4, 36992
  buffer_load_dwordx2 v[52:53], v10, s[16:19], s4 offen
  buffer_load_dwordx2 v[54:55], v10, s[16:19], s4 offen offset:16
  s_waitcnt vmcnt(0)
  s_lshl_b32 s4, s30, 5
  s_add_u32 s4, s4, s3
  s_lshl_b32 s29, s4, 2
  s_add_u32 s29, s29, 5120
  v_mov_b32 v12, s88
  v_mov_b32 v13, 0
  s_mov_b64 exec, 1
  buffer_store_dword v12, v13, s[8:11], s29 offen sc1
  s_mov_b64 exec, -1
  v_min_u32 v19, 4, v1
  v_lshlrev_b32 v19, 4, v19
  buffer_load_dword v18, v19, s[8:11], s29 offen sc1
  s_mov_b32 s33, 0xffff0000
  v_lshlrev_b32 v56, 16, v20
  v_and_b32 v57, s33, v20
  v_lshlrev_b32 v58, 16, v21
  v_and_b32 v59, s33, v21
  v_lshlrev_b32 v60, 16, v22
  v_and_b32 v61, s33, v22
  v_lshlrev_b32 v62, 16, v23
  v_and_b32 v63, s33, v23
  v_add_f32 v64, v56, v64
  v_add_f32 v65, v57, v65
  v_add_f32 v66, v58, v66
  v_add_f32 v67, v59, v67
  v_add_f32 v68, v60, v68
  v_add_f32 v69, v61, v69
  v_add_f32 v70, v62, v70
  v_add_f32 v71, v63, v71
  v_lshlrev_b32 v56, 16, v24
  v_and_b32 v57, s33, v24
  v_lshlrev_b32 v58, 16, v25
  v_and_b32 v59, s33, v25
  v_lshlrev_b32 v60, 16, v26
  v_and_b32 v61, s33, v26
  v_lshlrev_b32 v62, 16, v27
  v_and_b32 v63, s33, v27
  v_add_f32 v104, v56, v104
  v_add_f32 v105, v57, v105
  v_add_f32 v106, v58, v106
  v_add_f32 v107, v59, v107
  v_add_f32 v108, v60, v108
  v_add_f32 v109, v61, v109
  v_add_f32 v110, v62, v110
  v_add_f32 v111, v63, v111
  v_lshlrev_b32 v56, 16, v52
  v_and_b32 v57, s33, v52
  v_lshlrev_b32 v58, 16, v53
  v_and_b32 v59, s33, v53
  v_lshlrev_b32 v60, 16, v54
  v_and_b32 v61, s33, v54
  v_lshlrev_b32 v62, 16, v55
  v_and_b32 v63, s33, v55
  v_add_f32 v144, v56, v144
  v_add_f32 v145, v57, v145
  v_add_f32 v146, v58, v146
  v_add_f32 v147, v59, v147
  v_add_f32 v148, v60, v148
  v_add_f32 v149, v61, v149
  v_add_f32 v150, v62, v150
  v_add_f32 v151, v63, v151
  s_waitcnt vmcnt(0)
  s_mov_b32 s6, 0x1e
  s_mov_b32 s7, 0
  s_mov_b32 s5, 100000
LFL6:
  v_cmp_ne_u32 vcc, s88, v18
  s_nop 1
  s_and_b64 vcc, vcc, s[6:7]
  s_cbranch_vccz LFL6_ok
  s_sub_u32 s5, s5, 1
  s_cmp_eq_u32 s5, 0
  s_cbranch_scc1 LFL6_ok
  s_sleep 1
  buffer_load_dword v18, v19, s[8:11], s29 offen sc1
  s_waitcnt vmcnt(0)
  s_branch LFL6
LFL6_ok:
  s_add_u32 s4, s31, 4096
  buffer_load_dwordx4 v[160:163], v2, s[24:27], s4 offen sc1
  s_add_u32 s4, s31, 8192
  buffer_load_dwordx4 v[164:167], v2, s[24:27], s4 offen sc1
  s_add_u32 s4, s31, 12288
  buffer_load_dwordx4 v[168:171], v2, s[24:27], s4 offen sc1
  s_add_u32 s4, s31, 16384
  buffer_load_dwordx4 v[172:175], v2, s[24:27], s4 offen sc1
  s_add_u32 s4, s31, 106496
  buffer_load_dwordx4 v[176:179], v2, s[24:27], s4 offen sc1
  s_add_u32 s4, s31, 110592
  buffer_load_dwordx4 v[180:183], v2, s[24:27], s4 offen sc1
  s_add_u32 s4, s31, 114688
  buffer_load_dwordx4 v[184:187], v2, s[24:27], s4 offen sc1
  s_add_u32 s4, s31, 118784
  buffer_load_dwordx4 v[188:191], v2, s[24:27], s4 offen sc1
  s_add_u32 s4, s31, 208896
  buffer_load_dwordx4 v[192:195], v2, s[24:27], s4 offen sc1
  s_add_u32 s4, s31, 212992
  buffer_load_dwordx4 v[196:199], v2, s[24:27], s4 offen sc1
  s_add_u32 s4, s31, 217088
  buffer_load_dwordx4 v[200:203], v2, s[24:27], s4 offen sc1
  s_add_u32 s4, s31, 221184
  buffer_load_dwordx4 v[204:207], v2, s[24:27], s4 offen sc1
  s_mov_b32 s5, 0xffff0000
  s_waitcnt vmcnt(8)
  v_lshlrev_b32 v56, 16, v160
  v_and_b32 v57, s5, v160
  v_lshlrev_b32 v58, 16, v161
  v_and_b32 v59, s5, v161
  v_lshlrev_b32 v60, 16, v162
  v_and_b32 v61, s5, v162
  v_lshlrev_b32 v62, 16, v163
  v_and_b32 v63, s5, v163
  v_add_f32 v64, v64, v56
  v_add_f32 v65, v65, v57
  v_add_f32 v66, v66, v58
  v_add_f32 v67, v67, v59
  v_add_f32 v68, v68, v60
  v_add_f32 v69, v69, v61
  v_add_f32 v70, v70, v62
  v_add_f32 v71, v71, v63
  v_lshlrev_b32 v56, 16, v164
  v_and_b32 v57, s5, v164
  v_lshlrev_b32 v58, 16, v165
  v_and_b32 v59, s5, v165
  v_lshlrev_b32 v60, 16, v166
  v_and_b32 v61, s5, v166
  v_lshlrev_b32 v62, 16, v167
  v_and_b32 v63, s5, v167
  v_add_f32 v64, v64, v56
  v_add_f32 v65, v65, v57
  v_add_f32 v66, v66, v58
  v_add_f32 v67, v67, v59
  v_add_f32 v68, v68, v60
  v_add_f32 v69, v69, v61
  v_add_f32 v70, v70, v62
  v_add_f32 v71, v71, v63
  v_lshlrev_b32 v56, 16, v168
  v_and_b32 v57, s5, v168
  v_lshlrev_b32 v58, 16, v169
  v_and_b32 v59, s5, v169
  v_lshlrev_b32 v60, 16, v170
  v_and_b32 v61, s5, v170
  v_lshlrev_b32 v62, 16, v171
  v_and_b32 v63, s5, v171
  v_add_f32 v64, v64, v56
  v_add_f32 v65, v65, v57
  v_add_f32 v66, v66, v58
  v_add_f32 v67, v67, v59
  v_add_f32 v68, v68, v60
  v_add_f32 v69, v69, v61
  v_add_f32 v70, v70, v62
  v_add_f32 v71, v71, v63
  v_lshlrev_b32 v56, 16, v172
  v_and_b32 v57, s5, v172
  v_lshlrev_b32 v58, 16, v173
  v_and_b32 v59, s5, v173
  v_lshlrev_b32 v60, 16, v174
  v_and_b32 v61, s5, v174
  v_lshlrev_b32 v62, 16, v175
  v_and_b32 v63, s5, v175
  v_add_f32 v64, v64, v56
  v_add_f32 v65, v65, v57
  v_add_f32 v66, v66, v58
  v_add_f32 v67, v67, v59
  v_add_f32 v68, v68, v60
  v_add_f32 v69, v69, v61
  v_add_f32 v70, v70, v62
  v_add_f32 v71, v71, v63
  v_cvt_pk_bf16_f32 v40, v64, v65
  v_cvt_pk_bf16_f32 v41, v66, v67
  v_cvt_pk_bf16_f32 v42, v68, v69
  v_cvt_pk_bf16_f32 v43, v70, v71
  s_nop 1
  v_permlane32_swap_b32 v40, v42
  v_permlane32_swap_b32 v41, v43
  s_mov_b32 s4, 0
  buffer_store_dwordx4 v[40:43], v11, s[20:23], s4 offen
  s_waitcnt vmcnt(5)
  v_lshlrev_b32 v56, 16, v176
  v_and_b32 v57, s5, v176
  v_lshlrev_b32 v58, 16, v177
  v_and_b32 v59, s5, v177
  v_lshlrev_b32 v60, 16, v178
  v_and_b32 v61, s5, v178
  v_lshlrev_b32 v62, 16, v179
  v_and_b32 v63, s5, v179
  v_add_f32 v104, v104, v56
  v_add_f32 v105, v105, v57
  v_add_f32 v106, v106, v58
  v_add_f32 v107, v107, v59
  v_add_f32 v108, v108, v60
  v_add_f32 v109, v109, v61
  v_add_f32 v110, v110, v62
  v_add_f32 v111, v111, v63
  v_lshlrev_b32 v56, 16, v180
  v_and_b32 v57, s5, v180
  v_lshlrev_b32 v58, 16, v181
  v_and_b32 v59, s5, v181
  v_lshlrev_b32 v60, 16, v182
  v_and_b32 v61, s5, v182
  v_lshlrev_b32 v62, 16, v183
  v_and_b32 v63, s5, v183
  v_add_f32 v104, v104, v56
  v_add_f32 v105, v105, v57
  v_add_f32 v106, v106, v58
  v_add_f32 v107, v107, v59
  v_add_f32 v108, v108, v60
  v_add_f32 v109, v109, v61
  v_add_f32 v110, v110, v62
  v_add_f32 v111, v111, v63
  v_lshlrev_b32 v56, 16, v184
  v_and_b32 v57, s5, v184
  v_lshlrev_b32 v58, 16, v185
  v_and_b32 v59, s5, v185
  v_lshlrev_b32 v60, 16, v186
  v_and_b32 v61, s5, v186
  v_lshlrev_b32 v62, 16, v187
  v_and_b32 v63, s5, v187
  v_add_f32 v104, v104, v56
  v_add_f32 v105, v105, v57
  v_add_f32 v106, v106, v58
  v_add_f32 v107, v107, v59
  v_add_f32 v108, v108, v60
  v_add_f32 v109, v109, v61
  v_add_f32 v110, v110, v62
  v_add_f32 v111, v111, v63
  v_lshlrev_b32 v56, 16, v188
  v_and_b32 v57, s5, v188
  v_lshlrev_b32 v58, 16, v189
  v_and_b32 v59, s5, v189
  v_lshlrev_b32 v60, 16, v190
  v_and_b32 v61, s5, v190
  v_lshlrev_b32 v62, 16, v191
  v_and_b32 v63, s5, v191
  v_add_f32 v104, v104, v56
  v_add_f32 v105, v105, v57
  v_add_f32 v106, v106, v58
  v_add_f32 v107, v107, v59
  v_add_f32 v108, v108, v60
  v_add_f32 v109, v109, v61
  v_add_f32 v110, v110, v62
  v_add_f32 v111, v111, v63
  v_cvt_pk_bf16_f32 v44, v104, v105
  v_cvt_pk_bf16_f32 v45, v106, v107
  v_cvt_pk_bf16_f32 v46, v108, v109
  v_cvt_pk_bf16_f32 v47, v110, v111
  s_nop 1
  v_permlane32_swap_b32 v44, v46
  v_permlane32_swap_b32 v45, v47
  s_mov_b32 s4, 96
  buffer_store_dwordx4 v[44:47], v11, s[20:23], s4 offen
  s_waitcnt vmcnt(2)
  v_lshlrev_b32 v56, 16, v192
  v_and_b32 v57, s5, v192
  v_lshlrev_b32 v58, 16, v193
  v_and_b32 v59, s5, v193
  v_lshlrev_b32 v60, 16, v194
  v_and_b32 v61, s5, v194
  v_lshlrev_b32 v62, 16, v195
  v_and_b32 v63, s5, v195
  v_add_f32 v144, v144, v56
  v_add_f32 v145, v145, v57
  v_add_f32 v146, v146, v58
  v_add_f32 v147, v147, v59
  v_add_f32 v148, v148, v60
  v_add_f32 v149, v149, v61
  v_add_f32 v150, v150, v62
  v_add_f32 v151, v151, v63
  v_lshlrev_b32 v56, 16, v196
  v_and_b32 v57, s5, v196
  v_lshlrev_b32 v58, 16, v197
  v_and_b32 v59, s5, v197
  v_lshlrev_b32 v60, 16, v198
  v_and_b32 v61, s5, v198
  v_lshlrev_b32 v62, 16, v199
  v_and_b32 v63, s5, v199
  v_add_f32 v144, v144, v56
  v_add_f32 v145, v145, v57
  v_add_f32 v146, v146, v58
  v_add_f32 v147, v147, v59
  v_add_f32 v148, v148, v60
  v_add_f32 v149, v149, v61
  v_add_f32 v150, v150, v62
  v_add_f32 v151, v151, v63
  v_lshlrev_b32 v56, 16, v200
  v_and_b32 v57, s5, v200
  v_lshlrev_b32 v58, 16, v201
  v_and_b32 v59, s5, v201
  v_lshlrev_b32 v60, 16, v202
  v_and_b32 v61, s5, v202
  v_lshlrev_b32 v62, 16, v203
  v_and_b32 v63, s5, v203
  v_add_f32 v144, v144, v56
  v_add_f32 v145, v145, v57
  v_add_f32 v146, v146, v58
  v_add_f32 v147, v147, v59
  v_add_f32 v148, v148, v60
  v_add_f32 v149, v149, v61
  v_add_f32 v150, v150, v62
  v_add_f32 v151, v151, v63
  v_lshlrev_b32 v56, 16, v204
  v_and_b32 v57, s5, v204
  v_lshlrev_b32 v58, 16, v205
  v_and_b32 v59, s5, v205
  v_lshlrev_b32 v60, 16, v206
  v_and_b32 v61, s5, v206
  v_lshlrev_b32 v62, 16, v207
  v_and_b32 v63, s5, v207
  v_add_f32 v144, v144, v56
  v_add_f32 v145, v145, v57
  v_add_f32 v146, v146, v58
  v_add_f32 v147, v147, v59
  v_add_f32 v148, v148, v60
  v_add_f32 v149, v149, v61
  v_add_f32 v150, v150, v62
  v_add_f32 v151, v151, v63
  v_cvt_pk_bf16_f32 v48, v144, v145
  v_cvt_pk_bf16_f32 v49, v146, v147
  v_cvt_pk_bf16_f32 v50, v148, v149
  v_cvt_pk_bf16_f32 v51, v150, v151
  s_nop 1
  v_permlane32_swap_b32 v48, v50
  v_permlane32_swap_b32 v49, v51
  s_mov_b32 s4, 36992
  buffer_store_dwordx4 v[48:51], v11, s[20:23], s4 offen
  s_branch L_end
LX_n0:
  s_cmp_lg_u32 s40, 1
  s_cbranch_scc1 LX_n1
  v_cvt_pk_bf16_f32 v160, v64, v65
  v_cvt_pk_bf16_f32 v161, v66, v67
  v_cvt_pk_bf16_f32 v162, v68, v69
  v_cvt_pk_bf16_f32 v163, v70, v71
  s_add_u32 s4, s31, 4096
  buffer_store_dwordx4 v[160:163], v2, s[24:27], s4 offen sc1
  v_cvt_pk_bf16_f32 v164, v80, v81
  v_cvt_pk_bf16_f32 v165, v82, v83
  v_cvt_pk_bf16_f32 v166, v84, v85
  v_cvt_pk_bf16_f32 v167, v86, v87
  s_add_u32 s4, s31, 45056
  buffer_store_dwordx4 v[164:167], v2, s[24:27], s4 offen sc1
  v_cvt_pk_bf16_f32 v168, v88, v89
  v_cvt_pk_bf16_f32 v169, v90, v91
  v_cvt_pk_bf16_f32 v170, v92, v93
  v_cvt_pk_bf16_f32 v171, v94, v95
  s_add_u32 s4, s31, 65536
  buffer_store_dwordx4 v[168:171], v2, s[24:27], s4 offen sc1
  v_cvt_pk_bf16_f32 v172, v96, v97
  v_cvt_pk_bf16_f32 v173, v98, v99
  v_cvt_pk_bf16_f32 v174, v100, v101
  v_cvt_pk_bf16_f32 v175, v102, v103
  s_add_u32 s4, s31, 86016
  buffer_store_dwordx4 v[172:175], v2, s[24:27], s4 offen sc1
  v_cvt_pk_bf16_f32 v176, v104, v105
  v_cvt_pk_bf16_f32 v177, v106, v107
  v_cvt_pk_bf16_f32 v178, v108, v109
  v_cvt_pk_bf16_f32 v179, v110, v111
  s_add_u32 s4, s31, 106496
  buffer_store_dwordx4 v[176:179], v2, s[24:27], s4 offen sc1
  v_cvt_pk_bf16_f32 v180, v120, v121
  v_cvt_pk_bf16_f32 v181, v122, v123
  v_cvt_pk_bf16_f32 v182, v124, v125
  v_cvt_pk_bf16_f32 v183, v126, v127
  s_add_u32 s4, s31, 147456
  buffer_store_dwordx4 v[180:183], v2, s[24:27], s4 offen sc1
  v_cvt_pk_bf16_f32 v184, v128, v129
  v_cvt_pk_bf16_f32 v185, v130, v131
  v_cvt_pk_bf16_f32 v186, v132, v133
  v_cvt_pk_bf16_f32 v187, v134, v135
  s_add_u32 s4, s31, 167936
  buffer_store_dwordx4 v[184:187], v2, s[24:27], s4 offen sc1
  v_cvt_pk_bf16_f32 v188, v136, v137
  v_cvt_pk_bf16_f32 v189, v138, v139
  v_cvt_pk_bf16_f32 v190, v140, v141
  v_cvt_pk_bf16_f32 v191, v142, v143
  s_add_u32 s4, s31, 188416
  buffer_store_dwordx4 v[188:191], v2, s[24:27], s4 offen sc1
  v_cvt_pk_bf16_f32 v160, v144, v145
  v_cvt_pk_bf16_f32 v161, v146, v147
  v_cvt_pk_bf16_f32 v162, v148, v149
  v_cvt_pk_bf16_f32 v163, v150, v151
  s_add_u32 s4, s31, 208896
  buffer_store_dwordx4 v[160:163], v2, s[24:27], s4 offen sc1
  s_mov_b32 s4, 32
  buffer_load_dwordx2 v[20:21], v10, s[16:19], s4 offen
  buffer_load_dwordx2 v[22:23], v10, s[16:19], s4 offen offset:16
  s_mov_b32 s4, 36928
  buffer_load_dwordx2 v[24:25], v10, s[16:19], s4 offen
  buffer_load_dwordx2 v[26:27], v10, s[16:19], s4 offen offset:16
  s_mov_b32 s4, 37024
  buffer_load_dwordx2 v[52:53], v10, s[16:19], s4 offen
  buffer_load_dwordx2 v[54:55], v10, s[16:19], s4 offen offset:16
  s_waitcnt vmcnt(0)
  s_lshl_b32 s4, s30, 5
  s_add_u32 s4, s4, s3
  s_lshl_b32 s29, s4, 2
  s_add_u32 s29, s29, 5120
  v_mov_b32 v12, s88
  v_mov_b32 v13, 16
  s_mov_b64 exec, 1
  buffer_store_dword v12, v13, s[8:11], s29 offen sc1
  s_mov_b64 exec, -1
  v_min_u32 v19, 4, v1
  v_lshlrev_b32 v19, 4, v19
  buffer_load_dword v18, v19, s[8:11], s29 offen sc1
  s_mov_b32 s33, 0xffff0000
  v_lshlrev_b32 v56, 16, v20
  v_and_b32 v57, s33, v20
  v_lshlrev_b32 v58, 16, v21
  v_and_b32 v59, s33, v21
  v_lshlrev_b32 v60, 16, v22
  v_and_b32 v61, s33, v22
  v_lshlrev_b32 v62, 16, v23
  v_and_b32 v63, s33, v23
  v_add_f32 v72, v56, v72
  v_add_f32 v73, v57, v73
  v_add_f32 v74, v58, v74
  v_add_f32 v75, v59, v75
  v_add_f32 v76, v60, v76
  v_add_f32 v77, v61, v77
  v_add_f32 v78, v62, v78
  v_add_f32 v79, v63, v79
  v_lshlrev_b32 v56, 16, v24
  v_and_b32 v57, s33, v24
  v_lshlrev_b32 v58, 16, v25
  v_and_b32 v59, s33, v25
  v_lshlrev_b32 v60, 16, v26
  v_and_b32 v61, s33, v26
  v_lshlrev_b32 v62, 16, v27
  v_and_b32 v63, s33, v27
  v_add_f32 v112, v56, v112
  v_add_f32 v113, v57, v113
  v_add_f32 v114, v58, v114
  v_add_f32 v115, v59, v115
  v_add_f32 v116, v60, v116
  v_add_f32 v117, v61, v117
  v_add_f32 v118, v62, v118
  v_add_f32 v119, v63, v119
  v_lshlrev_b32 v56, 16, v52
  v_and_b32 v57, s33, v52
  v_lshlrev_b32 v58, 16, v53
  v_and_b32 v59, s33, v53
  v_lshlrev_b32 v60, 16, v54
  v_and_b32 v61, s33, v54
  v_lshlrev_b32 v62, 16, v55
  v_and_b32 v63, s33, v55
  v_add_f32 v152, v56, v152
  v_add_f32 v153, v57, v153
  v_add_f32 v154, v58, v154
  v_add_f32 v155, v59, v155
  v_add_f32 v156, v60, v156
  v_add_f32 v157, v61, v157
  v_add_f32 v158, v62, v158
  v_add_f32 v159, v63, v159
  s_waitcnt vmcnt(0)
  s_mov_b32 s6, 0x1d
  s_mov_b32 s7, 0
  s_mov_b32 s5, 100000
LFL7:
  v_cmp_ne_u32 vcc, s88, v18
  s_nop 1
  s_and_b64 vcc, vcc, s[6:7]
  s_cbranch_vccz LFL7_ok
  s_sub_u32 s5, s5, 1
  s_cmp_eq_u32 s5, 0
  s_cbranch_scc1 LFL7_ok
  s_sleep 1
  buffer_load_dword v18, v19, s[8:11], s29 offen sc1
  s_waitcnt vmcnt(0)
  s_branch LFL7
LFL7_ok:
  s_add_u32 s4, s31, 20480
  buffer_load_dwordx4 v[160:163], v2, s[24:27], s4 offen sc1
  s_add_u32 s4, s31, 28672
  buffer_load_dwordx4 v[164:167], v2, s[24:27], s4 offen sc1
  s_add_u32 s4, s31, 32768
  buffer_load_dwordx4 v[168:171], v2, s[24:27], s4 offen sc1
  s_add_u32 s4, s31, 36864
  buffer_load_dwordx4 v[172:175], v2, s[24:27], s4 offen sc1
  s_add_u32 s4, s31, 122880
  buffer_load_dwordx4 v[176:179], v2, s[24:27], s4 offen sc1
  s_add_u32 s4, s31, 131072
  buffer_load_dwordx4 v[180:183], v2, s[24:27], s4 offen sc1
  s_add_u32 s4, s31, 135168
  buffer_load_dwordx4 v[184:187], v2, s[24:27], s4 offen sc1
  s_add_u32 s4, s31, 139264
  buffer_load_dwordx4 v[188:191], v2, s[24:27], s4 offen sc1
  s_add_u32 s4, s31, 225280
  buffer_load_dwordx4 v[192:195], v2, s[24:27], s4 offen sc1
  s_add_u32 s4, s31, 233472
  buffer_load_dwordx4 v[196:199], v2, s[24:27], s4 offen sc1
  s_add_u32 s4, s31, 237568
  buffer_load_dwordx4 v[200:203], v2, s[24:27], s4 offen sc1
  s_add_u32 s4, s31, 241664
  buffer_load_dwordx4 v[204:207], v2, s[24:27], s4 offen sc1
  s_mov_b32 s5, 0xffff0000
  s_waitcnt vmcnt(8)
  v_lshlrev_b32 v56, 16, v160
  v_and_b32 v57, s5, v160
  v_lshlrev_b32 v58, 16, v161
  v_and_b32 v59, s5, v161
  v_lshlrev_b32 v60, 16, v162
  v_and_b32 v61, s5, v162
  v_lshlrev_b32 v62, 16, v163
  v_and_b32 v63, s5, v163
  v_add_f32 v72, v72, v56
  v_add_f32 v73, v73, v57
  v_add_f32 v74, v74, v58
  v_add_f32 v75, v75, v59
  v_add_f32 v76, v76, v60
  v_add_f32 v77, v77, v61
  v_add_f32 v78, v78, v62
  v_add_f32 v79, v79, v63
  v_lshlrev_b32 v56, 16, v164
  v_and_b32 v57, s5, v164
  v_lshlrev_b32 v58, 16, v165
  v_and_b32 v59, s5, v165
  v_lshlrev_b32 v60, 16, v166
  v_and_b32 v61, s5, v166
  v_lshlrev_b32 v62, 16, v167
  v_and_b32 v63, s5, v167
  v_add_f32 v72, v72, v56
  v_add_f32 v73, v73, v57
  v_add_f32 v74, v74, v58
  v_add_f32 v75, v75, v59
  v_add_f32 v76, v76, v60
  v_add_f32 v77, v77, v61
  v_add_f32 v78, v78, v62
  v_add_f32 v79, v79, v63
  v_lshlrev_b32 v56, 16, v168
  v_and_b32 v57, s5, v168
  v_lshlrev_b32 v58, 16, v169
  v_and_b32 v59, s5, v169
  v_lshlrev_b32 v60, 16, v170
  v_and_b32 v61, s5, v170
  v_lshlrev_b32 v62, 16, v171
  v_and_b32 v63, s5, v171
  v_add_f32 v72, v72, v56
  v_add_f32 v73, v73, v57
  v_add_f32 v74, v74, v58
  v_add_f32 v75, v75, v59
  v_add_f32 v76, v76, v60
  v_add_f32 v77, v77, v61
  v_add_f32 v78, v78, v62
  v_add_f32 v79, v79, v63
  v_lshlrev_b32 v56, 16, v172
  v_and_b32 v57, s5, v172
  v_lshlrev_b32 v58, 16, v173
  v_and_b32 v59, s5, v173
  v_lshlrev_b32 v60, 16, v174
  v_and_b32 v61, s5, v174
  v_lshlrev_b32 v62, 16, v175
  v_and_b32 v63, s5, v175
  v_add_f32 v72, v72, v56
  v_add_f32 v73, v73, v57
  v_add_f32 v74, v74, v58
  v_add_f32 v75, v75, v59
  v_add_f32 v76, v76, v60
  v_add_f32 v77, v77, v61
  v_add_f32 v78, v78, v62
  v_add_f32 v79, v79, v63
  v_cvt_pk_bf16_f32 v40, v72, v73
  v_cvt_pk_bf16_f32 v41, v74, v75
  v_cvt_pk_bf16_f32 v42, v76, v77
  v_cvt_pk_bf16_f32 v43, v78, v79
  s_nop 1
  v_permlane32_swap_b32 v40, v42
  v_permlane32_swap_b32 v41, v43
  s_mov_b32 s4, 32
  buffer_store_dwordx4 v[40:43], v11, s[20:23], s4 offen
  s_waitcnt vmcnt(5)
  v_lshlrev_b32 v56, 16, v176
  v_and_b32 v57, s5, v176
  v_lshlrev_b32 v58, 16, v177
  v_and_b32 v59, s5, v177
  v_lshlrev_b32 v60, 16, v178
  v_and_b32 v61, s5, v178
  v_lshlrev_b32 v62, 16, v179
  v_and_b32 v63, s5, v179
  v_add_f32 v112, v112, v56
  v_add_f32 v113, v113, v57
  v_add_f32 v114, v114, v58
  v_add_f32 v115, v115, v59
  v_add_f32 v116, v116, v60
  v_add_f32 v117, v117, v61
  v_add_f32 v118, v118, v62
  v_add_f32 v119, v119, v63
  v_lshlrev_b32 v56, 16, v180
  v_and_b32 v57, s5, v180
  v_lshlrev_b32 v58, 16, v181
  v_and_b32 v59, s5, v181
  v_lshlrev_b32 v60, 16, v182
  v_and_b32 v61, s5, v182
  v_lshlrev_b32 v62, 16, v183
  v_and_b32 v63, s5, v183
  v_add_f32 v112, v112, v56
  v_add_f32 v113, v113, v57
  v_add_f32 v114, v114, v58
  v_add_f32 v115, v115, v59
  v_add_f32 v116, v116, v60
  v_add_f32 v117, v117, v61
  v_add_f32 v118, v118, v62
  v_add_f32 v119, v119, v63
  v_lshlrev_b32 v56, 16, v184
  v_and_b32 v57, s5, v184
  v_lshlrev_b32 v58, 16, v185
  v_and_b32 v59, s5, v185
  v_lshlrev_b32 v60, 16, v186
  v_and_b32 v61, s5, v186
  v_lshlrev_b32 v62, 16, v187
  v_and_b32 v63, s5, v187
  v_add_f32 v112, v112, v56
  v_add_f32 v113, v113, v57
  v_add_f32 v114, v114, v58
  v_add_f32 v115, v115, v59
  v_add_f32 v116, v116, v60
  v_add_f32 v117, v117, v61
  v_add_f32 v118, v118, v62
  v_add_f32 v119, v119, v63
  v_lshlrev_b32 v56, 16, v188
  v_and_b32 v57, s5, v188
  v_lshlrev_b32 v58, 16, v189
  v_and_b32 v59, s5, v189
  v_lshlrev_b32 v60, 16, v190
  v_and_b32 v61, s5, v190
  v_lshlrev_b32 v62, 16, v191
  v_and_b32 v63, s5, v191
  v_add_f32 v112, v112, v56
  v_add_f32 v113, v113, v57
  v_add_f32 v114, v114, v58
  v_add_f32 v115, v115, v59
  v_add_f32 v116, v116, v60
  v_add_f32 v117, v117, v61
  v_add_f32 v118, v118, v62
  v_add_f32 v119, v119, v63
  v_cvt_pk_bf16_f32 v44, v112, v113
  v_cvt_pk_bf16_f32 v45, v114, v115
  v_cvt_pk_bf16_f32 v46, v116, v117
  v_cvt_pk_bf16_f32 v47, v118, v119
  s_nop 1
  v_permlane32_swap_b32 v44, v46
  v_permlane32_swap_b32 v45, v47
  s_mov_b32 s4, 36928
  buffer_store_dwordx4 v[44:47], v11, s[20:23], s4 offen
  s_waitcnt vmcnt(2)
  v_lshlrev_b32 v56, 16, v192
  v_and_b32 v57, s5, v192
  v_lshlrev_b32 v58, 16, v193
  v_and_b32 v59, s5, v193
  v_lshlrev_b32 v60, 16, v194
  v_and_b32 v61, s5, v194
  v_lshlrev_b32 v62, 16, v195
  v_and_b32 v63, s5, v195
  v_add_f32 v152, v152, v56
  v_add_f32 v153, v153, v57
  v_add_f32 v154, v154, v58
  v_add_f32 v155, v155, v59
  v_add_f32 v156, v156, v60
  v_add_f32 v157, v157, v61
  v_add_f32 v158, v158, v62
  v_add_f32 v159, v159, v63
  v_lshlrev_b32 v56, 16, v196
  v_and_b32 v57, s5, v196
  v_lshlrev_b32 v58, 16, v197
  v_and_b32 v59, s5, v197
  v_lshlrev_b32 v60, 16, v198
  v_and_b32 v61, s5, v198
  v_lshlrev_b32 v62, 16, v199
  v_and_b32 v63, s5, v199
  v_add_f32 v152, v152, v56
  v_add_f32 v153, v153, v57
  v_add_f32 v154, v154, v58
  v_add_f32 v155, v155, v59
  v_add_f32 v156, v156, v60
  v_add_f32 v157, v157, v61
  v_add_f32 v158, v158, v62
  v_add_f32 v159, v159, v63
  v_lshlrev_b32 v56, 16, v200
  v_and_b32 v57, s5, v200
  v_lshlrev_b32 v58, 16, v201
  v_and_b32 v59, s5, v201
  v_lshlrev_b32 v60, 16, v202
  v_and_b32 v61, s5, v202
  v_lshlrev_b32 v62, 16, v203
  v_and_b32 v63, s5, v203
  v_add_f32 v152, v152, v56
  v_add_f32 v153, v153, v57
  v_add_f32 v154, v154, v58
  v_add_f32 v155, v155, v59
  v_add_f32 v156, v156, v60
  v_add_f32 v157, v157, v61
  v_add_f32 v158, v158, v62
  v_add_f32 v159, v159, v63
  v_lshlrev_b32 v56, 16, v204
  v_and_b32 v57, s5, v204
  v_lshlrev_b32 v58, 16, v205
  v_and_b32 v59, s5, v205
  v_lshlrev_b32 v60, 16, v206
  v_and_b32 v61, s5, v206
  v_lshlrev_b32 v62, 16, v207
  v_and_b32 v63, s5, v207
  v_add_f32 v152, v152, v56
  v_add_f32 v153, v153, v57
  v_add_f32 v154, v154, v58
  v_add_f32 v155, v155, v59
  v_add_f32 v156, v156, v60
  v_add_f32 v157, v157, v61
  v_add_f32 v158, v158, v62
  v_add_f32 v159, v159, v63
  v_cvt_pk_bf16_f32 v48, v152, v153
  v_cvt_pk_bf16_f32 v49, v154, v155
  v_cvt_pk_bf16_f32 v50, v156, v157
  v_cvt_pk_bf16_f32 v51, v158, v159
  s_nop 1
  v_permlane32_swap_b32 v48, v50
  v_permlane32_swap_b32 v49, v51
  s_mov_b32 s4, 37024
  buffer_store_dwordx4 v[48:51], v11, s[20:23], s4 offen
  s_branch L_end
LX_n1:
  s_cmp_lg_u32 s40, 2
  s_cbranch_scc1 LX_n2
  v_cvt_pk_bf16_f32 v160, v64, v65
  v_cvt_pk_bf16_f32 v161, v66, v67
  v_cvt_pk_bf16_f32 v162, v68, v69
  v_cvt_pk_bf16_f32 v163, v70, v71
  s_add_u32 s4, s31, 8192
  buffer_store_dwordx4 v[160:163], v2, s[24:27], s4 offen sc1
  v_cvt_pk_bf16_f32 v164, v72, v73
  v_cvt_pk_bf16_f32 v165, v74, v75
  v_cvt_pk_bf16_f32 v166, v76, v77
  v_cvt_pk_bf16_f32 v167, v78, v79
  s_add_u32 s4, s31, 28672
  buffer_store_dwordx4 v[164:167], v2, s[24:27], s4 offen sc1
  v_cvt_pk_bf16_f32 v168, v88, v89
  v_cvt_pk_bf16_f32 v169, v90, v91
  v_cvt_pk_bf16_f32 v170, v92, v93
  v_cvt_pk_bf16_f32 v171, v94, v95
  s_add_u32 s4, s31, 69632
  buffer_store_dwordx4 v[168:171], v2, s[24:27], s4 offen sc1
  v_cvt_pk_bf16_f32 v172, v96, v97
  v_cvt_pk_bf16_f32 v173, v98, v99
  v_cvt_pk_bf16_f32 v174, v100, v101
  v_cvt_pk_bf16_f32 v175, v102, v103
  s_add_u32 s4, s31, 90112
  buffer_store_dwordx4 v[172:175], v2, s[24:27], s4 offen sc1
  v_cvt_pk_bf16_f32 v176, v104, v105
  v_cvt_pk_bf16_f32 v177, v106, v107
  v_cvt_pk_bf16_f32 v178, v108, v109
  v_cvt_pk_bf16_f32 v179, v110, v111
  s_add_u32 s4, s31, 110592
  buffer_store_dwordx4 v[176:179], v2, s[24:27], s4 offen sc1
  v_cvt_pk_bf16_f32 v180, v112, v113
  v_cvt_pk_bf16_f32 v181, v114, v115
  v_cvt_pk_bf16_f32 v182, v116, v117
  v_cvt_pk_bf16_f32 v183, v118, v119
  s_add_u32 s4, s31, 131072
  buffer_store_dwordx4 v[180:183], v2, s[24:27], s4 offen sc1
  v_cvt_pk_bf16_f32 v184, v128, v129
  v_cvt_pk_bf16_f32 v185, v130, v131
  v_cvt_pk_bf16_f32 v186, v132, v133
  v_cvt_pk_bf16_f32 v187, v134, v135
  s_add_u32 s4, s31, 172032
  buffer_store_dwordx4 v[184:187], v2, s[24:27], s4 offen sc1
  v_cvt_pk_bf16_f32 v188, v136, v137
  v_cvt_pk_bf16_f32 v189, v138, v139
  v_cvt_pk_bf16_f32 v190, v140, v141
  v_cvt_pk_bf16_f32 v191, v142, v143
  s_add_u32 s4, s31, 192512
  buffer_store_dwordx4 v[188:191], v2, s[24:27], s4 offen sc1
  v_cvt_pk_bf16_f32 v160, v144, v145
  v_cvt_pk_bf16_f32 v161, v146, v147
  v_cvt_pk_bf16_f32 v162, v148, v149
  v_cvt_pk_bf16_f32 v163, v150, v151
  s_add_u32 s4, s31, 212992
  buffer_store_dwordx4 v[160:163], v2, s[24:27], s4 offen sc1
  v_cvt_pk_bf16_f32 v164, v152, v153
  v_cvt_pk_bf16_f32 v165, v154, v155
  v_cvt_pk_bf16_f32 v166, v156, v157
  v_cvt_pk_bf16_f32 v167, v158, v159
  s_add_u32 s4, s31, 233472
  buffer_store_dwordx4 v[164:167], v2, s[24:27], s4 offen sc1
  s_mov_b32 s4, 36864
  buffer_load_dwordx2 v[20:21], v10, s[16:19], s4 offen
  buffer_load_dwordx2 v[22:23], v10, s[16:19], s4 offen offset:16
  s_mov_b32 s4, 36960
  buffer_load_dwordx2 v[24:25], v10, s[16:19], s4 offen
  buffer_load_dwordx2 v[26:27], v10, s[16:19], s4 offen offset:16
  s_waitcnt vmcnt(0)
  s_lshl_b32 s4, s30, 5
  s_add_u32 s4, s4, s3
  s_lshl_b32 s29, s4, 2
  s_add_u32 s29, s29, 5120
  v_mov_b32 v12, s88
  v_mov_b32 v13, 32
  s_mov_b64 exec, 1
  buffer_store_dword v12, v13, s[8:11], s29 offen sc1
  s_mov_b64 exec, -1
  v_min_u32 v19, 4, v1
  v_lshlrev_b32 v19, 4, v19
  buffer_load_dword v18, v19, s[8:11], s29 offen sc1
  s_mov_b32 s33, 0xffff0000
  v_lshlrev_b32 v56, 16, v20
  v_and_b32 v57, s33, v20
  v_lshlrev_b32 v58, 16, v21
  v_and_b32 v59, s33, v21
  v_lshlrev_b32 v60, 16, v22
  v_and_b32 v61, s33, v22
  v_lshlrev_b32 v62, 16, v23
  v_and_b32 v63, s33, v23
  v_add_f32 v80, v56, v80
  v_add_f32 v81, v57, v81
  v_add_f32 v82, v58, v82
  v_add_f32 v83, v59, v83
  v_add_f32 v84, v60, v84
  v_add_f32 v85, v61, v85
  v_add_f32 v86, v62, v86
  v_add_f32 v87, v63, v87
  v_lshlrev_b32 v56, 16, v24
  v_and_b32 v57, s33, v24
  v_lshlrev_b32 v58, 16, v25
  v_and_b32 v59, s33, v25
  v_lshlrev_b32 v60, 16, v26
  v_and_b32 v61, s33, v26
  v_lshlrev_b32 v62, 16, v27
  v_and_b32 v63, s33, v27
  v_add_f32 v120, v56, v120
  v_add_f32 v121, v57, v121
  v_add_f32 v122, v58, v122
  v_add_f32 v123, v59, v123
  v_add_f32 v124, v60, v124
  v_add_f32 v125, v61, v125
  v_add_f32 v126, v62, v126
  v_add_f32 v127, v63, v127
  s_waitcnt vmcnt(0)
  s_mov_b32 s6, 0x1b
  s_mov_b32 s7, 0
  s_mov_b32 s5, 100000
LFL8:
  v_cmp_ne_u32 vcc, s88, v18
  s_nop 1
  s_and_b64 vcc, vcc, s[6:7]
  s_cbranch_vccz LFL8_ok
  s_sub_u32 s5, s5, 1
  s_cmp_eq_u32 s5, 0
  s_cbranch_scc1 LFL8_ok
  s_sleep 1
  buffer_load_dword v18, v19, s[8:11], s29 offen sc1
  s_waitcnt vmcnt(0)
  s_branch LFL8
LFL8_ok:
  s_add_u32 s4, s31, 40960
  buffer_load_dwordx4 v[160:163], v2, s[24:27], s4 offen sc1
  s_add_u32 s4, s31, 45056
  buffer_load_dwordx4 v[164:167], v2, s[24:27], s4 offen sc1
  s_add_u32 s4, s31, 53248
  buffer_load_dwordx4 v[168:171], v2, s[24:27], s4 offen sc1
  s_add_u32 s4, s31, 57344
  buffer_load_dwordx4 v[172:175], v2, s[24:27], s4 offen sc1
  s_add_u32 s4, s31, 143360
  buffer_load_dwordx4 v[176:179], v2, s[24:27], s4 offen sc1
  s_add_u32 s4, s31, 147456
  buffer_load_dwordx4 v[180:183], v2, s[24:27], s4 offen sc1
  s_add_u32 s4, s31, 155648
  buffer_load_dwordx4 v[184:187], v2, s[24:27], s4 offen sc1
  s_add_u32 s4, s31, 159744
  buffer_load_dwordx4 v[188:191], v2, s[24:27], s4 offen sc1
  s_mov_b32 s5, 0xffff0000
  s_waitcnt vmcnt(4)
  v_lshlrev_b32 v56, 16, v160
  v_and_b32 v57, s5, v160
  v_lshlrev_b32 v58, 16, v161
  v_and_b32 v59, s5, v161
  v_lshlrev_b32 v60, 16, v162
  v_and_b32 v61, s5, v162
  v_lshlrev_b32 v62, 16, v163
  v_and_b32 v63, s5, v163
  v_add_f32 v80, v80, v56
  v_add_f32 v81, v81, v57
  v_add_f32 v82, v82, v58
  v_add_f32 v83, v83, v59
  v_add_f32 v84, v84, v60
  v_add_f32 v85, v85, v61
  v_add_f32 v86, v86, v62
  v_add_f32 v87, v87, v63
  v_lshlrev_b32 v56, 16, v164
  v_and_b32 v57, s5, v164
  v_lshlrev_b32 v58, 16, v165
  v_and_b32 v59, s5, v165
  v_lshlrev_b32 v60, 16, v166
  v_and_b32 v61, s5, v166
  v_lshlrev_b32 v62, 16, v167
  v_and_b32 v63, s5, v167
  v_add_f32 v80, v80, v56
  v_add_f32 v81, v81, v57
  v_add_f32 v82, v82, v58
  v_add_f32 v83, v83, v59
  v_add_f32 v84, v84, v60
  v_add_f32 v85, v85, v61
  v_add_f32 v86, v86, v62
  v_add_f32 v87, v87, v63
  v_lshlrev_b32 v56, 16, v168
  v_and_b32 v57, s5, v168
  v_lshlrev_b32 v58, 16, v169
  v_and_b32 v59, s5, v169
  v_lshlrev_b32 v60, 16, v170
  v_and_b32 v61, s5, v170
  v_lshlrev_b32 v62, 16, v171
  v_and_b32 v63, s5, v171
  v_add_f32 v80, v80, v56
  v_add_f32 v81, v81, v57
  v_add_f32 v82, v82, v58
  v_add_f32 v83, v83, v59
  v_add_f32 v84, v84, v60
  v_add_f32 v85, v85, v61
  v_add_f32 v86, v86, v62
  v_add_f32 v87, v87, v63
  v_lshlrev_b32 v56, 16, v172
  v_and_b32 v57, s5, v172
  v_lshlrev_b32 v58, 16, v173
  v_and_b32 v59, s5, v173
  v_lshlrev_b32 v60, 16, v174
  v_and_b32 v61, s5, v174
  v_lshlrev_b32 v62, 16, v175
  v_and_b32 v63, s5, v175
  v_add_f32 v80, v80, v56
  v_add_f32 v81, v81, v57
  v_add_f32 v82, v82, v58
  v_add_f32 v83, v83, v59
  v_add_f32 v84, v84, v60
  v_add_f32 v85, v85, v61
  v_add_f32 v86, v86, v62
  v_add_f32 v87, v87, v63
  v_cvt_pk_bf16_f32 v40, v80, v81
  v_cvt_pk_bf16_f32 v41, v82, v83
  v_cvt_pk_bf16_f32 v42, v84, v85
  v_cvt_pk_bf16_f32 v43, v86, v87
  s_nop 1
  v_permlane32_swap_b32 v40, v42
  v_permlane32_swap_b32 v41, v43
  s_mov_b32 s4, 36864
  buffer_store_dwordx4 v[40:43], v11, s[20:23], s4 offen
  s_waitcnt vmcnt(1)
  v_lshlrev_b32 v56, 16, v176
  v_and_b32 v57, s5, v176
  v_lshlrev_b32 v58, 16, v177
  v_and_b32 v59, s5, v177
  v_lshlrev_b32 v60, 16, v178
  v_and_b32 v61, s5, v178
  v_lshlrev_b32 v62, 16, v179
  v_and_b32 v63, s5, v179
  v_add_f32 v120, v120, v56
  v_add_f32 v121, v121, v57
  v_add_f32 v122, v122, v58
  v_add_f32 v123, v123, v59
  v_add_f32 v124, v124, v60
  v_add_f32 v125, v125, v61
  v_add_f32 v126, v126, v62
  v_add_f32 v127, v127, v63
  v_lshlrev_b32 v56, 16, v180
  v_and_b32 v57, s5, v180
  v_lshlrev_b32 v58, 16, v181
  v_and_b32 v59, s5, v181
  v_lshlrev_b32 v60, 16, v182
  v_and_b32 v61, s5, v182
  v_lshlrev_b32 v62, 16, v183
  v_and_b32 v63, s5, v183
  v_add_f32 v120, v120, v56
  v_add_f32 v121, v121, v57
  v_add_f32 v122, v122, v58
  v_add_f32 v123, v123, v59
  v_add_f32 v124, v124, v60
  v_add_f32 v125, v125, v61
  v_add_f32 v126, v126, v62
  v_add_f32 v127, v127, v63
  v_lshlrev_b32 v56, 16, v184
  v_and_b32 v57, s5, v184
  v_lshlrev_b32 v58, 16, v185
  v_and_b32 v59, s5, v185
  v_lshlrev_b32 v60, 16, v186
  v_and_b32 v61, s5, v186
  v_lshlrev_b32 v62, 16, v187
  v_and_b32 v63, s5, v187
  v_add_f32 v120, v120, v56
  v_add_f32 v121, v121, v57
  v_add_f32 v122, v122, v58
  v_add_f32 v123, v123, v59
  v_add_f32 v124, v124, v60
  v_add_f32 v125, v125, v61
  v_add_f32 v126, v126, v62
  v_add_f32 v127, v127, v63
  v_lshlrev_b32 v56, 16, v188
  v_and_b32 v57, s5, v188
  v_lshlrev_b32 v58, 16, v189
  v_and_b32 v59, s5, v189
  v_lshlrev_b32 v60, 16, v190
  v_and_b32 v61, s5, v190
  v_lshlrev_b32 v62, 16, v191
  v_and_b32 v63, s5, v191
  v_add_f32 v120, v120, v56
  v_add_f32 v121, v121, v57
  v_add_f32 v122, v122, v58
  v_add_f32 v123, v123, v59
  v_add_f32 v124, v124, v60
  v_add_f32 v125, v125, v61
  v_add_f32 v126, v126, v62
  v_add_f32 v127, v127, v63
  v_cvt_pk_bf16_f32 v44, v120, v121
  v_cvt_pk_bf16_f32 v45, v122, v123
  v_cvt_pk_bf16_f32 v46, v124, v125
  v_cvt_pk_bf16_f32 v47, v126, v127
  s_nop 1
  v_permlane32_swap_b32 v44, v46
  v_permlane32_swap_b32 v45, v47
  s_mov_b32 s4, 36960
  buffer_store_dwordx4 v[44:47], v11, s[20:23], s4 offen
  s_branch L_end
LX_n2:
  s_cmp_lg_u32 s40, 3
  s_cbranch_scc1 LX_n3
  v_cvt_pk_bf16_f32 v160, v64, v65
  v_cvt_pk_bf16_f32 v161, v66, v67
  v_cvt_pk_bf16_f32 v162, v68, v69
  v_cvt_pk_bf16_f32 v163, v70, v71
  s_add_u32 s4, s31, 12288
  buffer_store_dwordx4 v[160:163], v2, s[24:27], s4 offen sc1
  v_cvt_pk_bf16_f32 v164, v72, v73
  v_cvt_pk_bf16_f32 v165, v74, v75
  v_cvt_pk_bf16_f32 v166, v76, v77
  v_cvt_pk_bf16_f32 v167, v78, v79
  s_add_u32 s4, s31, 32768
  buffer_store_dwordx4 v[164:167], v2, s[24:27], s4 offen sc1
  v_cvt_pk_bf16_f32 v168, v80, v81
  v_cvt_pk_bf16_f32 v169, v82, v83
  v_cvt_pk_bf16_f32 v170, v84, v85
  v_cvt_pk_bf16_f32 v171, v86, v87
  s_add_u32 s4, s31, 53248
  buffer_store_dwordx4 v[168:171], v2, s[24:27], s4 offen sc1
  v_cvt_pk_bf16_f32 v172, v96, v97
  v_cvt_pk_bf16_f32 v173, v98, v99
  v_cvt_pk_bf16_f32 v174, v100, v101
  v_cvt_pk_bf16_f32 v175, v102, v103
  s_add_u32 s4, s31, 94208
  buffer_store_dwordx4 v[172:175], v2, s[24:27], s4 offen sc1
  v_cvt_pk_bf16_f32 v176, v104, v105
  v_cvt_pk_bf16_f32 v177, v106, v107
  v_cvt_pk_bf16_f32 v178, v108, v109
  v_cvt_pk_bf16_f32 v179, v110, v111
  s_add_u32 s4, s31, 114688
  buffer_store_dwordx4 v[176:179], v2, s[24:27], s4 offen sc1
  v_cvt_pk_bf16_f32 v180, v112, v113
  v_cvt_pk_bf16_f32 v181, v114, v115
  v_cvt_pk_bf16_f32 v182, v116, v117
  v_cvt_pk_bf16_f32 v183, v118, v119
  s_add_u32 s4, s31, 135168
  buffer_store_dwordx4 v[180:183], v2, s[24:27], s4 offen sc1
  v_cvt_pk_bf16_f32 v184, v120, v121
  v_cvt_pk_bf16_f32 v185, v122, v123
  v_cvt_pk_bf16_f32 v186, v124, v125
  v_cvt_pk_bf16_f32 v187, v126, v127
  s_add_u32 s4, s31, 155648
  buffer_store_dwordx4 v[184:187], v2, s[24:27], s4 offen sc1
  v_cvt_pk_bf16_f32 v188, v136, v137
  v_cvt_pk_bf16_f32 v189, v138, v139
  v_cvt_pk_bf16_f32 v190, v140, v141
  v_cvt_pk_bf16_f32 v191, v142, v143
  s_add_u32 s4, s31, 196608
  buffer_store_dwordx4 v[188:191], v2, s[24:27], s4 offen sc1
  v_cvt_pk_bf16_f32 v160, v144, v145
  v_cvt_pk_bf16_f32 v161, v146, v147
  v_cvt_pk_bf16_f32 v162, v148, v149
  v_cvt_pk_bf16_f32 v163, v150, v151
  s_add_u32 s4, s31, 217088
  buffer_store_dwordx4 v[160:163], v2, s[24:27], s4 offen sc1
  v_cvt_pk_bf16_f32 v164, v152, v153
  v_cvt_pk_bf16_f32 v165, v154, v155
  v_cvt_pk_bf16_f32 v166, v156, v157
  v_cvt_pk_bf16_f32 v167, v158, v159
  s_add_u32 s4, s31, 237568
  buffer_store_dwordx4 v[164:167], v2, s[24:27], s4 offen sc1
  s_mov_b32 s4, 36896
  buffer_load_dwordx2 v[20:21], v10, s[16:19], s4 offen
  buffer_load_dwordx2 v[22:23], v10, s[16:19], s4 offen offset:16
  s_mov_b32 s4, 128
  buffer_load_dwordx2 v[24:25], v10, s[16:19], s4 offen
  buffer_load_dwordx2 v[26:27], v10, s[16:19], s4 offen offset:16
  s_waitcnt vmcnt(0)
  s_lshl_b32 s4, s30, 5
  s_add_u32 s4, s4, s3
  s_lshl_b32 s29, s4, 2
  s_add_u32 s29, s29, 5120
  v_mov_b32 v12, s88
  v_mov_b32 v13, 48
  s_mov_b64 exec, 1
  buffer_store_dword v12, v13, s[8:11], s29 offen sc1
  s_mov_b64 exec, -1
  v_min_u32 v19, 4, v1
  v_lshlrev_b32 v19, 4, v19
  buffer_load_dword v18, v19, s[8:11], s29 offen sc1
  s_mov_b32 s33, 0xffff0000
  v_lshlrev_b32 v56, 16, v20
  v_and_b32 v57, s33, v20
  v_lshlrev_b32 v58, 16, v21
  v_and_b32 v59, s33, v21
  v_lshlrev_b32 v60, 16, v22
  v_and_b32 v61, s33, v22
  v_lshlrev_b32 v62, 16, v23
  v_and_b32 v63, s33, v23
  v_add_f32 v88, v56, v88
  v_add_f32 v89, v57, v89
  v_add_f32 v90, v58, v90
  v_add_f32 v91, v59, v91
  v_add_f32 v92, v60, v92
  v_add_f32 v93, v61, v93
  v_add_f32 v94, v62, v94
  v_add_f32 v95, v63, v95
  v_lshlrev_b32 v56, 16, v24
  v_and_b32 v57, s33, v24
  v_lshlrev_b32 v58, 16, v25
  v_and_b32 v59, s33, v25
  v_lshlrev_b32 v60, 16, v26
  v_and_b32 v61, s33, v26
  v_lshlrev_b32 v62, 16, v27
  v_and_b32 v63, s33, v27
  v_add_f32 v128, v56, v128
  v_add_f32 v129, v57, v129
  v_add_f32 v130, v58, v130
  v_add_f32 v131, v59, v131
  v_add_f32 v132, v60, v132
  v_add_f32 v133, v61, v133
  v_add_f32 v134, v62, v134
  v_add_f32 v135, v63, v135
  s_waitcnt vmcnt(0)
  s_mov_b32 s6, 0x17
  s_mov_b32 s7, 0
  s_mov_b32 s5, 100000
LFL9:
  v_cmp_ne_u32 vcc, s88, v18
  s_nop 1
  s_and_b64 vcc, vcc, s[6:7]
  s_cbranch_vccz LFL9_ok
  s_sub_u32 s5, s5, 1
  s_cmp_eq_u32 s5, 0
  s_cbranch_scc1 LFL9_ok
  s_sleep 1
  buffer_load_dword v18, v19, s[8:11], s29 offen sc1
  s_waitcnt vmcnt(0)
  s_branch LFL9
LFL9_ok:
  s_add_u32 s4, s31, 61440
  buffer_load_dwordx4 v[160:163], v2, s[24:27], s4 offen sc1
  s_add_u32 s4, s31, 65536
  buffer_load_dwordx4 v[164:167], v2, s[24:27], s4 offen sc1
  s_add_u32 s4, s31, 69632
  buffer_load_dwordx4 v[168:171], v2, s[24:27], s4 offen sc1
  s_add_u32 s4, s31, 77824
  buffer_load_dwordx4 v[172:175], v2, s[24:27], s4 offen sc1
  s_add_u32 s4, s31, 163840
  buffer_load_dwordx4 v[176:179], v2, s[24:27], s4 offen sc1
  s_add_u32 s4, s31, 167936
  buffer_load_dwordx4 v[180:183], v2, s[24:27], s4 offen sc1
  s_add_u32 s4, s31, 172032
  buffer_load_dwordx4 v[184:187], v2, s[24:27], s4 offen sc1
  s_add_u32 s4, s31, 180224
  buffer_load_dwordx4 v[188:191], v2, s[24:27], s4 offen sc1
  s_mov_b32 s5, 0xffff0000
  s_waitcnt vmcnt(4)
  v_lshlrev_b32 v56, 16, v160
  v_and_b32 v57, s5, v160
  v_lshlrev_b32 v58, 16, v161
  v_and_b32 v59, s5, v161
  v_lshlrev_b32 v60, 16, v162
  v_and_b32 v61, s5, v162
  v_lshlrev_b32 v62, 16, v163
  v_and_b32 v63, s5, v163
  v_add_f32 v88, v88, v56
  v_add_f32 v89, v89, v57
  v_add_f32 v90, v90, v58
  v_add_f32 v91, v91, v59
  v_add_f32 v92, v92, v60
  v_add_f32 v93, v93, v61
  v_add_f32 v94, v94, v62
  v_add_f32 v95, v95, v63
  v_lshlrev_b32 v56, 16, v164
  v_and_b32 v57, s5, v164
  v_lshlrev_b32 v58, 16, v165
  v_and_b32 v59, s5, v165
  v_lshlrev_b32 v60, 16, v166
  v_and_b32 v61, s5, v166
  v_lshlrev_b32 v62, 16, v167
  v_and_b32 v63, s5, v167
  v_add_f32 v88, v88, v56
  v_add_f32 v89, v89, v57
  v_add_f32 v90, v90, v58
  v_add_f32 v91, v91, v59
  v_add_f32 v92, v92, v60
  v_add_f32 v93, v93, v61
  v_add_f32 v94, v94, v62
  v_add_f32 v95, v95, v63
  v_lshlrev_b32 v56, 16, v168
  v_and_b32 v57, s5, v168
  v_lshlrev_b32 v58, 16, v169
  v_and_b32 v59, s5, v169
  v_lshlrev_b32 v60, 16, v170
  v_and_b32 v61, s5, v170
  v_lshlrev_b32 v62, 16, v171
  v_and_b32 v63, s5, v171
  v_add_f32 v88, v88, v56
  v_add_f32 v89, v89, v57
  v_add_f32 v90, v90, v58
  v_add_f32 v91, v91, v59
  v_add_f32 v92, v92, v60
  v_add_f32 v93, v93, v61
  v_add_f32 v94, v94, v62
  v_add_f32 v95, v95, v63
  v_lshlrev_b32 v56, 16, v172
  v_and_b32 v57, s5, v172
  v_lshlrev_b32 v58, 16, v173
  v_and_b32 v59, s5, v173
  v_lshlrev_b32 v60, 16, v174
  v_and_b32 v61, s5, v174
  v_lshlrev_b32 v62, 16, v175
  v_and_b32 v63, s5, v175
  v_add_f32 v88, v88, v56
  v_add_f32 v89, v89, v57
  v_add_f32 v90, v90, v58
  v_add_f32 v91, v91, v59
  v_add_f32 v92, v92, v60
  v_add_f32 v93, v93, v61
  v_add_f32 v94, v94, v62
  v_add_f32 v95, v95, v63
  v_cvt_pk_bf16_f32 v40, v88, v89
  v_cvt_pk_bf16_f32 v41, v90, v91
  v_cvt_pk_bf16_f32 v42, v92, v93
  v_cvt_pk_bf16_f32 v43, v94, v95
  s_nop 1
  v_permlane32_swap_b32 v40, v42
  v_permlane32_swap_b32 v41, v43
  s_mov_b32 s4, 36896
  buffer_store_dwordx4 v[40:43], v11, s[20:23], s4 offen
  s_waitcnt vmcnt(1)
  v_lshlrev_b32 v56, 16, v176
  v_and_b32 v57, s5, v176
  v_lshlrev_b32 v58, 16, v177
  v_and_b32 v59, s5, v177
  v_lshlrev_b32 v60, 16, v178
  v_and_b32 v61, s5, v178
  v_lshlrev_b32 v62, 16, v179
  v_and_b32 v63, s5, v179
  v_add_f32 v128, v128, v56
  v_add_f32 v129, v129, v57
  v_add_f32 v130, v130, v58
  v_add_f32 v131, v131, v59
  v_add_f32 v132, v132, v60
  v_add_f32 v133, v133, v61
  v_add_f32 v134, v134, v62
  v_add_f32 v135, v135, v63
  v_lshlrev_b32 v56, 16, v180
  v_and_b32 v57, s5, v180
  v_lshlrev_b32 v58, 16, v181
  v_and_b32 v59, s5, v181
  v_lshlrev_b32 v60, 16, v182
  v_and_b32 v61, s5, v182
  v_lshlrev_b32 v62, 16, v183
  v_and_b32 v63, s5, v183
  v_add_f32 v128, v128, v56
  v_add_f32 v129, v129, v57
  v_add_f32 v130, v130, v58
  v_add_f32 v131, v131, v59
  v_add_f32 v132, v132, v60
  v_add_f32 v133, v133, v61
  v_add_f32 v134, v134, v62
  v_add_f32 v135, v135, v63
  v_lshlrev_b32 v56, 16, v184
  v_and_b32 v57, s5, v184
  v_lshlrev_b32 v58, 16, v185
  v_and_b32 v59, s5, v185
  v_lshlrev_b32 v60, 16, v186
  v_and_b32 v61, s5, v186
  v_lshlrev_b32 v62, 16, v187
  v_and_b32 v63, s5, v187
  v_add_f32 v128, v128, v56
  v_add_f32 v129, v129, v57
  v_add_f32 v130, v130, v58
  v_add_f32 v131, v131, v59
  v_add_f32 v132, v132, v60
  v_add_f32 v133, v133, v61
  v_add_f32 v134, v134, v62
  v_add_f32 v135, v135, v63
  v_lshlrev_b32 v56, 16, v188
  v_and_b32 v57, s5, v188
  v_lshlrev_b32 v58, 16, v189
  v_and_b32 v59, s5, v189
  v_lshlrev_b32 v60, 16, v190
  v_and_b32 v61, s5, v190
  v_lshlrev_b32 v62, 16, v191
  v_and_b32 v63, s5, v191
  v_add_f32 v128, v128, v56
  v_add_f32 v129, v129, v57
  v_add_f32 v130, v130, v58
  v_add_f32 v131, v131, v59
  v_add_f32 v132, v132, v60
  v_add_f32 v133, v133, v61
  v_add_f32 v134, v134, v62
  v_add_f32 v135, v135, v63
  v_cvt_pk_bf16_f32 v44, v128, v129
  v_cvt_pk_bf16_f32 v45, v130, v131
  v_cvt_pk_bf16_f32 v46, v132, v133
  v_cvt_pk_bf16_f32 v47, v134, v135
  s_nop 1
  v_permlane32_swap_b32 v44, v46
  v_permlane32_swap_b32 v45, v47
  s_mov_b32 s4, 128
  buffer_store_dwordx4 v[44:47], v11, s[20:23], s4 offen
  s_branch L_end
LX_n3:
  v_cvt_pk_bf16_f32 v160, v64, v65
  v_cvt_pk_bf16_f32 v161, v66, v67
  v_cvt_pk_bf16_f32 v162, v68, v69
  v_cvt_pk_bf16_f32 v163, v70, v71
  s_add_u32 s4, s31, 16384
  buffer_store_dwordx4 v[160:163], v2, s[24:27], s4 offen sc1
  v_cvt_pk_bf16_f32 v164, v72, v73
  v_cvt_pk_bf16_f32 v165, v74, v75
  v_cvt_pk_bf16_f32 v166, v76, v77
  v_cvt_pk_bf16_f32 v167, v78, v79
  s_add_u32 s4, s31, 36864
  buffer_store_dwordx4 v[164:167], v2, s[24:27], s4 offen sc1
  v_cvt_pk_bf16_f32 v168, v80, v81
  v_cvt_pk_bf16_f32 v169, v82, v83
  v_cvt_pk_bf16_f32 v170, v84, v85
  v_cvt_pk_bf16_f32 v171, v86, v87
  s_add_u32 s4, s31, 57344
  buffer_store_dwordx4 v[168:171], v2, s[24:27], s4 offen sc1
  v_cvt_pk_bf16_f32 v172, v88, v89
  v_cvt_pk_bf16_f32 v173, v90, v91
  v_cvt_pk_bf16_f32 v174, v92, v93
  v_cvt_pk_bf16_f32 v175, v94, v95
  s_add_u32 s4, s31, 77824
  buffer_store_dwordx4 v[172:175], v2, s[24:27], s4 offen sc1
  v_cvt_pk_bf16_f32 v176, v104, v105
  v_cvt_pk_bf16_f32 v177, v106, v107
  v_cvt_pk_bf16_f32 v178, v108, v109
  v_cvt_pk_bf16_f32 v179, v110, v111
  s_add_u32 s4, s31, 118784
  buffer_store_dwordx4 v[176:179], v2, s[24:27], s4 offen sc1
  v_cvt_pk_bf16_f32 v180, v112, v113
  v_cvt_pk_bf16_f32 v181, v114, v115
  v_cvt_pk_bf16_f32 v182, v116, v117
  v_cvt_pk_bf16_f32 v183, v118, v119
  s_add_u32 s4, s31, 139264
  buffer_store_dwordx4 v[180:183], v2, s[24:27], s4 offen sc1
  v_cvt_pk_bf16_f32 v184, v120, v121
  v_cvt_pk_bf16_f32 v185, v122, v123
  v_cvt_pk_bf16_f32 v186, v124, v125
  v_cvt_pk_bf16_f32 v187, v126, v127
  s_add_u32 s4, s31, 159744
  buffer_store_dwordx4 v[184:187], v2, s[24:27], s4 offen sc1
  v_cvt_pk_bf16_f32 v188, v128, v129
  v_cvt_pk_bf16_f32 v189, v130, v131
  v_cvt_pk_bf16_f32 v190, v132, v133
  v_cvt_pk_bf16_f32 v191, v134, v135
  s_add_u32 s4, s31, 180224
  buffer_store_dwordx4 v[188:191], v2, s[24:27], s4 offen sc1
  v_cvt_pk_bf16_f32 v160, v144, v145
  v_cvt_pk_bf16_f32 v161, v146, v147
  v_cvt_pk_bf16_f32 v162, v148, v149
  v_cvt_pk_bf16_f32 v163, v150, v151
  s_add_u32 s4, s31, 221184
  buffer_store_dwordx4 v[160:163], v2, s[24:27], s4 offen sc1
  v_cvt_pk_bf16_f32 v164, v152, v153
  v_cvt_pk_bf16_f32 v165, v154, v155
  v_cvt_pk_bf16_f32 v166, v156, v157
  v_cvt_pk_bf16_f32 v167, v158, v159
  s_add_u32 s4, s31, 241664
  buffer_store_dwordx4 v[164:167], v2, s[24:27], s4 offen sc1
  s_mov_b32 s4, 64
  buffer_load_dwordx2 v[20:21], v10, s[16:19], s4 offen
  buffer_load_dwordx2 v[22:23], v10, s[16:19], s4 offen offset:16
  s_mov_b32 s4, 160
  buffer_load_dwordx2 v[24:25], v10, s[16:19], s4 offen
  buffer_load_dwordx2 v[26:27], v10, s[16:19], s4 offen offset:16
  s_waitcnt vmcnt(0)
  s_lshl_b32 s4, s30, 5
  s_add_u32 s4, s4, s3
  s_lshl_b32 s29, s4, 2
  s_add_u32 s29, s29, 5120
  v_mov_b32 v12, s88
  v_mov_b32 v13, 64
  s_mov_b64 exec, 1
  buffer_store_dword v12, v13, s[8:11], s29 offen sc1
  s_mov_b64 exec, -1
  v_min_u32 v19, 4, v1
  v_lshlrev_b32 v19, 4, v19
  buffer_load_dword v18, v19, s[8:11], s29 offen sc1
  s_mov_b32 s33, 0xffff0000
  v_lshlrev_b32 v56, 16, v20
  v_and_b32 v57, s33, v20
  v_lshlrev_b32 v58, 16, v21
  v_and_b32 v59, s33, v21
  v_lshlrev_b32 v60, 16, v22
  v_and_b32 v61, s33, v22
  v_lshlrev_b32 v62, 16, v23
  v_and_b32 v63, s33, v23
  v_add_f32 v96, v56, v96
  v_add_f32 v97, v57, v97
  v_add_f32 v98, v58, v98
  v_add_f32 v99, v59, v99
  v_add_f32 v100, v60, v100
  v_add_f32 v101, v61, v101
  v_add_f32 v102, v62, v102
  v_add_f32 v103, v63, v103
  v_lshlrev_b32 v56, 16, v24
  v_and_b32 v57, s33, v24
  v_lshlrev_b32 v58, 16, v25
  v_and_b32 v59, s33, v25
  v_lshlrev_b32 v60, 16, v26
  v_and_b32 v61, s33, v26
  v_lshlrev_b32 v62, 16, v27
  v_and_b32 v63, s33, v27
  v_add_f32 v136, v56, v136
  v_add_f32 v137, v57, v137
  v_add_f32 v138, v58, v138
  v_add_f32 v139, v59, v139
  v_add_f32 v140, v60, v140
  v_add_f32 v141, v61, v141
  v_add_f32 v142, v62, v142
  v_add_f32 v143, v63, v143
  s_waitcnt vmcnt(0)
  s_mov_b32 s6, 0xf
  s_mov_b32 s7, 0
  s_mov_b32 s5, 100000
LFL10:
  v_cmp_ne_u32 vcc, s88, v18
  s_nop 1
  s_and_b64 vcc, vcc, s[6:7]
  s_cbranch_vccz LFL10_ok
  s_sub_u32 s5, s5, 1
  s_cmp_eq_u32 s5, 0
  s_cbranch_scc1 LFL10_ok
  s_sleep 1
  buffer_load_dword v18, v19, s[8:11], s29 offen sc1
  s_waitcnt vmcnt(0)
  s_branch LFL10
LFL10_ok:
  s_add_u32 s4, s31, 81920
  buffer_load_dwordx4 v[160:163], v2, s[24:27], s4 offen sc1
  s_add_u32 s4, s31, 86016
  buffer_load_dwordx4 v[164:167], v2, s[24:27], s4 offen sc1
  s_add_u32 s4, s31, 90112
  buffer_load_dwordx4 v[168:171], v2, s[24:27], s4 offen sc1
  s_add_u32 s4, s31, 94208
  buffer_load_dwordx4 v[172:175], v2, s[24:27], s4 offen sc1
  s_add_u32 s4, s31, 184320
  buffer_load_dwordx4 v[176:179], v2, s[24:27], s4 offen sc1
  s_add_u32 s4, s31, 188416
  buffer_load_dwordx4 v[180:183], v2, s[24:27], s4 offen sc1
  s_add_u32 s4, s31, 192512
  buffer_load_dwordx4 v[184:187], v2, s[24:27], s4 offen sc1
  s_add_u32 s4, s31, 196608
  buffer_load_dwordx4 v[188:191], v2, s[24:27], s4 offen sc1
  s_mov_b32 s5, 0xffff0000
  s_waitcnt vmcnt(4)
  v_lshlrev_b32 v56, 16, v160
  v_and_b32 v57, s5, v160
  v_lshlrev_b32 v58, 16, v161
  v_and_b32 v59, s5, v161
  v_lshlrev_b32 v60, 16, v162
  v_and_b32 v61, s5, v162
  v_lshlrev_b32 v62, 16, v163
  v_and_b32 v63, s5, v163
  v_add_f32 v96, v96, v56
  v_add_f32 v97, v97, v57
  v_add_f32 v98, v98, v58
  v_add_f32 v99, v99, v59
  v_add_f32 v100, v100, v60
  v_add_f32 v101, v101, v61
  v_add_f32 v102, v102, v62
  v_add_f32 v103, v103, v63
  v_lshlrev_b32 v56, 16, v164
  v_and_b32 v57, s5, v164
  v_lshlrev_b32 v58, 16, v165
  v_and_b32 v59, s5, v165
  v_lshlrev_b32 v60, 16, v166
  v_and_b32 v61, s5, v166
  v_lshlrev_b32 v62, 16, v167
  v_and_b32 v63, s5, v167
  v_add_f32 v96, v96, v56
  v_add_f32 v97, v97, v57
  v_add_f32 v98, v98, v58
  v_add_f32 v99, v99, v59
  v_add_f32 v100, v100, v60
  v_add_f32 v101, v101, v61
  v_add_f32 v102, v102, v62
  v_add_f32 v103, v103, v63
  v_lshlrev_b32 v56, 16, v168
  v_and_b32 v57, s5, v168
  v_lshlrev_b32 v58, 16, v169
  v_and_b32 v59, s5, v169
  v_lshlrev_b32 v60, 16, v170
  v_and_b32 v61, s5, v170
  v_lshlrev_b32 v62, 16, v171
  v_and_b32 v63, s5, v171
  v_add_f32 v96, v96, v56
  v_add_f32 v97, v97, v57
  v_add_f32 v98, v98, v58
  v_add_f32 v99, v99, v59
  v_add_f32 v100, v100, v60
  v_add_f32 v101, v101, v61
  v_add_f32 v102, v102, v62
  v_add_f32 v103, v103, v63
  v_lshlrev_b32 v56, 16, v172
  v_and_b32 v57, s5, v172
  v_lshlrev_b32 v58, 16, v173
  v_and_b32 v59, s5, v173
  v_lshlrev_b32 v60, 16, v174
  v_and_b32 v61, s5, v174
  v_lshlrev_b32 v62, 16, v175
  v_and_b32 v63, s5, v175
  v_add_f32 v96, v96, v56
  v_add_f32 v97, v97, v57
  v_add_f32 v98, v98, v58
  v_add_f32 v99, v99, v59
  v_add_f32 v100, v100, v60
  v_add_f32 v101, v101, v61
  v_add_f32 v102, v102, v62
  v_add_f32 v103, v103, v63
  v_cvt_pk_bf16_f32 v40, v96, v97
  v_cvt_pk_bf16_f32 v41, v98, v99
  v_cvt_pk_bf16_f32 v42, v100, v101
  v_cvt_pk_bf16_f32 v43, v102, v103
  s_nop 1
  v_permlane32_swap_b32 v40, v42
  v_permlane32_swap_b32 v41, v43
  s_mov_b32 s4, 64
  buffer_store_dwordx4 v[40:43], v11, s[20:23], s4 offen
  s_waitcnt vmcnt(1)
  v_lshlrev_b32 v56, 16, v176
  v_and_b32 v57, s5, v176
  v_lshlrev_b32 v58, 16, v177
  v_and_b32 v59, s5, v177
  v_lshlrev_b32 v60, 16, v178
  v_and_b32 v61, s5, v178
  v_lshlrev_b32 v62, 16, v179
  v_and_b32 v63, s5, v179
  v_add_f32 v136, v136, v56
  v_add_f32 v137, v137, v57
  v_add_f32 v138, v138, v58
  v_add_f32 v139, v139, v59
  v_add_f32 v140, v140, v60
  v_add_f32 v141, v141, v61
  v_add_f32 v142, v142, v62
  v_add_f32 v143, v143, v63
  v_lshlrev_b32 v56, 16, v180
  v_and_b32 v57, s5, v180
  v_lshlrev_b32 v58, 16, v181
  v_and_b32 v59, s5, v181
  v_lshlrev_b32 v60, 16, v182
  v_and_b32 v61, s5, v182
  v_lshlrev_b32 v62, 16, v183
  v_and_b32 v63, s5, v183
  v_add_f32 v136, v136, v56
  v_add_f32 v137, v137, v57
  v_add_f32 v138, v138, v58
  v_add_f32 v139, v139, v59
  v_add_f32 v140, v140, v60
  v_add_f32 v141, v141, v61
  v_add_f32 v142, v142, v62
  v_add_f32 v143, v143, v63
  v_lshlrev_b32 v56, 16, v184
  v_and_b32 v57, s5, v184
  v_lshlrev_b32 v58, 16, v185
  v_and_b32 v59, s5, v185
  v_lshlrev_b32 v60, 16, v186
  v_and_b32 v61, s5, v186
  v_lshlrev_b32 v62, 16, v187
  v_and_b32 v63, s5, v187
  v_add_f32 v136, v136, v56
  v_add_f32 v137, v137, v57
  v_add_f32 v138, v138, v58
  v_add_f32 v139, v139, v59
  v_add_f32 v140, v140, v60
  v_add_f32 v141, v141, v61
  v_add_f32 v142, v142, v62
  v_add_f32 v143, v143, v63
  v_lshlrev_b32 v56, 16, v188
  v_and_b32 v57, s5, v188
  v_lshlrev_b32 v58, 16, v189
  v_and_b32 v59, s5, v189
  v_lshlrev_b32 v60, 16, v190
  v_and_b32 v61, s5, v190
  v_lshlrev_b32 v62, 16, v191
  v_and_b32 v63, s5, v191
  v_add_f32 v136, v136, v56
  v_add_f32 v137, v137, v57
  v_add_f32 v138, v138, v58
  v_add_f32 v139, v139, v59
  v_add_f32 v140, v140, v60
  v_add_f32 v141, v141, v61
  v_add_f32 v142, v142, v62
  v_add_f32 v143, v143, v63
  v_cvt_pk_bf16_f32 v44, v136, v137
  v_cvt_pk_bf16_f32 v45, v138, v139
  v_cvt_pk_bf16_f32 v46, v140, v141
  v_cvt_pk_bf16_f32 v47, v142, v143
  s_nop 1
  v_permlane32_swap_b32 v44, v46
  v_permlane32_swap_b32 v45, v47
  s_mov_b32 s4, 160
  buffer_store_dwordx4 v[44:47], v11, s[20:23], s4 offen
  s_branch L_end
L_end:
L_done:
  s_endpgm
L_codeend:
.section .rodata,"a"
.p2align 6
.amdhsa_kernel parallel_sum__compressed_kv_cla__glu_gated_geglu__prompt_kernel
  .amdhsa_next_free_vgpr 512
  .amdhsa_next_free_sgpr 102
  .amdhsa_accum_offset 256
  .amdhsa_group_segment_fixed_size 0
  .amdhsa_kernarg_size 104
  .amdhsa_user_sgpr_count 2
  .amdhsa_user_sgpr_kernarg_segment_ptr 1
  .amdhsa_system_sgpr_workgroup_id_x 1
  .amdhsa_float_denorm_mode_32 3
  .amdhsa_float_denorm_mode_16_64 3
.end_amdhsa_kernel
```
